```python
import torch

def _softmax(x, axis=-1):
    return torch.softmax(x, dim=axis)
def _gelu(x):
    return torch.nn.functional.gelu(x, approximate="tanh")
def _silu(x):
    return torch.nn.functional.silu(x)
def _sigmoid(x):
    return torch.sigmoid(x)
def _layernorm(x, axis=-1, eps=1e-5):
    m = x.mean(dim=axis, keepdim=True)
    v = x.var(dim=axis, keepdim=True, unbiased=False)
    return (x - m) / torch.sqrt(v + eps)
def _scatter_add(tgt, idx, src, axis=0):
    return tgt.clone().index_add_(axis, idx, src)
def _segment_sum(src, seg, n):
    out = torch.zeros((n,) + src.shape[1:], dtype=src.dtype)
    return out.index_add_(0, seg, src)
def _pad(x, pw):
    flat = tuple(v for pair in reversed(pw) for v in pair)
    return torch.nn.functional.pad(x, flat)

kernel_name = 'sequential_preLN__compressed_kv_cla__moe_arch_mod__prompt'

def setup_inputs():

    _w = (lambda a: (lambda t: t.to(torch.bfloat16) if t.is_floating_point() else t)(torch.as_tensor(a)))
    def _A_setup():
        B, H, Sq, Sk, D, M = 1, 32, 2048, 2048, 128, 640
        Dc = 4 * D
        return {
            "x": _w((lambda *s: torch.randn(*s, dtype=torch.bfloat16) * 0.05)(B, Sq, M)),
            "c_kv": _w((lambda *s: torch.randn(*s, dtype=torch.bfloat16) * 0.4)(B, Sk, Dc)),
            "w_q": _w((lambda *s: torch.randn(*s, dtype=torch.bfloat16) * 3.2)(M, H, D) * (M ** -0.5)),
            "w_uk": _w((lambda *s: torch.randn(*s, dtype=torch.bfloat16) * 3.2)(Dc, H, D) * (Dc ** -0.5)),
            "w_uv": _w((lambda *s: torch.randn(*s, dtype=torch.bfloat16) * 0.4)(Dc, H, D) * (Dc ** -0.5)),
            "w_o": _w((lambda *s: torch.randn(*s, dtype=torch.bfloat16) * 0.4)(H, D, M) * ((H * D) ** -0.5)),
        }
    _A_in = _A_setup()

    def _B_setup():
        B, S, D, F, C = 1, 2048, 640, 1728, 1
        return {
            "x": _w((lambda *s: torch.randn(*s, dtype=torch.bfloat16) * 0.05)(B, S, D)),
            "w_r": _w((lambda *s: torch.randn(*s, dtype=torch.bfloat16) * 0.05)(D)),
            "w_gate": _w((lambda *s: torch.randn(*s, dtype=torch.bfloat16) * 0.05)(D, F)),
            "w_up": _w((lambda *s: torch.randn(*s, dtype=torch.bfloat16) * 0.05)(D, F)),
            "w_down": _w((lambda *s: torch.randn(*s, dtype=torch.bfloat16) * 0.05)(F, D)),
        }
    _B_in = _B_setup()

    return {
        "A_x": _A_in["x"],
        "A_c_kv": _A_in["c_kv"],
        "A_w_q": _A_in["w_q"],
        "A_w_uk": _A_in["w_uk"],
        "A_w_uv": _A_in["w_uv"],
        "A_w_o": _A_in["w_o"],
        "B_x": _B_in["x"],
        "B_w_r": _B_in["w_r"],
        "B_w_gate": _B_in["w_gate"],
        "B_w_up": _B_in["w_up"],
        "B_w_down": _B_in["w_down"],
    }

def reference(A_x, A_c_kv, A_w_q, A_w_uk, A_w_uv, A_w_o, B_x, B_w_r, B_w_gate, B_w_up, B_w_down):
    def _A_ref(x, c_kv, w_q, w_uk, w_uv, w_o):
        B, Sq, M = x.shape[0], x.shape[1], x.shape[2]
        Sk = c_kv.shape[1]
        H, D = w_q.shape[1], w_q.shape[2]
        q = torch.einsum("bqm,mhd->bhqd", x, w_q)
        k = torch.einsum("bkc,chd->bhkd", c_kv, w_uk)
        v = torch.einsum("bkc,chd->bhkd", c_kv, w_uv)
        scores = torch.einsum("bhqd,bhkd->bhqk", q, k) * (D ** -0.5)
        off = Sk - Sq
        qi = torch.arange(Sq)[:, None]
        kj = torch.arange(Sk)[None, :]
        cmask = kj <= (qi + off)
        scores = torch.where(cmask[None, None], scores, -1e9)
        p = _softmax(scores, axis=-1)
        ctx = torch.einsum("bhqk,bhkd->bhqd", p, v)
        return torch.einsum("bhqd,hdm->bqm", ctx, w_o)

    def _B_ref(x, w_r, w_gate, w_up, w_down):
        B, S, D = x.shape
        C = 1
        r = x @ w_r
        idx = torch.argsort(-r, axis=-1)[:, :C]
        idx_e = (lambda x, n, axis: torch.repeat_interleave(x, n, dim=axis))(idx.reshape(B, C, 1), D, axis=2)
        x_sel = (lambda x, i, axis: torch.take_along_dim(x, i, dim=axis))(x, idx_e, axis=1)
        g = _silu(x_sel @ w_gate)
        u = x_sel @ w_up
        y = (g * u) @ w_down
        r_sel = _sigmoid((lambda x, i, axis: torch.take_along_dim(x, i, dim=axis))(r, idx, axis=1))
        y = y * r_sel.reshape(B, C, 1)
        b_off = (torch.arange(B) * S).reshape(B, 1)
        flat_idx = (idx + b_off).reshape(B * C)
        zero = (x * 0.0).reshape(B * S, D)
        upd = _scatter_add(zero, flat_idx, y.reshape(B * C, D), axis=0)
        return x + upd.reshape(B, S, D)

    x = A_x
    h = x + _A_ref(_layernorm(x, axis=-1), A_c_kv, A_w_q, A_w_uk, A_w_uv, A_w_o)
    h2 = h + _B_ref(_layernorm(h, axis=-1), B_w_r, B_w_gate, B_w_up, B_w_down)
    return h2
```

```asm
; @launch grid=(256,1,1) block=(256,1,1) lds=163840
.amdgcn_target "amdgcn-amd-amdhsa--gfx950"
.text
.globl sequential_preLN__compressed_kv_cla__moe_arch_mod__prompt_kernel
.p2align 8
.type sequential_preLN__compressed_kv_cla__moe_arch_mod__prompt_kernel,@function
sequential_preLN__compressed_kv_cla__moe_arch_mod__prompt_kernel:
    s_cmp_ge_u32 s2, 256
    s_cbranch_scc1 sequential_preLN__compressed_kv_cla__moe_arch_mod__prompt_kernel_done
    s_load_dwordx2 s[84:85], s[0:1], 0
    s_load_dwordx2 s[86:87], s[0:1], 8
    s_load_dwordx4 s[88:91], s[0:1], 24
    s_load_dwordx2 s[92:93], s[0:1], 16
    s_load_dwordx4 s[96:99], s[0:1], 96
    s_and_b32 s14, s2, 7
    s_lshr_b32 s15, s2, 3
    s_lshr_b32 s45, s15, 3
    s_lshl_b32 s14, s14, 2
    s_add_u32 s45, s45, s14
    s_and_b32 s46, s15, 7
    v_lshrrev_b32 v2, 6, v0
    v_and_b32 v0, 63, v0
    v_readfirstlane_b32 s44, v2
    v_lshlrev_b32 v1, 4, v0
    s_getreg_b32 s67, hwreg(HW_REG_XCC_ID, 0, 4)
    v_lshrrev_b32 v9, 4, v0
    v_bfe_u32 v10, v0, 1, 3
    v_xor_b32 v10, v10, v9
    v_and_b32 v11, 1, v0
    v_lshl_add_u32 v10, v10, 1, v11
    v_lshlrev_b32 v10, 4, v10
    v_lshl_add_u32 v4, v9, 13, v10
    v_add_u32 v5, 31744, v4
    v_xor_b32 v6, 128, v4
    v_add_u32 v7, 95232, v6
    v_add_u32 v6, 63488, v6
    v_bfe_u32 v9, v0, 2, 2
    v_lshrrev_b32 v10, 4, v0
    v_lshl_add_u32 v11, v10, 3, v9
    v_lshlrev_b32 v11, 8, v11
    v_and_b32 v10, 1, v10
    v_lshl_add_u32 v9, v10, 2, v9
    v_lshl_add_u32 v11, v9, 5, v11
    v_and_b32 v9, 3, v0
    v_lshl_add_u32 v8, v9, 3, v11
    v_lshrrev_b32 v9, 3, v0
    v_lshlrev_b32 v9, 10, v9
    v_lshrrev_b32 v10, 4, v0
    v_and_b32 v11, 7, v0
    v_xor_b32 v11, v11, v10
    v_lshl_add_u32 v16, v11, 4, v9
    v_xor_b32 v12, 4, v11
    v_lshl_add_u32 v17, v12, 4, v9
    v_add_u32 v18, 14336, v16
    v_add_u32 v19, 21504, v17
    v_add_u32 v17, 7168, v17
    v_and_b32 v9, 15, v0
    v_bfe_u32 v10, v0, 1, 3
    v_lshrrev_b32 v11, 4, v0
    v_xor_b32 v10, v10, v11
    v_lshlrev_b32 v9, 7, v9
    v_lshl_add_u32 v20, v10, 4, v9
    s_lshl_b32 s50, s44, 12
    s_lshl_b32 s51, s44, 17
    s_lshl_b32 s48, s45, 8
    s_add_u32 s51, s51, s48
    s_lshl_b32 s47, s46, 8
    s_lshl_b32 s48, s44, 6
    s_add_u32 s47, s47, s48
    s_lshl_b32 s62, s47, 10
    s_lshl_b32 s56, s45, 6
    s_lshr_b32 s48, s47, 5
    s_add_u32 s56, s56, s48
    s_lshl_b32 s56, s56, 13
    s_lshl_b32 s53, s44, 13
    s_waitcnt lgkmcnt(0)
    s_mov_b32 s4, s86
    s_mov_b32 s5, s87
    s_mov_b32 s6, 2097152
    s_mov_b32 s7, 0x00020000
    s_mov_b32 s36, s88
    s_mov_b32 s37, s89
    s_mov_b32 s38, 4194304
    s_mov_b32 s39, 0x00020000
    s_mov_b32 s40, s90
    s_mov_b32 s41, s91
    s_mov_b32 s42, 4194304
    s_mov_b32 s43, 0x00020000
    s_add_u32 s48, s62, 0
    s_add_u32 m0, s53, 98304
    s_nop 0
    buffer_load_dwordx4 v16, s[4:7], s48 offen offset:0 lds
    buffer_load_dwordx4 v17, s[4:7], s48 offen offset:1024 lds
    buffer_load_dwordx4 v18, s[4:7], s48 offen offset:2048 lds
    buffer_load_dwordx4 v19, s[4:7], s48 offen offset:3072 lds
    s_add_u32 s48, s62, 32768
    s_add_u32 m0, s53, 102400
    s_nop 0
    buffer_load_dwordx4 v16, s[4:7], s48 offen offset:0 lds
    buffer_load_dwordx4 v17, s[4:7], s48 offen offset:1024 lds
    buffer_load_dwordx4 v18, s[4:7], s48 offen offset:2048 lds
    buffer_load_dwordx4 v19, s[4:7], s48 offen offset:3072 lds
    s_add_u32 s47, s51, 0
    s_add_u32 m0, s50, 0
    s_nop 0
    buffer_load_dwordx4 v4, s[36:39], s47 offen offset:0 lds
    buffer_load_dwordx4 v5, s[36:39], s47 offen offset:1024 lds
    buffer_load_dwordx4 v6, s[36:39], s47 offen offset:2048 lds
    buffer_load_dwordx4 v7, s[36:39], s47 offen offset:3072 lds
    s_add_u32 s47, s51, 0
    s_add_u32 m0, s50, 16384
    s_nop 0
    buffer_load_dwordx4 v4, s[40:43], s47 offen offset:0 lds
    buffer_load_dwordx4 v5, s[40:43], s47 offen offset:1024 lds
    buffer_load_dwordx4 v6, s[40:43], s47 offen offset:2048 lds
    buffer_load_dwordx4 v7, s[40:43], s47 offen offset:3072 lds
    s_mov_b32 s8, s84
    s_mov_b32 s9, s85
    s_mov_b32 s10, 2621440
    s_mov_b32 s11, 0x00020000
    s_mov_b32 s16, s92
    s_mov_b32 s17, s93
    s_mov_b32 s18, 5242880
    s_mov_b32 s19, 0x00020000
    s_add_u32 s20, s98, 33554432
    s_addc_u32 s21, s99, 0
    s_mov_b32 s22, 2621440
    s_mov_b32 s23, 0x00020000
    s_mov_b32 s24, s98
    s_mov_b32 s25, s99
    s_mov_b32 s26, 16777216
    s_mov_b32 s27, 0x00020000
    s_add_u32 s28, s98, 16777216
    s_addc_u32 s29, s99, 0
    s_mov_b32 s30, 16777216
    s_mov_b32 s31, 0x00020000
    s_add_u32 s32, s98, 37748736
    s_addc_u32 s33, s99, 0
    s_mov_b32 s34, 16777216
    s_mov_b32 s35, 0x00020000
    s_add_u32 s68, s98, 85983232
    s_addc_u32 s69, s99, 0
    s_mov_b32 s70, 8192
    s_mov_b32 s71, 0x00020000
    s_lshl_b32 s48, s2, 3
    s_and_b32 s14, s44, 1
    s_lshl_b32 s14, s14, 2
    s_add_u32 s48, s48, s14
    v_and_b32 v9, 3, v0
    v_add_u32 v9, s48, v9
    v_lshrrev_b32 v10, 2, v0
    v_mul_u32_u24 v220, 1280, v9
    v_lshl_add_u32 v220, v10, 4, v220
    v_lshrrev_b32 v221, 4, v9
    v_mul_u32_u24 v221, 20, v221
    v_lshrrev_b32 v11, 2, v10
    v_add_u32 v221, v221, v11
    v_lshlrev_b32 v221, 10, v221
    v_and_b32 v11, 3, v10
    v_lshlrev_b32 v11, 4, v11
    v_and_b32 v12, 15, v9
    v_add_u32 v11, v11, v12
    v_lshl_add_u32 v221, v11, 4, v221
    buffer_load_dwordx4 v[200:203], v220, s[8:11], 0 offen offset:0
    buffer_load_dwordx4 v[204:207], v220, s[8:11], 0 offen offset:256
    buffer_load_dwordx4 v[208:211], v220, s[8:11], 0 offen offset:512
    buffer_load_dwordx4 v[212:215], v220, s[8:11], 0 offen offset:768
    buffer_load_dwordx4 v[216:219], v220, s[8:11], 0 offen offset:1024
    s_lshr_b32 s14, s2, 3
    s_cmp_ge_u32 s14, 12
    s_cbranch_scc1 sequential_preLN__compressed_kv_cla__moe_arch_mod__prompt_kernel_nocode
    s_cmp_lg_u32 s44, 3
    s_cbranch_scc1 sequential_preLN__compressed_kv_cla__moe_arch_mod__prompt_kernel_nocode
    s_getpc_b64 s[76:77]
sequential_preLN__compressed_kv_cla__moe_arch_mod__prompt_kernel_pc:
    s_lshl_b32 s14, s14, 13
    v_lshlrev_b32 v9, 7, v0
    v_add_u32 v9, s14, v9
    v_min_u32 v9, code_end_all-sequential_preLN__compressed_kv_cla__moe_arch_mod__prompt_kernel_pc-4, v9
    v_and_b32 v9, -4, v9
    global_load_dword v11, v9, s[76:77]
sequential_preLN__compressed_kv_cla__moe_arch_mod__prompt_kernel_nocode:
    s_mov_b32 s88, s96
    s_mov_b32 s89, s97
    s_mov_b32 s90, 256
    s_mov_b32 s91, 0x00020000
    v_mov_b32 v26, 0
    s_or_b32 s14, s2, 0
    s_add_u32 s14, s2, s44
    s_cmp_lg_u32 s14, 0
    s_cbranch_scc1 sequential_preLN__compressed_kv_cla__moe_arch_mod__prompt_kernel_notag
    s_memrealtime s[92:93]
    s_waitcnt lgkmcnt(0)
    s_or_b32 s92, s92, 1
    v_mov_b32 v24, s92
    buffer_store_dword v24, v26, s[88:91], 0 offen sc1
sequential_preLN__compressed_kv_cla__moe_arch_mod__prompt_kernel_notag:
    s_cmp_lg_u32 s2, 0
    s_cbranch_scc1 sequential_preLN__compressed_kv_cla__moe_arch_mod__prompt_kernel_nz
    s_add_u32 s76, s98, 84934656
    s_addc_u32 s77, s99, 0
    s_mov_b32 s78, 24832
    s_mov_b32 s79, 0x00020000
    v_mov_b32 v28, 0
    v_mov_b32 v29, 0
    v_mov_b32 v30, 0
    v_mov_b32 v31, 0
    s_mul_i32 s14, s44, 7168
    buffer_store_dwordx4 v[28:31], v1, s[76:79], s14 offen sc1
    s_add_u32 s14, s14, 1024
    buffer_store_dwordx4 v[28:31], v1, s[76:79], s14 offen sc1
    s_add_u32 s14, s14, 1024
    buffer_store_dwordx4 v[28:31], v1, s[76:79], s14 offen sc1
    s_add_u32 s14, s14, 1024
    buffer_store_dwordx4 v[28:31], v1, s[76:79], s14 offen sc1
    s_add_u32 s14, s14, 1024
    buffer_store_dwordx4 v[28:31], v1, s[76:79], s14 offen sc1
    s_add_u32 s14, s14, 1024
    buffer_store_dwordx4 v[28:31], v1, s[76:79], s14 offen sc1
    s_add_u32 s14, s14, 1024
    buffer_store_dwordx4 v[28:31], v1, s[76:79], s14 offen sc1
    s_add_u32 s14, s14, 1024
sequential_preLN__compressed_kv_cla__moe_arch_mod__prompt_kernel_nz:
    s_add_u32 s96, s98, 33554432
    s_addc_u32 s97, s99, 0
    s_mov_b32 s98, 2621440
    s_mov_b32 s99, 0x00020000
    s_cmp_lt_u32 s44, 2
    s_cselect_b32 s98, s98, 0
    s_waitcnt vmcnt(0)
    s_barrier
    v_lshlrev_b32 v30, 10, v0
    s_mov_b32 s64, 0
    s_add_u32 s65, s53, 98304
    s_add_u32 s54, s50, 65536
    s_add_u32 s55, s53, 98304
    s_lshl_b32 s63, s55, 1
    s_add_u32 s63, s63, 32768
    s_add_u32 s57, s51, 1048576
    s_add_u32 s62, s62, 256
    v_add_u32 v21, s65, v20
    v_xor_b32 v22, 64, v21
    v_add_u32 v120, s64, v8
    v_xor_b32 v121, 32, v120
    v_xor_b32 v122, 64, v120
    v_xor_b32 v123, 96, v120
    v_xor_b32 v124, 128, v120
    v_xor_b32 v125, 160, v120
    v_xor_b32 v126, 192, v120
    v_xor_b32 v127, 224, v120
    ds_read_b128 v[128:131], v21 offset:0
    ds_read_b128 v[132:135], v21 offset:2048
    ds_read_b128 v[136:139], v21 offset:4096
    ds_read_b128 v[140:143], v21 offset:6144
    ds_read_b64_tr_b16 v[32:33], v120 offset:0
    ds_read_b64_tr_b16 v[34:35], v120 offset:1024
    ds_read_b64_tr_b16 v[64:65], v120 offset:16384
    ds_read_b64_tr_b16 v[66:67], v120 offset:17408
    ds_read_b64_tr_b16 v[36:37], v121 offset:0
    ds_read_b64_tr_b16 v[38:39], v121 offset:1024
    ds_read_b64_tr_b16 v[68:69], v121 offset:16384
    ds_read_b64_tr_b16 v[70:71], v121 offset:17408
    ds_read_b64_tr_b16 v[40:41], v122 offset:0
    ds_read_b64_tr_b16 v[42:43], v122 offset:1024
    ds_read_b64_tr_b16 v[72:73], v122 offset:16384
    ds_read_b64_tr_b16 v[74:75], v122 offset:17408
    ds_read_b64_tr_b16 v[44:45], v123 offset:0
    ds_read_b64_tr_b16 v[46:47], v123 offset:1024
    ds_read_b64_tr_b16 v[76:77], v123 offset:16384
    ds_read_b64_tr_b16 v[78:79], v123 offset:17408
    ds_read_b64_tr_b16 v[48:49], v124 offset:0
    ds_read_b64_tr_b16 v[50:51], v124 offset:1024
    ds_read_b64_tr_b16 v[80:81], v124 offset:16384
    ds_read_b64_tr_b16 v[82:83], v124 offset:17408
    ds_read_b64_tr_b16 v[52:53], v125 offset:0
    ds_read_b64_tr_b16 v[54:55], v125 offset:1024
    ds_read_b64_tr_b16 v[84:85], v125 offset:16384
    ds_read_b64_tr_b16 v[86:87], v125 offset:17408
    ds_read_b64_tr_b16 v[56:57], v126 offset:0
    ds_read_b64_tr_b16 v[58:59], v126 offset:1024
    ds_read_b64_tr_b16 v[88:89], v126 offset:16384
    ds_read_b64_tr_b16 v[90:91], v126 offset:17408
    ds_read_b64_tr_b16 v[60:61], v127 offset:0
    ds_read_b64_tr_b16 v[62:63], v127 offset:1024
    ds_read_b64_tr_b16 v[92:93], v127 offset:16384
    ds_read_b64_tr_b16 v[94:95], v127 offset:17408
    s_waitcnt lgkmcnt(15)
    v_mfma_f32_16x16x32_bf16 a[0:3], v[32:35], v[128:131], 0
    v_mfma_f32_16x16x32_bf16 a[32:35], v[32:35], v[132:135], 0
    s_add_u32 s48, s62, 4294967168
    s_add_u32 m0, s53, 131072
    v_mfma_f32_16x16x32_bf16 a[64:67], v[32:35], v[136:139], 0
    buffer_load_dwordx4 v16, s[4:7], s48 offen offset:0 lds
    v_mfma_f32_16x16x32_bf16 a[96:99], v[32:35], v[140:143], 0
    ds_read_b64_tr_b16 v[32:33], v120 offset:8192
    v_mfma_f32_16x16x32_bf16 a[128:131], v[128:131], v[64:67], 0
    ds_read_b64_tr_b16 v[34:35], v120 offset:9216
    v_lshlrev_b32 v160, 16, v200
    v_and_b32 v161, 0xffff0000, v200
    v_mfma_f32_16x16x32_bf16 a[132:135], v[132:135], v[64:67], 0
    buffer_load_dwordx4 v17, s[4:7], s48 offen offset:1024 lds
    v_lshlrev_b32 v162, 16, v201
    v_and_b32 v163, 0xffff0000, v201
    v_mfma_f32_16x16x32_bf16 a[192:195], v[136:139], v[64:67], 0
    buffer_load_dwordx4 v18, s[4:7], s48 offen offset:2048 lds
    v_lshlrev_b32 v164, 16, v202
    v_mfma_f32_16x16x32_bf16 a[196:199], v[140:143], v[64:67], 0
    ds_read_b64_tr_b16 v[64:65], v120 offset:24576
    v_and_b32 v165, 0xffff0000, v202
    v_lshlrev_b32 v166, 16, v203
    v_mfma_f32_16x16x32_bf16 a[4:7], v[36:39], v[128:131], 0
    ds_read_b64_tr_b16 v[66:67], v120 offset:25600
    v_and_b32 v167, 0xffff0000, v203
    v_mfma_f32_16x16x32_bf16 a[36:39], v[36:39], v[132:135], 0
    ds_read_b128 v[144:147], v22 offset:0
    v_lshlrev_b32 v168, 16, v204
    v_and_b32 v169, 0xffff0000, v204
    v_mfma_f32_16x16x32_bf16 a[68:71], v[36:39], v[136:139], 0
    buffer_load_dwordx4 v19, s[4:7], s48 offen offset:3072 lds
    v_lshlrev_b32 v170, 16, v205
    v_mfma_f32_16x16x32_bf16 a[100:103], v[36:39], v[140:143], 0
    s_add_u32 s48, s62, 32640
    ds_read_b64_tr_b16 v[36:37], v121 offset:8192
    v_and_b32 v171, 0xffff0000, v205
    v_mfma_f32_16x16x32_bf16 a[136:139], v[128:131], v[68:71], 0
    s_add_u32 m0, s53, 135168
    ds_read_b64_tr_b16 v[38:39], v121 offset:9216
    v_lshlrev_b32 v172, 16, v206
    v_and_b32 v173, 0xffff0000, v206
    v_mfma_f32_16x16x32_bf16 a[140:143], v[132:135], v[68:71], 0
    buffer_load_dwordx4 v16, s[4:7], s48 offen offset:0 lds
    v_lshlrev_b32 v174, 16, v207
    v_and_b32 v175, 0xffff0000, v207
    v_mfma_f32_16x16x32_bf16 a[200:203], v[136:139], v[68:71], 0
    ds_read_b128 v[148:151], v22 offset:2048
    v_lshlrev_b32 v176, 16, v208
    v_and_b32 v177, 0xffff0000, v208
    v_mfma_f32_16x16x32_bf16 a[204:207], v[140:143], v[68:71], 0
    ds_read_b64_tr_b16 v[68:69], v121 offset:24576
    v_lshlrev_b32 v178, 16, v209
    v_mfma_f32_16x16x32_bf16 a[8:11], v[40:43], v[128:131], 0
    ds_read_b64_tr_b16 v[70:71], v121 offset:25600
    v_and_b32 v179, 0xffff0000, v209
    v_lshlrev_b32 v180, 16, v210
    v_mfma_f32_16x16x32_bf16 a[40:43], v[40:43], v[132:135], 0
    buffer_load_dwordx4 v17, s[4:7], s48 offen offset:1024 lds
    v_and_b32 v181, 0xffff0000, v210
    v_mfma_f32_16x16x32_bf16 a[72:75], v[40:43], v[136:139], 0
    buffer_load_dwordx4 v18, s[4:7], s48 offen offset:2048 lds
    v_lshlrev_b32 v182, 16, v211
    v_and_b32 v183, 0xffff0000, v211
    v_mfma_f32_16x16x32_bf16 a[104:107], v[40:43], v[140:143], 0
    ds_read_b64_tr_b16 v[40:41], v122 offset:8192
    v_lshlrev_b32 v184, 16, v212
    v_mfma_f32_16x16x32_bf16 a[144:147], v[128:131], v[72:75], 0
    ds_read_b64_tr_b16 v[42:43], v122 offset:9216
    v_and_b32 v185, 0xffff0000, v212
    v_lshlrev_b32 v186, 16, v213
    v_mfma_f32_16x16x32_bf16 a[148:151], v[132:135], v[72:75], 0
    ds_read_b128 v[152:155], v22 offset:4096
    v_and_b32 v187, 0xffff0000, v213
    v_lshlrev_b32 v188, 16, v214
    v_mfma_f32_16x16x32_bf16 a[208:211], v[136:139], v[72:75], 0
    buffer_load_dwordx4 v19, s[4:7], s48 offen offset:3072 lds
    v_and_b32 v189, 0xffff0000, v214
    v_mfma_f32_16x16x32_bf16 a[212:215], v[140:143], v[72:75], 0
    s_add_u32 s47, s51, 524288
    ds_read_b64_tr_b16 v[72:73], v122 offset:24576
    v_lshlrev_b32 v190, 16, v215
    v_mfma_f32_16x16x32_bf16 a[12:15], v[44:47], v[128:131], 0
    s_add_u32 m0, s50, 32768
    ds_read_b64_tr_b16 v[74:75], v122 offset:25600
    v_and_b32 v191, 0xffff0000, v215
    v_lshlrev_b32 v192, 16, v216
    v_mfma_f32_16x16x32_bf16 a[44:47], v[44:47], v[132:135], 0
    ds_read_b128 v[156:159], v22 offset:6144
    v_and_b32 v193, 0xffff0000, v216
    v_lshlrev_b32 v194, 16, v217
    v_mfma_f32_16x16x32_bf16 a[76:79], v[44:47], v[136:139], 0
    buffer_load_dwordx4 v4, s[36:39], s47 offen offset:0 lds
    v_and_b32 v195, 0xffff0000, v217
    v_mfma_f32_16x16x32_bf16 a[108:111], v[44:47], v[140:143], 0
    ds_read_b64_tr_b16 v[44:45], v123 offset:8192
    v_lshlrev_b32 v196, 16, v218
    v_and_b32 v197, 0xffff0000, v218
    v_mfma_f32_16x16x32_bf16 a[152:155], v[128:131], v[76:79], 0
    ds_read_b64_tr_b16 v[46:47], v123 offset:9216
    v_lshlrev_b32 v198, 16, v219
    v_mfma_f32_16x16x32_bf16 a[156:159], v[132:135], v[76:79], 0
    buffer_load_dwordx4 v5, s[36:39], s47 offen offset:1024 lds
    v_and_b32 v199, 0xffff0000, v219
    v_add_f32 v224, v160, v161
    v_mfma_f32_16x16x32_bf16 a[216:219], v[136:139], v[76:79], 0
    buffer_load_dwordx4 v6, s[36:39], s47 offen offset:2048 lds
    v_add_f32 v230, v162, v163
    v_add_f32 v224, v224, v164
    v_mfma_f32_16x16x32_bf16 a[220:223], v[140:143], v[76:79], 0
    s_waitcnt lgkmcnt(15)
    ds_read_b64_tr_b16 v[76:77], v123 offset:24576
    v_add_f32 v230, v230, v165
    v_mfma_f32_16x16x32_bf16 a[16:19], v[48:51], v[128:131], 0
    ds_read_b64_tr_b16 v[78:79], v123 offset:25600
    v_add_f32 v224, v224, v166
    v_add_f32 v230, v230, v167
    v_mfma_f32_16x16x32_bf16 a[48:51], v[48:51], v[132:135], 0
    buffer_load_dwordx4 v7, s[36:39], s47 offen offset:3072 lds
    v_add_f32 v224, v224, v168
    v_mfma_f32_16x16x32_bf16 a[80:83], v[48:51], v[136:139], 0
    s_add_u32 s47, s51, 524288
    s_add_u32 m0, s50, 49152
    v_add_f32 v230, v230, v169
    v_add_f32 v224, v224, v170
    v_mfma_f32_16x16x32_bf16 a[112:115], v[48:51], v[140:143], 0
    ds_read_b64_tr_b16 v[48:49], v124 offset:8192
    v_add_f32 v230, v230, v171
    v_mfma_f32_16x16x32_bf16 a[160:163], v[128:131], v[80:83], 0
    ds_read_b64_tr_b16 v[50:51], v124 offset:9216
    v_add_f32 v224, v224, v172
    v_add_f32 v230, v230, v173
    v_mfma_f32_16x16x32_bf16 a[164:167], v[132:135], v[80:83], 0
    buffer_load_dwordx4 v4, s[40:43], s47 offen offset:0 lds
    v_add_f32 v224, v224, v174
    v_mfma_f32_16x16x32_bf16 a[224:227], v[136:139], v[80:83], 0
    buffer_load_dwordx4 v5, s[40:43], s47 offen offset:1024 lds
    v_add_f32 v230, v230, v175
    v_add_f32 v224, v224, v176
    v_mfma_f32_16x16x32_bf16 a[228:231], v[140:143], v[80:83], 0
    ds_read_b64_tr_b16 v[80:81], v124 offset:24576
    v_add_f32 v230, v230, v177
    v_add_f32 v224, v224, v178
    v_mfma_f32_16x16x32_bf16 a[20:23], v[52:55], v[128:131], 0
    ds_read_b64_tr_b16 v[82:83], v124 offset:25600
    v_add_f32 v230, v230, v179
    v_mfma_f32_16x16x32_bf16 a[52:55], v[52:55], v[132:135], 0
    buffer_load_dwordx4 v6, s[40:43], s47 offen offset:2048 lds
    v_add_f32 v224, v224, v180
    v_add_f32 v230, v230, v181
    v_mfma_f32_16x16x32_bf16 a[84:87], v[52:55], v[136:139], 0
    buffer_load_dwordx4 v7, s[40:43], s47 offen offset:3072 lds
    v_add_f32 v224, v224, v182
    v_mfma_f32_16x16x32_bf16 a[116:119], v[52:55], v[140:143], 0
    s_add_u32 m0, s54, 0
    ds_read_b64_tr_b16 v[52:53], v125 offset:8192
    v_add_f32 v230, v230, v183
    v_mfma_f32_16x16x32_bf16 a[168:171], v[128:131], v[84:87], 0
    ds_read_b64_tr_b16 v[54:55], v125 offset:9216
    v_add_f32 v224, v224, v184
    v_add_f32 v230, v230, v185
    v_mfma_f32_16x16x32_bf16 a[172:175], v[132:135], v[84:87], 0
    buffer_load_dwordx4 v4, s[36:39], s57 offen offset:0 lds
    v_add_f32 v224, v224, v186
    v_add_f32 v230, v230, v187
    v_mfma_f32_16x16x32_bf16 a[232:235], v[136:139], v[84:87], 0
    buffer_load_dwordx4 v5, s[36:39], s57 offen offset:1024 lds
    v_add_f32 v224, v224, v188
    v_add_f32 v230, v230, v189
    v_mfma_f32_16x16x32_bf16 a[236:239], v[140:143], v[84:87], 0
    ds_read_b64_tr_b16 v[84:85], v125 offset:24576
    v_add_f32 v224, v224, v190
    v_mfma_f32_16x16x32_bf16 a[24:27], v[56:59], v[128:131], 0
    ds_read_b64_tr_b16 v[86:87], v125 offset:25600
    v_add_f32 v230, v230, v191
    v_add_f32 v224, v224, v192
    v_mfma_f32_16x16x32_bf16 a[56:59], v[56:59], v[132:135], 0
    buffer_load_dwordx4 v6, s[36:39], s57 offen offset:2048 lds
    v_add_f32 v230, v230, v193
    v_mfma_f32_16x16x32_bf16 a[88:91], v[56:59], v[136:139], 0
    buffer_load_dwordx4 v7, s[36:39], s57 offen offset:3072 lds
    v_add_f32 v224, v224, v194
    v_add_f32 v230, v230, v195
    v_mfma_f32_16x16x32_bf16 a[120:123], v[56:59], v[140:143], 0
    s_add_u32 m0, s54, 16384
    ds_read_b64_tr_b16 v[56:57], v126 offset:8192
    v_add_f32 v224, v224, v196
    v_mfma_f32_16x16x32_bf16 a[176:179], v[128:131], v[88:91], 0
    ds_read_b64_tr_b16 v[58:59], v126 offset:9216
    v_add_f32 v230, v230, v197
    v_add_f32 v224, v224, v198
    v_mfma_f32_16x16x32_bf16 a[180:183], v[132:135], v[88:91], 0
    buffer_load_dwordx4 v4, s[40:43], s57 offen offset:0 lds
    v_add_f32 v230, v230, v199
    v_mfma_f32_16x16x32_bf16 a[240:243], v[136:139], v[88:91], 0
    buffer_load_dwordx4 v5, s[40:43], s57 offen offset:1024 lds
    v_add_f32 v224, v224, v230
    v_mfma_f32_16x16x32_bf16 a[244:247], v[140:143], v[88:91], 0
    s_nop 1
    ds_read_b64_tr_b16 v[88:89], v126 offset:24576
    v_add_f32_dpp v224, v224, v224 row_ror:8 row_mask:0xf bank_mask:0xf
    v_mfma_f32_16x16x32_bf16 a[28:31], v[60:63], v[128:131], 0
    s_nop 1
    ds_read_b64_tr_b16 v[90:91], v126 offset:25600
    v_add_f32_dpp v224, v224, v224 row_ror:4 row_mask:0xf bank_mask:0xf
    v_mfma_f32_16x16x32_bf16 a[60:63], v[60:63], v[132:135], 0
    buffer_load_dwordx4 v6, s[40:43], s57 offen offset:2048 lds
    v_mov_b32 v230, v224
    v_mfma_f32_16x16x32_bf16 a[92:95], v[60:63], v[136:139], 0
    s_nop 1
    buffer_load_dwordx4 v7, s[40:43], s57 offen offset:3072 lds
    v_permlane16_swap_b32 v224, v230
    v_mfma_f32_16x16x32_bf16 a[124:127], v[60:63], v[140:143], 0
    s_add_u32 s57, s57, 524288
    s_nop 1
    ds_read_b64_tr_b16 v[60:61], v127 offset:8192
    v_mfma_f32_16x16x32_bf16 a[184:187], v[128:131], v[92:95], 0
    s_add_u32 s54, s54, 32768
    ds_read_b64_tr_b16 v[62:63], v127 offset:9216
    v_add_f32 v224, v224, v230
    v_mov_b32 v230, v224
    v_mfma_f32_16x16x32_bf16 a[188:191], v[132:135], v[92:95], 0
    s_cmp_ge_u32 s54, 98304
    s_cselect_b32 s54, s50, s54
    s_nop 1
    v_permlane32_swap_b32 v224, v230
    v_mfma_f32_16x16x32_bf16 a[248:251], v[136:139], v[92:95], 0
    s_nop 1
    v_mfma_f32_16x16x32_bf16 a[252:255], v[140:143], v[92:95], 0
    s_waitcnt lgkmcnt(15)
    ds_read_b64_tr_b16 v[92:93], v127 offset:24576
    v_add_f32 v224, v224, v230
    v_mul_f32 v225, 0x3acccccd, v224
    v_mfma_f32_16x16x32_bf16 a[0:3], v[32:35], v[144:147], a[0:3]
    ds_read_b64_tr_b16 v[94:95], v127 offset:25600
    v_cvt_pk_bf16_f32 v226, v225, v225
    v_lshlrev_b32 v226, 16, v226
    v_mfma_f32_16x16x32_bf16 a[32:35], v[32:35], v[148:151], a[32:35]
    s_add_u32 s64, s64, 32768
    v_sub_f32 v230, v160, v225
    v_mfma_f32_16x16x32_bf16 a[64:67], v[32:35], v[152:155], a[64:67]
    s_cmp_ge_u32 s64, 98304
    s_cselect_b32 s64, 0, s64
    v_sub_f32 v231, v161, v225
    v_mul_f32 v227, v230, v230
    v_mfma_f32_16x16x32_bf16 a[96:99], v[32:35], v[156:159], a[96:99]
    s_sub_u32 s65, s63, s65
    v_mul_f32 v229, v231, v231
    v_mfma_f32_16x16x32_bf16 a[128:131], v[144:147], v[64:67], a[128:131]
    v_add_u32 v21, s65, v20
    v_xor_b32 v22, 64, v21
    v_sub_f32 v230, v162, v225
    v_mfma_f32_16x16x32_bf16 a[132:135], v[148:151], v[64:67], a[132:135]
    v_add_u32 v120, s64, v8
    v_xor_b32 v121, 32, v120
    v_sub_f32 v231, v163, v225
    v_mfma_f32_16x16x32_bf16 a[192:195], v[152:155], v[64:67], a[192:195]
    v_xor_b32 v122, 64, v120
    v_xor_b32 v123, 96, v120
    v_fmac_f32 v227, v230, v230
    v_mfma_f32_16x16x32_bf16 a[196:199], v[156:159], v[64:67], a[196:199]
    s_waitcnt vmcnt(8) lgkmcnt(0)
    s_barrier
    v_xor_b32 v124, 128, v120
    v_mfma_f32_16x16x32_bf16 a[4:7], v[36:39], v[144:147], a[4:7]
    s_add_u32 s48, s62, 0
    buffer_load_dword v24, v26, s[88:91], 0 offen sc1
    v_xor_b32 v125, 160, v120
    v_xor_b32 v126, 192, v120
    v_mfma_f32_16x16x32_bf16 a[36:39], v[36:39], v[148:151], a[36:39]
    s_add_u32 m0, s55, 0
    v_xor_b32 v127, 224, v120
    v_fmac_f32 v229, v231, v231
    v_sub_f32 v230, v164, v225
    v_mfma_f32_16x16x32_bf16 a[68:71], v[36:39], v[152:155], a[68:71]
    buffer_load_dwordx4 v16, s[4:7], s48 offen offset:0 lds
    v_sub_f32 v231, v165, v225
    v_fmac_f32 v227, v230, v230
    v_mfma_f32_16x16x32_bf16 a[100:103], v[36:39], v[156:159], a[100:103]
    v_fmac_f32 v229, v231, v231
    v_sub_f32 v230, v166, v225
    v_sub_f32 v231, v167, v225
    v_mfma_f32_16x16x32_bf16 a[136:139], v[144:147], v[68:71], a[136:139]
    buffer_load_dwordx4 v17, s[4:7], s48 offen offset:1024 lds
    v_fmac_f32 v227, v230, v230
    v_fmac_f32 v229, v231, v231
    v_mfma_f32_16x16x32_bf16 a[140:143], v[148:151], v[68:71], a[140:143]
    v_sub_f32 v230, v168, v225
    v_sub_f32 v231, v169, v225
    v_fmac_f32 v227, v230, v230
    v_mfma_f32_16x16x32_bf16 a[200:203], v[152:155], v[68:71], a[200:203]
    v_fmac_f32 v229, v231, v231
    v_sub_f32 v230, v170, v225
    v_mfma_f32_16x16x32_bf16 a[204:207], v[156:159], v[68:71], a[204:207]
    v_sub_f32 v231, v171, v225
    v_fmac_f32 v227, v230, v230
    v_mfma_f32_16x16x32_bf16 a[8:11], v[40:43], v[144:147], a[8:11]
    buffer_load_dwordx4 v18, s[4:7], s48 offen offset:2048 lds
    v_fmac_f32 v229, v231, v231
    v_mfma_f32_16x16x32_bf16 a[40:43], v[40:43], v[148:151], a[40:43]
    ds_read_b64_tr_b16 v[32:33], v120 offset:0
    v_sub_f32 v230, v172, v225
    v_sub_f32 v231, v173, v225
    v_mfma_f32_16x16x32_bf16 a[72:75], v[40:43], v[152:155], a[72:75]
    ds_read_b64_tr_b16 v[34:35], v120 offset:1024
    v_fmac_f32 v227, v230, v230
    v_fmac_f32 v229, v231, v231
    v_mfma_f32_16x16x32_bf16 a[104:107], v[40:43], v[156:159], a[104:107]
    ds_read_b64_tr_b16 v[64:65], v120 offset:16384
    v_sub_f32 v230, v174, v225
    v_mfma_f32_16x16x32_bf16 a[144:147], v[144:147], v[72:75], a[144:147]
    ds_read_b64_tr_b16 v[66:67], v120 offset:17408
    v_sub_f32 v231, v175, v225
    v_fmac_f32 v227, v230, v230
    v_mfma_f32_16x16x32_bf16 a[148:151], v[148:151], v[72:75], a[148:151]
    ds_read_b64_tr_b16 v[36:37], v121 offset:0
    v_fmac_f32 v229, v231, v231
    v_mfma_f32_16x16x32_bf16 a[208:211], v[152:155], v[72:75], a[208:211]
    ds_read_b64_tr_b16 v[38:39], v121 offset:1024
    v_sub_f32 v230, v176, v225
    v_sub_f32 v231, v177, v225
    v_mfma_f32_16x16x32_bf16 a[212:215], v[156:159], v[72:75], a[212:215]
    ds_read_b64_tr_b16 v[68:69], v121 offset:16384
    v_fmac_f32 v227, v230, v230
    v_mfma_f32_16x16x32_bf16 a[12:15], v[44:47], v[144:147], a[12:15]
    ds_read_b64_tr_b16 v[70:71], v121 offset:17408
    v_fmac_f32 v229, v231, v231
    v_sub_f32 v230, v178, v225
    v_mfma_f32_16x16x32_bf16 a[44:47], v[44:47], v[148:151], a[44:47]
    ds_read_b64_tr_b16 v[40:41], v122 offset:0
    v_sub_f32 v231, v179, v225
    v_fmac_f32 v227, v230, v230
    v_mfma_f32_16x16x32_bf16 a[76:79], v[44:47], v[152:155], a[76:79]
    ds_read_b64_tr_b16 v[42:43], v122 offset:1024
    v_fmac_f32 v229, v231, v231
    v_mfma_f32_16x16x32_bf16 a[108:111], v[44:47], v[156:159], a[108:111]
    ds_read_b64_tr_b16 v[72:73], v122 offset:16384
    v_sub_f32 v230, v180, v225
    v_sub_f32 v231, v181, v225
    v_mfma_f32_16x16x32_bf16 a[152:155], v[144:147], v[76:79], a[152:155]
    ds_read_b64_tr_b16 v[74:75], v122 offset:17408
    v_fmac_f32 v227, v230, v230
    v_mfma_f32_16x16x32_bf16 a[156:159], v[148:151], v[76:79], a[156:159]
    ds_read_b64_tr_b16 v[44:45], v123 offset:0
    v_fmac_f32 v229, v231, v231
    v_sub_f32 v230, v182, v225
    v_mfma_f32_16x16x32_bf16 a[216:219], v[152:155], v[76:79], a[216:219]
    ds_read_b64_tr_b16 v[46:47], v123 offset:1024
    v_sub_f32 v231, v183, v225
    v_mfma_f32_16x16x32_bf16 a[220:223], v[156:159], v[76:79], a[220:223]
    ds_read_b64_tr_b16 v[76:77], v123 offset:16384
    v_fmac_f32 v227, v230, v230
    v_fmac_f32 v229, v231, v231
    v_mfma_f32_16x16x32_bf16 a[16:19], v[48:51], v[144:147], a[16:19]
    ds_read_b64_tr_b16 v[78:79], v123 offset:17408
    v_sub_f32 v230, v184, v225
    v_mfma_f32_16x16x32_bf16 a[48:51], v[48:51], v[148:151], a[48:51]
    ds_read_b128 v[128:131], v21 offset:0
    v_sub_f32 v231, v185, v225
    v_fmac_f32 v227, v230, v230
    v_mfma_f32_16x16x32_bf16 a[80:83], v[48:51], v[152:155], a[80:83]
    ds_read_b128 v[132:135], v21 offset:2048
    v_fmac_f32 v229, v231, v231
    v_sub_f32 v230, v186, v225
    v_mfma_f32_16x16x32_bf16 a[112:115], v[48:51], v[156:159], a[112:115]
    ds_read_b64_tr_b16 v[48:49], v124 offset:0
    v_sub_f32 v231, v187, v225
    v_mfma_f32_16x16x32_bf16 a[160:163], v[144:147], v[80:83], a[160:163]
    ds_read_b64_tr_b16 v[50:51], v124 offset:1024
    v_fmac_f32 v227, v230, v230
    v_fmac_f32 v229, v231, v231
    v_mfma_f32_16x16x32_bf16 a[164:167], v[148:151], v[80:83], a[164:167]
    ds_read_b128 v[136:139], v21 offset:4096
    v_sub_f32 v230, v188, v225
    v_mfma_f32_16x16x32_bf16 a[224:227], v[152:155], v[80:83], a[224:227]
    ds_read_b128 v[140:143], v21 offset:6144
    v_sub_f32 v231, v189, v225
    v_fmac_f32 v227, v230, v230
    v_mfma_f32_16x16x32_bf16 a[228:231], v[156:159], v[80:83], a[228:231]
    ds_read_b64_tr_b16 v[80:81], v124 offset:16384
    v_fmac_f32 v229, v231, v231
    v_mfma_f32_16x16x32_bf16 a[20:23], v[52:55], v[144:147], a[20:23]
    ds_read_b64_tr_b16 v[82:83], v124 offset:17408
    v_sub_f32 v230, v190, v225
    v_sub_f32 v231, v191, v225
    v_mfma_f32_16x16x32_bf16 a[52:55], v[52:55], v[148:151], a[52:55]
    buffer_load_dwordx4 v19, s[4:7], s48 offen offset:3072 lds
    v_fmac_f32 v227, v230, v230
    v_mfma_f32_16x16x32_bf16 a[84:87], v[52:55], v[152:155], a[84:87]
    s_add_u32 s48, s62, 32768
    s_add_u32 m0, s55, 4096
    v_fmac_f32 v229, v231, v231
    v_sub_f32 v230, v192, v225
    v_mfma_f32_16x16x32_bf16 a[116:119], v[52:55], v[156:159], a[116:119]
    ds_read_b64_tr_b16 v[52:53], v125 offset:0
    buffer_load_dwordx4 v16, s[4:7], s48 offen offset:0 lds
    v_mfma_f32_16x16x32_bf16 a[168:171], v[144:147], v[84:87], a[168:171]
    ds_read_b64_tr_b16 v[54:55], v125 offset:1024
    buffer_load_dwordx4 v17, s[4:7], s48 offen offset:1024 lds
    v_mfma_f32_16x16x32_bf16 a[172:175], v[148:151], v[84:87], a[172:175]
    buffer_load_dwordx4 v18, s[4:7], s48 offen offset:2048 lds
    v_sub_f32 v231, v193, v225
    v_fmac_f32 v227, v230, v230
    v_mfma_f32_16x16x32_bf16 a[232:235], v[152:155], v[84:87], a[232:235]
    buffer_load_dwordx4 v19, s[4:7], s48 offen offset:3072 lds
    v_fmac_f32 v229, v231, v231
    v_sub_f32 v230, v194, v225
    v_mfma_f32_16x16x32_bf16 a[236:239], v[156:159], v[84:87], a[236:239]
    s_add_u32 s62, s62, 128
    s_sub_u32 s55, s63, s55
    ds_read_b64_tr_b16 v[84:85], v125 offset:16384
    v_mfma_f32_16x16x32_bf16 a[24:27], v[56:59], v[144:147], a[24:27]
    ds_read_b64_tr_b16 v[86:87], v125 offset:17408
    v_sub_f32 v231, v195, v225
    v_fmac_f32 v227, v230, v230
    v_mfma_f32_16x16x32_bf16 a[56:59], v[56:59], v[148:151], a[56:59]
    v_fmac_f32 v229, v231, v231
    v_sub_f32 v230, v196, v225
    v_sub_f32 v231, v197, v225
    v_mfma_f32_16x16x32_bf16 a[88:91], v[56:59], v[152:155], a[88:91]
    v_fmac_f32 v227, v230, v230
    v_fmac_f32 v229, v231, v231
    v_sub_f32 v230, v198, v225
    v_mfma_f32_16x16x32_bf16 a[120:123], v[56:59], v[156:159], a[120:123]
    ds_read_b64_tr_b16 v[56:57], v126 offset:0
    v_sub_f32 v231, v199, v225
    v_fmac_f32 v227, v230, v230
    v_mfma_f32_16x16x32_bf16 a[176:179], v[144:147], v[88:91], a[176:179]
    ds_read_b64_tr_b16 v[58:59], v126 offset:1024
    v_fmac_f32 v229, v231, v231
    v_add_f32 v227, v227, v229
    v_mfma_f32_16x16x32_bf16 a[180:183], v[148:151], v[88:91], a[180:183]
    s_nop 1
    v_mfma_f32_16x16x32_bf16 a[240:243], v[152:155], v[88:91], a[240:243]
    v_add_f32_dpp v227, v227, v227 row_ror:8 row_mask:0xf bank_mask:0xf
    v_mfma_f32_16x16x32_bf16 a[244:247], v[156:159], v[88:91], a[244:247]
    s_nop 1
    ds_read_b64_tr_b16 v[88:89], v126 offset:16384
    v_add_f32_dpp v227, v227, v227 row_ror:4 row_mask:0xf bank_mask:0xf
    v_mfma_f32_16x16x32_bf16 a[28:31], v[60:63], v[144:147], a[28:31]
    ds_read_b64_tr_b16 v[90:91], v126 offset:17408
    v_mov_b32 v230, v227
    v_mfma_f32_16x16x32_bf16 a[60:63], v[60:63], v[148:151], a[60:63]
    s_nop 1
    v_permlane16_swap_b32 v227, v230
    v_mfma_f32_16x16x32_bf16 a[92:95], v[60:63], v[152:155], a[92:95]
    s_nop 1
    v_add_f32 v227, v227, v230
    v_mfma_f32_16x16x32_bf16 a[124:127], v[60:63], v[156:159], a[124:127]
    ds_read_b64_tr_b16 v[60:61], v127 offset:0
    v_mov_b32 v230, v227
    v_mfma_f32_16x16x32_bf16 a[184:187], v[144:147], v[92:95], a[184:187]
    ds_read_b64_tr_b16 v[62:63], v127 offset:1024
    v_mfma_f32_16x16x32_bf16 a[188:191], v[148:151], v[92:95], a[188:191]
    v_mfma_f32_16x16x32_bf16 a[248:251], v[152:155], v[92:95], a[248:251]
    v_mfma_f32_16x16x32_bf16 a[252:255], v[156:159], v[92:95], a[252:255]
    ds_read_b64_tr_b16 v[92:93], v127 offset:16384
    ds_read_b64_tr_b16 v[94:95], v127 offset:17408
    s_waitcnt lgkmcnt(14)
    v_mfma_f32_16x16x32_bf16 a[0:3], v[32:35], v[128:131], a[0:3]
    s_nop 1
    v_permlane32_swap_b32 v227, v230
    v_mfma_f32_16x16x32_bf16 a[32:35], v[32:35], v[132:135], a[32:35]
    s_add_u32 m0, s54, 0
    s_nop 1
    v_add_f32 v227, v227, v230
    v_mfma_f32_16x16x32_bf16 a[64:67], v[32:35], v[136:139], a[64:67]
    buffer_load_dwordx4 v4, s[36:39], s57 offen offset:0 lds
    v_mul_f32 v227, 0x3acccccd, v227
    v_mfma_f32_16x16x32_bf16 a[96:99], v[32:35], v[140:143], a[96:99]
    ds_read_b64_tr_b16 v[32:33], v120 offset:8192
    v_cvt_pk_bf16_f32 v227, v227, v227
    v_lshlrev_b32 v227, 16, v227
    v_mfma_f32_16x16x32_bf16 a[128:131], v[128:131], v[64:67], a[128:131]
    ds_read_b64_tr_b16 v[34:35], v120 offset:9216
    v_add_f32 v227, 0x3727c5ac, v227
    v_mfma_f32_16x16x32_bf16 a[132:135], v[132:135], v[64:67], a[132:135]
    v_cvt_pk_bf16_f32 v227, v227, v227
    v_lshlrev_b32 v227, 16, v227
    v_mfma_f32_16x16x32_bf16 a[192:195], v[136:139], v[64:67], a[192:195]
    v_sqrt_f32 v228, v227
    v_mfma_f32_16x16x32_bf16 a[196:199], v[140:143], v[64:67], a[196:199]
    s_nop 0
    ds_read_b64_tr_b16 v[64:65], v120 offset:24576
    v_cvt_pk_bf16_f32 v228, v228, v228
    v_mfma_f32_16x16x32_bf16 a[4:7], v[36:39], v[128:131], a[4:7]
    ds_read_b64_tr_b16 v[66:67], v120 offset:25600
    v_lshlrev_b32 v228, 16, v228
    v_mfma_f32_16x16x32_bf16 a[36:39], v[36:39], v[132:135], a[36:39]
    ds_read_b128 v[144:147], v22 offset:0
    v_rcp_f32 v229, v228
    v_mfma_f32_16x16x32_bf16 a[68:71], v[36:39], v[136:139], a[68:71]
    s_nop 0
    buffer_load_dwordx4 v5, s[36:39], s57 offen offset:1024 lds
    v_mul_f32 v229, 0x3e0293ee, v229
    v_sub_f32 v230, v160, v226
    v_mfma_f32_16x16x32_bf16 a[100:103], v[36:39], v[140:143], a[100:103]
    ds_read_b64_tr_b16 v[36:37], v121 offset:8192
    v_sub_f32 v231, v161, v226
    v_cvt_pk_bf16_f32 v230, v230, v231
    v_mfma_f32_16x16x32_bf16 a[136:139], v[128:131], v[68:71], a[136:139]
    ds_read_b64_tr_b16 v[38:39], v121 offset:9216
    v_and_b32 v231, 0xffff0000, v230
    v_mfma_f32_16x16x32_bf16 a[140:143], v[132:135], v[68:71], a[140:143]
    v_lshlrev_b32 v230, 16, v230
    v_mul_f32 v230, v230, v229
    v_mfma_f32_16x16x32_bf16 a[200:203], v[136:139], v[68:71], a[200:203]
    ds_read_b128 v[148:151], v22 offset:2048
    v_mul_f32 v231, v231, v229
    v_mfma_f32_16x16x32_bf16 a[204:207], v[140:143], v[68:71], a[204:207]
    ds_read_b64_tr_b16 v[68:69], v121 offset:24576
    v_cvt_pk_bf16_f32 v160, v230, v231
    v_sub_f32 v230, v162, v226
    v_mfma_f32_16x16x32_bf16 a[8:11], v[40:43], v[128:131], a[8:11]
    ds_read_b64_tr_b16 v[70:71], v121 offset:25600
    v_sub_f32 v231, v163, v226
    v_mfma_f32_16x16x32_bf16 a[40:43], v[40:43], v[132:135], a[40:43]
    buffer_load_dwordx4 v6, s[36:39], s57 offen offset:2048 lds
    v_cvt_pk_bf16_f32 v230, v230, v231
    v_and_b32 v231, 0xffff0000, v230
    v_mfma_f32_16x16x32_bf16 a[72:75], v[40:43], v[136:139], a[72:75]
    v_lshlrev_b32 v230, 16, v230
    v_mul_f32 v230, v230, v229
    v_mfma_f32_16x16x32_bf16 a[104:107], v[40:43], v[140:143], a[104:107]
    ds_read_b64_tr_b16 v[40:41], v122 offset:8192
    v_mul_f32 v231, v231, v229
    v_mfma_f32_16x16x32_bf16 a[144:147], v[128:131], v[72:75], a[144:147]
    ds_read_b64_tr_b16 v[42:43], v122 offset:9216
    v_cvt_pk_bf16_f32 v161, v230, v231
    v_sub_f32 v230, v164, v226
    v_mfma_f32_16x16x32_bf16 a[148:151], v[132:135], v[72:75], a[148:151]
    ds_read_b128 v[152:155], v22 offset:4096
    v_sub_f32 v231, v165, v226
    v_mfma_f32_16x16x32_bf16 a[208:211], v[136:139], v[72:75], a[208:211]
    v_cvt_pk_bf16_f32 v230, v230, v231
    v_and_b32 v231, 0xffff0000, v230
    v_mfma_f32_16x16x32_bf16 a[212:215], v[140:143], v[72:75], a[212:215]
    ds_read_b64_tr_b16 v[72:73], v122 offset:24576
    v_lshlrev_b32 v230, 16, v230
    v_mul_f32 v230, v230, v229
    v_mfma_f32_16x16x32_bf16 a[12:15], v[44:47], v[128:131], a[12:15]
    ds_read_b64_tr_b16 v[74:75], v122 offset:25600
    v_mul_f32 v231, v231, v229
    v_mfma_f32_16x16x32_bf16 a[44:47], v[44:47], v[132:135], a[44:47]
    ds_read_b128 v[156:159], v22 offset:6144
    v_cvt_pk_bf16_f32 v162, v230, v231
    v_sub_f32 v230, v166, v226
    v_mfma_f32_16x16x32_bf16 a[76:79], v[44:47], v[136:139], a[76:79]
    buffer_load_dwordx4 v7, s[36:39], s57 offen offset:3072 lds
    v_sub_f32 v231, v167, v226
    v_mfma_f32_16x16x32_bf16 a[108:111], v[44:47], v[140:143], a[108:111]
    ds_read_b64_tr_b16 v[44:45], v123 offset:8192
    v_cvt_pk_bf16_f32 v230, v230, v231
    v_and_b32 v231, 0xffff0000, v230
    v_mfma_f32_16x16x32_bf16 a[152:155], v[128:131], v[76:79], a[152:155]
    ds_read_b64_tr_b16 v[46:47], v123 offset:9216
    v_lshlrev_b32 v230, 16, v230
    v_mfma_f32_16x16x32_bf16 a[156:159], v[132:135], v[76:79], a[156:159]
    v_mul_f32 v230, v230, v229
    v_mul_f32 v231, v231, v229
    v_mfma_f32_16x16x32_bf16 a[216:219], v[136:139], v[76:79], a[216:219]
    v_cvt_pk_bf16_f32 v163, v230, v231
    v_sub_f32 v230, v168, v226
    v_mfma_f32_16x16x32_bf16 a[220:223], v[140:143], v[76:79], a[220:223]
    s_add_u32 m0, s54, 16384
    ds_read_b64_tr_b16 v[76:77], v123 offset:24576
    v_sub_f32 v231, v169, v226
    v_mfma_f32_16x16x32_bf16 a[16:19], v[48:51], v[128:131], a[16:19]
    ds_read_b64_tr_b16 v[78:79], v123 offset:25600
    v_cvt_pk_bf16_f32 v230, v230, v231
    v_and_b32 v231, 0xffff0000, v230
    v_mfma_f32_16x16x32_bf16 a[48:51], v[48:51], v[132:135], a[48:51]
    buffer_load_dwordx4 v4, s[40:43], s57 offen offset:0 lds
    v_lshlrev_b32 v230, 16, v230
    v_mfma_f32_16x16x32_bf16 a[80:83], v[48:51], v[136:139], a[80:83]
    v_mul_f32 v230, v230, v229
    v_mul_f32 v231, v231, v229
    v_mfma_f32_16x16x32_bf16 a[112:115], v[48:51], v[140:143], a[112:115]
    s_waitcnt lgkmcnt(15)
    ds_read_b64_tr_b16 v[48:49], v124 offset:8192
    v_cvt_pk_bf16_f32 v164, v230, v231
    v_sub_f32 v230, v170, v226
    v_mfma_f32_16x16x32_bf16 a[160:163], v[128:131], v[80:83], a[160:163]
    ds_read_b64_tr_b16 v[50:51], v124 offset:9216
    v_sub_f32 v231, v171, v226
    v_mfma_f32_16x16x32_bf16 a[164:167], v[132:135], v[80:83], a[164:167]
    v_cvt_pk_bf16_f32 v230, v230, v231
    v_and_b32 v231, 0xffff0000, v230
    v_mfma_f32_16x16x32_bf16 a[224:227], v[136:139], v[80:83], a[224:227]
    v_lshlrev_b32 v230, 16, v230
    v_mfma_f32_16x16x32_bf16 a[228:231], v[140:143], v[80:83], a[228:231]
    ds_read_b64_tr_b16 v[80:81], v124 offset:24576
    v_mul_f32 v230, v230, v229
    v_mul_f32 v231, v231, v229
    v_mfma_f32_16x16x32_bf16 a[20:23], v[52:55], v[128:131], a[20:23]
    ds_read_b64_tr_b16 v[82:83], v124 offset:25600
    v_cvt_pk_bf16_f32 v165, v230, v231
    v_mfma_f32_16x16x32_bf16 a[52:55], v[52:55], v[132:135], a[52:55]
    buffer_load_dwordx4 v5, s[40:43], s57 offen offset:1024 lds
    v_sub_f32 v230, v172, v226
    v_sub_f32 v231, v173, v226
    v_mfma_f32_16x16x32_bf16 a[84:87], v[52:55], v[136:139], a[84:87]
    v_cvt_pk_bf16_f32 v230, v230, v231
    v_and_b32 v231, 0xffff0000, v230
    v_mfma_f32_16x16x32_bf16 a[116:119], v[52:55], v[140:143], a[116:119]
    ds_read_b64_tr_b16 v[52:53], v125 offset:8192
    v_lshlrev_b32 v230, 16, v230
    v_mfma_f32_16x16x32_bf16 a[168:171], v[128:131], v[84:87], a[168:171]
    ds_read_b64_tr_b16 v[54:55], v125 offset:9216
    v_mul_f32 v230, v230, v229
    v_mul_f32 v231, v231, v229
    v_mfma_f32_16x16x32_bf16 a[172:175], v[132:135], v[84:87], a[172:175]
    v_cvt_pk_bf16_f32 v166, v230, v231
    v_mfma_f32_16x16x32_bf16 a[232:235], v[136:139], v[84:87], a[232:235]
    v_sub_f32 v230, v174, v226
    v_sub_f32 v231, v175, v226
    v_mfma_f32_16x16x32_bf16 a[236:239], v[140:143], v[84:87], a[236:239]
    ds_read_b64_tr_b16 v[84:85], v125 offset:24576
    v_cvt_pk_bf16_f32 v230, v230, v231
    v_and_b32 v231, 0xffff0000, v230
    v_mfma_f32_16x16x32_bf16 a[24:27], v[56:59], v[128:131], a[24:27]
    ds_read_b64_tr_b16 v[86:87], v125 offset:25600
    v_lshlrev_b32 v230, 16, v230
    v_mfma_f32_16x16x32_bf16 a[56:59], v[56:59], v[132:135], a[56:59]
    buffer_load_dwordx4 v6, s[40:43], s57 offen offset:2048 lds
    v_mul_f32 v230, v230, v229
    v_mul_f32 v231, v231, v229
    v_mfma_f32_16x16x32_bf16 a[88:91], v[56:59], v[136:139], a[88:91]
    v_cvt_pk_bf16_f32 v167, v230, v231
    v_mfma_f32_16x16x32_bf16 a[120:123], v[56:59], v[140:143], a[120:123]
    ds_read_b64_tr_b16 v[56:57], v126 offset:8192
    v_sub_f32 v230, v176, v226
    v_sub_f32 v231, v177, v226
    v_mfma_f32_16x16x32_bf16 a[176:179], v[128:131], v[88:91], a[176:179]
    ds_read_b64_tr_b16 v[58:59], v126 offset:9216
    v_cvt_pk_bf16_f32 v230, v230, v231
    v_mfma_f32_16x16x32_bf16 a[180:183], v[132:135], v[88:91], a[180:183]
    v_and_b32 v231, 0xffff0000, v230
    v_lshlrev_b32 v230, 16, v230
    v_mfma_f32_16x16x32_bf16 a[240:243], v[136:139], v[88:91], a[240:243]
    v_mul_f32 v230, v230, v229
    v_mul_f32 v231, v231, v229
    v_mfma_f32_16x16x32_bf16 a[244:247], v[140:143], v[88:91], a[244:247]
    ds_read_b64_tr_b16 v[88:89], v126 offset:24576
    v_cvt_pk_bf16_f32 v168, v230, v231
    v_mfma_f32_16x16x32_bf16 a[28:31], v[60:63], v[128:131], a[28:31]
    ds_read_b64_tr_b16 v[90:91], v126 offset:25600
    v_sub_f32 v230, v178, v226
    v_sub_f32 v231, v179, v226
    v_mfma_f32_16x16x32_bf16 a[60:63], v[60:63], v[132:135], a[60:63]
    buffer_load_dwordx4 v7, s[40:43], s57 offen offset:3072 lds
    v_cvt_pk_bf16_f32 v230, v230, v231
    v_mfma_f32_16x16x32_bf16 a[92:95], v[60:63], v[136:139], a[92:95]
    v_and_b32 v231, 0xffff0000, v230
    v_lshlrev_b32 v230, 16, v230
    v_mfma_f32_16x16x32_bf16 a[124:127], v[60:63], v[140:143], a[124:127]
    ds_read_b64_tr_b16 v[60:61], v127 offset:8192
    v_mul_f32 v230, v230, v229
    v_mul_f32 v231, v231, v229
    v_mfma_f32_16x16x32_bf16 a[184:187], v[128:131], v[92:95], a[184:187]
    ds_read_b64_tr_b16 v[62:63], v127 offset:9216
    v_cvt_pk_bf16_f32 v169, v230, v231
    v_mfma_f32_16x16x32_bf16 a[188:191], v[132:135], v[92:95], a[188:191]
    v_sub_f32 v230, v180, v226
    v_sub_f32 v231, v181, v226
    v_mfma_f32_16x16x32_bf16 a[248:251], v[136:139], v[92:95], a[248:251]
    v_cvt_pk_bf16_f32 v230, v230, v231
    v_mfma_f32_16x16x32_bf16 a[252:255], v[140:143], v[92:95], a[252:255]
    s_waitcnt lgkmcnt(15)
    s_add_u32 s57, s57, 524288
    ds_read_b64_tr_b16 v[92:93], v127 offset:24576
    v_and_b32 v231, 0xffff0000, v230
    v_mfma_f32_16x16x32_bf16 a[0:3], v[32:35], v[144:147], a[0:3]
    s_add_u32 s54, s54, 32768
    ds_read_b64_tr_b16 v[94:95], v127 offset:25600
    v_lshlrev_b32 v230, 16, v230
    v_mul_f32 v230, v230, v229
    v_mfma_f32_16x16x32_bf16 a[32:35], v[32:35], v[148:151], a[32:35]
    s_add_u32 s64, s64, 32768
    s_cmp_ge_u32 s54, 98304
    s_cselect_b32 s54, s50, s54
    v_mul_f32 v231, v231, v229
    v_mfma_f32_16x16x32_bf16 a[64:67], v[32:35], v[152:155], a[64:67]
    s_cmp_ge_u32 s64, 98304
    s_cselect_b32 s64, 0, s64
    v_cvt_pk_bf16_f32 v170, v230, v231
    v_sub_f32 v230, v182, v226
    v_mfma_f32_16x16x32_bf16 a[96:99], v[32:35], v[156:159], a[96:99]
    s_sub_u32 s65, s63, s65
    v_sub_f32 v231, v183, v226
    v_cvt_pk_bf16_f32 v230, v230, v231
    v_mfma_f32_16x16x32_bf16 a[128:131], v[144:147], v[64:67], a[128:131]
    v_add_u32 v21, s65, v20
    v_xor_b32 v22, 64, v21
    v_and_b32 v231, 0xffff0000, v230
    v_mfma_f32_16x16x32_bf16 a[132:135], v[148:151], v[64:67], a[132:135]
    v_add_u32 v120, s64, v8
    v_xor_b32 v121, 32, v120
    v_lshlrev_b32 v230, 16, v230
    v_mfma_f32_16x16x32_bf16 a[192:195], v[152:155], v[64:67], a[192:195]
    v_xor_b32 v122, 64, v120
    v_xor_b32 v123, 96, v120
    v_mul_f32 v230, v230, v229
    v_mfma_f32_16x16x32_bf16 a[196:199], v[156:159], v[64:67], a[196:199]
    s_waitcnt vmcnt(8) lgkmcnt(0)
    s_barrier
    s_mov_b32 s14, 0
sequential_preLN__compressed_kv_cla__moe_arch_mod__prompt_kernel_tagpoll:
    v_readfirstlane_b32 s3, v24
    s_add_u32 s14, s14, 1
    s_nop 2
    s_cmp_lg_u32 s3, 0
    s_cbranch_scc1 sequential_preLN__compressed_kv_cla__moe_arch_mod__prompt_kernel_notag2
    s_cmp_ge_u32 s14, 65536
    s_cbranch_scc1 sequential_preLN__compressed_kv_cla__moe_arch_mod__prompt_kernel_notag2
    buffer_load_dword v24, v26, s[88:91], 0 offen sc1
    s_waitcnt vmcnt(0)
    s_branch sequential_preLN__compressed_kv_cla__moe_arch_mod__prompt_kernel_tagpoll
sequential_preLN__compressed_kv_cla__moe_arch_mod__prompt_kernel_notag2:
    v_xor_b32 v124, 128, v120
    v_mfma_f32_16x16x32_bf16 a[4:7], v[36:39], v[144:147], a[4:7]
    s_add_u32 s48, s62, 0
    v_xor_b32 v125, 160, v120
    v_xor_b32 v126, 192, v120
    v_mul_f32 v231, v231, v229
    v_mfma_f32_16x16x32_bf16 a[36:39], v[36:39], v[148:151], a[36:39]
    s_add_u32 m0, s55, 0
    v_xor_b32 v127, 224, v120
    v_cvt_pk_bf16_f32 v171, v230, v231
    v_sub_f32 v230, v184, v226
    v_mfma_f32_16x16x32_bf16 a[68:71], v[36:39], v[152:155], a[68:71]
    buffer_load_dwordx4 v16, s[4:7], s48 offen offset:0 lds
    v_sub_f32 v231, v185, v226
    v_cvt_pk_bf16_f32 v230, v230, v231
    v_mfma_f32_16x16x32_bf16 a[100:103], v[36:39], v[156:159], a[100:103]
    v_and_b32 v231, 0xffff0000, v230
    v_lshlrev_b32 v230, 16, v230
    v_mul_f32 v230, v230, v229
    v_mfma_f32_16x16x32_bf16 a[136:139], v[144:147], v[68:71], a[136:139]
    buffer_load_dwordx4 v17, s[4:7], s48 offen offset:1024 lds
    v_mul_f32 v231, v231, v229
    v_cvt_pk_bf16_f32 v172, v230, v231
    v_mfma_f32_16x16x32_bf16 a[140:143], v[148:151], v[68:71], a[140:143]
    v_sub_f32 v230, v186, v226
    v_sub_f32 v231, v187, v226
    v_cvt_pk_bf16_f32 v230, v230, v231
    v_mfma_f32_16x16x32_bf16 a[200:203], v[152:155], v[68:71], a[200:203]
    v_and_b32 v231, 0xffff0000, v230
    v_lshlrev_b32 v230, 16, v230
    v_mfma_f32_16x16x32_bf16 a[204:207], v[156:159], v[68:71], a[204:207]
    v_mul_f32 v230, v230, v229
    v_mfma_f32_16x16x32_bf16 a[8:11], v[40:43], v[144:147], a[8:11]
    buffer_load_dwordx4 v18, s[4:7], s48 offen offset:2048 lds
    v_mul_f32 v231, v231, v229
    v_cvt_pk_bf16_f32 v173, v230, v231
    v_mfma_f32_16x16x32_bf16 a[40:43], v[40:43], v[148:151], a[40:43]
    ds_read_b64_tr_b16 v[32:33], v120 offset:0
    v_sub_f32 v230, v188, v226
    v_mfma_f32_16x16x32_bf16 a[72:75], v[40:43], v[152:155], a[72:75]
    ds_read_b64_tr_b16 v[34:35], v120 offset:1024
    v_sub_f32 v231, v189, v226
    v_cvt_pk_bf16_f32 v230, v230, v231
    v_mfma_f32_16x16x32_bf16 a[104:107], v[40:43], v[156:159], a[104:107]
    ds_read_b64_tr_b16 v[64:65], v120 offset:16384
    v_and_b32 v231, 0xffff0000, v230
    v_lshlrev_b32 v230, 16, v230
    v_mfma_f32_16x16x32_bf16 a[144:147], v[144:147], v[72:75], a[144:147]
    ds_read_b64_tr_b16 v[66:67], v120 offset:17408
    v_mul_f32 v230, v230, v229
    v_mfma_f32_16x16x32_bf16 a[148:151], v[148:151], v[72:75], a[148:151]
    ds_read_b64_tr_b16 v[36:37], v121 offset:0
    v_mul_f32 v231, v231, v229
    v_cvt_pk_bf16_f32 v174, v230, v231
    v_mfma_f32_16x16x32_bf16 a[208:211], v[152:155], v[72:75], a[208:211]
    ds_read_b64_tr_b16 v[38:39], v121 offset:1024
    v_sub_f32 v230, v190, v226
    v_mfma_f32_16x16x32_bf16 a[212:215], v[156:159], v[72:75], a[212:215]
    ds_read_b64_tr_b16 v[68:69], v121 offset:16384
    v_sub_f32 v231, v191, v226
    v_cvt_pk_bf16_f32 v230, v230, v231
    v_mfma_f32_16x16x32_bf16 a[12:15], v[44:47], v[144:147], a[12:15]
    ds_read_b64_tr_b16 v[70:71], v121 offset:17408
    v_and_b32 v231, 0xffff0000, v230
    v_lshlrev_b32 v230, 16, v230
    v_mfma_f32_16x16x32_bf16 a[44:47], v[44:47], v[148:151], a[44:47]
    ds_read_b64_tr_b16 v[40:41], v122 offset:0
    v_mul_f32 v230, v230, v229
    v_mfma_f32_16x16x32_bf16 a[76:79], v[44:47], v[152:155], a[76:79]
    ds_read_b64_tr_b16 v[42:43], v122 offset:1024
    v_mul_f32 v231, v231, v229
    v_cvt_pk_bf16_f32 v175, v230, v231
    v_mfma_f32_16x16x32_bf16 a[108:111], v[44:47], v[156:159], a[108:111]
    ds_read_b64_tr_b16 v[72:73], v122 offset:16384
    v_sub_f32 v230, v192, v226
    v_mfma_f32_16x16x32_bf16 a[152:155], v[144:147], v[76:79], a[152:155]
    ds_read_b64_tr_b16 v[74:75], v122 offset:17408
    v_sub_f32 v231, v193, v226
    v_cvt_pk_bf16_f32 v230, v230, v231
    v_mfma_f32_16x16x32_bf16 a[156:159], v[148:151], v[76:79], a[156:159]
    ds_read_b64_tr_b16 v[44:45], v123 offset:0
    v_and_b32 v231, 0xffff0000, v230
    v_mfma_f32_16x16x32_bf16 a[216:219], v[152:155], v[76:79], a[216:219]
    ds_read_b64_tr_b16 v[46:47], v123 offset:1024
    v_lshlrev_b32 v230, 16, v230
    v_mul_f32 v230, v230, v229
    v_mfma_f32_16x16x32_bf16 a[220:223], v[156:159], v[76:79], a[220:223]
    ds_read_b64_tr_b16 v[76:77], v123 offset:16384
    v_mul_f32 v231, v231, v229
    v_cvt_pk_bf16_f32 v176, v230, v231
    v_mfma_f32_16x16x32_bf16 a[16:19], v[48:51], v[144:147], a[16:19]
    ds_read_b64_tr_b16 v[78:79], v123 offset:17408
    v_sub_f32 v230, v194, v226
    v_mfma_f32_16x16x32_bf16 a[48:51], v[48:51], v[148:151], a[48:51]
    ds_read_b128 v[128:131], v21 offset:0
    v_sub_f32 v231, v195, v226
    v_cvt_pk_bf16_f32 v230, v230, v231
    v_mfma_f32_16x16x32_bf16 a[80:83], v[48:51], v[152:155], a[80:83]
    ds_read_b128 v[132:135], v21 offset:2048
    v_and_b32 v231, 0xffff0000, v230
    v_mfma_f32_16x16x32_bf16 a[112:115], v[48:51], v[156:159], a[112:115]
    ds_read_b64_tr_b16 v[48:49], v124 offset:0
    v_lshlrev_b32 v230, 16, v230
    v_mul_f32 v230, v230, v229
    v_mfma_f32_16x16x32_bf16 a[160:163], v[144:147], v[80:83], a[160:163]
    ds_read_b64_tr_b16 v[50:51], v124 offset:1024
    v_mul_f32 v231, v231, v229
    v_cvt_pk_bf16_f32 v177, v230, v231
    v_mfma_f32_16x16x32_bf16 a[164:167], v[148:151], v[80:83], a[164:167]
    ds_read_b128 v[136:139], v21 offset:4096
    v_sub_f32 v230, v196, v226
    v_mfma_f32_16x16x32_bf16 a[224:227], v[152:155], v[80:83], a[224:227]
    ds_read_b128 v[140:143], v21 offset:6144
    v_sub_f32 v231, v197, v226
    v_cvt_pk_bf16_f32 v230, v230, v231
    v_mfma_f32_16x16x32_bf16 a[228:231], v[156:159], v[80:83], a[228:231]
    ds_read_b64_tr_b16 v[80:81], v124 offset:16384
    v_and_b32 v231, 0xffff0000, v230
    v_mfma_f32_16x16x32_bf16 a[20:23], v[52:55], v[144:147], a[20:23]
    ds_read_b64_tr_b16 v[82:83], v124 offset:17408
    v_lshlrev_b32 v230, 16, v230
    v_mul_f32 v230, v230, v229
    v_mfma_f32_16x16x32_bf16 a[52:55], v[52:55], v[148:151], a[52:55]
    buffer_load_dwordx4 v19, s[4:7], s48 offen offset:3072 lds
    v_mul_f32 v231, v231, v229
    v_mfma_f32_16x16x32_bf16 a[84:87], v[52:55], v[152:155], a[84:87]
    s_add_u32 s48, s62, 32768
    s_add_u32 m0, s55, 4096
    v_cvt_pk_bf16_f32 v178, v230, v231
    v_sub_f32 v230, v198, v226
    v_mfma_f32_16x16x32_bf16 a[116:119], v[52:55], v[156:159], a[116:119]
    ds_read_b64_tr_b16 v[52:53], v125 offset:0
    buffer_load_dwordx4 v16, s[4:7], s48 offen offset:0 lds
    v_mfma_f32_16x16x32_bf16 a[168:171], v[144:147], v[84:87], a[168:171]
    ds_read_b64_tr_b16 v[54:55], v125 offset:1024
    buffer_load_dwordx4 v17, s[4:7], s48 offen offset:1024 lds
    v_mfma_f32_16x16x32_bf16 a[172:175], v[148:151], v[84:87], a[172:175]
    buffer_load_dwordx4 v18, s[4:7], s48 offen offset:2048 lds
    v_sub_f32 v231, v199, v226
    v_cvt_pk_bf16_f32 v230, v230, v231
    v_mfma_f32_16x16x32_bf16 a[232:235], v[152:155], v[84:87], a[232:235]
    buffer_load_dwordx4 v19, s[4:7], s48 offen offset:3072 lds
    v_and_b32 v231, 0xffff0000, v230
    v_lshlrev_b32 v230, 16, v230
    v_mfma_f32_16x16x32_bf16 a[236:239], v[156:159], v[84:87], a[236:239]
    s_add_u32 s62, s62, 128
    s_sub_u32 s55, s63, s55
    ds_read_b64_tr_b16 v[84:85], v125 offset:16384
    v_mfma_f32_16x16x32_bf16 a[24:27], v[56:59], v[144:147], a[24:27]
    ds_read_b64_tr_b16 v[86:87], v125 offset:17408
    v_mul_f32 v230, v230, v229
    v_mul_f32 v231, v231, v229
    v_mfma_f32_16x16x32_bf16 a[56:59], v[56:59], v[148:151], a[56:59]
    v_cvt_pk_bf16_f32 v179, v230, v231
    v_mfma_f32_16x16x32_bf16 a[88:91], v[56:59], v[152:155], a[88:91]
    s_mov_b32 s14, 0
    buffer_store_dwordx4 v[160:163], v221, s[96:99], s14 offen sc1
    v_mfma_f32_16x16x32_bf16 a[120:123], v[56:59], v[156:159], a[120:123]
    s_mov_b32 s14, 4096
    ds_read_b64_tr_b16 v[56:57], v126 offset:0
    v_mfma_f32_16x16x32_bf16 a[176:179], v[144:147], v[88:91], a[176:179]
    ds_read_b64_tr_b16 v[58:59], v126 offset:1024
    v_mfma_f32_16x16x32_bf16 a[180:183], v[148:151], v[88:91], a[180:183]
    buffer_store_dwordx4 v[164:167], v221, s[96:99], s14 offen sc1
    v_mfma_f32_16x16x32_bf16 a[240:243], v[152:155], v[88:91], a[240:243]
    s_mov_b32 s14, 8192
    buffer_store_dwordx4 v[168:171], v221, s[96:99], s14 offen sc1
    v_mfma_f32_16x16x32_bf16 a[244:247], v[156:159], v[88:91], a[244:247]
    s_mov_b32 s14, 12288
    ds_read_b64_tr_b16 v[88:89], v126 offset:16384
    v_mfma_f32_16x16x32_bf16 a[28:31], v[60:63], v[144:147], a[28:31]
    ds_read_b64_tr_b16 v[90:91], v126 offset:17408
    v_mfma_f32_16x16x32_bf16 a[60:63], v[60:63], v[148:151], a[60:63]
    buffer_store_dwordx4 v[172:175], v221, s[96:99], s14 offen sc1
    v_mfma_f32_16x16x32_bf16 a[92:95], v[60:63], v[152:155], a[92:95]
    s_mov_b32 s14, 16384
    buffer_store_dwordx4 v[176:179], v221, s[96:99], s14 offen sc1
    v_mfma_f32_16x16x32_bf16 a[124:127], v[60:63], v[156:159], a[124:127]
    ds_read_b64_tr_b16 v[60:61], v127 offset:0
    v_mfma_f32_16x16x32_bf16 a[184:187], v[144:147], v[92:95], a[184:187]
    ds_read_b64_tr_b16 v[62:63], v127 offset:1024
    v_mfma_f32_16x16x32_bf16 a[188:191], v[148:151], v[92:95], a[188:191]
    v_mfma_f32_16x16x32_bf16 a[248:251], v[152:155], v[92:95], a[248:251]
    v_mfma_f32_16x16x32_bf16 a[252:255], v[156:159], v[92:95], a[252:255]
    ds_read_b64_tr_b16 v[92:93], v127 offset:16384
    ds_read_b64_tr_b16 v[94:95], v127 offset:17408
    s_mov_b32 s61, 0
sequential_preLN__compressed_kv_cla__moe_arch_mod__prompt_kernel_stageA:
    s_waitcnt lgkmcnt(14)
    v_mfma_f32_16x16x32_bf16 a[0:3], v[32:35], v[128:131], a[0:3]
    v_mfma_f32_16x16x32_bf16 a[32:35], v[32:35], v[132:135], a[32:35]
    s_add_u32 m0, s54, 0
    v_mfma_f32_16x16x32_bf16 a[64:67], v[32:35], v[136:139], a[64:67]
    buffer_load_dwordx4 v4, s[36:39], s57 offen offset:0 lds
    v_mfma_f32_16x16x32_bf16 a[96:99], v[32:35], v[140:143], a[96:99]
    ds_read_b64_tr_b16 v[32:33], v120 offset:8192
    v_mfma_f32_16x16x32_bf16 a[128:131], v[128:131], v[64:67], a[128:131]
    ds_read_b64_tr_b16 v[34:35], v120 offset:9216
    v_mfma_f32_16x16x32_bf16 a[132:135], v[132:135], v[64:67], a[132:135]
    v_mfma_f32_16x16x32_bf16 a[192:195], v[136:139], v[64:67], a[192:195]
    v_mfma_f32_16x16x32_bf16 a[196:199], v[140:143], v[64:67], a[196:199]
    ds_read_b64_tr_b16 v[64:65], v120 offset:24576
    v_mfma_f32_16x16x32_bf16 a[4:7], v[36:39], v[128:131], a[4:7]
    ds_read_b64_tr_b16 v[66:67], v120 offset:25600
    v_mfma_f32_16x16x32_bf16 a[36:39], v[36:39], v[132:135], a[36:39]
    ds_read_b128 v[144:147], v22 offset:0
    v_mfma_f32_16x16x32_bf16 a[68:71], v[36:39], v[136:139], a[68:71]
    buffer_load_dwordx4 v5, s[36:39], s57 offen offset:1024 lds
    v_mfma_f32_16x16x32_bf16 a[100:103], v[36:39], v[140:143], a[100:103]
    ds_read_b64_tr_b16 v[36:37], v121 offset:8192
    v_mfma_f32_16x16x32_bf16 a[136:139], v[128:131], v[68:71], a[136:139]
    ds_read_b64_tr_b16 v[38:39], v121 offset:9216
    v_mfma_f32_16x16x32_bf16 a[140:143], v[132:135], v[68:71], a[140:143]
    v_mfma_f32_16x16x32_bf16 a[200:203], v[136:139], v[68:71], a[200:203]
    ds_read_b128 v[148:151], v22 offset:2048
    v_mfma_f32_16x16x32_bf16 a[204:207], v[140:143], v[68:71], a[204:207]
    ds_read_b64_tr_b16 v[68:69], v121 offset:24576
    v_mfma_f32_16x16x32_bf16 a[8:11], v[40:43], v[128:131], a[8:11]
    ds_read_b64_tr_b16 v[70:71], v121 offset:25600
    v_mfma_f32_16x16x32_bf16 a[40:43], v[40:43], v[132:135], a[40:43]
    buffer_load_dwordx4 v6, s[36:39], s57 offen offset:2048 lds
    v_mfma_f32_16x16x32_bf16 a[72:75], v[40:43], v[136:139], a[72:75]
    v_mfma_f32_16x16x32_bf16 a[104:107], v[40:43], v[140:143], a[104:107]
    ds_read_b64_tr_b16 v[40:41], v122 offset:8192
    v_mfma_f32_16x16x32_bf16 a[144:147], v[128:131], v[72:75], a[144:147]
    ds_read_b64_tr_b16 v[42:43], v122 offset:9216
    v_mfma_f32_16x16x32_bf16 a[148:151], v[132:135], v[72:75], a[148:151]
    ds_read_b128 v[152:155], v22 offset:4096
    v_mfma_f32_16x16x32_bf16 a[208:211], v[136:139], v[72:75], a[208:211]
    v_mfma_f32_16x16x32_bf16 a[212:215], v[140:143], v[72:75], a[212:215]
    ds_read_b64_tr_b16 v[72:73], v122 offset:24576
    v_mfma_f32_16x16x32_bf16 a[12:15], v[44:47], v[128:131], a[12:15]
    ds_read_b64_tr_b16 v[74:75], v122 offset:25600
    v_mfma_f32_16x16x32_bf16 a[44:47], v[44:47], v[132:135], a[44:47]
    ds_read_b128 v[156:159], v22 offset:6144
    v_mfma_f32_16x16x32_bf16 a[76:79], v[44:47], v[136:139], a[76:79]
    buffer_load_dwordx4 v7, s[36:39], s57 offen offset:3072 lds
    v_mfma_f32_16x16x32_bf16 a[108:111], v[44:47], v[140:143], a[108:111]
    ds_read_b64_tr_b16 v[44:45], v123 offset:8192
    v_mfma_f32_16x16x32_bf16 a[152:155], v[128:131], v[76:79], a[152:155]
    ds_read_b64_tr_b16 v[46:47], v123 offset:9216
    v_mfma_f32_16x16x32_bf16 a[156:159], v[132:135], v[76:79], a[156:159]
    v_mfma_f32_16x16x32_bf16 a[216:219], v[136:139], v[76:79], a[216:219]
    v_mfma_f32_16x16x32_bf16 a[220:223], v[140:143], v[76:79], a[220:223]
    s_add_u32 m0, s54, 16384
    ds_read_b64_tr_b16 v[76:77], v123 offset:24576
    v_mfma_f32_16x16x32_bf16 a[16:19], v[48:51], v[128:131], a[16:19]
    ds_read_b64_tr_b16 v[78:79], v123 offset:25600
    v_mfma_f32_16x16x32_bf16 a[48:51], v[48:51], v[132:135], a[48:51]
    buffer_load_dwordx4 v4, s[40:43], s57 offen offset:0 lds
    v_mfma_f32_16x16x32_bf16 a[80:83], v[48:51], v[136:139], a[80:83]
    v_mfma_f32_16x16x32_bf16 a[112:115], v[48:51], v[140:143], a[112:115]
    s_waitcnt lgkmcnt(15)
    ds_read_b64_tr_b16 v[48:49], v124 offset:8192
    v_mfma_f32_16x16x32_bf16 a[160:163], v[128:131], v[80:83], a[160:163]
    ds_read_b64_tr_b16 v[50:51], v124 offset:9216
    v_mfma_f32_16x16x32_bf16 a[164:167], v[132:135], v[80:83], a[164:167]
    v_mfma_f32_16x16x32_bf16 a[224:227], v[136:139], v[80:83], a[224:227]
    v_mfma_f32_16x16x32_bf16 a[228:231], v[140:143], v[80:83], a[228:231]
    ds_read_b64_tr_b16 v[80:81], v124 offset:24576
    v_mfma_f32_16x16x32_bf16 a[20:23], v[52:55], v[128:131], a[20:23]
    ds_read_b64_tr_b16 v[82:83], v124 offset:25600
    v_mfma_f32_16x16x32_bf16 a[52:55], v[52:55], v[132:135], a[52:55]
    buffer_load_dwordx4 v5, s[40:43], s57 offen offset:1024 lds
    v_mfma_f32_16x16x32_bf16 a[84:87], v[52:55], v[136:139], a[84:87]
    v_mfma_f32_16x16x32_bf16 a[116:119], v[52:55], v[140:143], a[116:119]
    ds_read_b64_tr_b16 v[52:53], v125 offset:8192
    v_mfma_f32_16x16x32_bf16 a[168:171], v[128:131], v[84:87], a[168:171]
    ds_read_b64_tr_b16 v[54:55], v125 offset:9216
    v_mfma_f32_16x16x32_bf16 a[172:175], v[132:135], v[84:87], a[172:175]
    v_mfma_f32_16x16x32_bf16 a[232:235], v[136:139], v[84:87], a[232:235]
    v_mfma_f32_16x16x32_bf16 a[236:239], v[140:143], v[84:87], a[236:239]
    ds_read_b64_tr_b16 v[84:85], v125 offset:24576
    v_mfma_f32_16x16x32_bf16 a[24:27], v[56:59], v[128:131], a[24:27]
    ds_read_b64_tr_b16 v[86:87], v125 offset:25600
    v_mfma_f32_16x16x32_bf16 a[56:59], v[56:59], v[132:135], a[56:59]
    buffer_load_dwordx4 v6, s[40:43], s57 offen offset:2048 lds
    v_mfma_f32_16x16x32_bf16 a[88:91], v[56:59], v[136:139], a[88:91]
    v_mfma_f32_16x16x32_bf16 a[120:123], v[56:59], v[140:143], a[120:123]
    ds_read_b64_tr_b16 v[56:57], v126 offset:8192
    v_mfma_f32_16x16x32_bf16 a[176:179], v[128:131], v[88:91], a[176:179]
    ds_read_b64_tr_b16 v[58:59], v126 offset:9216
    v_mfma_f32_16x16x32_bf16 a[180:183], v[132:135], v[88:91], a[180:183]
    v_mfma_f32_16x16x32_bf16 a[240:243], v[136:139], v[88:91], a[240:243]
    v_mfma_f32_16x16x32_bf16 a[244:247], v[140:143], v[88:91], a[244:247]
    ds_read_b64_tr_b16 v[88:89], v126 offset:24576
    v_mfma_f32_16x16x32_bf16 a[28:31], v[60:63], v[128:131], a[28:31]
    ds_read_b64_tr_b16 v[90:91], v126 offset:25600
    v_mfma_f32_16x16x32_bf16 a[60:63], v[60:63], v[132:135], a[60:63]
    buffer_load_dwordx4 v7, s[40:43], s57 offen offset:3072 lds
    v_mfma_f32_16x16x32_bf16 a[92:95], v[60:63], v[136:139], a[92:95]
    v_mfma_f32_16x16x32_bf16 a[124:127], v[60:63], v[140:143], a[124:127]
    ds_read_b64_tr_b16 v[60:61], v127 offset:8192
    v_mfma_f32_16x16x32_bf16 a[184:187], v[128:131], v[92:95], a[184:187]
    ds_read_b64_tr_b16 v[62:63], v127 offset:9216
    v_mfma_f32_16x16x32_bf16 a[188:191], v[132:135], v[92:95], a[188:191]
    v_mfma_f32_16x16x32_bf16 a[248:251], v[136:139], v[92:95], a[248:251]
    v_mfma_f32_16x16x32_bf16 a[252:255], v[140:143], v[92:95], a[252:255]
    s_waitcnt lgkmcnt(15)
    s_add_u32 s57, s57, 524288
    ds_read_b64_tr_b16 v[92:93], v127 offset:24576
    v_mfma_f32_16x16x32_bf16 a[0:3], v[32:35], v[144:147], a[0:3]
    s_add_u32 s54, s54, 32768
    ds_read_b64_tr_b16 v[94:95], v127 offset:25600
    v_mfma_f32_16x16x32_bf16 a[32:35], v[32:35], v[148:151], a[32:35]
    s_add_u32 s64, s64, 32768
    s_cmp_ge_u32 s54, 98304
    s_cselect_b32 s54, s50, s54
    v_mfma_f32_16x16x32_bf16 a[64:67], v[32:35], v[152:155], a[64:67]
    s_cmp_ge_u32 s64, 98304
    s_cselect_b32 s64, 0, s64
    v_mfma_f32_16x16x32_bf16 a[96:99], v[32:35], v[156:159], a[96:99]
    s_sub_u32 s65, s63, s65
    v_mfma_f32_16x16x32_bf16 a[128:131], v[144:147], v[64:67], a[128:131]
    v_add_u32 v21, s65, v20
    v_xor_b32 v22, 64, v21
    v_mfma_f32_16x16x32_bf16 a[132:135], v[148:151], v[64:67], a[132:135]
    v_add_u32 v120, s64, v8
    v_xor_b32 v121, 32, v120
    v_mfma_f32_16x16x32_bf16 a[192:195], v[152:155], v[64:67], a[192:195]
    v_xor_b32 v122, 64, v120
    v_xor_b32 v123, 96, v120
    v_mfma_f32_16x16x32_bf16 a[196:199], v[156:159], v[64:67], a[196:199]
    s_waitcnt vmcnt(8) lgkmcnt(0)
    s_barrier
    s_cmp_lg_u32 s61, 0
    s_cbranch_scc1 sequential_preLN__compressed_kv_cla__moe_arch_mod__prompt_kernel_nopub
    s_cmp_lg_u32 s44, 0
    s_cbranch_scc1 sequential_preLN__compressed_kv_cla__moe_arch_mod__prompt_kernel_nopub
    s_lshl_b32 s14, s2, 3
    v_mov_b32 v24, s3
    v_mov_b32 v25, s67
    v_mov_b32 v26, 0
    buffer_store_dwordx2 v[24:25], v26, s[68:71], s14 offen sc1
sequential_preLN__compressed_kv_cla__moe_arch_mod__prompt_kernel_nopub:
    v_xor_b32 v124, 128, v120
    v_mfma_f32_16x16x32_bf16 a[4:7], v[36:39], v[144:147], a[4:7]
    s_add_u32 s48, s62, 0
    v_xor_b32 v125, 160, v120
    v_xor_b32 v126, 192, v120
    v_mfma_f32_16x16x32_bf16 a[36:39], v[36:39], v[148:151], a[36:39]
    s_add_u32 m0, s55, 0
    v_xor_b32 v127, 224, v120
    v_mfma_f32_16x16x32_bf16 a[68:71], v[36:39], v[152:155], a[68:71]
    buffer_load_dwordx4 v16, s[4:7], s48 offen offset:0 lds
    v_mfma_f32_16x16x32_bf16 a[100:103], v[36:39], v[156:159], a[100:103]
    v_mfma_f32_16x16x32_bf16 a[136:139], v[144:147], v[68:71], a[136:139]
    buffer_load_dwordx4 v17, s[4:7], s48 offen offset:1024 lds
    v_mfma_f32_16x16x32_bf16 a[140:143], v[148:151], v[68:71], a[140:143]
    v_mfma_f32_16x16x32_bf16 a[200:203], v[152:155], v[68:71], a[200:203]
    v_mfma_f32_16x16x32_bf16 a[204:207], v[156:159], v[68:71], a[204:207]
    v_mfma_f32_16x16x32_bf16 a[8:11], v[40:43], v[144:147], a[8:11]
    buffer_load_dwordx4 v18, s[4:7], s48 offen offset:2048 lds
    v_mfma_f32_16x16x32_bf16 a[40:43], v[40:43], v[148:151], a[40:43]
    ds_read_b64_tr_b16 v[32:33], v120 offset:0
    v_mfma_f32_16x16x32_bf16 a[72:75], v[40:43], v[152:155], a[72:75]
    ds_read_b64_tr_b16 v[34:35], v120 offset:1024
    v_mfma_f32_16x16x32_bf16 a[104:107], v[40:43], v[156:159], a[104:107]
    ds_read_b64_tr_b16 v[64:65], v120 offset:16384
    v_mfma_f32_16x16x32_bf16 a[144:147], v[144:147], v[72:75], a[144:147]
    ds_read_b64_tr_b16 v[66:67], v120 offset:17408
    v_mfma_f32_16x16x32_bf16 a[148:151], v[148:151], v[72:75], a[148:151]
    ds_read_b64_tr_b16 v[36:37], v121 offset:0
    v_mfma_f32_16x16x32_bf16 a[208:211], v[152:155], v[72:75], a[208:211]
    ds_read_b64_tr_b16 v[38:39], v121 offset:1024
    v_mfma_f32_16x16x32_bf16 a[212:215], v[156:159], v[72:75], a[212:215]
    ds_read_b64_tr_b16 v[68:69], v121 offset:16384
    v_mfma_f32_16x16x32_bf16 a[12:15], v[44:47], v[144:147], a[12:15]
    ds_read_b64_tr_b16 v[70:71], v121 offset:17408
    v_mfma_f32_16x16x32_bf16 a[44:47], v[44:47], v[148:151], a[44:47]
    ds_read_b64_tr_b16 v[40:41], v122 offset:0
    v_mfma_f32_16x16x32_bf16 a[76:79], v[44:47], v[152:155], a[76:79]
    ds_read_b64_tr_b16 v[42:43], v122 offset:1024
    v_mfma_f32_16x16x32_bf16 a[108:111], v[44:47], v[156:159], a[108:111]
    ds_read_b64_tr_b16 v[72:73], v122 offset:16384
    v_mfma_f32_16x16x32_bf16 a[152:155], v[144:147], v[76:79], a[152:155]
    ds_read_b64_tr_b16 v[74:75], v122 offset:17408
    v_mfma_f32_16x16x32_bf16 a[156:159], v[148:151], v[76:79], a[156:159]
    ds_read_b64_tr_b16 v[44:45], v123 offset:0
    v_mfma_f32_16x16x32_bf16 a[216:219], v[152:155], v[76:79], a[216:219]
    ds_read_b64_tr_b16 v[46:47], v123 offset:1024
    v_mfma_f32_16x16x32_bf16 a[220:223], v[156:159], v[76:79], a[220:223]
    ds_read_b64_tr_b16 v[76:77], v123 offset:16384
    v_mfma_f32_16x16x32_bf16 a[16:19], v[48:51], v[144:147], a[16:19]
    ds_read_b64_tr_b16 v[78:79], v123 offset:17408
    v_mfma_f32_16x16x32_bf16 a[48:51], v[48:51], v[148:151], a[48:51]
    ds_read_b128 v[128:131], v21 offset:0
    v_mfma_f32_16x16x32_bf16 a[80:83], v[48:51], v[152:155], a[80:83]
    ds_read_b128 v[132:135], v21 offset:2048
    v_mfma_f32_16x16x32_bf16 a[112:115], v[48:51], v[156:159], a[112:115]
    ds_read_b64_tr_b16 v[48:49], v124 offset:0
    v_mfma_f32_16x16x32_bf16 a[160:163], v[144:147], v[80:83], a[160:163]
    ds_read_b64_tr_b16 v[50:51], v124 offset:1024
    v_mfma_f32_16x16x32_bf16 a[164:167], v[148:151], v[80:83], a[164:167]
    ds_read_b128 v[136:139], v21 offset:4096
    v_mfma_f32_16x16x32_bf16 a[224:227], v[152:155], v[80:83], a[224:227]
    ds_read_b128 v[140:143], v21 offset:6144
    v_mfma_f32_16x16x32_bf16 a[228:231], v[156:159], v[80:83], a[228:231]
    ds_read_b64_tr_b16 v[80:81], v124 offset:16384
    v_mfma_f32_16x16x32_bf16 a[20:23], v[52:55], v[144:147], a[20:23]
    ds_read_b64_tr_b16 v[82:83], v124 offset:17408
    v_mfma_f32_16x16x32_bf16 a[52:55], v[52:55], v[148:151], a[52:55]
    buffer_load_dwordx4 v19, s[4:7], s48 offen offset:3072 lds
    v_mfma_f32_16x16x32_bf16 a[84:87], v[52:55], v[152:155], a[84:87]
    s_add_u32 s48, s62, 32768
    s_add_u32 m0, s55, 4096
    v_mfma_f32_16x16x32_bf16 a[116:119], v[52:55], v[156:159], a[116:119]
    ds_read_b64_tr_b16 v[52:53], v125 offset:0
    buffer_load_dwordx4 v16, s[4:7], s48 offen offset:0 lds
    v_mfma_f32_16x16x32_bf16 a[168:171], v[144:147], v[84:87], a[168:171]
    ds_read_b64_tr_b16 v[54:55], v125 offset:1024
    buffer_load_dwordx4 v17, s[4:7], s48 offen offset:1024 lds
    v_mfma_f32_16x16x32_bf16 a[172:175], v[148:151], v[84:87], a[172:175]
    buffer_load_dwordx4 v18, s[4:7], s48 offen offset:2048 lds
    v_mfma_f32_16x16x32_bf16 a[232:235], v[152:155], v[84:87], a[232:235]
    buffer_load_dwordx4 v19, s[4:7], s48 offen offset:3072 lds
    v_mfma_f32_16x16x32_bf16 a[236:239], v[156:159], v[84:87], a[236:239]
    s_add_u32 s62, s62, 128
    s_sub_u32 s55, s63, s55
    ds_read_b64_tr_b16 v[84:85], v125 offset:16384
    v_mfma_f32_16x16x32_bf16 a[24:27], v[56:59], v[144:147], a[24:27]
    ds_read_b64_tr_b16 v[86:87], v125 offset:17408
    v_mfma_f32_16x16x32_bf16 a[56:59], v[56:59], v[148:151], a[56:59]
    v_mfma_f32_16x16x32_bf16 a[88:91], v[56:59], v[152:155], a[88:91]
    v_mfma_f32_16x16x32_bf16 a[120:123], v[56:59], v[156:159], a[120:123]
    ds_read_b64_tr_b16 v[56:57], v126 offset:0
    v_mfma_f32_16x16x32_bf16 a[176:179], v[144:147], v[88:91], a[176:179]
    ds_read_b64_tr_b16 v[58:59], v126 offset:1024
    v_mfma_f32_16x16x32_bf16 a[180:183], v[148:151], v[88:91], a[180:183]
    v_mfma_f32_16x16x32_bf16 a[240:243], v[152:155], v[88:91], a[240:243]
    v_mfma_f32_16x16x32_bf16 a[244:247], v[156:159], v[88:91], a[244:247]
    ds_read_b64_tr_b16 v[88:89], v126 offset:16384
    v_mfma_f32_16x16x32_bf16 a[28:31], v[60:63], v[144:147], a[28:31]
    ds_read_b64_tr_b16 v[90:91], v126 offset:17408
    v_mfma_f32_16x16x32_bf16 a[60:63], v[60:63], v[148:151], a[60:63]
    v_mfma_f32_16x16x32_bf16 a[92:95], v[60:63], v[152:155], a[92:95]
    v_mfma_f32_16x16x32_bf16 a[124:127], v[60:63], v[156:159], a[124:127]
    ds_read_b64_tr_b16 v[60:61], v127 offset:0
    v_mfma_f32_16x16x32_bf16 a[184:187], v[144:147], v[92:95], a[184:187]
    ds_read_b64_tr_b16 v[62:63], v127 offset:1024
    v_mfma_f32_16x16x32_bf16 a[188:191], v[148:151], v[92:95], a[188:191]
    v_mfma_f32_16x16x32_bf16 a[248:251], v[152:155], v[92:95], a[248:251]
    v_mfma_f32_16x16x32_bf16 a[252:255], v[156:159], v[92:95], a[252:255]
    ds_read_b64_tr_b16 v[92:93], v127 offset:16384
    ds_read_b64_tr_b16 v[94:95], v127 offset:17408
    s_add_u32 s61, s61, 1
    s_cmp_lt_u32 s61, 4
    s_cbranch_scc1 sequential_preLN__compressed_kv_cla__moe_arch_mod__prompt_kernel_stageA
    s_waitcnt lgkmcnt(14)
    v_mfma_f32_16x16x32_bf16 a[0:3], v[32:35], v[128:131], a[0:3]
    v_mfma_f32_16x16x32_bf16 a[32:35], v[32:35], v[132:135], a[32:35]
    s_add_u32 s47, s51, 2097152
    s_add_u32 m0, s50, 65536
    v_mfma_f32_16x16x32_bf16 a[64:67], v[32:35], v[136:139], a[64:67]
    buffer_load_dwordx4 v4, s[16:19], s47 offen offset:0 lds
    v_mfma_f32_16x16x32_bf16 a[96:99], v[32:35], v[140:143], a[96:99]
    ds_read_b64_tr_b16 v[32:33], v120 offset:8192
    v_mfma_f32_16x16x32_bf16 a[128:131], v[128:131], v[64:67], a[128:131]
    ds_read_b64_tr_b16 v[34:35], v120 offset:9216
    v_mfma_f32_16x16x32_bf16 a[132:135], v[132:135], v[64:67], a[132:135]
    v_mfma_f32_16x16x32_bf16 a[192:195], v[136:139], v[64:67], a[192:195]
    v_mfma_f32_16x16x32_bf16 a[196:199], v[140:143], v[64:67], a[196:199]
    ds_read_b64_tr_b16 v[64:65], v120 offset:24576
    v_mfma_f32_16x16x32_bf16 a[4:7], v[36:39], v[128:131], a[4:7]
    ds_read_b64_tr_b16 v[66:67], v120 offset:25600
    v_mfma_f32_16x16x32_bf16 a[36:39], v[36:39], v[132:135], a[36:39]
    ds_read_b128 v[144:147], v22 offset:0
    v_mfma_f32_16x16x32_bf16 a[68:71], v[36:39], v[136:139], a[68:71]
    buffer_load_dwordx4 v5, s[16:19], s47 offen offset:1024 lds
    v_mfma_f32_16x16x32_bf16 a[100:103], v[36:39], v[140:143], a[100:103]
    ds_read_b64_tr_b16 v[36:37], v121 offset:8192
    v_mfma_f32_16x16x32_bf16 a[136:139], v[128:131], v[68:71], a[136:139]
    ds_read_b64_tr_b16 v[38:39], v121 offset:9216
    v_mfma_f32_16x16x32_bf16 a[140:143], v[132:135], v[68:71], a[140:143]
    v_mfma_f32_16x16x32_bf16 a[200:203], v[136:139], v[68:71], a[200:203]
    ds_read_b128 v[148:151], v22 offset:2048
    v_mfma_f32_16x16x32_bf16 a[204:207], v[140:143], v[68:71], a[204:207]
    ds_read_b64_tr_b16 v[68:69], v121 offset:24576
    v_mfma_f32_16x16x32_bf16 a[8:11], v[40:43], v[128:131], a[8:11]
    ds_read_b64_tr_b16 v[70:71], v121 offset:25600
    v_mfma_f32_16x16x32_bf16 a[40:43], v[40:43], v[132:135], a[40:43]
    buffer_load_dwordx4 v6, s[16:19], s47 offen offset:2048 lds
    v_mfma_f32_16x16x32_bf16 a[72:75], v[40:43], v[136:139], a[72:75]
    v_mfma_f32_16x16x32_bf16 a[104:107], v[40:43], v[140:143], a[104:107]
    ds_read_b64_tr_b16 v[40:41], v122 offset:8192
    v_mfma_f32_16x16x32_bf16 a[144:147], v[128:131], v[72:75], a[144:147]
    ds_read_b64_tr_b16 v[42:43], v122 offset:9216
    v_mfma_f32_16x16x32_bf16 a[148:151], v[132:135], v[72:75], a[148:151]
    ds_read_b128 v[152:155], v22 offset:4096
    v_mfma_f32_16x16x32_bf16 a[208:211], v[136:139], v[72:75], a[208:211]
    v_mfma_f32_16x16x32_bf16 a[212:215], v[140:143], v[72:75], a[212:215]
    ds_read_b64_tr_b16 v[72:73], v122 offset:24576
    v_mfma_f32_16x16x32_bf16 a[12:15], v[44:47], v[128:131], a[12:15]
    ds_read_b64_tr_b16 v[74:75], v122 offset:25600
    v_mfma_f32_16x16x32_bf16 a[44:47], v[44:47], v[132:135], a[44:47]
    ds_read_b128 v[156:159], v22 offset:6144
    v_mfma_f32_16x16x32_bf16 a[76:79], v[44:47], v[136:139], a[76:79]
    buffer_load_dwordx4 v7, s[16:19], s47 offen offset:3072 lds
    v_mfma_f32_16x16x32_bf16 a[108:111], v[44:47], v[140:143], a[108:111]
    ds_read_b64_tr_b16 v[44:45], v123 offset:8192
    v_mfma_f32_16x16x32_bf16 a[152:155], v[128:131], v[76:79], a[152:155]
    ds_read_b64_tr_b16 v[46:47], v123 offset:9216
    v_mfma_f32_16x16x32_bf16 a[156:159], v[132:135], v[76:79], a[156:159]
    v_mfma_f32_16x16x32_bf16 a[216:219], v[136:139], v[76:79], a[216:219]
    v_mfma_f32_16x16x32_bf16 a[220:223], v[140:143], v[76:79], a[220:223]
    s_add_u32 s47, s51, 2621440
    ds_read_b64_tr_b16 v[76:77], v123 offset:24576
    v_mfma_f32_16x16x32_bf16 a[16:19], v[48:51], v[128:131], a[16:19]
    s_add_u32 m0, s50, 81920
    ds_read_b64_tr_b16 v[78:79], v123 offset:25600
    v_mfma_f32_16x16x32_bf16 a[48:51], v[48:51], v[132:135], a[48:51]
    buffer_load_dwordx4 v4, s[16:19], s47 offen offset:0 lds
    v_mfma_f32_16x16x32_bf16 a[80:83], v[48:51], v[136:139], a[80:83]
    v_mfma_f32_16x16x32_bf16 a[112:115], v[48:51], v[140:143], a[112:115]
    s_waitcnt lgkmcnt(15)
    ds_read_b64_tr_b16 v[48:49], v124 offset:8192
    v_mfma_f32_16x16x32_bf16 a[160:163], v[128:131], v[80:83], a[160:163]
    ds_read_b64_tr_b16 v[50:51], v124 offset:9216
    v_mfma_f32_16x16x32_bf16 a[164:167], v[132:135], v[80:83], a[164:167]
    v_mfma_f32_16x16x32_bf16 a[224:227], v[136:139], v[80:83], a[224:227]
    v_mfma_f32_16x16x32_bf16 a[228:231], v[140:143], v[80:83], a[228:231]
    ds_read_b64_tr_b16 v[80:81], v124 offset:24576
    v_mfma_f32_16x16x32_bf16 a[20:23], v[52:55], v[128:131], a[20:23]
    ds_read_b64_tr_b16 v[82:83], v124 offset:25600
    v_mfma_f32_16x16x32_bf16 a[52:55], v[52:55], v[132:135], a[52:55]
    buffer_load_dwordx4 v5, s[16:19], s47 offen offset:1024 lds
    v_mfma_f32_16x16x32_bf16 a[84:87], v[52:55], v[136:139], a[84:87]
    v_mfma_f32_16x16x32_bf16 a[116:119], v[52:55], v[140:143], a[116:119]
    ds_read_b64_tr_b16 v[52:53], v125 offset:8192
    v_mfma_f32_16x16x32_bf16 a[168:171], v[128:131], v[84:87], a[168:171]
    ds_read_b64_tr_b16 v[54:55], v125 offset:9216
    v_mfma_f32_16x16x32_bf16 a[172:175], v[132:135], v[84:87], a[172:175]
    v_mfma_f32_16x16x32_bf16 a[232:235], v[136:139], v[84:87], a[232:235]
    v_mfma_f32_16x16x32_bf16 a[236:239], v[140:143], v[84:87], a[236:239]
    ds_read_b64_tr_b16 v[84:85], v125 offset:24576
    v_mfma_f32_16x16x32_bf16 a[24:27], v[56:59], v[128:131], a[24:27]
    ds_read_b64_tr_b16 v[86:87], v125 offset:25600
    v_mfma_f32_16x16x32_bf16 a[56:59], v[56:59], v[132:135], a[56:59]
    buffer_load_dwordx4 v6, s[16:19], s47 offen offset:2048 lds
    v_mfma_f32_16x16x32_bf16 a[88:91], v[56:59], v[136:139], a[88:91]
    v_mfma_f32_16x16x32_bf16 a[120:123], v[56:59], v[140:143], a[120:123]
    ds_read_b64_tr_b16 v[56:57], v126 offset:8192
    v_mfma_f32_16x16x32_bf16 a[176:179], v[128:131], v[88:91], a[176:179]
    ds_read_b64_tr_b16 v[58:59], v126 offset:9216
    v_mfma_f32_16x16x32_bf16 a[180:183], v[132:135], v[88:91], a[180:183]
    v_mfma_f32_16x16x32_bf16 a[240:243], v[136:139], v[88:91], a[240:243]
    v_mfma_f32_16x16x32_bf16 a[244:247], v[140:143], v[88:91], a[244:247]
    ds_read_b64_tr_b16 v[88:89], v126 offset:24576
    v_mfma_f32_16x16x32_bf16 a[28:31], v[60:63], v[128:131], a[28:31]
    ds_read_b64_tr_b16 v[90:91], v126 offset:25600
    v_mfma_f32_16x16x32_bf16 a[60:63], v[60:63], v[132:135], a[60:63]
    buffer_load_dwordx4 v7, s[16:19], s47 offen offset:3072 lds
    v_mfma_f32_16x16x32_bf16 a[92:95], v[60:63], v[136:139], a[92:95]
    v_mfma_f32_16x16x32_bf16 a[124:127], v[60:63], v[140:143], a[124:127]
    ds_read_b64_tr_b16 v[60:61], v127 offset:8192
    v_mfma_f32_16x16x32_bf16 a[184:187], v[128:131], v[92:95], a[184:187]
    ds_read_b64_tr_b16 v[62:63], v127 offset:9216
    v_mfma_f32_16x16x32_bf16 a[188:191], v[132:135], v[92:95], a[188:191]
    v_mfma_f32_16x16x32_bf16 a[248:251], v[136:139], v[92:95], a[248:251]
    v_mfma_f32_16x16x32_bf16 a[252:255], v[140:143], v[92:95], a[252:255]
    s_waitcnt lgkmcnt(15)
    ds_read_b64_tr_b16 v[92:93], v127 offset:24576
    v_mfma_f32_16x16x32_bf16 a[0:3], v[32:35], v[144:147], a[0:3]
    ds_read_b64_tr_b16 v[94:95], v127 offset:25600
    v_mfma_f32_16x16x32_bf16 a[32:35], v[32:35], v[148:151], a[32:35]
    s_add_u32 s64, s64, 32768
    v_mfma_f32_16x16x32_bf16 a[64:67], v[32:35], v[152:155], a[64:67]
    s_cmp_ge_u32 s64, 98304
    s_cselect_b32 s64, 0, s64
    v_mfma_f32_16x16x32_bf16 a[96:99], v[32:35], v[156:159], a[96:99]
    s_sub_u32 s65, s63, s65
    v_mfma_f32_16x16x32_bf16 a[128:131], v[144:147], v[64:67], a[128:131]
    v_add_u32 v21, s65, v20
    v_xor_b32 v22, 64, v21
    v_mfma_f32_16x16x32_bf16 a[132:135], v[148:151], v[64:67], a[132:135]
    v_add_u32 v120, s64, v8
    v_xor_b32 v121, 32, v120
    v_mfma_f32_16x16x32_bf16 a[192:195], v[152:155], v[64:67], a[192:195]
    v_xor_b32 v122, 64, v120
    v_xor_b32 v123, 96, v120
    v_mfma_f32_16x16x32_bf16 a[196:199], v[156:159], v[64:67], a[196:199]
    s_waitcnt vmcnt(8) lgkmcnt(0)
    s_barrier
    v_xor_b32 v124, 128, v120
    v_mfma_f32_16x16x32_bf16 a[4:7], v[36:39], v[144:147], a[4:7]
    s_add_u32 s47, s51, 0
    v_xor_b32 v125, 160, v120
    v_xor_b32 v126, 192, v120
    v_mfma_f32_16x16x32_bf16 a[36:39], v[36:39], v[148:151], a[36:39]
    s_add_u32 m0, s50, 0
    v_xor_b32 v127, 224, v120
    v_mfma_f32_16x16x32_bf16 a[68:71], v[36:39], v[152:155], a[68:71]
    buffer_load_dwordx4 v4, s[16:19], s47 offen offset:0 lds
    v_mfma_f32_16x16x32_bf16 a[100:103], v[36:39], v[156:159], a[100:103]
    v_mfma_f32_16x16x32_bf16 a[136:139], v[144:147], v[68:71], a[136:139]
    v_mfma_f32_16x16x32_bf16 a[140:143], v[148:151], v[68:71], a[140:143]
    v_mfma_f32_16x16x32_bf16 a[200:203], v[152:155], v[68:71], a[200:203]
    buffer_load_dwordx4 v5, s[16:19], s47 offen offset:1024 lds
    v_mfma_f32_16x16x32_bf16 a[204:207], v[156:159], v[68:71], a[204:207]
    v_mfma_f32_16x16x32_bf16 a[8:11], v[40:43], v[144:147], a[8:11]
    v_mfma_f32_16x16x32_bf16 a[40:43], v[40:43], v[148:151], a[40:43]
    ds_read_b64_tr_b16 v[32:33], v120 offset:0
    v_mfma_f32_16x16x32_bf16 a[72:75], v[40:43], v[152:155], a[72:75]
    ds_read_b64_tr_b16 v[34:35], v120 offset:1024
    v_mfma_f32_16x16x32_bf16 a[104:107], v[40:43], v[156:159], a[104:107]
    ds_read_b64_tr_b16 v[64:65], v120 offset:16384
    v_mfma_f32_16x16x32_bf16 a[144:147], v[144:147], v[72:75], a[144:147]
    ds_read_b64_tr_b16 v[66:67], v120 offset:17408
    v_mfma_f32_16x16x32_bf16 a[148:151], v[148:151], v[72:75], a[148:151]
    ds_read_b64_tr_b16 v[36:37], v121 offset:0
    v_mfma_f32_16x16x32_bf16 a[208:211], v[152:155], v[72:75], a[208:211]
    ds_read_b64_tr_b16 v[38:39], v121 offset:1024
    v_mfma_f32_16x16x32_bf16 a[212:215], v[156:159], v[72:75], a[212:215]
    ds_read_b64_tr_b16 v[68:69], v121 offset:16384
    v_mfma_f32_16x16x32_bf16 a[12:15], v[44:47], v[144:147], a[12:15]
    ds_read_b64_tr_b16 v[70:71], v121 offset:17408
    v_mfma_f32_16x16x32_bf16 a[44:47], v[44:47], v[148:151], a[44:47]
    ds_read_b64_tr_b16 v[40:41], v122 offset:0
    v_mfma_f32_16x16x32_bf16 a[76:79], v[44:47], v[152:155], a[76:79]
    ds_read_b64_tr_b16 v[42:43], v122 offset:1024
    v_mfma_f32_16x16x32_bf16 a[108:111], v[44:47], v[156:159], a[108:111]
    ds_read_b64_tr_b16 v[72:73], v122 offset:16384
    v_mfma_f32_16x16x32_bf16 a[152:155], v[144:147], v[76:79], a[152:155]
    ds_read_b64_tr_b16 v[74:75], v122 offset:17408
    v_mfma_f32_16x16x32_bf16 a[156:159], v[148:151], v[76:79], a[156:159]
    ds_read_b64_tr_b16 v[44:45], v123 offset:0
    v_mfma_f32_16x16x32_bf16 a[216:219], v[152:155], v[76:79], a[216:219]
    ds_read_b64_tr_b16 v[46:47], v123 offset:1024
    v_mfma_f32_16x16x32_bf16 a[220:223], v[156:159], v[76:79], a[220:223]
    s_sub_u32 s59, 15, s46
    ds_read_b64_tr_b16 v[76:77], v123 offset:16384
    v_mfma_f32_16x16x32_bf16 a[16:19], v[48:51], v[144:147], a[16:19]
    s_mov_b32 s60, s46
    ds_read_b64_tr_b16 v[78:79], v123 offset:17408
    v_and_b32 v24, 15, v0
    v_mfma_f32_16x16x32_bf16 a[48:51], v[48:51], v[148:151], a[48:51]
    ds_read_b128 v[128:131], v21 offset:0
    v_bfe_u32 v25, v0, 4, 1
    v_mfma_f32_16x16x32_bf16 a[80:83], v[48:51], v[152:155], a[80:83]
    ds_read_b128 v[132:135], v21 offset:2048
    v_mov_b32 v26, s59
    v_mfma_f32_16x16x32_bf16 a[112:115], v[48:51], v[156:159], a[112:115]
    ds_read_b64_tr_b16 v[48:49], v124 offset:0
    v_mov_b32 v27, s60
    v_mfma_f32_16x16x32_bf16 a[160:163], v[144:147], v[80:83], a[160:163]
    ds_read_b64_tr_b16 v[50:51], v124 offset:1024
    v_cmp_eq_u32 vcc, 0, v25
    v_mfma_f32_16x16x32_bf16 a[164:167], v[148:151], v[80:83], a[164:167]
    s_nop 1
    ds_read_b128 v[136:139], v21 offset:4096
    v_cndmask_b32 v26, v27, v26, vcc
    v_mfma_f32_16x16x32_bf16 a[224:227], v[152:155], v[80:83], a[224:227]
    ds_read_b128 v[140:143], v21 offset:6144
    v_lshl_add_u32 v24, v26, 4, v24
    v_mfma_f32_16x16x32_bf16 a[228:231], v[156:159], v[80:83], a[228:231]
    s_and_b32 s14, s45, 3
    ds_read_b64_tr_b16 v[80:81], v124 offset:16384
    v_mfma_f32_16x16x32_bf16 a[20:23], v[52:55], v[144:147], a[20:23]
    s_lshl_b32 s14, s14, 6
    s_lshr_b32 s15, s45, 2
    ds_read_b64_tr_b16 v[82:83], v124 offset:17408
    v_mfma_f32_16x16x32_bf16 a[52:55], v[52:55], v[148:151], a[52:55]
    s_add_u32 s14, s14, s15
    buffer_load_dwordx4 v6, s[16:19], s47 offen offset:2048 lds
    v_and_b32 v25, 7, v0
    v_mfma_f32_16x16x32_bf16 a[84:87], v[52:55], v[152:155], a[84:87]
    buffer_load_dwordx4 v7, s[16:19], s47 offen offset:3072 lds
    v_lshlrev_b32 v25, 3, v25
    v_mfma_f32_16x16x32_bf16 a[116:119], v[52:55], v[156:159], a[116:119]
    s_add_u32 s47, s51, 524288
    ds_read_b64_tr_b16 v[52:53], v125 offset:0
    v_mfma_f32_16x16x32_bf16 a[168:171], v[144:147], v[84:87], a[168:171]
    s_add_u32 m0, s50, 16384
    ds_read_b64_tr_b16 v[54:55], v125 offset:1024
    v_add_u32 v25, s14, v25
    v_mfma_f32_16x16x32_bf16 a[172:175], v[148:151], v[84:87], a[172:175]
    buffer_load_dwordx4 v4, s[16:19], s47 offen offset:0 lds
    v_cmp_gt_u32 vcc, 32, v0
    v_mfma_f32_16x16x32_bf16 a[232:235], v[152:155], v[84:87], a[232:235]
    s_nop 1
    buffer_load_dwordx4 v5, s[16:19], s47 offen offset:1024 lds
    v_cndmask_b32 v24, v25, v24, vcc
    v_mfma_f32_16x16x32_bf16 a[236:239], v[156:159], v[84:87], a[236:239]
    ds_read_b64_tr_b16 v[84:85], v125 offset:16384
    v_lshlrev_b32 v24, 3, v24
    v_mfma_f32_16x16x32_bf16 a[24:27], v[56:59], v[144:147], a[24:27]
    ds_read_b64_tr_b16 v[86:87], v125 offset:17408
    v_mfma_f32_16x16x32_bf16 a[56:59], v[56:59], v[148:151], a[56:59]
    buffer_load_dwordx4 v6, s[16:19], s47 offen offset:2048 lds
    v_mfma_f32_16x16x32_bf16 a[88:91], v[56:59], v[152:155], a[88:91]
    buffer_load_dwordx4 v7, s[16:19], s47 offen offset:3072 lds
    v_mfma_f32_16x16x32_bf16 a[120:123], v[56:59], v[156:159], a[120:123]
    ds_read_b64_tr_b16 v[56:57], v126 offset:0
    v_mfma_f32_16x16x32_bf16 a[176:179], v[144:147], v[88:91], a[176:179]
    ds_read_b64_tr_b16 v[58:59], v126 offset:1024
    v_mfma_f32_16x16x32_bf16 a[180:183], v[148:151], v[88:91], a[180:183]
    buffer_load_dwordx2 v[28:29], v24, s[68:71], 0 offen sc1
    v_mfma_f32_16x16x32_bf16 a[240:243], v[152:155], v[88:91], a[240:243]
    v_mfma_f32_16x16x32_bf16 a[244:247], v[156:159], v[88:91], a[244:247]
    ds_read_b64_tr_b16 v[88:89], v126 offset:16384
    v_mfma_f32_16x16x32_bf16 a[28:31], v[60:63], v[144:147], a[28:31]
    ds_read_b64_tr_b16 v[90:91], v126 offset:17408
    v_mfma_f32_16x16x32_bf16 a[60:63], v[60:63], v[148:151], a[60:63]
    v_mfma_f32_16x16x32_bf16 a[92:95], v[60:63], v[152:155], a[92:95]
    v_mfma_f32_16x16x32_bf16 a[124:127], v[60:63], v[156:159], a[124:127]
    ds_read_b64_tr_b16 v[60:61], v127 offset:0
    v_mfma_f32_16x16x32_bf16 a[184:187], v[144:147], v[92:95], a[184:187]
    ds_read_b64_tr_b16 v[62:63], v127 offset:1024
    v_mfma_f32_16x16x32_bf16 a[188:191], v[148:151], v[92:95], a[188:191]
    v_mfma_f32_16x16x32_bf16 a[248:251], v[152:155], v[92:95], a[248:251]
    v_mfma_f32_16x16x32_bf16 a[252:255], v[156:159], v[92:95], a[252:255]
    ds_read_b64_tr_b16 v[92:93], v127 offset:16384
    ds_read_b64_tr_b16 v[94:95], v127 offset:17408
    s_waitcnt lgkmcnt(14)
    v_mfma_f32_16x16x32_bf16 a[0:3], v[32:35], v[128:131], a[0:3]
    v_mfma_f32_16x16x32_bf16 a[32:35], v[32:35], v[132:135], a[32:35]
    s_lshl_b32 s48, s59, 3
    s_lshl_b32 s47, s44, 1
    s_add_u32 s48, s48, s47
    v_mfma_f32_16x16x32_bf16 a[64:67], v[32:35], v[136:139], a[64:67]
    s_mul_i32 s52, s48, 20480
    s_lshl_b32 s48, s60, 3
    s_add_u32 s48, s48, s47
    v_mfma_f32_16x16x32_bf16 a[96:99], v[32:35], v[140:143], a[96:99]
    s_mul_i32 s53, s48, 20480
    ds_read_b64_tr_b16 v[32:33], v120 offset:8192
    v_mfma_f32_16x16x32_bf16 a[128:131], v[128:131], v[64:67], a[128:131]
    s_add_u32 s47, s51, 3145728
    s_add_u32 m0, s50, 98304
    ds_read_b64_tr_b16 v[34:35], v120 offset:9216
    v_mfma_f32_16x16x32_bf16 a[132:135], v[132:135], v[64:67], a[132:135]
    buffer_load_dwordx4 v4, s[16:19], s47 offen offset:0 lds
    v_mfma_f32_16x16x32_bf16 a[192:195], v[136:139], v[64:67], a[192:195]
    v_mfma_f32_16x16x32_bf16 a[196:199], v[140:143], v[64:67], a[196:199]
    ds_read_b64_tr_b16 v[64:65], v120 offset:24576
    v_mfma_f32_16x16x32_bf16 a[4:7], v[36:39], v[128:131], a[4:7]
    ds_read_b64_tr_b16 v[66:67], v120 offset:25600
    v_mfma_f32_16x16x32_bf16 a[36:39], v[36:39], v[132:135], a[36:39]
    ds_read_b128 v[144:147], v22 offset:0
    v_mfma_f32_16x16x32_bf16 a[68:71], v[36:39], v[136:139], a[68:71]
    buffer_load_dwordx4 v5, s[16:19], s47 offen offset:1024 lds
    v_mfma_f32_16x16x32_bf16 a[100:103], v[36:39], v[140:143], a[100:103]
    ds_read_b64_tr_b16 v[36:37], v121 offset:8192
    v_mfma_f32_16x16x32_bf16 a[136:139], v[128:131], v[68:71], a[136:139]
    ds_read_b64_tr_b16 v[38:39], v121 offset:9216
    v_mfma_f32_16x16x32_bf16 a[140:143], v[132:135], v[68:71], a[140:143]
    v_mfma_f32_16x16x32_bf16 a[200:203], v[136:139], v[68:71], a[200:203]
    ds_read_b128 v[148:151], v22 offset:2048
    v_mfma_f32_16x16x32_bf16 a[204:207], v[140:143], v[68:71], a[204:207]
    ds_read_b64_tr_b16 v[68:69], v121 offset:24576
    v_mfma_f32_16x16x32_bf16 a[8:11], v[40:43], v[128:131], a[8:11]
    ds_read_b64_tr_b16 v[70:71], v121 offset:25600
    v_mfma_f32_16x16x32_bf16 a[40:43], v[40:43], v[132:135], a[40:43]
    buffer_load_dwordx4 v6, s[16:19], s47 offen offset:2048 lds
    v_mfma_f32_16x16x32_bf16 a[72:75], v[40:43], v[136:139], a[72:75]
    v_mfma_f32_16x16x32_bf16 a[104:107], v[40:43], v[140:143], a[104:107]
    ds_read_b64_tr_b16 v[40:41], v122 offset:8192
    v_mfma_f32_16x16x32_bf16 a[144:147], v[128:131], v[72:75], a[144:147]
    ds_read_b64_tr_b16 v[42:43], v122 offset:9216
    v_mfma_f32_16x16x32_bf16 a[148:151], v[132:135], v[72:75], a[148:151]
    ds_read_b128 v[152:155], v22 offset:4096
    v_mfma_f32_16x16x32_bf16 a[208:211], v[136:139], v[72:75], a[208:211]
    v_mfma_f32_16x16x32_bf16 a[212:215], v[140:143], v[72:75], a[212:215]
    ds_read_b64_tr_b16 v[72:73], v122 offset:24576
    v_mfma_f32_16x16x32_bf16 a[12:15], v[44:47], v[128:131], a[12:15]
    ds_read_b64_tr_b16 v[74:75], v122 offset:25600
    v_mfma_f32_16x16x32_bf16 a[44:47], v[44:47], v[132:135], a[44:47]
    ds_read_b128 v[156:159], v22 offset:6144
    v_mfma_f32_16x16x32_bf16 a[76:79], v[44:47], v[136:139], a[76:79]
    buffer_load_dwordx4 v7, s[16:19], s47 offen offset:3072 lds
    v_mfma_f32_16x16x32_bf16 a[108:111], v[44:47], v[140:143], a[108:111]
    ds_read_b64_tr_b16 v[44:45], v123 offset:8192
    v_mfma_f32_16x16x32_bf16 a[152:155], v[128:131], v[76:79], a[152:155]
    ds_read_b64_tr_b16 v[46:47], v123 offset:9216
    v_mfma_f32_16x16x32_bf16 a[156:159], v[132:135], v[76:79], a[156:159]
    v_mfma_f32_16x16x32_bf16 a[216:219], v[136:139], v[76:79], a[216:219]
    v_mfma_f32_16x16x32_bf16 a[220:223], v[140:143], v[76:79], a[220:223]
    s_add_u32 s47, s51, 3670016
    ds_read_b64_tr_b16 v[76:77], v123 offset:24576
    v_mfma_f32_16x16x32_bf16 a[16:19], v[48:51], v[128:131], a[16:19]
    s_add_u32 m0, s50, 114688
    ds_read_b64_tr_b16 v[78:79], v123 offset:25600
    v_mfma_f32_16x16x32_bf16 a[48:51], v[48:51], v[132:135], a[48:51]
    buffer_load_dwordx4 v4, s[16:19], s47 offen offset:0 lds
    v_mfma_f32_16x16x32_bf16 a[80:83], v[48:51], v[136:139], a[80:83]
    v_mfma_f32_16x16x32_bf16 a[112:115], v[48:51], v[140:143], a[112:115]
    s_waitcnt lgkmcnt(15)
    ds_read_b64_tr_b16 v[48:49], v124 offset:8192
    v_mfma_f32_16x16x32_bf16 a[160:163], v[128:131], v[80:83], a[160:163]
    ds_read_b64_tr_b16 v[50:51], v124 offset:9216
    v_mfma_f32_16x16x32_bf16 a[164:167], v[132:135], v[80:83], a[164:167]
    v_mfma_f32_16x16x32_bf16 a[224:227], v[136:139], v[80:83], a[224:227]
    v_mfma_f32_16x16x32_bf16 a[228:231], v[140:143], v[80:83], a[228:231]
    ds_read_b64_tr_b16 v[80:81], v124 offset:24576
    v_mfma_f32_16x16x32_bf16 a[20:23], v[52:55], v[128:131], a[20:23]
    ds_read_b64_tr_b16 v[82:83], v124 offset:25600
    v_mfma_f32_16x16x32_bf16 a[52:55], v[52:55], v[132:135], a[52:55]
    buffer_load_dwordx4 v5, s[16:19], s47 offen offset:1024 lds
    v_mfma_f32_16x16x32_bf16 a[84:87], v[52:55], v[136:139], a[84:87]
    v_mfma_f32_16x16x32_bf16 a[116:119], v[52:55], v[140:143], a[116:119]
    ds_read_b64_tr_b16 v[52:53], v125 offset:8192
    v_mfma_f32_16x16x32_bf16 a[168:171], v[128:131], v[84:87], a[168:171]
    ds_read_b64_tr_b16 v[54:55], v125 offset:9216
    v_mfma_f32_16x16x32_bf16 a[172:175], v[132:135], v[84:87], a[172:175]
    v_mfma_f32_16x16x32_bf16 a[232:235], v[136:139], v[84:87], a[232:235]
    v_mfma_f32_16x16x32_bf16 a[236:239], v[140:143], v[84:87], a[236:239]
    ds_read_b64_tr_b16 v[84:85], v125 offset:24576
    v_mfma_f32_16x16x32_bf16 a[24:27], v[56:59], v[128:131], a[24:27]
    ds_read_b64_tr_b16 v[86:87], v125 offset:25600
    v_mfma_f32_16x16x32_bf16 a[56:59], v[56:59], v[132:135], a[56:59]
    buffer_load_dwordx4 v6, s[16:19], s47 offen offset:2048 lds
    v_mfma_f32_16x16x32_bf16 a[88:91], v[56:59], v[136:139], a[88:91]
    v_mfma_f32_16x16x32_bf16 a[120:123], v[56:59], v[140:143], a[120:123]
    ds_read_b64_tr_b16 v[56:57], v126 offset:8192
    v_mfma_f32_16x16x32_bf16 a[176:179], v[128:131], v[88:91], a[176:179]
    ds_read_b64_tr_b16 v[58:59], v126 offset:9216
    v_mfma_f32_16x16x32_bf16 a[180:183], v[132:135], v[88:91], a[180:183]
    v_mfma_f32_16x16x32_bf16 a[240:243], v[136:139], v[88:91], a[240:243]
    v_mfma_f32_16x16x32_bf16 a[244:247], v[140:143], v[88:91], a[244:247]
    ds_read_b64_tr_b16 v[88:89], v126 offset:24576
    v_mfma_f32_16x16x32_bf16 a[28:31], v[60:63], v[128:131], a[28:31]
    ds_read_b64_tr_b16 v[90:91], v126 offset:25600
    v_mfma_f32_16x16x32_bf16 a[60:63], v[60:63], v[132:135], a[60:63]
    buffer_load_dwordx4 v7, s[16:19], s47 offen offset:3072 lds
    v_mfma_f32_16x16x32_bf16 a[92:95], v[60:63], v[136:139], a[92:95]
    v_mfma_f32_16x16x32_bf16 a[124:127], v[60:63], v[140:143], a[124:127]
    ds_read_b64_tr_b16 v[60:61], v127 offset:8192
    v_mfma_f32_16x16x32_bf16 a[184:187], v[128:131], v[92:95], a[184:187]
    ds_read_b64_tr_b16 v[62:63], v127 offset:9216
    v_mfma_f32_16x16x32_bf16 a[188:191], v[132:135], v[92:95], a[188:191]
    v_mfma_f32_16x16x32_bf16 a[248:251], v[136:139], v[92:95], a[248:251]
    v_mfma_f32_16x16x32_bf16 a[252:255], v[140:143], v[92:95], a[252:255]
    s_waitcnt lgkmcnt(15)
    ds_read_b64_tr_b16 v[92:93], v127 offset:24576
    v_mfma_f32_16x16x32_bf16 a[0:3], v[32:35], v[144:147], a[0:3]
    ds_read_b64_tr_b16 v[94:95], v127 offset:25600
    v_mfma_f32_16x16x32_bf16 a[32:35], v[32:35], v[148:151], a[32:35]
    v_mfma_f32_16x16x32_bf16 a[64:67], v[32:35], v[152:155], a[64:67]
    v_mfma_f32_16x16x32_bf16 a[96:99], v[32:35], v[156:159], a[96:99]
    v_mfma_f32_16x16x32_bf16 a[128:131], v[144:147], v[64:67], a[128:131]
    v_add_u32 v120, 0, v8
    v_xor_b32 v121, 32, v120
    v_mfma_f32_16x16x32_bf16 a[132:135], v[148:151], v[64:67], a[132:135]
    v_xor_b32 v122, 64, v120
    v_xor_b32 v123, 96, v120
    v_mfma_f32_16x16x32_bf16 a[192:195], v[152:155], v[64:67], a[192:195]
    v_xor_b32 v124, 128, v120
    v_xor_b32 v125, 160, v120
    v_mfma_f32_16x16x32_bf16 a[196:199], v[156:159], v[64:67], a[196:199]
    s_waitcnt vmcnt(8) lgkmcnt(0)
    s_cmp_lg_u32 s44, 0
    s_cbranch_scc1 sequential_preLN__compressed_kv_cla__moe_arch_mod__prompt_kernel_lnok
    s_mov_b32 s14, 0
sequential_preLN__compressed_kv_cla__moe_arch_mod__prompt_kernel_lnpoll:
    v_cmp_ne_u32 vcc, s3, v28
    s_add_u32 s14, s14, 1
    s_cbranch_vccz sequential_preLN__compressed_kv_cla__moe_arch_mod__prompt_kernel_lnok2
    s_cmp_ge_u32 s14, 65536
    s_cbranch_scc1 sequential_preLN__compressed_kv_cla__moe_arch_mod__prompt_kernel_lnok2
    buffer_load_dwordx2 v[28:29], v24, s[68:71], 0 offen sc1
    s_waitcnt vmcnt(0)
    s_branch sequential_preLN__compressed_kv_cla__moe_arch_mod__prompt_kernel_lnpoll
sequential_preLN__compressed_kv_cla__moe_arch_mod__prompt_kernel_lnok2:
    v_cmp_ne_u32 vcc, s67, v29
    s_nop 1
    s_lshr_b64 s[14:15], vcc, 32
    s_cmp_eq_u64 s[14:15], 0
    s_cselect_b32 s66, 1, 0
sequential_preLN__compressed_kv_cla__moe_arch_mod__prompt_kernel_lnok:
    s_barrier
    v_xor_b32 v126, 192, v120
    v_mfma_f32_16x16x32_bf16 a[4:7], v[36:39], v[144:147], a[4:7]
    s_add_u32 s47, s51, 1048576
    s_add_u32 m0, s50, 32768
    v_xor_b32 v127, 224, v120
    v_mfma_f32_16x16x32_bf16 a[36:39], v[36:39], v[148:151], a[36:39]
    s_add_u32 s48, s52, 0
    buffer_load_dwordx4 v4, s[16:19], s47 offen offset:0 lds
    v_mfma_f32_16x16x32_bf16 a[68:71], v[36:39], v[152:155], a[68:71]
    buffer_load_dwordx4 v[16:19], v1, s[20:23], s48 offen offset:0 sc1
    v_mfma_f32_16x16x32_bf16 a[100:103], v[36:39], v[156:159], a[100:103]
    s_add_u32 s48, s52, 20480
    buffer_load_dwordx4 v5, s[16:19], s47 offen offset:1024 lds
    v_mfma_f32_16x16x32_bf16 a[136:139], v[144:147], v[68:71], a[136:139]
    buffer_load_dwordx4 v[20:23], v1, s[20:23], s48 offen offset:0 sc1
    v_mfma_f32_16x16x32_bf16 a[140:143], v[148:151], v[68:71], a[140:143]
    s_add_u32 s48, s53, 0
    buffer_load_dwordx4 v[24:27], v1, s[20:23], s48 offen offset:0 sc1
    v_mfma_f32_16x16x32_bf16 a[200:203], v[152:155], v[68:71], a[200:203]
    s_add_u32 s48, s53, 20480
    buffer_load_dwordx4 v6, s[16:19], s47 offen offset:2048 lds
    v_mfma_f32_16x16x32_bf16 a[204:207], v[156:159], v[68:71], a[204:207]
    buffer_load_dwordx4 v[28:31], v1, s[20:23], s48 offen offset:0 sc1
    v_mfma_f32_16x16x32_bf16 a[8:11], v[40:43], v[144:147], a[8:11]
    s_add_u32 s48, s52, 0
    buffer_load_dwordx4 v[96:99], v1, s[20:23], s48 offen offset:1024 sc1
    v_mfma_f32_16x16x32_bf16 a[40:43], v[40:43], v[148:151], a[40:43]
    s_add_u32 s48, s52, 20480
    ds_read_b64_tr_b16 v[64:65], v124 offset:0
    v_mfma_f32_16x16x32_bf16 a[72:75], v[40:43], v[152:155], a[72:75]
    ds_read_b64_tr_b16 v[66:67], v124 offset:1024
    v_mfma_f32_16x16x32_bf16 a[104:107], v[40:43], v[156:159], a[104:107]
    ds_read_b64_tr_b16 v[68:69], v125 offset:0
    v_mfma_f32_16x16x32_bf16 a[144:147], v[144:147], v[72:75], a[144:147]
    ds_read_b64_tr_b16 v[70:71], v125 offset:1024
    v_mfma_f32_16x16x32_bf16 a[148:151], v[148:151], v[72:75], a[148:151]
    buffer_load_dwordx4 v7, s[16:19], s47 offen offset:3072 lds
    v_mfma_f32_16x16x32_bf16 a[208:211], v[152:155], v[72:75], a[208:211]
    s_add_u32 s47, s51, 1572864
    s_add_u32 m0, s50, 49152
    buffer_load_dwordx4 v[100:103], v1, s[20:23], s48 offen offset:1024 sc1
    v_mfma_f32_16x16x32_bf16 a[212:215], v[156:159], v[72:75], a[212:215]
    s_add_u32 s48, s53, 0
    buffer_load_dwordx4 v4, s[16:19], s47 offen offset:0 lds
    v_mfma_f32_16x16x32_bf16 a[12:15], v[44:47], v[144:147], a[12:15]
    ds_read_b64_tr_b16 v[72:73], v126 offset:0
    v_mfma_f32_16x16x32_bf16 a[44:47], v[44:47], v[148:151], a[44:47]
    ds_read_b64_tr_b16 v[74:75], v126 offset:1024
    v_mfma_f32_16x16x32_bf16 a[76:79], v[44:47], v[152:155], a[76:79]
    buffer_load_dwordx4 v5, s[16:19], s47 offen offset:1024 lds
    v_mfma_f32_16x16x32_bf16 a[108:111], v[44:47], v[156:159], a[108:111]
    buffer_load_dwordx4 v6, s[16:19], s47 offen offset:2048 lds
    v_mfma_f32_16x16x32_bf16 a[152:155], v[144:147], v[76:79], a[152:155]
    buffer_load_dwordx4 v[104:107], v1, s[20:23], s48 offen offset:1024 sc1
    v_mfma_f32_16x16x32_bf16 a[156:159], v[148:151], v[76:79], a[156:159]
    s_add_u32 s48, s53, 20480
    buffer_load_dwordx4 v7, s[16:19], s47 offen offset:3072 lds
    v_mfma_f32_16x16x32_bf16 a[216:219], v[152:155], v[76:79], a[216:219]
    s_add_u32 s47, s51, 4194304
    s_add_u32 m0, s50, 131072
    buffer_load_dwordx4 v[108:111], v1, s[20:23], s48 offen offset:1024 sc1
    v_mfma_f32_16x16x32_bf16 a[220:223], v[156:159], v[76:79], a[220:223]
    v_mfma_f32_16x16x32_bf16 a[16:19], v[48:51], v[144:147], a[16:19]
    s_add_u32 s48, s52, 0
    ds_read_b64_tr_b16 v[76:77], v127 offset:0
    v_mfma_f32_16x16x32_bf16 a[48:51], v[48:51], v[148:151], a[48:51]
    ds_read_b64_tr_b16 v[78:79], v127 offset:1024
    v_mfma_f32_16x16x32_bf16 a[80:83], v[48:51], v[152:155], a[80:83]
    buffer_load_dwordx4 v4, s[16:19], s47 offen offset:0 lds
    v_mfma_f32_16x16x32_bf16 a[112:115], v[48:51], v[156:159], a[112:115]
    buffer_load_dwordx4 v5, s[16:19], s47 offen offset:1024 lds
    v_mfma_f32_16x16x32_bf16 a[160:163], v[144:147], v[80:83], a[160:163]
    ds_read_b64_tr_b16 v[48:49], v120 offset:0
    v_mfma_f32_16x16x32_bf16 a[164:167], v[148:151], v[80:83], a[164:167]
    ds_read_b64_tr_b16 v[50:51], v120 offset:1024
    v_mfma_f32_16x16x32_bf16 a[224:227], v[152:155], v[80:83], a[224:227]
    buffer_load_dwordx4 v6, s[16:19], s47 offen offset:2048 lds
    v_mfma_f32_16x16x32_bf16 a[228:231], v[156:159], v[80:83], a[228:231]
    buffer_load_dwordx4 v[32:35], v1, s[20:23], s48 offen offset:2048 sc1
    v_mfma_f32_16x16x32_bf16 a[20:23], v[52:55], v[144:147], a[20:23]
    s_add_u32 s48, s52, 20480
    buffer_load_dwordx4 v[36:39], v1, s[20:23], s48 offen offset:2048 sc1
    v_mfma_f32_16x16x32_bf16 a[52:55], v[52:55], v[148:151], a[52:55]
    s_add_u32 s48, s53, 0
    buffer_load_dwordx4 v7, s[16:19], s47 offen offset:3072 lds
    v_mfma_f32_16x16x32_bf16 a[84:87], v[52:55], v[152:155], a[84:87]
    s_add_u32 s47, s51, 4718592
    s_add_u32 m0, s50, 147456
    buffer_load_dwordx4 v[40:43], v1, s[20:23], s48 offen offset:2048 sc1
    v_mfma_f32_16x16x32_bf16 a[116:119], v[52:55], v[156:159], a[116:119]
    s_add_u32 s48, s53, 20480
    buffer_load_dwordx4 v[44:47], v1, s[20:23], s48 offen offset:2048 sc1
    v_mfma_f32_16x16x32_bf16 a[168:171], v[144:147], v[84:87], a[168:171]
    ds_read_b64_tr_b16 v[52:53], v121 offset:0
    v_mfma_f32_16x16x32_bf16 a[172:175], v[148:151], v[84:87], a[172:175]
    ds_read_b64_tr_b16 v[54:55], v121 offset:1024
    v_mfma_f32_16x16x32_bf16 a[232:235], v[152:155], v[84:87], a[232:235]
    buffer_load_dwordx4 v4, s[16:19], s47 offen offset:0 lds
    v_mfma_f32_16x16x32_bf16 a[236:239], v[156:159], v[84:87], a[236:239]
    buffer_load_dwordx4 v5, s[16:19], s47 offen offset:1024 lds
    v_mfma_f32_16x16x32_bf16 a[24:27], v[56:59], v[144:147], a[24:27]
    v_mfma_f32_16x16x32_bf16 a[56:59], v[56:59], v[148:151], a[56:59]
    v_mfma_f32_16x16x32_bf16 a[88:91], v[56:59], v[152:155], a[88:91]
    buffer_load_dwordx4 v6, s[16:19], s47 offen offset:2048 lds
    v_mfma_f32_16x16x32_bf16 a[120:123], v[56:59], v[156:159], a[120:123]
    v_mfma_f32_16x16x32_bf16 a[176:179], v[144:147], v[88:91], a[176:179]
    ds_read_b64_tr_b16 v[56:57], v122 offset:0
    v_mfma_f32_16x16x32_bf16 a[180:183], v[148:151], v[88:91], a[180:183]
    ds_read_b64_tr_b16 v[58:59], v122 offset:1024
    v_mfma_f32_16x16x32_bf16 a[240:243], v[152:155], v[88:91], a[240:243]
    buffer_load_dwordx4 v7, s[16:19], s47 offen offset:3072 lds
    v_mfma_f32_16x16x32_bf16 a[244:247], v[156:159], v[88:91], a[244:247]
    v_mfma_f32_16x16x32_bf16 a[28:31], v[60:63], v[144:147], a[28:31]
    v_mfma_f32_16x16x32_bf16 a[60:63], v[60:63], v[148:151], a[60:63]
    v_mfma_f32_16x16x32_bf16 a[92:95], v[60:63], v[152:155], a[92:95]
    v_mfma_f32_16x16x32_bf16 a[124:127], v[60:63], v[156:159], a[124:127]
    v_mfma_f32_16x16x32_bf16 a[184:187], v[144:147], v[92:95], a[184:187]
    ds_read_b64_tr_b16 v[60:61], v123 offset:0
    v_mfma_f32_16x16x32_bf16 a[188:191], v[148:151], v[92:95], a[188:191]
    ds_read_b64_tr_b16 v[62:63], v123 offset:1024
    v_mfma_f32_16x16x32_bf16 a[248:251], v[152:155], v[92:95], a[248:251]
    v_mfma_f32_16x16x32_bf16 a[252:255], v[156:159], v[92:95], a[252:255]
    s_waitcnt vmcnt(21)
    s_waitcnt lgkmcnt(4)
    v_mfma_f32_16x16x32_bf16 v[128:131], v[48:51], v[16:19], 0
    v_mfma_f32_16x16x32_bf16 v[160:163], v[48:51], v[20:23], 0
    s_add_u32 s48, s52, 0
    buffer_load_dwordx4 v[80:83], v1, s[20:23], s48 offen offset:3072 sc1
    v_mfma_f32_16x16x32_bf16 v[192:195], v[48:51], v[24:27], 0
    s_add_u32 s48, s52, 20480
    buffer_load_dwordx4 v[84:87], v1, s[20:23], s48 offen offset:3072 sc1
    v_mfma_f32_16x16x32_bf16 v[224:227], v[48:51], v[28:31], 0
    s_add_u32 s48, s53, 0
    ds_read_b64_tr_b16 v[48:49], v120 offset:8192
    v_mfma_f32_16x16x32_bf16 v[132:135], v[52:55], v[16:19], 0
    ds_read_b64_tr_b16 v[50:51], v120 offset:9216
    v_mfma_f32_16x16x32_bf16 v[164:167], v[52:55], v[20:23], 0
    buffer_load_dwordx4 v[88:91], v1, s[20:23], s48 offen offset:3072 sc1
    v_mfma_f32_16x16x32_bf16 v[196:199], v[52:55], v[24:27], 0
    s_add_u32 s48, s53, 20480
    buffer_load_dwordx4 v[92:95], v1, s[20:23], s48 offen offset:3072 sc1
    v_mfma_f32_16x16x32_bf16 v[228:231], v[52:55], v[28:31], 0
    s_waitcnt lgkmcnt(2)
    ds_read_b64_tr_b16 v[52:53], v121 offset:8192
    v_mfma_f32_16x16x32_bf16 v[136:139], v[56:59], v[16:19], 0
    ds_read_b64_tr_b16 v[54:55], v121 offset:9216
    v_mfma_f32_16x16x32_bf16 v[168:171], v[56:59], v[20:23], 0
    v_mfma_f32_16x16x32_bf16 v[200:203], v[56:59], v[24:27], 0
    v_mfma_f32_16x16x32_bf16 v[232:235], v[56:59], v[28:31], 0
    ds_read_b64_tr_b16 v[56:57], v122 offset:8192
    v_mfma_f32_16x16x32_bf16 v[140:143], v[60:63], v[16:19], 0
    ds_read_b64_tr_b16 v[58:59], v122 offset:9216
    v_accvgpr_read_b32 v112, a0
    v_mfma_f32_16x16x32_bf16 v[172:175], v[60:63], v[20:23], 0
    v_accvgpr_read_b32 v113, a1
    v_mfma_f32_16x16x32_bf16 v[204:207], v[60:63], v[24:27], 0
    v_accvgpr_read_b32 v114, a2
    v_mfma_f32_16x16x32_bf16 v[236:239], v[60:63], v[28:31], 0
    ds_read_b64_tr_b16 v[60:61], v123 offset:8192
    v_accvgpr_read_b32 v115, a3
    v_mfma_f32_16x16x32_bf16 v[144:147], v[64:67], v[16:19], 0
    ds_read_b64_tr_b16 v[62:63], v123 offset:9216
    v_mfma_f32_16x16x32_bf16 v[176:179], v[64:67], v[20:23], 0
    v_accvgpr_read_b32 v116, a4
    v_mfma_f32_16x16x32_bf16 v[208:211], v[64:67], v[24:27], 0
    v_accvgpr_read_b32 v117, a5
    v_mfma_f32_16x16x32_bf16 v[240:243], v[64:67], v[28:31], 0
    ds_read_b64_tr_b16 v[64:65], v124 offset:8192
    v_accvgpr_read_b32 v118, a6
    v_mfma_f32_16x16x32_bf16 v[148:151], v[68:71], v[16:19], 0
    ds_read_b64_tr_b16 v[66:67], v124 offset:9216
    v_accvgpr_read_b32 v119, a7
    v_mfma_f32_16x16x32_bf16 v[180:183], v[68:71], v[20:23], 0
    v_mfma_f32_16x16x32_bf16 v[212:215], v[68:71], v[24:27], 0
    v_cvt_pk_bf16_f32 v112, v112, v113
    v_mfma_f32_16x16x32_bf16 v[244:247], v[68:71], v[28:31], 0
    ds_read_b64_tr_b16 v[68:69], v125 offset:8192
    v_cvt_pk_bf16_f32 v113, v114, v115
    v_mfma_f32_16x16x32_bf16 v[152:155], v[72:75], v[16:19], 0
    ds_read_b64_tr_b16 v[70:71], v125 offset:9216
    v_cvt_pk_bf16_f32 v114, v116, v117
    v_mfma_f32_16x16x32_bf16 v[184:187], v[72:75], v[20:23], 0
    v_mfma_f32_16x16x32_bf16 v[216:219], v[72:75], v[24:27], 0
    v_cvt_pk_bf16_f32 v115, v118, v119
    v_mfma_f32_16x16x32_bf16 v[248:251], v[72:75], v[28:31], 0
    s_add_u32 s64, s56, 0
    ds_read_b64_tr_b16 v[72:73], v126 offset:8192
    v_mfma_f32_16x16x32_bf16 v[156:159], v[76:79], v[16:19], 0
    ds_read_b64_tr_b16 v[74:75], v126 offset:9216
    v_mfma_f32_16x16x32_bf16 v[188:191], v[76:79], v[20:23], 0
    buffer_store_dwordx4 v[112:115], v1, s[24:27], s64 offen offset:0
    v_mfma_f32_16x16x32_bf16 v[220:223], v[76:79], v[24:27], 0
    s_waitcnt vmcnt(17)
    s_nop 0
    v_mfma_f32_16x16x32_bf16 v[252:255], v[76:79], v[28:31], 0
    s_waitcnt lgkmcnt(10)
    ds_read_b64_tr_b16 v[76:77], v127 offset:8192
    v_accvgpr_read_b32 v112, a8
    v_mfma_f32_16x16x32_bf16 v[128:131], v[48:51], v[96:99], v[128:131]
    ds_read_b64_tr_b16 v[78:79], v127 offset:9216
    v_accvgpr_read_b32 v113, a9
    v_mfma_f32_16x16x32_bf16 v[160:163], v[48:51], v[100:103], v[160:163]
    v_add_u32 v120, 16384, v8
    v_xor_b32 v121, 32, v120
    v_mfma_f32_16x16x32_bf16 v[192:195], v[48:51], v[104:107], v[192:195]
    v_xor_b32 v122, 64, v120
    v_xor_b32 v123, 96, v120
    v_mfma_f32_16x16x32_bf16 v[224:227], v[48:51], v[108:111], v[224:227]
    v_xor_b32 v124, 128, v120
    v_xor_b32 v125, 160, v120
    v_mfma_f32_16x16x32_bf16 v[132:135], v[52:55], v[96:99], v[132:135]
    v_xor_b32 v126, 192, v120
    v_xor_b32 v127, 224, v120
    v_mfma_f32_16x16x32_bf16 v[164:167], v[52:55], v[100:103], v[164:167]
    v_accvgpr_read_b32 v114, a10
    v_accvgpr_read_b32 v115, a11
    v_mfma_f32_16x16x32_bf16 v[196:199], v[52:55], v[104:107], v[196:199]
    v_accvgpr_read_b32 v116, a12
    v_accvgpr_read_b32 v117, a13
    v_mfma_f32_16x16x32_bf16 v[228:231], v[52:55], v[108:111], v[228:231]
    s_waitcnt lgkmcnt(8)
    v_accvgpr_read_b32 v118, a14
    v_mfma_f32_16x16x32_bf16 v[136:139], v[56:59], v[96:99], v[136:139]
    v_accvgpr_read_b32 v119, a15
    v_mfma_f32_16x16x32_bf16 v[168:171], v[56:59], v[100:103], v[168:171]
    s_add_u32 s48, s52, 4096
    ds_read_b64_tr_b16 v[48:49], v120 offset:0
    v_cvt_pk_bf16_f32 v112, v112, v113
    v_mfma_f32_16x16x32_bf16 v[200:203], v[56:59], v[104:107], v[200:203]
    ds_read_b64_tr_b16 v[50:51], v120 offset:1024
    v_cvt_pk_bf16_f32 v113, v114, v115
    v_mfma_f32_16x16x32_bf16 v[232:235], v[56:59], v[108:111], v[232:235]
    ds_read_b64_tr_b16 v[52:53], v121 offset:0
    v_cvt_pk_bf16_f32 v114, v116, v117
    v_mfma_f32_16x16x32_bf16 v[140:143], v[60:63], v[96:99], v[140:143]
    ds_read_b64_tr_b16 v[54:55], v121 offset:1024
    v_mfma_f32_16x16x32_bf16 v[172:175], v[60:63], v[100:103], v[172:175]
    ds_read_b64_tr_b16 v[56:57], v122 offset:0
    v_cvt_pk_bf16_f32 v115, v118, v119
    v_mfma_f32_16x16x32_bf16 v[204:207], v[60:63], v[104:107], v[204:207]
    s_add_u32 s64, s56, 0
    ds_read_b64_tr_b16 v[58:59], v122 offset:1024
    v_mfma_f32_16x16x32_bf16 v[236:239], v[60:63], v[108:111], v[236:239]
    s_waitcnt lgkmcnt(10)
    ds_read_b64_tr_b16 v[60:61], v123 offset:0
    v_mfma_f32_16x16x32_bf16 v[144:147], v[64:67], v[96:99], v[144:147]
    ds_read_b64_tr_b16 v[62:63], v123 offset:1024
    v_mfma_f32_16x16x32_bf16 v[176:179], v[64:67], v[100:103], v[176:179]
    buffer_store_dwordx4 v[112:115], v1, s[24:27], s64 offen offset:1024
    v_mfma_f32_16x16x32_bf16 v[208:211], v[64:67], v[104:107], v[208:211]
    s_nop 0
    buffer_load_dwordx4 a[0:3], v1, s[20:23], s48 offen offset:0 sc1
    v_accvgpr_read_b32 v112, a16
    v_mfma_f32_16x16x32_bf16 v[240:243], v[64:67], v[108:111], v[240:243]
    s_add_u32 s48, s52, 24576
    ds_read_b64_tr_b16 v[64:65], v124 offset:0
    v_accvgpr_read_b32 v113, a17
    v_mfma_f32_16x16x32_bf16 v[148:151], v[68:71], v[96:99], v[148:151]
    ds_read_b64_tr_b16 v[66:67], v124 offset:1024
    v_accvgpr_read_b32 v114, a18
    v_mfma_f32_16x16x32_bf16 v[180:183], v[68:71], v[100:103], v[180:183]
    buffer_load_dwordx4 a[4:7], v1, s[20:23], s48 offen offset:0 sc1
    v_mfma_f32_16x16x32_bf16 v[212:215], v[68:71], v[104:107], v[212:215]
    s_add_u32 s48, s53, 4096
    buffer_load_dwordx4 a[8:11], v1, s[20:23], s48 offen offset:0 sc1
    v_accvgpr_read_b32 v115, a19
    v_mfma_f32_16x16x32_bf16 v[244:247], v[68:71], v[108:111], v[244:247]
    s_waitcnt lgkmcnt(10)
    ds_read_b64_tr_b16 v[68:69], v125 offset:0
    v_accvgpr_read_b32 v116, a20
    v_mfma_f32_16x16x32_bf16 v[152:155], v[72:75], v[96:99], v[152:155]
    s_add_u32 s48, s53, 24576
    ds_read_b64_tr_b16 v[70:71], v125 offset:1024
    v_accvgpr_read_b32 v117, a21
    v_mfma_f32_16x16x32_bf16 v[184:187], v[72:75], v[100:103], v[184:187]
    buffer_load_dwordx4 a[12:15], v1, s[20:23], s48 offen offset:0 sc1
    v_accvgpr_read_b32 v118, a22
    v_mfma_f32_16x16x32_bf16 v[216:219], v[72:75], v[104:107], v[216:219]
    v_mfma_f32_16x16x32_bf16 v[248:251], v[72:75], v[108:111], v[248:251]
    ds_read_b64_tr_b16 v[72:73], v126 offset:0
    v_accvgpr_read_b32 v119, a23
    v_mfma_f32_16x16x32_bf16 v[156:159], v[76:79], v[96:99], v[156:159]
    ds_read_b64_tr_b16 v[74:75], v126 offset:1024
    v_cvt_pk_bf16_f32 v112, v112, v113
    v_mfma_f32_16x16x32_bf16 v[188:191], v[76:79], v[100:103], v[188:191]
    v_cvt_pk_bf16_f32 v113, v114, v115
    v_mfma_f32_16x16x32_bf16 v[220:223], v[76:79], v[104:107], v[220:223]
    s_waitcnt vmcnt(14)
    v_mfma_f32_16x16x32_bf16 v[252:255], v[76:79], v[108:111], v[252:255]
    s_waitcnt lgkmcnt(10)
    ds_read_b64_tr_b16 v[76:77], v127 offset:0
    v_cvt_pk_bf16_f32 v114, v116, v117
    v_mfma_f32_16x16x32_bf16 v[128:131], v[48:51], v[32:35], v[128:131]
    ds_read_b64_tr_b16 v[78:79], v127 offset:1024
    v_cvt_pk_bf16_f32 v115, v118, v119
    v_mfma_f32_16x16x32_bf16 v[160:163], v[48:51], v[36:39], v[160:163]
    s_add_u32 s64, s56, 0
    v_mfma_f32_16x16x32_bf16 v[192:195], v[48:51], v[40:43], v[192:195]
    buffer_store_dwordx4 v[112:115], v1, s[24:27], s64 offen offset:2048
    v_mfma_f32_16x16x32_bf16 v[224:227], v[48:51], v[44:47], v[224:227]
    ds_read_b64_tr_b16 v[48:49], v120 offset:8192
    v_mfma_f32_16x16x32_bf16 v[132:135], v[52:55], v[32:35], v[132:135]
    s_nop 0
    ds_read_b64_tr_b16 v[50:51], v120 offset:9216
    v_mfma_f32_16x16x32_bf16 v[164:167], v[52:55], v[36:39], v[164:167]
    v_accvgpr_read_b32 v112, a24
    v_mfma_f32_16x16x32_bf16 v[196:199], v[52:55], v[40:43], v[196:199]
    v_accvgpr_read_b32 v113, a25
    v_mfma_f32_16x16x32_bf16 v[228:231], v[52:55], v[44:47], v[228:231]
    s_waitcnt lgkmcnt(10)
    ds_read_b64_tr_b16 v[52:53], v121 offset:8192
    v_accvgpr_read_b32 v114, a26
    v_mfma_f32_16x16x32_bf16 v[136:139], v[56:59], v[32:35], v[136:139]
    ds_read_b64_tr_b16 v[54:55], v121 offset:9216
    v_mfma_f32_16x16x32_bf16 v[168:171], v[56:59], v[36:39], v[168:171]
    v_accvgpr_read_b32 v115, a27
    v_mfma_f32_16x16x32_bf16 v[200:203], v[56:59], v[40:43], v[200:203]
    v_accvgpr_read_b32 v116, a28
    v_mfma_f32_16x16x32_bf16 v[232:235], v[56:59], v[44:47], v[232:235]
    ds_read_b64_tr_b16 v[56:57], v122 offset:8192
    v_accvgpr_read_b32 v117, a29
    v_mfma_f32_16x16x32_bf16 v[140:143], v[60:63], v[32:35], v[140:143]
    ds_read_b64_tr_b16 v[58:59], v122 offset:9216
    v_mfma_f32_16x16x32_bf16 v[172:175], v[60:63], v[36:39], v[172:175]
    v_accvgpr_read_b32 v118, a30
    v_mfma_f32_16x16x32_bf16 v[204:207], v[60:63], v[40:43], v[204:207]
    v_accvgpr_read_b32 v119, a31
    v_mfma_f32_16x16x32_bf16 v[236:239], v[60:63], v[44:47], v[236:239]
    s_waitcnt lgkmcnt(10)
    ds_read_b64_tr_b16 v[60:61], v123 offset:8192
    v_cvt_pk_bf16_f32 v112, v112, v113
    v_mfma_f32_16x16x32_bf16 v[144:147], v[64:67], v[32:35], v[144:147]
    s_add_u32 s48, s52, 4096
    ds_read_b64_tr_b16 v[62:63], v123 offset:9216
    v_cvt_pk_bf16_f32 v113, v114, v115
    v_mfma_f32_16x16x32_bf16 v[176:179], v[64:67], v[36:39], v[176:179]
    buffer_load_dwordx4 a[16:19], v1, s[20:23], s48 offen offset:1024 sc1
    v_mfma_f32_16x16x32_bf16 v[208:211], v[64:67], v[40:43], v[208:211]
    s_add_u32 s48, s52, 24576
    buffer_load_dwordx4 a[20:23], v1, s[20:23], s48 offen offset:1024 sc1
    v_cvt_pk_bf16_f32 v114, v116, v117
    v_mfma_f32_16x16x32_bf16 v[240:243], v[64:67], v[44:47], v[240:243]
    s_add_u32 s48, s53, 4096
    ds_read_b64_tr_b16 v[64:65], v124 offset:8192
    v_cvt_pk_bf16_f32 v115, v118, v119
    v_mfma_f32_16x16x32_bf16 v[148:151], v[68:71], v[32:35], v[148:151]
    s_add_u32 s64, s56, 0
    ds_read_b64_tr_b16 v[66:67], v124 offset:9216
    v_mfma_f32_16x16x32_bf16 v[180:183], v[68:71], v[36:39], v[180:183]
    buffer_store_dwordx4 v[112:115], v1, s[24:27], s64 offen offset:3072
    v_mfma_f32_16x16x32_bf16 v[212:215], v[68:71], v[40:43], v[212:215]
    buffer_load_dwordx4 a[24:27], v1, s[20:23], s48 offen offset:1024 sc1
    v_mfma_f32_16x16x32_bf16 v[244:247], v[68:71], v[44:47], v[244:247]
    s_waitcnt lgkmcnt(10)
    s_nop 0
    ds_read_b64_tr_b16 v[68:69], v125 offset:8192
    v_mfma_f32_16x16x32_bf16 v[152:155], v[72:75], v[32:35], v[152:155]
    s_add_u32 s48, s53, 24576
    ds_read_b64_tr_b16 v[70:71], v125 offset:9216
    v_accvgpr_read_b32 v112, a32
    v_mfma_f32_16x16x32_bf16 v[184:187], v[72:75], v[36:39], v[184:187]
    buffer_load_dwordx4 a[28:31], v1, s[20:23], s48 offen offset:1024 sc1
    v_accvgpr_read_b32 v113, a33
    v_mfma_f32_16x16x32_bf16 v[216:219], v[72:75], v[40:43], v[216:219]
    v_mfma_f32_16x16x32_bf16 v[248:251], v[72:75], v[44:47], v[248:251]
    ds_read_b64_tr_b16 v[72:73], v126 offset:8192
    v_accvgpr_read_b32 v114, a34
    v_mfma_f32_16x16x32_bf16 v[156:159], v[76:79], v[32:35], v[156:159]
    ds_read_b64_tr_b16 v[74:75], v126 offset:9216
    v_accvgpr_read_b32 v115, a35
    v_mfma_f32_16x16x32_bf16 v[188:191], v[76:79], v[36:39], v[188:191]
    v_accvgpr_read_b32 v116, a36
    v_mfma_f32_16x16x32_bf16 v[220:223], v[76:79], v[40:43], v[220:223]
    s_waitcnt vmcnt(12)
    v_accvgpr_read_b32 v117, a37
    v_mfma_f32_16x16x32_bf16 v[252:255], v[76:79], v[44:47], v[252:255]
    s_waitcnt lgkmcnt(10)
    ds_read_b64_tr_b16 v[76:77], v127 offset:8192
    v_mfma_f32_16x16x32_bf16 v[128:131], v[48:51], v[80:83], v[128:131]
    ds_read_b64_tr_b16 v[78:79], v127 offset:9216
    v_accvgpr_read_b32 v118, a38
    v_mfma_f32_16x16x32_bf16 v[160:163], v[48:51], v[84:87], v[160:163]
    v_add_u32 v120, 32768, v8
    v_xor_b32 v121, 32, v120
    v_mfma_f32_16x16x32_bf16 v[192:195], v[48:51], v[88:91], v[192:195]
    v_xor_b32 v122, 64, v120
    v_xor_b32 v123, 96, v120
    v_mfma_f32_16x16x32_bf16 v[224:227], v[48:51], v[92:95], v[224:227]
    s_waitcnt lgkmcnt(0)
    s_barrier
    v_xor_b32 v124, 128, v120
    v_mfma_f32_16x16x32_bf16 v[132:135], v[52:55], v[80:83], v[132:135]
    v_xor_b32 v125, 160, v120
    v_xor_b32 v126, 192, v120
    v_mfma_f32_16x16x32_bf16 v[164:167], v[52:55], v[84:87], v[164:167]
    v_xor_b32 v127, 224, v120
    v_accvgpr_read_b32 v119, a39
    v_mfma_f32_16x16x32_bf16 v[196:199], v[52:55], v[88:91], v[196:199]
    v_cvt_pk_bf16_f32 v112, v112, v113
    v_cvt_pk_bf16_f32 v113, v114, v115
    v_mfma_f32_16x16x32_bf16 v[228:231], v[52:55], v[92:95], v[228:231]
    v_cvt_pk_bf16_f32 v114, v116, v117
    v_cvt_pk_bf16_f32 v115, v118, v119
    v_mfma_f32_16x16x32_bf16 v[136:139], v[56:59], v[80:83], v[136:139]
    s_add_u32 s64, s56, 4096
    v_mfma_f32_16x16x32_bf16 v[168:171], v[56:59], v[84:87], v[168:171]
    ds_read_b64_tr_b16 v[48:49], v120 offset:0
    v_mfma_f32_16x16x32_bf16 v[200:203], v[56:59], v[88:91], v[200:203]
    ds_read_b64_tr_b16 v[50:51], v120 offset:1024
    v_mfma_f32_16x16x32_bf16 v[232:235], v[56:59], v[92:95], v[232:235]
    ds_read_b64_tr_b16 v[52:53], v121 offset:0
    v_mfma_f32_16x16x32_bf16 v[140:143], v[60:63], v[80:83], v[140:143]
    ds_read_b64_tr_b16 v[54:55], v121 offset:1024
    v_mfma_f32_16x16x32_bf16 v[172:175], v[60:63], v[84:87], v[172:175]
    ds_read_b64_tr_b16 v[56:57], v122 offset:0
    v_mfma_f32_16x16x32_bf16 v[204:207], v[60:63], v[88:91], v[204:207]
    ds_read_b64_tr_b16 v[58:59], v122 offset:1024
    v_mfma_f32_16x16x32_bf16 v[236:239], v[60:63], v[92:95], v[236:239]
    ds_read_b64_tr_b16 v[60:61], v123 offset:0
    v_mfma_f32_16x16x32_bf16 v[144:147], v[64:67], v[80:83], v[144:147]
    ds_read_b64_tr_b16 v[62:63], v123 offset:1024
    v_mfma_f32_16x16x32_bf16 v[176:179], v[64:67], v[84:87], v[176:179]
    buffer_store_dwordx4 v[112:115], v1, s[24:27], s64 offen offset:0
    v_mfma_f32_16x16x32_bf16 v[208:211], v[64:67], v[88:91], v[208:211]
    s_nop 0
    v_accvgpr_read_b32 v112, a40
    v_accvgpr_read_b32 v113, a41
    v_mfma_f32_16x16x32_bf16 v[240:243], v[64:67], v[92:95], v[240:243]
    ds_read_b64_tr_b16 v[64:65], v124 offset:0
    v_accvgpr_read_b32 v114, a42
    v_mfma_f32_16x16x32_bf16 v[148:151], v[68:71], v[80:83], v[148:151]
    ds_read_b64_tr_b16 v[66:67], v124 offset:1024
    v_accvgpr_read_b32 v115, a43
    v_mfma_f32_16x16x32_bf16 v[180:183], v[68:71], v[84:87], v[180:183]
    v_accvgpr_read_b32 v116, a44
    v_accvgpr_read_b32 v117, a45
    v_mfma_f32_16x16x32_bf16 v[212:215], v[68:71], v[88:91], v[212:215]
    v_accvgpr_read_b32 v118, a46
    v_accvgpr_read_b32 v119, a47
    v_mfma_f32_16x16x32_bf16 v[244:247], v[68:71], v[92:95], v[244:247]
    ds_read_b64_tr_b16 v[68:69], v125 offset:0
    v_cvt_pk_bf16_f32 v112, v112, v113
    v_mfma_f32_16x16x32_bf16 v[152:155], v[72:75], v[80:83], v[152:155]
    s_add_u32 s48, s52, 4096
    ds_read_b64_tr_b16 v[70:71], v125 offset:1024
    v_cvt_pk_bf16_f32 v113, v114, v115
    v_mfma_f32_16x16x32_bf16 v[184:187], v[72:75], v[84:87], v[184:187]
    v_cvt_pk_bf16_f32 v114, v116, v117
    v_cvt_pk_bf16_f32 v115, v118, v119
    v_mfma_f32_16x16x32_bf16 v[216:219], v[72:75], v[88:91], v[216:219]
    s_add_u32 s64, s56, 4096
    buffer_load_dwordx4 a[32:35], v1, s[20:23], s48 offen offset:2048 sc1
    v_mfma_f32_16x16x32_bf16 v[248:251], v[72:75], v[92:95], v[248:251]
    s_add_u32 s48, s52, 24576
    ds_read_b64_tr_b16 v[72:73], v126 offset:0
    v_mfma_f32_16x16x32_bf16 v[156:159], v[76:79], v[80:83], v[156:159]
    ds_read_b64_tr_b16 v[74:75], v126 offset:1024
    v_mfma_f32_16x16x32_bf16 v[188:191], v[76:79], v[84:87], v[188:191]
    buffer_store_dwordx4 v[112:115], v1, s[24:27], s64 offen offset:1024
    v_mfma_f32_16x16x32_bf16 v[220:223], v[76:79], v[88:91], v[220:223]
    s_waitcnt vmcnt(9)
    s_nop 0
    v_accvgpr_read_b32 v112, a48
    v_mfma_f32_16x16x32_bf16 v[252:255], v[76:79], v[92:95], v[252:255]
    s_waitcnt lgkmcnt(10)
    ds_read_b64_tr_b16 v[76:77], v127 offset:0
    v_mfma_f32_16x16x32_bf16 v[128:131], v[48:51], a[0:3], v[128:131]
    ds_read_b64_tr_b16 v[78:79], v127 offset:1024
    v_accvgpr_read_b32 v113, a49
    v_mfma_f32_16x16x32_bf16 v[160:163], v[48:51], a[4:7], v[160:163]
    buffer_load_dwordx4 a[36:39], v1, s[20:23], s48 offen offset:2048 sc1
    v_accvgpr_read_b32 v114, a50
    v_mfma_f32_16x16x32_bf16 v[192:195], v[48:51], a[8:11], v[192:195]
    s_add_u32 s48, s53, 4096
    buffer_load_dwordx4 a[40:43], v1, s[20:23], s48 offen offset:2048 sc1
    v_accvgpr_read_b32 v115, a51
    v_mfma_f32_16x16x32_bf16 v[224:227], v[48:51], a[12:15], v[224:227]
    s_add_u32 s48, s53, 24576
    ds_read_b64_tr_b16 v[48:49], v120 offset:8192
    v_accvgpr_read_b32 v116, a52
    v_mfma_f32_16x16x32_bf16 v[132:135], v[52:55], a[0:3], v[132:135]
    ds_read_b64_tr_b16 v[50:51], v120 offset:9216
    v_mfma_f32_16x16x32_bf16 v[164:167], v[52:55], a[4:7], v[164:167]
    buffer_load_dwordx4 a[44:47], v1, s[20:23], s48 offen offset:2048 sc1
    v_accvgpr_read_b32 v117, a53
    v_mfma_f32_16x16x32_bf16 v[196:199], v[52:55], a[8:11], v[196:199]
    v_accvgpr_read_b32 v118, a54
    v_mfma_f32_16x16x32_bf16 v[228:231], v[52:55], a[12:15], v[228:231]
    s_waitcnt lgkmcnt(10)
    ds_read_b64_tr_b16 v[52:53], v121 offset:8192
    v_accvgpr_read_b32 v119, a55
    v_mfma_f32_16x16x32_bf16 v[136:139], v[56:59], a[0:3], v[136:139]
    ds_read_b64_tr_b16 v[54:55], v121 offset:9216
    v_cvt_pk_bf16_f32 v112, v112, v113
    v_mfma_f32_16x16x32_bf16 v[168:171], v[56:59], a[4:7], v[168:171]
    v_mfma_f32_16x16x32_bf16 v[200:203], v[56:59], a[8:11], v[200:203]
    v_cvt_pk_bf16_f32 v113, v114, v115
    v_mfma_f32_16x16x32_bf16 v[232:235], v[56:59], a[12:15], v[232:235]
    ds_read_b64_tr_b16 v[56:57], v122 offset:8192
    v_cvt_pk_bf16_f32 v114, v116, v117
    v_mfma_f32_16x16x32_bf16 v[140:143], v[60:63], a[0:3], v[140:143]
    ds_read_b64_tr_b16 v[58:59], v122 offset:9216
    v_cvt_pk_bf16_f32 v115, v118, v119
    v_mfma_f32_16x16x32_bf16 v[172:175], v[60:63], a[4:7], v[172:175]
    v_mfma_f32_16x16x32_bf16 v[204:207], v[60:63], a[8:11], v[204:207]
    s_add_u32 s64, s56, 4096
    v_mfma_f32_16x16x32_bf16 v[236:239], v[60:63], a[12:15], v[236:239]
    s_waitcnt lgkmcnt(10)
    ds_read_b64_tr_b16 v[60:61], v123 offset:8192
    v_mfma_f32_16x16x32_bf16 v[144:147], v[64:67], a[0:3], v[144:147]
    ds_read_b64_tr_b16 v[62:63], v123 offset:9216
    v_mfma_f32_16x16x32_bf16 v[176:179], v[64:67], a[4:7], v[176:179]
    buffer_store_dwordx4 v[112:115], v1, s[24:27], s64 offen offset:2048
    v_mfma_f32_16x16x32_bf16 v[208:211], v[64:67], a[8:11], v[208:211]
    s_nop 0
    v_accvgpr_read_b32 v112, a56
    v_mfma_f32_16x16x32_bf16 v[240:243], v[64:67], a[12:15], v[240:243]
    ds_read_b64_tr_b16 v[64:65], v124 offset:8192
    v_accvgpr_read_b32 v113, a57
    v_mfma_f32_16x16x32_bf16 v[148:151], v[68:71], a[0:3], v[148:151]
    ds_read_b64_tr_b16 v[66:67], v124 offset:9216
    v_accvgpr_read_b32 v114, a58
    v_mfma_f32_16x16x32_bf16 v[180:183], v[68:71], a[4:7], v[180:183]
    v_accvgpr_read_b32 v115, a59
    v_mfma_f32_16x16x32_bf16 v[212:215], v[68:71], a[8:11], v[212:215]
    v_accvgpr_read_b32 v116, a60
    v_mfma_f32_16x16x32_bf16 v[244:247], v[68:71], a[12:15], v[244:247]
    s_waitcnt lgkmcnt(10)
    ds_read_b64_tr_b16 v[68:69], v125 offset:8192
    v_mfma_f32_16x16x32_bf16 v[152:155], v[72:75], a[0:3], v[152:155]
    ds_read_b64_tr_b16 v[70:71], v125 offset:9216
    v_accvgpr_read_b32 v117, a61
    v_mfma_f32_16x16x32_bf16 v[184:187], v[72:75], a[4:7], v[184:187]
    v_accvgpr_read_b32 v118, a62
    v_mfma_f32_16x16x32_bf16 v[216:219], v[72:75], a[8:11], v[216:219]
    v_accvgpr_read_b32 v119, a63
    v_mfma_f32_16x16x32_bf16 v[248:251], v[72:75], a[12:15], v[248:251]
    s_add_u32 s48, s52, 4096
    ds_read_b64_tr_b16 v[72:73], v126 offset:8192
    v_mfma_f32_16x16x32_bf16 v[156:159], v[76:79], a[0:3], v[156:159]
    ds_read_b64_tr_b16 v[74:75], v126 offset:9216
    v_cvt_pk_bf16_f32 v112, v112, v113
    v_mfma_f32_16x16x32_bf16 v[188:191], v[76:79], a[4:7], v[188:191]
    buffer_load_dwordx4 a[48:51], v1, s[20:23], s48 offen offset:3072 sc1
    v_cvt_pk_bf16_f32 v113, v114, v115
    v_mfma_f32_16x16x32_bf16 v[220:223], v[76:79], a[8:11], v[220:223]
    s_waitcnt vmcnt(8)
    s_add_u32 s48, s52, 24576
    v_cvt_pk_bf16_f32 v114, v116, v117
    v_mfma_f32_16x16x32_bf16 v[252:255], v[76:79], a[12:15], v[252:255]
    s_waitcnt lgkmcnt(10)
    ds_read_b64_tr_b16 v[76:77], v127 offset:8192
    v_cvt_pk_bf16_f32 v115, v118, v119
    v_mfma_f32_16x16x32_bf16 v[128:131], v[48:51], a[16:19], v[128:131]
    ds_read_b64_tr_b16 v[78:79], v127 offset:9216
    v_mfma_f32_16x16x32_bf16 v[160:163], v[48:51], a[20:23], v[160:163]
    s_add_u32 s64, s56, 4096
    v_add_u32 v120, 49152, v8
    v_xor_b32 v121, 32, v120
    v_mfma_f32_16x16x32_bf16 v[192:195], v[48:51], a[24:27], v[192:195]
    v_xor_b32 v122, 64, v120
    v_xor_b32 v123, 96, v120
    v_mfma_f32_16x16x32_bf16 v[224:227], v[48:51], a[28:31], v[224:227]
    v_xor_b32 v124, 128, v120
    v_xor_b32 v125, 160, v120
    v_mfma_f32_16x16x32_bf16 v[132:135], v[52:55], a[16:19], v[132:135]
    v_xor_b32 v126, 192, v120
    v_xor_b32 v127, 224, v120
    v_mfma_f32_16x16x32_bf16 v[164:167], v[52:55], a[20:23], v[164:167]
    buffer_store_dwordx4 v[112:115], v1, s[24:27], s64 offen offset:3072
    v_mfma_f32_16x16x32_bf16 v[196:199], v[52:55], a[24:27], v[196:199]
    s_nop 0
    v_accvgpr_read_b32 v112, a64
    v_accvgpr_read_b32 v113, a65
    v_mfma_f32_16x16x32_bf16 v[228:231], v[52:55], a[28:31], v[228:231]
    s_waitcnt lgkmcnt(8)
    buffer_load_dwordx4 a[52:55], v1, s[20:23], s48 offen offset:3072 sc1
    v_accvgpr_read_b32 v114, a66
    v_mfma_f32_16x16x32_bf16 v[136:139], v[56:59], a[16:19], v[136:139]
    s_add_u32 s48, s53, 4096
    buffer_load_dwordx4 a[56:59], v1, s[20:23], s48 offen offset:3072 sc1
    v_accvgpr_read_b32 v115, a67
    v_mfma_f32_16x16x32_bf16 v[168:171], v[56:59], a[20:23], v[168:171]
    s_add_u32 s48, s53, 24576
    ds_read_b64_tr_b16 v[48:49], v120 offset:0
    v_mfma_f32_16x16x32_bf16 v[200:203], v[56:59], a[24:27], v[200:203]
    ds_read_b64_tr_b16 v[50:51], v120 offset:1024
    v_accvgpr_read_b32 v116, a68
    v_mfma_f32_16x16x32_bf16 v[232:235], v[56:59], a[28:31], v[232:235]
    ds_read_b64_tr_b16 v[52:53], v121 offset:0
    v_accvgpr_read_b32 v117, a69
    v_mfma_f32_16x16x32_bf16 v[140:143], v[60:63], a[16:19], v[140:143]
    ds_read_b64_tr_b16 v[54:55], v121 offset:1024
    v_accvgpr_read_b32 v118, a70
    v_mfma_f32_16x16x32_bf16 v[172:175], v[60:63], a[20:23], v[172:175]
    ds_read_b64_tr_b16 v[56:57], v122 offset:0
    v_accvgpr_read_b32 v119, a71
    v_mfma_f32_16x16x32_bf16 v[204:207], v[60:63], a[24:27], v[204:207]
    ds_read_b64_tr_b16 v[58:59], v122 offset:1024
    v_mfma_f32_16x16x32_bf16 v[236:239], v[60:63], a[28:31], v[236:239]
    s_waitcnt lgkmcnt(10)
    ds_read_b64_tr_b16 v[60:61], v123 offset:0
    v_cvt_pk_bf16_f32 v112, v112, v113
    v_mfma_f32_16x16x32_bf16 v[144:147], v[64:67], a[16:19], v[144:147]
    ds_read_b64_tr_b16 v[62:63], v123 offset:1024
    v_cvt_pk_bf16_f32 v113, v114, v115
    v_mfma_f32_16x16x32_bf16 v[176:179], v[64:67], a[20:23], v[176:179]
    buffer_load_dwordx4 a[60:63], v1, s[20:23], s48 offen offset:3072 sc1
    v_cvt_pk_bf16_f32 v114, v116, v117
    v_mfma_f32_16x16x32_bf16 v[208:211], v[64:67], a[24:27], v[208:211]
    s_add_u32 s48, s52, 8192
    buffer_load_dwordx4 v[16:19], v1, s[20:23], s48 offen offset:0 sc1
    v_mfma_f32_16x16x32_bf16 v[240:243], v[64:67], a[28:31], v[240:243]
    s_add_u32 s48, s52, 28672
    ds_read_b64_tr_b16 v[64:65], v124 offset:0
    v_cvt_pk_bf16_f32 v115, v118, v119
    v_mfma_f32_16x16x32_bf16 v[148:151], v[68:71], a[16:19], v[148:151]
    s_add_u32 s64, s56, 8192
    ds_read_b64_tr_b16 v[66:67], v124 offset:1024
    v_mfma_f32_16x16x32_bf16 v[180:183], v[68:71], a[20:23], v[180:183]
    buffer_store_dwordx4 v[112:115], v1, s[24:27], s64 offen offset:0
    v_mfma_f32_16x16x32_bf16 v[212:215], v[68:71], a[24:27], v[212:215]
    s_nop 0
    buffer_load_dwordx4 v[20:23], v1, s[20:23], s48 offen offset:0 sc1
    v_mfma_f32_16x16x32_bf16 v[244:247], v[68:71], a[28:31], v[244:247]
    s_waitcnt lgkmcnt(10)
    s_add_u32 s48, s53, 8192
    ds_read_b64_tr_b16 v[68:69], v125 offset:0
    v_mfma_f32_16x16x32_bf16 v[152:155], v[72:75], a[16:19], v[152:155]
    ds_read_b64_tr_b16 v[70:71], v125 offset:1024
    v_accvgpr_read_b32 v112, a72
    v_mfma_f32_16x16x32_bf16 v[184:187], v[72:75], a[20:23], v[184:187]
    buffer_load_dwordx4 v[24:27], v1, s[20:23], s48 offen offset:0 sc1
    v_accvgpr_read_b32 v113, a73
    v_mfma_f32_16x16x32_bf16 v[216:219], v[72:75], a[24:27], v[216:219]
    s_add_u32 s48, s53, 28672
    buffer_load_dwordx4 v[28:31], v1, s[20:23], s48 offen offset:0 sc1
    v_accvgpr_read_b32 v114, a74
    v_mfma_f32_16x16x32_bf16 v[248:251], v[72:75], a[28:31], v[248:251]
    s_add_u32 s48, s52, 8192
    ds_read_b64_tr_b16 v[72:73], v126 offset:0
    v_accvgpr_read_b32 v115, a75
    v_mfma_f32_16x16x32_bf16 v[156:159], v[76:79], a[16:19], v[156:159]
    ds_read_b64_tr_b16 v[74:75], v126 offset:1024
    v_mfma_f32_16x16x32_bf16 v[188:191], v[76:79], a[20:23], v[188:191]
    buffer_load_dwordx4 v[96:99], v1, s[20:23], s48 offen offset:1024 sc1
    v_accvgpr_read_b32 v116, a76
    v_mfma_f32_16x16x32_bf16 v[220:223], v[76:79], a[24:27], v[220:223]
    s_waitcnt vmcnt(12)
    s_add_u32 s48, s52, 28672
    v_accvgpr_read_b32 v117, a77
    v_mfma_f32_16x16x32_bf16 v[252:255], v[76:79], a[28:31], v[252:255]
    s_waitcnt lgkmcnt(10)
    ds_read_b64_tr_b16 v[76:77], v127 offset:0
    v_accvgpr_read_b32 v118, a78
    v_mfma_f32_16x16x32_bf16 v[128:131], v[48:51], a[32:35], v[128:131]
    ds_read_b64_tr_b16 v[78:79], v127 offset:1024
    v_mfma_f32_16x16x32_bf16 v[160:163], v[48:51], a[36:39], v[160:163]
    buffer_load_dwordx4 v[100:103], v1, s[20:23], s48 offen offset:1024 sc1
    v_accvgpr_read_b32 v119, a79
    v_mfma_f32_16x16x32_bf16 v[192:195], v[48:51], a[40:43], v[192:195]
    s_add_u32 s48, s53, 8192
    buffer_load_dwordx4 v[104:107], v1, s[20:23], s48 offen offset:1024 sc1
    v_cvt_pk_bf16_f32 v112, v112, v113
    v_mfma_f32_16x16x32_bf16 v[224:227], v[48:51], a[44:47], v[224:227]
    s_add_u32 s48, s53, 28672
    ds_read_b64_tr_b16 v[48:49], v120 offset:8192
    v_cvt_pk_bf16_f32 v113, v114, v115
    v_mfma_f32_16x16x32_bf16 v[132:135], v[52:55], a[32:35], v[132:135]
    ds_read_b64_tr_b16 v[50:51], v120 offset:9216
    v_cvt_pk_bf16_f32 v114, v116, v117
    v_mfma_f32_16x16x32_bf16 v[164:167], v[52:55], a[36:39], v[164:167]
    buffer_load_dwordx4 v[108:111], v1, s[20:23], s48 offen offset:1024 sc1
    v_mfma_f32_16x16x32_bf16 v[196:199], v[52:55], a[40:43], v[196:199]
    s_add_u32 s48, s52, 8192
    buffer_load_dwordx4 v[32:35], v1, s[20:23], s48 offen offset:2048 sc1
    v_cvt_pk_bf16_f32 v115, v118, v119
    v_mfma_f32_16x16x32_bf16 v[228:231], v[52:55], a[44:47], v[228:231]
    s_waitcnt lgkmcnt(10)
    s_add_u32 s64, s56, 8192
    ds_read_b64_tr_b16 v[52:53], v121 offset:8192
    v_mfma_f32_16x16x32_bf16 v[136:139], v[56:59], a[32:35], v[136:139]
    s_add_u32 s48, s52, 28672
    ds_read_b64_tr_b16 v[54:55], v121 offset:9216
    v_mfma_f32_16x16x32_bf16 v[168:171], v[56:59], a[36:39], v[168:171]
    buffer_store_dwordx4 v[112:115], v1, s[24:27], s64 offen offset:1024
    v_mfma_f32_16x16x32_bf16 v[200:203], v[56:59], a[40:43], v[200:203]
    s_nop 0
    buffer_load_dwordx4 v[36:39], v1, s[20:23], s48 offen offset:2048 sc1
    v_mfma_f32_16x16x32_bf16 v[232:235], v[56:59], a[44:47], v[232:235]
    s_add_u32 s48, s53, 8192
    ds_read_b64_tr_b16 v[56:57], v122 offset:8192
    v_accvgpr_read_b32 v112, a80
    v_mfma_f32_16x16x32_bf16 v[140:143], v[60:63], a[32:35], v[140:143]
    ds_read_b64_tr_b16 v[58:59], v122 offset:9216
    v_accvgpr_read_b32 v113, a81
    v_mfma_f32_16x16x32_bf16 v[172:175], v[60:63], a[36:39], v[172:175]
    buffer_load_dwordx4 v[40:43], v1, s[20:23], s48 offen offset:2048 sc1
    v_accvgpr_read_b32 v114, a82
    v_mfma_f32_16x16x32_bf16 v[204:207], v[60:63], a[40:43], v[204:207]
    s_add_u32 s48, s53, 28672
    buffer_load_dwordx4 v[44:47], v1, s[20:23], s48 offen offset:2048 sc1
    v_mfma_f32_16x16x32_bf16 v[236:239], v[60:63], a[44:47], v[236:239]
    s_waitcnt lgkmcnt(10)
    ds_read_b64_tr_b16 v[60:61], v123 offset:8192
    v_accvgpr_read_b32 v115, a83
    v_mfma_f32_16x16x32_bf16 v[144:147], v[64:67], a[32:35], v[144:147]
    s_add_u32 s48, s52, 8192
    ds_read_b64_tr_b16 v[62:63], v123 offset:9216
    v_accvgpr_read_b32 v116, a84
    v_mfma_f32_16x16x32_bf16 v[176:179], v[64:67], a[36:39], v[176:179]
    buffer_load_dwordx4 v[80:83], v1, s[20:23], s48 offen offset:3072 sc1
    v_accvgpr_read_b32 v117, a85
    v_mfma_f32_16x16x32_bf16 v[208:211], v[64:67], a[40:43], v[208:211]
    s_add_u32 s48, s52, 28672
    buffer_load_dwordx4 v[84:87], v1, s[20:23], s48 offen offset:3072 sc1
    v_accvgpr_read_b32 v118, a86
    v_mfma_f32_16x16x32_bf16 v[240:243], v[64:67], a[44:47], v[240:243]
    s_add_u32 s48, s53, 8192
    ds_read_b64_tr_b16 v[64:65], v124 offset:8192
    v_mfma_f32_16x16x32_bf16 v[148:151], v[68:71], a[32:35], v[148:151]
    ds_read_b64_tr_b16 v[66:67], v124 offset:9216
    v_accvgpr_read_b32 v119, a87
    v_mfma_f32_16x16x32_bf16 v[180:183], v[68:71], a[36:39], v[180:183]
    buffer_load_dwordx4 v[88:91], v1, s[20:23], s48 offen offset:3072 sc1
    v_cvt_pk_bf16_f32 v112, v112, v113
    v_mfma_f32_16x16x32_bf16 v[212:215], v[68:71], a[40:43], v[212:215]
    s_add_u32 s48, s53, 28672
    buffer_load_dwordx4 v[92:95], v1, s[20:23], s48 offen offset:3072 sc1
    v_cvt_pk_bf16_f32 v113, v114, v115
    v_mfma_f32_16x16x32_bf16 v[244:247], v[68:71], a[44:47], v[244:247]
    s_waitcnt lgkmcnt(10)
    s_add_u32 s48, s52, 12288
    ds_read_b64_tr_b16 v[68:69], v125 offset:8192
    v_mfma_f32_16x16x32_bf16 v[152:155], v[72:75], a[32:35], v[152:155]
    ds_read_b64_tr_b16 v[70:71], v125 offset:9216
    v_cvt_pk_bf16_f32 v114, v116, v117
    v_mfma_f32_16x16x32_bf16 v[184:187], v[72:75], a[36:39], v[184:187]
    buffer_load_dwordx4 a[0:3], v1, s[20:23], s48 offen offset:0 sc1
    v_cvt_pk_bf16_f32 v115, v118, v119
    v_mfma_f32_16x16x32_bf16 v[216:219], v[72:75], a[40:43], v[216:219]
    s_add_u32 s64, s56, 8192
    s_add_u32 s48, s52, 32768
    buffer_load_dwordx4 a[4:7], v1, s[20:23], s48 offen offset:0 sc1
    v_mfma_f32_16x16x32_bf16 v[248:251], v[72:75], a[44:47], v[248:251]
    s_add_u32 s48, s53, 12288
    ds_read_b64_tr_b16 v[72:73], v126 offset:8192
    v_mfma_f32_16x16x32_bf16 v[156:159], v[76:79], a[32:35], v[156:159]
    ds_read_b64_tr_b16 v[74:75], v126 offset:9216
    v_mfma_f32_16x16x32_bf16 v[188:191], v[76:79], a[36:39], v[188:191]
    buffer_store_dwordx4 v[112:115], v1, s[24:27], s64 offen offset:2048
    v_mfma_f32_16x16x32_bf16 v[220:223], v[76:79], a[40:43], v[220:223]
    s_waitcnt vmcnt(21)
    s_nop 0
    v_accvgpr_read_b32 v112, a88
    v_mfma_f32_16x16x32_bf16 v[252:255], v[76:79], a[44:47], v[252:255]
    s_waitcnt lgkmcnt(10)
    ds_read_b64_tr_b16 v[76:77], v127 offset:8192
    v_accvgpr_read_b32 v113, a89
    v_mfma_f32_16x16x32_bf16 v[128:131], v[48:51], a[48:51], v[128:131]
    ds_read_b64_tr_b16 v[78:79], v127 offset:9216
    v_accvgpr_read_b32 v114, a90
    v_mfma_f32_16x16x32_bf16 v[160:163], v[48:51], a[52:55], v[160:163]
    v_add_u32 v120, 65536, v8
    v_xor_b32 v121, 32, v120
    v_mfma_f32_16x16x32_bf16 v[192:195], v[48:51], a[56:59], v[192:195]
    v_xor_b32 v122, 64, v120
    v_xor_b32 v123, 96, v120
    v_mfma_f32_16x16x32_bf16 v[224:227], v[48:51], a[60:63], v[224:227]
    v_xor_b32 v124, 128, v120
    v_xor_b32 v125, 160, v120
    v_mfma_f32_16x16x32_bf16 v[132:135], v[52:55], a[48:51], v[132:135]
    v_xor_b32 v126, 192, v120
    v_xor_b32 v127, 224, v120
    v_mfma_f32_16x16x32_bf16 v[164:167], v[52:55], a[52:55], v[164:167]
    v_accvgpr_read_b32 v115, a91
    v_accvgpr_read_b32 v116, a92
    v_mfma_f32_16x16x32_bf16 v[196:199], v[52:55], a[56:59], v[196:199]
    v_accvgpr_read_b32 v117, a93
    v_accvgpr_read_b32 v118, a94
    v_mfma_f32_16x16x32_bf16 v[228:231], v[52:55], a[60:63], v[228:231]
    s_waitcnt lgkmcnt(8)
    buffer_load_dwordx4 a[8:11], v1, s[20:23], s48 offen offset:0 sc1
    v_accvgpr_read_b32 v119, a95
    v_mfma_f32_16x16x32_bf16 v[136:139], v[56:59], a[48:51], v[136:139]
    s_add_u32 s48, s53, 32768
    buffer_load_dwordx4 a[12:15], v1, s[20:23], s48 offen offset:0 sc1
    v_cvt_pk_bf16_f32 v112, v112, v113
    v_mfma_f32_16x16x32_bf16 v[168:171], v[56:59], a[52:55], v[168:171]
    s_add_u32 s48, s52, 12288
    ds_read_b64_tr_b16 v[48:49], v120 offset:0
    v_cvt_pk_bf16_f32 v113, v114, v115
    v_mfma_f32_16x16x32_bf16 v[200:203], v[56:59], a[56:59], v[200:203]
    ds_read_b64_tr_b16 v[50:51], v120 offset:1024
    v_mfma_f32_16x16x32_bf16 v[232:235], v[56:59], a[60:63], v[232:235]
    ds_read_b64_tr_b16 v[52:53], v121 offset:0
    v_cvt_pk_bf16_f32 v114, v116, v117
    v_mfma_f32_16x16x32_bf16 v[140:143], v[60:63], a[48:51], v[140:143]
    ds_read_b64_tr_b16 v[54:55], v121 offset:1024
    v_cvt_pk_bf16_f32 v115, v118, v119
    v_mfma_f32_16x16x32_bf16 v[172:175], v[60:63], a[52:55], v[172:175]
    s_add_u32 s64, s56, 8192
    ds_read_b64_tr_b16 v[56:57], v122 offset:0
    v_mfma_f32_16x16x32_bf16 v[204:207], v[60:63], a[56:59], v[204:207]
    ds_read_b64_tr_b16 v[58:59], v122 offset:1024
    v_mfma_f32_16x16x32_bf16 v[236:239], v[60:63], a[60:63], v[236:239]
    s_waitcnt lgkmcnt(10)
    ds_read_b64_tr_b16 v[60:61], v123 offset:0
    v_mfma_f32_16x16x32_bf16 v[144:147], v[64:67], a[48:51], v[144:147]
    ds_read_b64_tr_b16 v[62:63], v123 offset:1024
    v_mfma_f32_16x16x32_bf16 v[176:179], v[64:67], a[52:55], v[176:179]
    buffer_store_dwordx4 v[112:115], v1, s[24:27], s64 offen offset:3072
    v_mfma_f32_16x16x32_bf16 v[208:211], v[64:67], a[56:59], v[208:211]
    s_nop 0
    v_accvgpr_read_b32 v112, a96
    v_accvgpr_read_b32 v113, a97
    v_mfma_f32_16x16x32_bf16 v[240:243], v[64:67], a[60:63], v[240:243]
    ds_read_b64_tr_b16 v[64:65], v124 offset:0
    v_mfma_f32_16x16x32_bf16 v[148:151], v[68:71], a[48:51], v[148:151]
    ds_read_b64_tr_b16 v[66:67], v124 offset:1024
    v_accvgpr_read_b32 v114, a98
    v_mfma_f32_16x16x32_bf16 v[180:183], v[68:71], a[52:55], v[180:183]
    buffer_load_dwordx4 a[16:19], v1, s[20:23], s48 offen offset:1024 sc1
    v_accvgpr_read_b32 v115, a99
    v_mfma_f32_16x16x32_bf16 v[212:215], v[68:71], a[56:59], v[212:215]
    s_add_u32 s48, s52, 32768
    buffer_load_dwordx4 a[20:23], v1, s[20:23], s48 offen offset:1024 sc1
    v_accvgpr_read_b32 v116, a100
    v_mfma_f32_16x16x32_bf16 v[244:247], v[68:71], a[60:63], v[244:247]
    s_waitcnt lgkmcnt(10)
    ds_read_b64_tr_b16 v[68:69], v125 offset:0
    v_accvgpr_read_b32 v117, a101
    v_mfma_f32_16x16x32_bf16 v[152:155], v[72:75], a[48:51], v[152:155]
    s_add_u32 s48, s53, 12288
    ds_read_b64_tr_b16 v[70:71], v125 offset:1024
    v_mfma_f32_16x16x32_bf16 v[184:187], v[72:75], a[52:55], v[184:187]
    buffer_load_dwordx4 a[24:27], v1, s[20:23], s48 offen offset:1024 sc1
    v_accvgpr_read_b32 v118, a102
    v_mfma_f32_16x16x32_bf16 v[216:219], v[72:75], a[56:59], v[216:219]
    s_add_u32 s48, s53, 32768
    buffer_load_dwordx4 a[28:31], v1, s[20:23], s48 offen offset:1024 sc1
    v_accvgpr_read_b32 v119, a103
    v_mfma_f32_16x16x32_bf16 v[248:251], v[72:75], a[60:63], v[248:251]
    s_add_u32 s48, s52, 12288
    ds_read_b64_tr_b16 v[72:73], v126 offset:0
    v_cvt_pk_bf16_f32 v112, v112, v113
    v_mfma_f32_16x16x32_bf16 v[156:159], v[76:79], a[48:51], v[156:159]
    ds_read_b64_tr_b16 v[74:75], v126 offset:1024
    v_cvt_pk_bf16_f32 v113, v114, v115
    v_mfma_f32_16x16x32_bf16 v[188:191], v[76:79], a[52:55], v[188:191]
    buffer_load_dwordx4 a[32:35], v1, s[20:23], s48 offen offset:2048 sc1
    v_mfma_f32_16x16x32_bf16 v[220:223], v[76:79], a[56:59], v[220:223]
    s_waitcnt vmcnt(24)
    s_add_u32 s48, s52, 32768
    v_cvt_pk_bf16_f32 v114, v116, v117
    v_mfma_f32_16x16x32_bf16 v[252:255], v[76:79], a[60:63], v[252:255]
    s_waitcnt lgkmcnt(10)
    ds_read_b64_tr_b16 v[76:77], v127 offset:0
    v_cvt_pk_bf16_f32 v115, v118, v119
    v_mfma_f32_16x16x32_bf16 v[128:131], v[48:51], v[16:19], v[128:131]
    s_add_u32 s64, s56, 12288
    ds_read_b64_tr_b16 v[78:79], v127 offset:1024
    v_mfma_f32_16x16x32_bf16 v[160:163], v[48:51], v[20:23], v[160:163]
    buffer_load_dwordx4 a[36:39], v1, s[20:23], s48 offen offset:2048 sc1
    v_mfma_f32_16x16x32_bf16 v[192:195], v[48:51], v[24:27], v[192:195]
    s_add_u32 s48, s53, 12288
    buffer_store_dwordx4 v[112:115], v1, s[24:27], s64 offen offset:0
    v_mfma_f32_16x16x32_bf16 v[224:227], v[48:51], v[28:31], v[224:227]
    s_nop 0
    ds_read_b64_tr_b16 v[48:49], v120 offset:8192
    v_mfma_f32_16x16x32_bf16 v[132:135], v[52:55], v[16:19], v[132:135]
    ds_read_b64_tr_b16 v[50:51], v120 offset:9216
    v_accvgpr_read_b32 v112, a104
    v_mfma_f32_16x16x32_bf16 v[164:167], v[52:55], v[20:23], v[164:167]
    buffer_load_dwordx4 a[40:43], v1, s[20:23], s48 offen offset:2048 sc1
    v_accvgpr_read_b32 v113, a105
    v_mfma_f32_16x16x32_bf16 v[196:199], v[52:55], v[24:27], v[196:199]
    s_add_u32 s48, s53, 32768
    buffer_load_dwordx4 a[44:47], v1, s[20:23], s48 offen offset:2048 sc1
    v_mfma_f32_16x16x32_bf16 v[228:231], v[52:55], v[28:31], v[228:231]
    s_waitcnt lgkmcnt(10)
    ds_read_b64_tr_b16 v[52:53], v121 offset:8192
    v_accvgpr_read_b32 v114, a106
    v_mfma_f32_16x16x32_bf16 v[136:139], v[56:59], v[16:19], v[136:139]
    s_add_u32 s48, s52, 12288
    ds_read_b64_tr_b16 v[54:55], v121 offset:9216
    v_accvgpr_read_b32 v115, a107
    v_mfma_f32_16x16x32_bf16 v[168:171], v[56:59], v[20:23], v[168:171]
    buffer_load_dwordx4 a[48:51], v1, s[20:23], s48 offen offset:3072 sc1
    v_accvgpr_read_b32 v116, a108
    v_mfma_f32_16x16x32_bf16 v[200:203], v[56:59], v[24:27], v[200:203]
    s_add_u32 s48, s52, 32768
    buffer_load_dwordx4 a[52:55], v1, s[20:23], s48 offen offset:3072 sc1
    v_mfma_f32_16x16x32_bf16 v[232:235], v[56:59], v[28:31], v[232:235]
    s_add_u32 s48, s53, 12288
    ds_read_b64_tr_b16 v[56:57], v122 offset:8192
    v_accvgpr_read_b32 v117, a109
    v_mfma_f32_16x16x32_bf16 v[140:143], v[60:63], v[16:19], v[140:143]
    ds_read_b64_tr_b16 v[58:59], v122 offset:9216
    v_accvgpr_read_b32 v118, a110
    v_mfma_f32_16x16x32_bf16 v[172:175], v[60:63], v[20:23], v[172:175]
    buffer_load_dwordx4 a[56:59], v1, s[20:23], s48 offen offset:3072 sc1
    v_accvgpr_read_b32 v119, a111
    v_mfma_f32_16x16x32_bf16 v[204:207], v[60:63], v[24:27], v[204:207]
    s_add_u32 s48, s53, 32768
    buffer_load_dwordx4 a[60:63], v1, s[20:23], s48 offen offset:3072 sc1
    v_cvt_pk_bf16_f32 v112, v112, v113
    v_mfma_f32_16x16x32_bf16 v[236:239], v[60:63], v[28:31], v[236:239]
    s_waitcnt lgkmcnt(10)
    ds_read_b64_tr_b16 v[60:61], v123 offset:8192
    v_mfma_f32_16x16x32_bf16 v[144:147], v[64:67], v[16:19], v[144:147]
    ds_read_b64_tr_b16 v[62:63], v123 offset:9216
    v_cvt_pk_bf16_f32 v113, v114, v115
    v_mfma_f32_16x16x32_bf16 v[176:179], v[64:67], v[20:23], v[176:179]
    v_cvt_pk_bf16_f32 v114, v116, v117
    v_mfma_f32_16x16x32_bf16 v[208:211], v[64:67], v[24:27], v[208:211]
    v_cvt_pk_bf16_f32 v115, v118, v119
    v_mfma_f32_16x16x32_bf16 v[240:243], v[64:67], v[28:31], v[240:243]
    s_add_u32 s64, s56, 12288
    ds_read_b64_tr_b16 v[64:65], v124 offset:8192
    v_mfma_f32_16x16x32_bf16 v[148:151], v[68:71], v[16:19], v[148:151]
    ds_read_b64_tr_b16 v[66:67], v124 offset:9216
    v_mfma_f32_16x16x32_bf16 v[180:183], v[68:71], v[20:23], v[180:183]
    buffer_store_dwordx4 v[112:115], v1, s[24:27], s64 offen offset:1024
    v_mfma_f32_16x16x32_bf16 v[212:215], v[68:71], v[24:27], v[212:215]
    s_nop 0
    v_mfma_f32_16x16x32_bf16 v[244:247], v[68:71], v[28:31], v[244:247]
    s_waitcnt lgkmcnt(10)
    ds_read_b64_tr_b16 v[68:69], v125 offset:8192
    v_accvgpr_read_b32 v112, a112
    v_mfma_f32_16x16x32_bf16 v[152:155], v[72:75], v[16:19], v[152:155]
    ds_read_b64_tr_b16 v[70:71], v125 offset:9216
    v_mfma_f32_16x16x32_bf16 v[184:187], v[72:75], v[20:23], v[184:187]
    v_accvgpr_read_b32 v113, a113
    v_mfma_f32_16x16x32_bf16 v[216:219], v[72:75], v[24:27], v[216:219]
    v_accvgpr_read_b32 v114, a114
    v_mfma_f32_16x16x32_bf16 v[248:251], v[72:75], v[28:31], v[248:251]
    ds_read_b64_tr_b16 v[72:73], v126 offset:8192
    v_accvgpr_read_b32 v115, a115
    v_mfma_f32_16x16x32_bf16 v[156:159], v[76:79], v[16:19], v[156:159]
    ds_read_b64_tr_b16 v[74:75], v126 offset:9216
    v_accvgpr_read_b32 v116, a116
    v_mfma_f32_16x16x32_bf16 v[188:191], v[76:79], v[20:23], v[188:191]
    v_mfma_f32_16x16x32_bf16 v[220:223], v[76:79], v[24:27], v[220:223]
    s_waitcnt vmcnt(29)
    v_accvgpr_read_b32 v117, a117
    v_mfma_f32_16x16x32_bf16 v[252:255], v[76:79], v[28:31], v[252:255]
    s_waitcnt lgkmcnt(10)
    ds_read_b64_tr_b16 v[76:77], v127 offset:8192
    v_accvgpr_read_b32 v118, a118
    v_mfma_f32_16x16x32_bf16 v[128:131], v[48:51], v[96:99], v[128:131]
    s_add_u32 s48, s52, 16384
    ds_read_b64_tr_b16 v[78:79], v127 offset:9216
    v_accvgpr_read_b32 v119, a119
    v_mfma_f32_16x16x32_bf16 v[160:163], v[48:51], v[100:103], v[160:163]
    v_add_u32 v120, 81920, v8
    v_xor_b32 v121, 32, v120
    v_mfma_f32_16x16x32_bf16 v[192:195], v[48:51], v[104:107], v[192:195]
    v_xor_b32 v122, 64, v120
    v_xor_b32 v123, 96, v120
    v_mfma_f32_16x16x32_bf16 v[224:227], v[48:51], v[108:111], v[224:227]
    v_xor_b32 v124, 128, v120
    v_xor_b32 v125, 160, v120
    v_mfma_f32_16x16x32_bf16 v[132:135], v[52:55], v[96:99], v[132:135]
    v_xor_b32 v126, 192, v120
    v_xor_b32 v127, 224, v120
    v_mfma_f32_16x16x32_bf16 v[164:167], v[52:55], v[100:103], v[164:167]
    v_cvt_pk_bf16_f32 v112, v112, v113
    v_cvt_pk_bf16_f32 v113, v114, v115
    v_mfma_f32_16x16x32_bf16 v[196:199], v[52:55], v[104:107], v[196:199]
    v_cvt_pk_bf16_f32 v114, v116, v117
    v_cvt_pk_bf16_f32 v115, v118, v119
    v_mfma_f32_16x16x32_bf16 v[228:231], v[52:55], v[108:111], v[228:231]
    s_waitcnt lgkmcnt(8)
    s_add_u32 s64, s56, 12288
    buffer_load_dwordx4 v[16:19], v1, s[20:23], s48 offen offset:0 sc1
    v_mfma_f32_16x16x32_bf16 v[136:139], v[56:59], v[96:99], v[136:139]
    s_add_u32 s48, s52, 36864
    buffer_store_dwordx4 v[112:115], v1, s[24:27], s64 offen offset:2048
    v_mfma_f32_16x16x32_bf16 v[168:171], v[56:59], v[100:103], v[168:171]
    s_nop 0
    ds_read_b64_tr_b16 v[48:49], v120 offset:0
    v_mfma_f32_16x16x32_bf16 v[200:203], v[56:59], v[104:107], v[200:203]
    ds_read_b64_tr_b16 v[50:51], v120 offset:1024
    v_accvgpr_read_b32 v112, a120
    v_mfma_f32_16x16x32_bf16 v[232:235], v[56:59], v[108:111], v[232:235]
    ds_read_b64_tr_b16 v[52:53], v121 offset:0
    v_mfma_f32_16x16x32_bf16 v[140:143], v[60:63], v[96:99], v[140:143]
    ds_read_b64_tr_b16 v[54:55], v121 offset:1024
    v_accvgpr_read_b32 v113, a121
    v_mfma_f32_16x16x32_bf16 v[172:175], v[60:63], v[100:103], v[172:175]
    ds_read_b64_tr_b16 v[56:57], v122 offset:0
    v_accvgpr_read_b32 v114, a122
    v_mfma_f32_16x16x32_bf16 v[204:207], v[60:63], v[104:107], v[204:207]
    ds_read_b64_tr_b16 v[58:59], v122 offset:1024
    v_accvgpr_read_b32 v115, a123
    v_mfma_f32_16x16x32_bf16 v[236:239], v[60:63], v[108:111], v[236:239]
    s_waitcnt lgkmcnt(10)
    ds_read_b64_tr_b16 v[60:61], v123 offset:0
    v_accvgpr_read_b32 v116, a124
    v_mfma_f32_16x16x32_bf16 v[144:147], v[64:67], v[96:99], v[144:147]
    ds_read_b64_tr_b16 v[62:63], v123 offset:1024
    v_mfma_f32_16x16x32_bf16 v[176:179], v[64:67], v[100:103], v[176:179]
    buffer_load_dwordx4 v[20:23], v1, s[20:23], s48 offen offset:0 sc1
    v_accvgpr_read_b32 v117, a125
    v_mfma_f32_16x16x32_bf16 v[208:211], v[64:67], v[104:107], v[208:211]
    s_add_u32 s48, s53, 16384
    buffer_load_dwordx4 v[24:27], v1, s[20:23], s48 offen offset:0 sc1
    v_accvgpr_read_b32 v118, a126
    v_mfma_f32_16x16x32_bf16 v[240:243], v[64:67], v[108:111], v[240:243]
    s_add_u32 s48, s53, 36864
    ds_read_b64_tr_b16 v[64:65], v124 offset:0
    v_accvgpr_read_b32 v119, a127
    v_mfma_f32_16x16x32_bf16 v[148:151], v[68:71], v[96:99], v[148:151]
    ds_read_b64_tr_b16 v[66:67], v124 offset:1024
    v_mfma_f32_16x16x32_bf16 v[180:183], v[68:71], v[100:103], v[180:183]
    buffer_load_dwordx4 v[28:31], v1, s[20:23], s48 offen offset:0 sc1
    v_cvt_pk_bf16_f32 v112, v112, v113
    v_mfma_f32_16x16x32_bf16 v[212:215], v[68:71], v[104:107], v[212:215]
    v_cvt_pk_bf16_f32 v113, v114, v115
    v_mfma_f32_16x16x32_bf16 v[244:247], v[68:71], v[108:111], v[244:247]
    s_waitcnt lgkmcnt(10)
    ds_read_b64_tr_b16 v[68:69], v125 offset:0
    v_cvt_pk_bf16_f32 v114, v116, v117
    v_mfma_f32_16x16x32_bf16 v[152:155], v[72:75], v[96:99], v[152:155]
    ds_read_b64_tr_b16 v[70:71], v125 offset:1024
    v_cvt_pk_bf16_f32 v115, v118, v119
    v_mfma_f32_16x16x32_bf16 v[184:187], v[72:75], v[100:103], v[184:187]
    v_mfma_f32_16x16x32_bf16 v[216:219], v[72:75], v[104:107], v[216:219]
    s_add_u32 s64, s56, 12288
    v_mfma_f32_16x16x32_bf16 v[248:251], v[72:75], v[108:111], v[248:251]
    ds_read_b64_tr_b16 v[72:73], v126 offset:0
    v_mfma_f32_16x16x32_bf16 v[156:159], v[76:79], v[96:99], v[156:159]
    ds_read_b64_tr_b16 v[74:75], v126 offset:1024
    v_mfma_f32_16x16x32_bf16 v[188:191], v[76:79], v[100:103], v[188:191]
    buffer_store_dwordx4 v[112:115], v1, s[24:27], s64 offen offset:3072
    v_mfma_f32_16x16x32_bf16 v[220:223], v[76:79], v[104:107], v[220:223]
    s_waitcnt vmcnt(30)
    s_nop 0
    v_accvgpr_read_b32 v112, a128
    v_mfma_f32_16x16x32_bf16 v[252:255], v[76:79], v[108:111], v[252:255]
    s_waitcnt lgkmcnt(10)
    ds_read_b64_tr_b16 v[76:77], v127 offset:0
    v_accvgpr_read_b32 v113, a129
    v_mfma_f32_16x16x32_bf16 v[128:131], v[48:51], v[32:35], v[128:131]
    s_add_u32 s48, s52, 16384
    ds_read_b64_tr_b16 v[78:79], v127 offset:1024
    v_accvgpr_read_b32 v114, a130
    v_mfma_f32_16x16x32_bf16 v[160:163], v[48:51], v[36:39], v[160:163]
    buffer_load_dwordx4 v[96:99], v1, s[20:23], s48 offen offset:1024 sc1
    v_accvgpr_read_b32 v115, a131
    v_mfma_f32_16x16x32_bf16 v[192:195], v[48:51], v[40:43], v[192:195]
    s_add_u32 s48, s52, 36864
    buffer_load_dwordx4 v[100:103], v1, s[20:23], s48 offen offset:1024 sc1
    v_mfma_f32_16x16x32_bf16 v[224:227], v[48:51], v[44:47], v[224:227]
    s_add_u32 s48, s53, 16384
    ds_read_b64_tr_b16 v[48:49], v120 offset:8192
    v_accvgpr_read_b32 v116, a132
    v_mfma_f32_16x16x32_bf16 v[132:135], v[52:55], v[32:35], v[132:135]
    ds_read_b64_tr_b16 v[50:51], v120 offset:9216
    v_accvgpr_read_b32 v117, a133
    v_mfma_f32_16x16x32_bf16 v[164:167], v[52:55], v[36:39], v[164:167]
    buffer_load_dwordx4 v[104:107], v1, s[20:23], s48 offen offset:1024 sc1
    v_accvgpr_read_b32 v118, a134
    v_mfma_f32_16x16x32_bf16 v[196:199], v[52:55], v[40:43], v[196:199]
    s_add_u32 s48, s53, 36864
    buffer_load_dwordx4 v[108:111], v1, s[20:23], s48 offen offset:1024 sc1
    v_accvgpr_read_b32 v119, a135
    v_mfma_f32_16x16x32_bf16 v[228:231], v[52:55], v[44:47], v[228:231]
    s_waitcnt lgkmcnt(10)
    ds_read_b64_tr_b16 v[52:53], v121 offset:8192
    v_mfma_f32_16x16x32_bf16 v[136:139], v[56:59], v[32:35], v[136:139]
    ds_read_b64_tr_b16 v[54:55], v121 offset:9216
    v_cvt_pk_bf16_f32 v112, v112, v113
    v_mfma_f32_16x16x32_bf16 v[168:171], v[56:59], v[36:39], v[168:171]
    v_cvt_pk_bf16_f32 v113, v114, v115
    v_mfma_f32_16x16x32_bf16 v[200:203], v[56:59], v[40:43], v[200:203]
    v_cvt_pk_bf16_f32 v114, v116, v117
    v_mfma_f32_16x16x32_bf16 v[232:235], v[56:59], v[44:47], v[232:235]
    ds_read_b64_tr_b16 v[56:57], v122 offset:8192
    v_mfma_f32_16x16x32_bf16 v[140:143], v[60:63], v[32:35], v[140:143]
    ds_read_b64_tr_b16 v[58:59], v122 offset:9216
    v_cvt_pk_bf16_f32 v115, v118, v119
    v_mfma_f32_16x16x32_bf16 v[172:175], v[60:63], v[36:39], v[172:175]
    s_add_u32 s64, s56, 0
    v_mfma_f32_16x16x32_bf16 v[204:207], v[60:63], v[40:43], v[204:207]
    buffer_store_dwordx4 v[112:115], v1, s[28:31], s64 offen offset:0 sc1
    v_mfma_f32_16x16x32_bf16 v[236:239], v[60:63], v[44:47], v[236:239]
    s_waitcnt lgkmcnt(10)
    s_nop 0
    ds_read_b64_tr_b16 v[60:61], v123 offset:8192
    v_mfma_f32_16x16x32_bf16 v[144:147], v[64:67], v[32:35], v[144:147]
    ds_read_b64_tr_b16 v[62:63], v123 offset:9216
    v_mfma_f32_16x16x32_bf16 v[176:179], v[64:67], v[36:39], v[176:179]
    v_accvgpr_read_b32 v112, a136
    v_mfma_f32_16x16x32_bf16 v[208:211], v[64:67], v[40:43], v[208:211]
    v_accvgpr_read_b32 v113, a137
    v_mfma_f32_16x16x32_bf16 v[240:243], v[64:67], v[44:47], v[240:243]
    ds_read_b64_tr_b16 v[64:65], v124 offset:8192
    v_accvgpr_read_b32 v114, a138
    v_mfma_f32_16x16x32_bf16 v[148:151], v[68:71], v[32:35], v[148:151]
    ds_read_b64_tr_b16 v[66:67], v124 offset:9216
    v_accvgpr_read_b32 v115, a139
    v_mfma_f32_16x16x32_bf16 v[180:183], v[68:71], v[36:39], v[180:183]
    v_mfma_f32_16x16x32_bf16 v[212:215], v[68:71], v[40:43], v[212:215]
    v_accvgpr_read_b32 v116, a140
    v_mfma_f32_16x16x32_bf16 v[244:247], v[68:71], v[44:47], v[244:247]
    s_waitcnt lgkmcnt(10)
    ds_read_b64_tr_b16 v[68:69], v125 offset:8192
    v_accvgpr_read_b32 v117, a141
    v_mfma_f32_16x16x32_bf16 v[152:155], v[72:75], v[32:35], v[152:155]
    ds_read_b64_tr_b16 v[70:71], v125 offset:9216
    v_accvgpr_read_b32 v118, a142
    v_mfma_f32_16x16x32_bf16 v[184:187], v[72:75], v[36:39], v[184:187]
    v_mfma_f32_16x16x32_bf16 v[216:219], v[72:75], v[40:43], v[216:219]
    v_accvgpr_read_b32 v119, a143
    v_mfma_f32_16x16x32_bf16 v[248:251], v[72:75], v[44:47], v[248:251]
    ds_read_b64_tr_b16 v[72:73], v126 offset:8192
    v_cvt_pk_bf16_f32 v112, v112, v113
    v_mfma_f32_16x16x32_bf16 v[156:159], v[76:79], v[32:35], v[156:159]
    ds_read_b64_tr_b16 v[74:75], v126 offset:9216
    v_cvt_pk_bf16_f32 v113, v114, v115
    v_mfma_f32_16x16x32_bf16 v[188:191], v[76:79], v[36:39], v[188:191]
    v_cvt_pk_bf16_f32 v114, v116, v117
    v_mfma_f32_16x16x32_bf16 v[220:223], v[76:79], v[40:43], v[220:223]
    s_waitcnt vmcnt(31)
    v_mfma_f32_16x16x32_bf16 v[252:255], v[76:79], v[44:47], v[252:255]
    s_waitcnt lgkmcnt(10)
    ds_read_b64_tr_b16 v[76:77], v127 offset:8192
    v_cvt_pk_bf16_f32 v115, v118, v119
    v_mfma_f32_16x16x32_bf16 v[128:131], v[48:51], v[80:83], v[128:131]
    s_add_u32 s64, s56, 0
    s_add_u32 s48, s52, 16384
    ds_read_b64_tr_b16 v[78:79], v127 offset:9216
    v_mfma_f32_16x16x32_bf16 v[160:163], v[48:51], v[84:87], v[160:163]
    v_add_u32 v120, 98304, v8
    v_xor_b32 v121, 32, v120
    v_mfma_f32_16x16x32_bf16 v[192:195], v[48:51], v[88:91], v[192:195]
    v_xor_b32 v122, 64, v120
    v_xor_b32 v123, 96, v120
    v_mfma_f32_16x16x32_bf16 v[224:227], v[48:51], v[92:95], v[224:227]
    v_xor_b32 v124, 128, v120
    v_xor_b32 v125, 160, v120
    v_mfma_f32_16x16x32_bf16 v[132:135], v[52:55], v[80:83], v[132:135]
    v_xor_b32 v126, 192, v120
    v_xor_b32 v127, 224, v120
    v_mfma_f32_16x16x32_bf16 v[164:167], v[52:55], v[84:87], v[164:167]
    buffer_store_dwordx4 v[112:115], v1, s[28:31], s64 offen offset:1024 sc1
    v_mfma_f32_16x16x32_bf16 v[196:199], v[52:55], v[88:91], v[196:199]
    s_nop 0
    v_accvgpr_read_b32 v112, a144
    v_accvgpr_read_b32 v113, a145
    v_mfma_f32_16x16x32_bf16 v[228:231], v[52:55], v[92:95], v[228:231]
    s_waitcnt lgkmcnt(8)
    buffer_load_dwordx4 v[32:35], v1, s[20:23], s48 offen offset:2048 sc1
    v_accvgpr_read_b32 v114, a146
    v_mfma_f32_16x16x32_bf16 v[136:139], v[56:59], v[80:83], v[136:139]
    s_add_u32 s48, s52, 36864
    buffer_load_dwordx4 v[36:39], v1, s[20:23], s48 offen offset:2048 sc1
    v_accvgpr_read_b32 v115, a147
    v_mfma_f32_16x16x32_bf16 v[168:171], v[56:59], v[84:87], v[168:171]
    s_add_u32 s48, s53, 16384
    ds_read_b64_tr_b16 v[48:49], v120 offset:0
    v_accvgpr_read_b32 v116, a148
    v_mfma_f32_16x16x32_bf16 v[200:203], v[56:59], v[88:91], v[200:203]
    ds_read_b64_tr_b16 v[50:51], v120 offset:1024
    v_accvgpr_read_b32 v117, a149
    v_mfma_f32_16x16x32_bf16 v[232:235], v[56:59], v[92:95], v[232:235]
    ds_read_b64_tr_b16 v[52:53], v121 offset:0
    v_accvgpr_read_b32 v118, a150
    v_mfma_f32_16x16x32_bf16 v[140:143], v[60:63], v[80:83], v[140:143]
    ds_read_b64_tr_b16 v[54:55], v121 offset:1024
    v_mfma_f32_16x16x32_bf16 v[172:175], v[60:63], v[84:87], v[172:175]
    ds_read_b64_tr_b16 v[56:57], v122 offset:0
    v_accvgpr_read_b32 v119, a151
    v_mfma_f32_16x16x32_bf16 v[204:207], v[60:63], v[88:91], v[204:207]
    ds_read_b64_tr_b16 v[58:59], v122 offset:1024
    v_cvt_pk_bf16_f32 v112, v112, v113
    v_mfma_f32_16x16x32_bf16 v[236:239], v[60:63], v[92:95], v[236:239]
    s_waitcnt lgkmcnt(10)
    ds_read_b64_tr_b16 v[60:61], v123 offset:0
    v_cvt_pk_bf16_f32 v113, v114, v115
    v_mfma_f32_16x16x32_bf16 v[144:147], v[64:67], v[80:83], v[144:147]
    ds_read_b64_tr_b16 v[62:63], v123 offset:1024
    v_mfma_f32_16x16x32_bf16 v[176:179], v[64:67], v[84:87], v[176:179]
    buffer_load_dwordx4 v[40:43], v1, s[20:23], s48 offen offset:2048 sc1
    v_cvt_pk_bf16_f32 v114, v116, v117
    v_mfma_f32_16x16x32_bf16 v[208:211], v[64:67], v[88:91], v[208:211]
    s_add_u32 s48, s53, 36864
    buffer_load_dwordx4 v[44:47], v1, s[20:23], s48 offen offset:2048 sc1
    v_cvt_pk_bf16_f32 v115, v118, v119
    v_mfma_f32_16x16x32_bf16 v[240:243], v[64:67], v[92:95], v[240:243]
    s_add_u32 s64, s56, 0
    ds_read_b64_tr_b16 v[64:65], v124 offset:0
    v_mfma_f32_16x16x32_bf16 v[148:151], v[68:71], v[80:83], v[148:151]
    ds_read_b64_tr_b16 v[66:67], v124 offset:1024
    v_mfma_f32_16x16x32_bf16 v[180:183], v[68:71], v[84:87], v[180:183]
    buffer_store_dwordx4 v[112:115], v1, s[28:31], s64 offen offset:2048 sc1
    v_mfma_f32_16x16x32_bf16 v[212:215], v[68:71], v[88:91], v[212:215]
    s_nop 0
    v_mfma_f32_16x16x32_bf16 v[244:247], v[68:71], v[92:95], v[244:247]
    s_waitcnt lgkmcnt(10)
    ds_read_b64_tr_b16 v[68:69], v125 offset:0
    v_accvgpr_read_b32 v112, a152
    v_mfma_f32_16x16x32_bf16 v[152:155], v[72:75], v[80:83], v[152:155]
    ds_read_b64_tr_b16 v[70:71], v125 offset:1024
    v_accvgpr_read_b32 v113, a153
    v_mfma_f32_16x16x32_bf16 v[184:187], v[72:75], v[84:87], v[184:187]
    v_accvgpr_read_b32 v114, a154
    v_mfma_f32_16x16x32_bf16 v[216:219], v[72:75], v[88:91], v[216:219]
    v_mfma_f32_16x16x32_bf16 v[248:251], v[72:75], v[92:95], v[248:251]
    ds_read_b64_tr_b16 v[72:73], v126 offset:0
    v_accvgpr_read_b32 v115, a155
    v_mfma_f32_16x16x32_bf16 v[156:159], v[76:79], v[80:83], v[156:159]
    ds_read_b64_tr_b16 v[74:75], v126 offset:1024
    v_accvgpr_read_b32 v116, a156
    v_mfma_f32_16x16x32_bf16 v[188:191], v[76:79], v[84:87], v[188:191]
    v_accvgpr_read_b32 v117, a157
    v_mfma_f32_16x16x32_bf16 v[220:223], v[76:79], v[88:91], v[220:223]
    s_waitcnt vmcnt(32)
    v_mfma_f32_16x16x32_bf16 v[252:255], v[76:79], v[92:95], v[252:255]
    s_waitcnt lgkmcnt(10)
    ds_read_b64_tr_b16 v[76:77], v127 offset:0
    v_accvgpr_read_b32 v118, a158
    v_mfma_f32_16x16x32_bf16 v[128:131], v[48:51], a[0:3], v[128:131]
    s_add_u32 s48, s52, 16384
    ds_read_b64_tr_b16 v[78:79], v127 offset:1024
    v_accvgpr_read_b32 v119, a159
    v_mfma_f32_16x16x32_bf16 v[160:163], v[48:51], a[4:7], v[160:163]
    buffer_load_dwordx4 v[80:83], v1, s[20:23], s48 offen offset:3072 sc1
    v_cvt_pk_bf16_f32 v112, v112, v113
    v_mfma_f32_16x16x32_bf16 v[192:195], v[48:51], a[8:11], v[192:195]
    s_add_u32 s48, s52, 36864
    buffer_load_dwordx4 v[84:87], v1, s[20:23], s48 offen offset:3072 sc1
    v_cvt_pk_bf16_f32 v113, v114, v115
    v_mfma_f32_16x16x32_bf16 v[224:227], v[48:51], a[12:15], v[224:227]
    s_add_u32 s48, s53, 16384
    ds_read_b64_tr_b16 v[48:49], v120 offset:8192
    v_mfma_f32_16x16x32_bf16 v[132:135], v[52:55], a[0:3], v[132:135]
    ds_read_b64_tr_b16 v[50:51], v120 offset:9216
    v_cvt_pk_bf16_f32 v114, v116, v117
    v_mfma_f32_16x16x32_bf16 v[164:167], v[52:55], a[4:7], v[164:167]
    buffer_load_dwordx4 v[88:91], v1, s[20:23], s48 offen offset:3072 sc1
    v_cvt_pk_bf16_f32 v115, v118, v119
    v_mfma_f32_16x16x32_bf16 v[196:199], v[52:55], a[8:11], v[196:199]
    s_add_u32 s64, s56, 0
    s_add_u32 s48, s53, 36864
    buffer_load_dwordx4 v[92:95], v1, s[20:23], s48 offen offset:3072 sc1
    v_mfma_f32_16x16x32_bf16 v[228:231], v[52:55], a[12:15], v[228:231]
    s_waitcnt lgkmcnt(10)
    ds_read_b64_tr_b16 v[52:53], v121 offset:8192
    v_mfma_f32_16x16x32_bf16 v[136:139], v[56:59], a[0:3], v[136:139]
    ds_read_b64_tr_b16 v[54:55], v121 offset:9216
    v_mfma_f32_16x16x32_bf16 v[168:171], v[56:59], a[4:7], v[168:171]
    buffer_store_dwordx4 v[112:115], v1, s[28:31], s64 offen offset:3072 sc1
    v_mfma_f32_16x16x32_bf16 v[200:203], v[56:59], a[8:11], v[200:203]
    s_nop 0
    v_accvgpr_read_b32 v112, a160
    v_mfma_f32_16x16x32_bf16 v[232:235], v[56:59], a[12:15], v[232:235]
    ds_read_b64_tr_b16 v[56:57], v122 offset:8192
    v_accvgpr_read_b32 v113, a161
    v_mfma_f32_16x16x32_bf16 v[140:143], v[60:63], a[0:3], v[140:143]
    ds_read_b64_tr_b16 v[58:59], v122 offset:9216
    v_mfma_f32_16x16x32_bf16 v[172:175], v[60:63], a[4:7], v[172:175]
    v_accvgpr_read_b32 v114, a162
    v_mfma_f32_16x16x32_bf16 v[204:207], v[60:63], a[8:11], v[204:207]
    v_accvgpr_read_b32 v115, a163
    v_mfma_f32_16x16x32_bf16 v[236:239], v[60:63], a[12:15], v[236:239]
    s_waitcnt lgkmcnt(10)
    ds_read_b64_tr_b16 v[60:61], v123 offset:8192
    v_accvgpr_read_b32 v116, a164
    v_mfma_f32_16x16x32_bf16 v[144:147], v[64:67], a[0:3], v[144:147]
    ds_read_b64_tr_b16 v[62:63], v123 offset:9216
    v_accvgpr_read_b32 v117, a165
    v_mfma_f32_16x16x32_bf16 v[176:179], v[64:67], a[4:7], v[176:179]
    v_mfma_f32_16x16x32_bf16 v[208:211], v[64:67], a[8:11], v[208:211]
    v_accvgpr_read_b32 v118, a166
    v_mfma_f32_16x16x32_bf16 v[240:243], v[64:67], a[12:15], v[240:243]
    ds_read_b64_tr_b16 v[64:65], v124 offset:8192
    v_accvgpr_read_b32 v119, a167
    v_mfma_f32_16x16x32_bf16 v[148:151], v[68:71], a[0:3], v[148:151]
    ds_read_b64_tr_b16 v[66:67], v124 offset:9216
    v_cvt_pk_bf16_f32 v112, v112, v113
    v_mfma_f32_16x16x32_bf16 v[180:183], v[68:71], a[4:7], v[180:183]
    v_cvt_pk_bf16_f32 v113, v114, v115
    v_mfma_f32_16x16x32_bf16 v[212:215], v[68:71], a[8:11], v[212:215]
    v_mfma_f32_16x16x32_bf16 v[244:247], v[68:71], a[12:15], v[244:247]
    s_waitcnt lgkmcnt(10)
    ds_read_b64_tr_b16 v[68:69], v125 offset:8192
    v_cvt_pk_bf16_f32 v114, v116, v117
    v_mfma_f32_16x16x32_bf16 v[152:155], v[72:75], a[0:3], v[152:155]
    ds_read_b64_tr_b16 v[70:71], v125 offset:9216
    v_cvt_pk_bf16_f32 v115, v118, v119
    v_mfma_f32_16x16x32_bf16 v[184:187], v[72:75], a[4:7], v[184:187]
    s_add_u32 s64, s56, 4096
    v_mfma_f32_16x16x32_bf16 v[216:219], v[72:75], a[8:11], v[216:219]
    v_mfma_f32_16x16x32_bf16 v[248:251], v[72:75], a[12:15], v[248:251]
    ds_read_b64_tr_b16 v[72:73], v126 offset:8192
    v_mfma_f32_16x16x32_bf16 v[156:159], v[76:79], a[0:3], v[156:159]
    ds_read_b64_tr_b16 v[74:75], v126 offset:9216
    v_mfma_f32_16x16x32_bf16 v[188:191], v[76:79], a[4:7], v[188:191]
    buffer_store_dwordx4 v[112:115], v1, s[28:31], s64 offen offset:0 sc1
    v_mfma_f32_16x16x32_bf16 v[220:223], v[76:79], a[8:11], v[220:223]
    s_waitcnt vmcnt(33)
    s_nop 0
    v_accvgpr_read_b32 v112, a168
    v_mfma_f32_16x16x32_bf16 v[252:255], v[76:79], a[12:15], v[252:255]
    s_waitcnt lgkmcnt(10)
    ds_read_b64_tr_b16 v[76:77], v127 offset:8192
    v_accvgpr_read_b32 v113, a169
    v_mfma_f32_16x16x32_bf16 v[128:131], v[48:51], a[16:19], v[128:131]
    ds_read_b64_tr_b16 v[78:79], v127 offset:9216
    v_accvgpr_read_b32 v114, a170
    v_mfma_f32_16x16x32_bf16 v[160:163], v[48:51], a[20:23], v[160:163]
    v_add_u32 v120, 114688, v8
    v_xor_b32 v121, 32, v120
    v_mfma_f32_16x16x32_bf16 v[192:195], v[48:51], a[24:27], v[192:195]
    v_xor_b32 v122, 64, v120
    v_xor_b32 v123, 96, v120
    v_mfma_f32_16x16x32_bf16 v[224:227], v[48:51], a[28:31], v[224:227]
    v_xor_b32 v124, 128, v120
    v_xor_b32 v125, 160, v120
    v_mfma_f32_16x16x32_bf16 v[132:135], v[52:55], a[16:19], v[132:135]
    v_xor_b32 v126, 192, v120
    v_xor_b32 v127, 224, v120
    v_mfma_f32_16x16x32_bf16 v[164:167], v[52:55], a[20:23], v[164:167]
    v_accvgpr_read_b32 v115, a171
    v_accvgpr_read_b32 v116, a172
    v_mfma_f32_16x16x32_bf16 v[196:199], v[52:55], a[24:27], v[196:199]
    v_accvgpr_read_b32 v117, a173
    v_accvgpr_read_b32 v118, a174
    v_mfma_f32_16x16x32_bf16 v[228:231], v[52:55], a[28:31], v[228:231]
    s_waitcnt lgkmcnt(8)
    v_accvgpr_read_b32 v119, a175
    v_cvt_pk_bf16_f32 v112, v112, v113
    v_mfma_f32_16x16x32_bf16 v[136:139], v[56:59], a[16:19], v[136:139]
    v_mfma_f32_16x16x32_bf16 v[168:171], v[56:59], a[20:23], v[168:171]
    ds_read_b64_tr_b16 v[48:49], v120 offset:0
    v_cvt_pk_bf16_f32 v113, v114, v115
    v_mfma_f32_16x16x32_bf16 v[200:203], v[56:59], a[24:27], v[200:203]
    ds_read_b64_tr_b16 v[50:51], v120 offset:1024
    v_cvt_pk_bf16_f32 v114, v116, v117
    v_mfma_f32_16x16x32_bf16 v[232:235], v[56:59], a[28:31], v[232:235]
    ds_read_b64_tr_b16 v[52:53], v121 offset:0
    v_cvt_pk_bf16_f32 v115, v118, v119
    v_mfma_f32_16x16x32_bf16 v[140:143], v[60:63], a[16:19], v[140:143]
    s_add_u32 s64, s56, 4096
    ds_read_b64_tr_b16 v[54:55], v121 offset:1024
    v_mfma_f32_16x16x32_bf16 v[172:175], v[60:63], a[20:23], v[172:175]
    ds_read_b64_tr_b16 v[56:57], v122 offset:0
    v_mfma_f32_16x16x32_bf16 v[204:207], v[60:63], a[24:27], v[204:207]
    ds_read_b64_tr_b16 v[58:59], v122 offset:1024
    v_mfma_f32_16x16x32_bf16 v[236:239], v[60:63], a[28:31], v[236:239]
    s_waitcnt lgkmcnt(10)
    ds_read_b64_tr_b16 v[60:61], v123 offset:0
    v_mfma_f32_16x16x32_bf16 v[144:147], v[64:67], a[16:19], v[144:147]
    ds_read_b64_tr_b16 v[62:63], v123 offset:1024
    v_mfma_f32_16x16x32_bf16 v[176:179], v[64:67], a[20:23], v[176:179]
    buffer_store_dwordx4 v[112:115], v1, s[28:31], s64 offen offset:1024 sc1
    v_mfma_f32_16x16x32_bf16 v[208:211], v[64:67], a[24:27], v[208:211]
    s_nop 0
    v_accvgpr_read_b32 v112, a176
    v_accvgpr_read_b32 v113, a177
    v_mfma_f32_16x16x32_bf16 v[240:243], v[64:67], a[28:31], v[240:243]
    ds_read_b64_tr_b16 v[64:65], v124 offset:0
    v_accvgpr_read_b32 v114, a178
    v_mfma_f32_16x16x32_bf16 v[148:151], v[68:71], a[16:19], v[148:151]
    ds_read_b64_tr_b16 v[66:67], v124 offset:1024
    v_accvgpr_read_b32 v115, a179
    v_mfma_f32_16x16x32_bf16 v[180:183], v[68:71], a[20:23], v[180:183]
    v_accvgpr_read_b32 v116, a180
    v_mfma_f32_16x16x32_bf16 v[212:215], v[68:71], a[24:27], v[212:215]
    v_mfma_f32_16x16x32_bf16 v[244:247], v[68:71], a[28:31], v[244:247]
    s_waitcnt lgkmcnt(10)
    ds_read_b64_tr_b16 v[68:69], v125 offset:0
    v_accvgpr_read_b32 v117, a181
    v_mfma_f32_16x16x32_bf16 v[152:155], v[72:75], a[16:19], v[152:155]
    ds_read_b64_tr_b16 v[70:71], v125 offset:1024
    v_accvgpr_read_b32 v118, a182
    v_mfma_f32_16x16x32_bf16 v[184:187], v[72:75], a[20:23], v[184:187]
    v_accvgpr_read_b32 v119, a183
    v_mfma_f32_16x16x32_bf16 v[216:219], v[72:75], a[24:27], v[216:219]
    v_cvt_pk_bf16_f32 v112, v112, v113
    v_mfma_f32_16x16x32_bf16 v[248:251], v[72:75], a[28:31], v[248:251]
    ds_read_b64_tr_b16 v[72:73], v126 offset:0
    v_mfma_f32_16x16x32_bf16 v[156:159], v[76:79], a[16:19], v[156:159]
    ds_read_b64_tr_b16 v[74:75], v126 offset:1024
    v_cvt_pk_bf16_f32 v113, v114, v115
    v_mfma_f32_16x16x32_bf16 v[188:191], v[76:79], a[20:23], v[188:191]
    v_cvt_pk_bf16_f32 v114, v116, v117
    v_mfma_f32_16x16x32_bf16 v[220:223], v[76:79], a[24:27], v[220:223]
    s_waitcnt vmcnt(29)
    v_cvt_pk_bf16_f32 v115, v118, v119
    v_mfma_f32_16x16x32_bf16 v[252:255], v[76:79], a[28:31], v[252:255]
    s_waitcnt lgkmcnt(10)
    ds_read_b64_tr_b16 v[76:77], v127 offset:0
    v_mfma_f32_16x16x32_bf16 v[128:131], v[48:51], a[32:35], v[128:131]
    s_add_u32 s64, s56, 4096
    ds_read_b64_tr_b16 v[78:79], v127 offset:1024
    v_mfma_f32_16x16x32_bf16 v[160:163], v[48:51], a[36:39], v[160:163]
    buffer_store_dwordx4 v[112:115], v1, s[28:31], s64 offen offset:2048 sc1
    v_mfma_f32_16x16x32_bf16 v[192:195], v[48:51], a[40:43], v[192:195]
    s_nop 0
    v_mfma_f32_16x16x32_bf16 v[224:227], v[48:51], a[44:47], v[224:227]
    ds_read_b64_tr_b16 v[48:49], v120 offset:8192
    v_accvgpr_read_b32 v112, a184
    v_mfma_f32_16x16x32_bf16 v[132:135], v[52:55], a[32:35], v[132:135]
    ds_read_b64_tr_b16 v[50:51], v120 offset:9216
    v_mfma_f32_16x16x32_bf16 v[164:167], v[52:55], a[36:39], v[164:167]
    v_accvgpr_read_b32 v113, a185
    v_mfma_f32_16x16x32_bf16 v[196:199], v[52:55], a[40:43], v[196:199]
    v_accvgpr_read_b32 v114, a186
    v_mfma_f32_16x16x32_bf16 v[228:231], v[52:55], a[44:47], v[228:231]
    s_waitcnt lgkmcnt(10)
    ds_read_b64_tr_b16 v[52:53], v121 offset:8192
    v_accvgpr_read_b32 v115, a187
    v_mfma_f32_16x16x32_bf16 v[136:139], v[56:59], a[32:35], v[136:139]
    ds_read_b64_tr_b16 v[54:55], v121 offset:9216
    v_accvgpr_read_b32 v116, a188
    v_mfma_f32_16x16x32_bf16 v[168:171], v[56:59], a[36:39], v[168:171]
    v_mfma_f32_16x16x32_bf16 v[200:203], v[56:59], a[40:43], v[200:203]
    v_accvgpr_read_b32 v117, a189
    v_mfma_f32_16x16x32_bf16 v[232:235], v[56:59], a[44:47], v[232:235]
    ds_read_b64_tr_b16 v[56:57], v122 offset:8192
    v_accvgpr_read_b32 v118, a190
    v_mfma_f32_16x16x32_bf16 v[140:143], v[60:63], a[32:35], v[140:143]
    ds_read_b64_tr_b16 v[58:59], v122 offset:9216
    v_accvgpr_read_b32 v119, a191
    v_mfma_f32_16x16x32_bf16 v[172:175], v[60:63], a[36:39], v[172:175]
    v_mfma_f32_16x16x32_bf16 v[204:207], v[60:63], a[40:43], v[204:207]
    v_cvt_pk_bf16_f32 v112, v112, v113
    v_mfma_f32_16x16x32_bf16 v[236:239], v[60:63], a[44:47], v[236:239]
    s_waitcnt lgkmcnt(10)
    ds_read_b64_tr_b16 v[60:61], v123 offset:8192
    v_cvt_pk_bf16_f32 v113, v114, v115
    v_mfma_f32_16x16x32_bf16 v[144:147], v[64:67], a[32:35], v[144:147]
    ds_read_b64_tr_b16 v[62:63], v123 offset:9216
    v_cvt_pk_bf16_f32 v114, v116, v117
    v_mfma_f32_16x16x32_bf16 v[176:179], v[64:67], a[36:39], v[176:179]
    v_cvt_pk_bf16_f32 v115, v118, v119
    v_mfma_f32_16x16x32_bf16 v[208:211], v[64:67], a[40:43], v[208:211]
    v_mfma_f32_16x16x32_bf16 v[240:243], v[64:67], a[44:47], v[240:243]
    s_add_u32 s64, s56, 4096
    ds_read_b64_tr_b16 v[64:65], v124 offset:8192
    v_mfma_f32_16x16x32_bf16 v[148:151], v[68:71], a[32:35], v[148:151]
    ds_read_b64_tr_b16 v[66:67], v124 offset:9216
    v_mfma_f32_16x16x32_bf16 v[180:183], v[68:71], a[36:39], v[180:183]
    buffer_store_dwordx4 v[112:115], v1, s[28:31], s64 offen offset:3072 sc1
    v_mfma_f32_16x16x32_bf16 v[212:215], v[68:71], a[40:43], v[212:215]
    s_nop 0
    v_mfma_f32_16x16x32_bf16 v[244:247], v[68:71], a[44:47], v[244:247]
    s_waitcnt lgkmcnt(10)
    ds_read_b64_tr_b16 v[68:69], v125 offset:8192
    v_accvgpr_read_b32 v112, a192
    v_mfma_f32_16x16x32_bf16 v[152:155], v[72:75], a[32:35], v[152:155]
    ds_read_b64_tr_b16 v[70:71], v125 offset:9216
    v_accvgpr_read_b32 v113, a193
    v_mfma_f32_16x16x32_bf16 v[184:187], v[72:75], a[36:39], v[184:187]
    v_accvgpr_read_b32 v114, a194
    v_mfma_f32_16x16x32_bf16 v[216:219], v[72:75], a[40:43], v[216:219]
    v_accvgpr_read_b32 v115, a195
    v_mfma_f32_16x16x32_bf16 v[248:251], v[72:75], a[44:47], v[248:251]
    ds_read_b64_tr_b16 v[72:73], v126 offset:8192
    v_mfma_f32_16x16x32_bf16 v[156:159], v[76:79], a[32:35], v[156:159]
    ds_read_b64_tr_b16 v[74:75], v126 offset:9216
    v_accvgpr_read_b32 v116, a196
    v_mfma_f32_16x16x32_bf16 v[188:191], v[76:79], a[36:39], v[188:191]
    v_accvgpr_read_b32 v117, a197
    v_mfma_f32_16x16x32_bf16 v[220:223], v[76:79], a[40:43], v[220:223]
    s_waitcnt vmcnt(27)
    v_accvgpr_read_b32 v118, a198
    v_mfma_f32_16x16x32_bf16 v[252:255], v[76:79], a[44:47], v[252:255]
    s_waitcnt lgkmcnt(10)
    ds_read_b64_tr_b16 v[76:77], v127 offset:8192
    v_accvgpr_read_b32 v119, a199
    v_mfma_f32_16x16x32_bf16 v[128:131], v[48:51], a[48:51], v[128:131]
    ds_read_b64_tr_b16 v[78:79], v127 offset:9216
    v_mfma_f32_16x16x32_bf16 v[160:163], v[48:51], a[52:55], v[160:163]
    v_add_u32 v120, 131072, v8
    v_xor_b32 v121, 32, v120
    v_mfma_f32_16x16x32_bf16 v[192:195], v[48:51], a[56:59], v[192:195]
    v_xor_b32 v122, 64, v120
    v_xor_b32 v123, 96, v120
    v_mfma_f32_16x16x32_bf16 v[224:227], v[48:51], a[60:63], v[224:227]
    v_xor_b32 v124, 128, v120
    v_xor_b32 v125, 160, v120
    v_mfma_f32_16x16x32_bf16 v[132:135], v[52:55], a[48:51], v[132:135]
    v_xor_b32 v126, 192, v120
    v_xor_b32 v127, 224, v120
    v_mfma_f32_16x16x32_bf16 v[164:167], v[52:55], a[52:55], v[164:167]
    v_cvt_pk_bf16_f32 v112, v112, v113
    v_cvt_pk_bf16_f32 v113, v114, v115
    v_mfma_f32_16x16x32_bf16 v[196:199], v[52:55], a[56:59], v[196:199]
    v_cvt_pk_bf16_f32 v114, v116, v117
    v_cvt_pk_bf16_f32 v115, v118, v119
    v_mfma_f32_16x16x32_bf16 v[228:231], v[52:55], a[60:63], v[228:231]
    s_waitcnt lgkmcnt(8)
    s_add_u32 s64, s56, 8192
    buffer_store_dwordx4 v[112:115], v1, s[28:31], s64 offen offset:0 sc1
    v_mfma_f32_16x16x32_bf16 v[136:139], v[56:59], a[48:51], v[136:139]
    s_nop 0
    v_mfma_f32_16x16x32_bf16 v[168:171], v[56:59], a[52:55], v[168:171]
    ds_read_b64_tr_b16 v[48:49], v120 offset:0
    v_mfma_f32_16x16x32_bf16 v[200:203], v[56:59], a[56:59], v[200:203]
    ds_read_b64_tr_b16 v[50:51], v120 offset:1024
    v_accvgpr_read_b32 v112, a200
    v_mfma_f32_16x16x32_bf16 v[232:235], v[56:59], a[60:63], v[232:235]
    ds_read_b64_tr_b16 v[52:53], v121 offset:0
    v_accvgpr_read_b32 v113, a201
    v_mfma_f32_16x16x32_bf16 v[140:143], v[60:63], a[48:51], v[140:143]
    ds_read_b64_tr_b16 v[54:55], v121 offset:1024
    v_accvgpr_read_b32 v114, a202
    v_mfma_f32_16x16x32_bf16 v[172:175], v[60:63], a[52:55], v[172:175]
    ds_read_b64_tr_b16 v[56:57], v122 offset:0
    v_accvgpr_read_b32 v115, a203
    v_mfma_f32_16x16x32_bf16 v[204:207], v[60:63], a[56:59], v[204:207]
    ds_read_b64_tr_b16 v[58:59], v122 offset:1024
    v_mfma_f32_16x16x32_bf16 v[236:239], v[60:63], a[60:63], v[236:239]
    s_waitcnt lgkmcnt(10)
    ds_read_b64_tr_b16 v[60:61], v123 offset:0
    v_accvgpr_read_b32 v116, a204
    v_mfma_f32_16x16x32_bf16 v[144:147], v[64:67], a[48:51], v[144:147]
    ds_read_b64_tr_b16 v[62:63], v123 offset:1024
    v_accvgpr_read_b32 v117, a205
    v_mfma_f32_16x16x32_bf16 v[176:179], v[64:67], a[52:55], v[176:179]
    v_accvgpr_read_b32 v118, a206
    v_mfma_f32_16x16x32_bf16 v[208:211], v[64:67], a[56:59], v[208:211]
    v_mfma_f32_16x16x32_bf16 v[240:243], v[64:67], a[60:63], v[240:243]
    ds_read_b64_tr_b16 v[64:65], v124 offset:0
    v_accvgpr_read_b32 v119, a207
    v_mfma_f32_16x16x32_bf16 v[148:151], v[68:71], a[48:51], v[148:151]
    ds_read_b64_tr_b16 v[66:67], v124 offset:1024
    v_cvt_pk_bf16_f32 v112, v112, v113
    v_mfma_f32_16x16x32_bf16 v[180:183], v[68:71], a[52:55], v[180:183]
    v_cvt_pk_bf16_f32 v113, v114, v115
    v_mfma_f32_16x16x32_bf16 v[212:215], v[68:71], a[56:59], v[212:215]
    v_cvt_pk_bf16_f32 v114, v116, v117
    v_mfma_f32_16x16x32_bf16 v[244:247], v[68:71], a[60:63], v[244:247]
    s_waitcnt lgkmcnt(10)
    ds_read_b64_tr_b16 v[68:69], v125 offset:0
    v_mfma_f32_16x16x32_bf16 v[152:155], v[72:75], a[48:51], v[152:155]
    ds_read_b64_tr_b16 v[70:71], v125 offset:1024
    v_cvt_pk_bf16_f32 v115, v118, v119
    v_mfma_f32_16x16x32_bf16 v[184:187], v[72:75], a[52:55], v[184:187]
    s_add_u32 s64, s56, 8192
    v_mfma_f32_16x16x32_bf16 v[216:219], v[72:75], a[56:59], v[216:219]
    buffer_store_dwordx4 v[112:115], v1, s[28:31], s64 offen offset:1024 sc1
    v_mfma_f32_16x16x32_bf16 v[248:251], v[72:75], a[60:63], v[248:251]
    s_nop 0
    ds_read_b64_tr_b16 v[72:73], v126 offset:0
    v_mfma_f32_16x16x32_bf16 v[156:159], v[76:79], a[48:51], v[156:159]
    ds_read_b64_tr_b16 v[74:75], v126 offset:1024
    v_mfma_f32_16x16x32_bf16 v[188:191], v[76:79], a[52:55], v[188:191]
    v_accvgpr_read_b32 v112, a208
    v_mfma_f32_16x16x32_bf16 v[220:223], v[76:79], a[56:59], v[220:223]
    s_waitcnt vmcnt(23)
    v_accvgpr_read_b32 v113, a209
    v_mfma_f32_16x16x32_bf16 v[252:255], v[76:79], a[60:63], v[252:255]
    s_waitcnt lgkmcnt(10)
    ds_read_b64_tr_b16 v[76:77], v127 offset:0
    v_accvgpr_read_b32 v114, a210
    v_mfma_f32_16x16x32_bf16 v[128:131], v[48:51], v[16:19], v[128:131]
    ds_read_b64_tr_b16 v[78:79], v127 offset:1024
    v_mfma_f32_16x16x32_bf16 v[160:163], v[48:51], v[20:23], v[160:163]
    v_accvgpr_read_b32 v115, a211
    v_mfma_f32_16x16x32_bf16 v[192:195], v[48:51], v[24:27], v[192:195]
    v_accvgpr_read_b32 v116, a212
    v_mfma_f32_16x16x32_bf16 v[224:227], v[48:51], v[28:31], v[224:227]
    ds_read_b64_tr_b16 v[48:49], v120 offset:8192
    v_accvgpr_read_b32 v117, a213
    v_mfma_f32_16x16x32_bf16 v[132:135], v[52:55], v[16:19], v[132:135]
    ds_read_b64_tr_b16 v[50:51], v120 offset:9216
    v_accvgpr_read_b32 v118, a214
    v_mfma_f32_16x16x32_bf16 v[164:167], v[52:55], v[20:23], v[164:167]
    v_mfma_f32_16x16x32_bf16 v[196:199], v[52:55], v[24:27], v[196:199]
    v_accvgpr_read_b32 v119, a215
    v_mfma_f32_16x16x32_bf16 v[228:231], v[52:55], v[28:31], v[228:231]
    s_waitcnt lgkmcnt(10)
    ds_read_b64_tr_b16 v[52:53], v121 offset:8192
    v_cvt_pk_bf16_f32 v112, v112, v113
    v_mfma_f32_16x16x32_bf16 v[136:139], v[56:59], v[16:19], v[136:139]
    ds_read_b64_tr_b16 v[54:55], v121 offset:9216
    v_cvt_pk_bf16_f32 v113, v114, v115
    v_mfma_f32_16x16x32_bf16 v[168:171], v[56:59], v[20:23], v[168:171]
    v_mfma_f32_16x16x32_bf16 v[200:203], v[56:59], v[24:27], v[200:203]
    v_cvt_pk_bf16_f32 v114, v116, v117
    v_mfma_f32_16x16x32_bf16 v[232:235], v[56:59], v[28:31], v[232:235]
    ds_read_b64_tr_b16 v[56:57], v122 offset:8192
    v_cvt_pk_bf16_f32 v115, v118, v119
    v_mfma_f32_16x16x32_bf16 v[140:143], v[60:63], v[16:19], v[140:143]
    s_add_u32 s64, s56, 8192
    ds_read_b64_tr_b16 v[58:59], v122 offset:9216
    v_mfma_f32_16x16x32_bf16 v[172:175], v[60:63], v[20:23], v[172:175]
    buffer_store_dwordx4 v[112:115], v1, s[28:31], s64 offen offset:2048 sc1
    v_mfma_f32_16x16x32_bf16 v[204:207], v[60:63], v[24:27], v[204:207]
    v_mfma_f32_16x16x32_bf16 v[236:239], v[60:63], v[28:31], v[236:239]
    s_waitcnt lgkmcnt(10)
    s_nop 0
    ds_read_b64_tr_b16 v[60:61], v123 offset:8192
    v_mfma_f32_16x16x32_bf16 v[144:147], v[64:67], v[16:19], v[144:147]
    ds_read_b64_tr_b16 v[62:63], v123 offset:9216
    v_accvgpr_read_b32 v112, a216
    v_mfma_f32_16x16x32_bf16 v[176:179], v[64:67], v[20:23], v[176:179]
    v_accvgpr_read_b32 v113, a217
    v_mfma_f32_16x16x32_bf16 v[208:211], v[64:67], v[24:27], v[208:211]
    v_accvgpr_read_b32 v114, a218
    v_mfma_f32_16x16x32_bf16 v[240:243], v[64:67], v[28:31], v[240:243]
    ds_read_b64_tr_b16 v[64:65], v124 offset:8192
    v_mfma_f32_16x16x32_bf16 v[148:151], v[68:71], v[16:19], v[148:151]
    ds_read_b64_tr_b16 v[66:67], v124 offset:9216
    v_accvgpr_read_b32 v115, a219
    v_mfma_f32_16x16x32_bf16 v[180:183], v[68:71], v[20:23], v[180:183]
    v_accvgpr_read_b32 v116, a220
    v_mfma_f32_16x16x32_bf16 v[212:215], v[68:71], v[24:27], v[212:215]
    v_accvgpr_read_b32 v117, a221
    v_mfma_f32_16x16x32_bf16 v[244:247], v[68:71], v[28:31], v[244:247]
    s_waitcnt lgkmcnt(10)
    ds_read_b64_tr_b16 v[68:69], v125 offset:8192
    v_mfma_f32_16x16x32_bf16 v[152:155], v[72:75], v[16:19], v[152:155]
    ds_read_b64_tr_b16 v[70:71], v125 offset:9216
    v_accvgpr_read_b32 v118, a222
    v_mfma_f32_16x16x32_bf16 v[184:187], v[72:75], v[20:23], v[184:187]
    v_accvgpr_read_b32 v119, a223
    v_mfma_f32_16x16x32_bf16 v[216:219], v[72:75], v[24:27], v[216:219]
    v_cvt_pk_bf16_f32 v112, v112, v113
    v_mfma_f32_16x16x32_bf16 v[248:251], v[72:75], v[28:31], v[248:251]
    ds_read_b64_tr_b16 v[72:73], v126 offset:8192
    v_cvt_pk_bf16_f32 v113, v114, v115
    v_mfma_f32_16x16x32_bf16 v[156:159], v[76:79], v[16:19], v[156:159]
    ds_read_b64_tr_b16 v[74:75], v126 offset:9216
    v_mfma_f32_16x16x32_bf16 v[188:191], v[76:79], v[20:23], v[188:191]
    v_cvt_pk_bf16_f32 v114, v116, v117
    v_mfma_f32_16x16x32_bf16 v[220:223], v[76:79], v[24:27], v[220:223]
    s_waitcnt vmcnt(19)
    v_cvt_pk_bf16_f32 v115, v118, v119
    v_mfma_f32_16x16x32_bf16 v[252:255], v[76:79], v[28:31], v[252:255]
    s_waitcnt lgkmcnt(10)
    s_add_u32 s64, s56, 8192
    ds_read_b64_tr_b16 v[76:77], v127 offset:8192
    v_mfma_f32_16x16x32_bf16 v[128:131], v[48:51], v[96:99], v[128:131]
    ds_read_b64_tr_b16 v[78:79], v127 offset:9216
    v_mfma_f32_16x16x32_bf16 v[160:163], v[48:51], v[100:103], v[160:163]
    v_add_u32 v120, 147456, v8
    v_xor_b32 v121, 32, v120
    v_mfma_f32_16x16x32_bf16 v[192:195], v[48:51], v[104:107], v[192:195]
    v_xor_b32 v122, 64, v120
    v_xor_b32 v123, 96, v120
    v_mfma_f32_16x16x32_bf16 v[224:227], v[48:51], v[108:111], v[224:227]
    v_xor_b32 v124, 128, v120
    v_xor_b32 v125, 160, v120
    v_mfma_f32_16x16x32_bf16 v[132:135], v[52:55], v[96:99], v[132:135]
    v_xor_b32 v126, 192, v120
    v_xor_b32 v127, 224, v120
    v_mfma_f32_16x16x32_bf16 v[164:167], v[52:55], v[100:103], v[164:167]
    buffer_store_dwordx4 v[112:115], v1, s[28:31], s64 offen offset:3072 sc1
    v_mfma_f32_16x16x32_bf16 v[196:199], v[52:55], v[104:107], v[196:199]
    s_nop 0
    v_accvgpr_read_b32 v112, a224
    v_accvgpr_read_b32 v113, a225
    v_mfma_f32_16x16x32_bf16 v[228:231], v[52:55], v[108:111], v[228:231]
    s_waitcnt lgkmcnt(8)
    v_accvgpr_read_b32 v114, a226
    v_accvgpr_read_b32 v115, a227
    v_mfma_f32_16x16x32_bf16 v[136:139], v[56:59], v[96:99], v[136:139]
    v_accvgpr_read_b32 v116, a228
    v_mfma_f32_16x16x32_bf16 v[168:171], v[56:59], v[100:103], v[168:171]
    ds_read_b64_tr_b16 v[48:49], v120 offset:0
    v_accvgpr_read_b32 v117, a229
    v_mfma_f32_16x16x32_bf16 v[200:203], v[56:59], v[104:107], v[200:203]
    ds_read_b64_tr_b16 v[50:51], v120 offset:1024
    v_mfma_f32_16x16x32_bf16 v[232:235], v[56:59], v[108:111], v[232:235]
    ds_read_b64_tr_b16 v[52:53], v121 offset:0
    v_accvgpr_read_b32 v118, a230
    v_mfma_f32_16x16x32_bf16 v[140:143], v[60:63], v[96:99], v[140:143]
    ds_read_b64_tr_b16 v[54:55], v121 offset:1024
    v_accvgpr_read_b32 v119, a231
    v_mfma_f32_16x16x32_bf16 v[172:175], v[60:63], v[100:103], v[172:175]
    ds_read_b64_tr_b16 v[56:57], v122 offset:0
    v_cvt_pk_bf16_f32 v112, v112, v113
    v_mfma_f32_16x16x32_bf16 v[204:207], v[60:63], v[104:107], v[204:207]
    ds_read_b64_tr_b16 v[58:59], v122 offset:1024
    v_cvt_pk_bf16_f32 v113, v114, v115
    v_mfma_f32_16x16x32_bf16 v[236:239], v[60:63], v[108:111], v[236:239]
    s_waitcnt lgkmcnt(10)
    ds_read_b64_tr_b16 v[60:61], v123 offset:0
    v_mfma_f32_16x16x32_bf16 v[144:147], v[64:67], v[96:99], v[144:147]
    ds_read_b64_tr_b16 v[62:63], v123 offset:1024
    v_cvt_pk_bf16_f32 v114, v116, v117
    v_mfma_f32_16x16x32_bf16 v[176:179], v[64:67], v[100:103], v[176:179]
    v_cvt_pk_bf16_f32 v115, v118, v119
    v_mfma_f32_16x16x32_bf16 v[208:211], v[64:67], v[104:107], v[208:211]
    s_add_u32 s64, s56, 12288
    v_mfma_f32_16x16x32_bf16 v[240:243], v[64:67], v[108:111], v[240:243]
    ds_read_b64_tr_b16 v[64:65], v124 offset:0
    v_mfma_f32_16x16x32_bf16 v[148:151], v[68:71], v[96:99], v[148:151]
    ds_read_b64_tr_b16 v[66:67], v124 offset:1024
    v_mfma_f32_16x16x32_bf16 v[180:183], v[68:71], v[100:103], v[180:183]
    buffer_store_dwordx4 v[112:115], v1, s[28:31], s64 offen offset:0 sc1
    v_mfma_f32_16x16x32_bf16 v[212:215], v[68:71], v[104:107], v[212:215]
    s_nop 0
    v_accvgpr_read_b32 v112, a232
    v_mfma_f32_16x16x32_bf16 v[244:247], v[68:71], v[108:111], v[244:247]
    s_waitcnt lgkmcnt(10)
    ds_read_b64_tr_b16 v[68:69], v125 offset:0
    v_accvgpr_read_b32 v113, a233
    v_mfma_f32_16x16x32_bf16 v[152:155], v[72:75], v[96:99], v[152:155]
    ds_read_b64_tr_b16 v[70:71], v125 offset:1024
    v_mfma_f32_16x16x32_bf16 v[184:187], v[72:75], v[100:103], v[184:187]
    v_accvgpr_read_b32 v114, a234
    v_mfma_f32_16x16x32_bf16 v[216:219], v[72:75], v[104:107], v[216:219]
    v_accvgpr_read_b32 v115, a235
    v_mfma_f32_16x16x32_bf16 v[248:251], v[72:75], v[108:111], v[248:251]
    ds_read_b64_tr_b16 v[72:73], v126 offset:0
    v_accvgpr_read_b32 v116, a236
    v_mfma_f32_16x16x32_bf16 v[156:159], v[76:79], v[96:99], v[156:159]
    ds_read_b64_tr_b16 v[74:75], v126 offset:1024
    v_mfma_f32_16x16x32_bf16 v[188:191], v[76:79], v[100:103], v[188:191]
    v_accvgpr_read_b32 v117, a237
    v_mfma_f32_16x16x32_bf16 v[220:223], v[76:79], v[104:107], v[220:223]
    s_waitcnt vmcnt(15)
    v_accvgpr_read_b32 v118, a238
    v_mfma_f32_16x16x32_bf16 v[252:255], v[76:79], v[108:111], v[252:255]
    s_waitcnt lgkmcnt(10)
    ds_read_b64_tr_b16 v[76:77], v127 offset:0
    v_accvgpr_read_b32 v119, a239
    v_mfma_f32_16x16x32_bf16 v[128:131], v[48:51], v[32:35], v[128:131]
    ds_read_b64_tr_b16 v[78:79], v127 offset:1024
    v_cvt_pk_bf16_f32 v112, v112, v113
    v_mfma_f32_16x16x32_bf16 v[160:163], v[48:51], v[36:39], v[160:163]
    v_mfma_f32_16x16x32_bf16 v[192:195], v[48:51], v[40:43], v[192:195]
    v_cvt_pk_bf16_f32 v113, v114, v115
    v_mfma_f32_16x16x32_bf16 v[224:227], v[48:51], v[44:47], v[224:227]
    ds_read_b64_tr_b16 v[48:49], v120 offset:8192
    v_cvt_pk_bf16_f32 v114, v116, v117
    v_mfma_f32_16x16x32_bf16 v[132:135], v[52:55], v[32:35], v[132:135]
    ds_read_b64_tr_b16 v[50:51], v120 offset:9216
    v_cvt_pk_bf16_f32 v115, v118, v119
    v_mfma_f32_16x16x32_bf16 v[164:167], v[52:55], v[36:39], v[164:167]
    s_add_u32 s64, s56, 12288
    v_mfma_f32_16x16x32_bf16 v[196:199], v[52:55], v[40:43], v[196:199]
    v_mfma_f32_16x16x32_bf16 v[228:231], v[52:55], v[44:47], v[228:231]
    s_waitcnt lgkmcnt(10)
    ds_read_b64_tr_b16 v[52:53], v121 offset:8192
    v_mfma_f32_16x16x32_bf16 v[136:139], v[56:59], v[32:35], v[136:139]
    ds_read_b64_tr_b16 v[54:55], v121 offset:9216
    v_mfma_f32_16x16x32_bf16 v[168:171], v[56:59], v[36:39], v[168:171]
    buffer_store_dwordx4 v[112:115], v1, s[28:31], s64 offen offset:1024 sc1
    v_mfma_f32_16x16x32_bf16 v[200:203], v[56:59], v[40:43], v[200:203]
    s_nop 0
    v_accvgpr_read_b32 v112, a240
    v_mfma_f32_16x16x32_bf16 v[232:235], v[56:59], v[44:47], v[232:235]
    ds_read_b64_tr_b16 v[56:57], v122 offset:8192
    v_accvgpr_read_b32 v113, a241
    v_mfma_f32_16x16x32_bf16 v[140:143], v[60:63], v[32:35], v[140:143]
    ds_read_b64_tr_b16 v[58:59], v122 offset:9216
    v_accvgpr_read_b32 v114, a242
    v_mfma_f32_16x16x32_bf16 v[172:175], v[60:63], v[36:39], v[172:175]
    v_accvgpr_read_b32 v115, a243
    v_mfma_f32_16x16x32_bf16 v[204:207], v[60:63], v[40:43], v[204:207]
    v_accvgpr_read_b32 v116, a244
    v_mfma_f32_16x16x32_bf16 v[236:239], v[60:63], v[44:47], v[236:239]
    s_waitcnt lgkmcnt(10)
    ds_read_b64_tr_b16 v[60:61], v123 offset:8192
    v_mfma_f32_16x16x32_bf16 v[144:147], v[64:67], v[32:35], v[144:147]
    ds_read_b64_tr_b16 v[62:63], v123 offset:9216
    v_accvgpr_read_b32 v117, a245
    v_mfma_f32_16x16x32_bf16 v[176:179], v[64:67], v[36:39], v[176:179]
    v_accvgpr_read_b32 v118, a246
    v_mfma_f32_16x16x32_bf16 v[208:211], v[64:67], v[40:43], v[208:211]
    v_accvgpr_read_b32 v119, a247
    v_mfma_f32_16x16x32_bf16 v[240:243], v[64:67], v[44:47], v[240:243]
    ds_read_b64_tr_b16 v[64:65], v124 offset:8192
    v_cvt_pk_bf16_f32 v112, v112, v113
    v_mfma_f32_16x16x32_bf16 v[148:151], v[68:71], v[32:35], v[148:151]
    ds_read_b64_tr_b16 v[66:67], v124 offset:9216
    v_mfma_f32_16x16x32_bf16 v[180:183], v[68:71], v[36:39], v[180:183]
    v_cvt_pk_bf16_f32 v113, v114, v115
    v_mfma_f32_16x16x32_bf16 v[212:215], v[68:71], v[40:43], v[212:215]
    v_cvt_pk_bf16_f32 v114, v116, v117
    v_mfma_f32_16x16x32_bf16 v[244:247], v[68:71], v[44:47], v[244:247]
    s_waitcnt lgkmcnt(10)
    ds_read_b64_tr_b16 v[68:69], v125 offset:8192
    v_cvt_pk_bf16_f32 v115, v118, v119
    v_mfma_f32_16x16x32_bf16 v[152:155], v[72:75], v[32:35], v[152:155]
    ds_read_b64_tr_b16 v[70:71], v125 offset:9216
    v_mfma_f32_16x16x32_bf16 v[184:187], v[72:75], v[36:39], v[184:187]
    s_add_u32 s64, s56, 12288
    v_mfma_f32_16x16x32_bf16 v[216:219], v[72:75], v[40:43], v[216:219]
    buffer_store_dwordx4 v[112:115], v1, s[28:31], s64 offen offset:2048 sc1
    v_mfma_f32_16x16x32_bf16 v[248:251], v[72:75], v[44:47], v[248:251]
    s_nop 0
    ds_read_b64_tr_b16 v[72:73], v126 offset:8192
    v_mfma_f32_16x16x32_bf16 v[156:159], v[76:79], v[32:35], v[156:159]
    ds_read_b64_tr_b16 v[74:75], v126 offset:9216
    v_accvgpr_read_b32 v112, a248
    v_mfma_f32_16x16x32_bf16 v[188:191], v[76:79], v[36:39], v[188:191]
    v_mfma_f32_16x16x32_bf16 v[220:223], v[76:79], v[40:43], v[220:223]
    s_waitcnt vmcnt(12)
    v_accvgpr_read_b32 v113, a249
    v_mfma_f32_16x16x32_bf16 v[252:255], v[76:79], v[44:47], v[252:255]
    s_waitcnt lgkmcnt(10)
    ds_read_b64_tr_b16 v[76:77], v127 offset:8192
    v_accvgpr_read_b32 v114, a250
    v_mfma_f32_16x16x32_bf16 v[128:131], v[48:51], v[80:83], v[128:131]
    ds_read_b64_tr_b16 v[78:79], v127 offset:9216
    v_accvgpr_read_b32 v115, a251
    v_mfma_f32_16x16x32_bf16 v[160:163], v[48:51], v[84:87], v[160:163]
    v_accvgpr_read_b32 v116, a252
    v_mfma_f32_16x16x32_bf16 v[192:195], v[48:51], v[88:91], v[192:195]
    v_mfma_f32_16x16x32_bf16 v[224:227], v[48:51], v[92:95], v[224:227]
    v_accvgpr_read_b32 v117, a253
    v_mfma_f32_16x16x32_bf16 v[132:135], v[52:55], v[80:83], v[132:135]
    v_accvgpr_read_b32 v118, a254
    v_mfma_f32_16x16x32_bf16 v[164:167], v[52:55], v[84:87], v[164:167]
    v_accvgpr_read_b32 v119, a255
    v_mfma_f32_16x16x32_bf16 v[196:199], v[52:55], v[88:91], v[196:199]
    v_mfma_f32_16x16x32_bf16 v[228:231], v[52:55], v[92:95], v[228:231]
    s_waitcnt lgkmcnt(8)
    v_cvt_pk_bf16_f32 v112, v112, v113
    v_mfma_f32_16x16x32_bf16 v[136:139], v[56:59], v[80:83], v[136:139]
    v_cvt_pk_bf16_f32 v113, v114, v115
    v_mfma_f32_16x16x32_bf16 v[168:171], v[56:59], v[84:87], v[168:171]
    v_cvt_pk_bf16_f32 v114, v116, v117
    v_mfma_f32_16x16x32_bf16 v[200:203], v[56:59], v[88:91], v[200:203]
    v_cvt_pk_bf16_f32 v115, v118, v119
    v_mfma_f32_16x16x32_bf16 v[232:235], v[56:59], v[92:95], v[232:235]
    v_mfma_f32_16x16x32_bf16 v[140:143], v[60:63], v[80:83], v[140:143]
    s_add_u32 s64, s56, 12288
    v_mfma_f32_16x16x32_bf16 v[172:175], v[60:63], v[84:87], v[172:175]
    buffer_store_dwordx4 v[112:115], v1, s[28:31], s64 offen offset:3072 sc1
    v_mfma_f32_16x16x32_bf16 v[204:207], v[60:63], v[88:91], v[204:207]
    s_nop 0
    v_mfma_f32_16x16x32_bf16 v[236:239], v[60:63], v[92:95], v[236:239]
    s_waitcnt lgkmcnt(4)
    v_mfma_f32_16x16x32_bf16 v[144:147], v[64:67], v[80:83], v[144:147]
    v_mfma_f32_16x16x32_bf16 v[176:179], v[64:67], v[84:87], v[176:179]
    v_mfma_f32_16x16x32_bf16 v[208:211], v[64:67], v[88:91], v[208:211]
    v_mfma_f32_16x16x32_bf16 v[240:243], v[64:67], v[92:95], v[240:243]
    v_mfma_f32_16x16x32_bf16 v[148:151], v[68:71], v[80:83], v[148:151]
    v_mfma_f32_16x16x32_bf16 v[180:183], v[68:71], v[84:87], v[180:183]
    v_mfma_f32_16x16x32_bf16 v[212:215], v[68:71], v[88:91], v[212:215]
    v_mfma_f32_16x16x32_bf16 v[244:247], v[68:71], v[92:95], v[244:247]
    s_waitcnt lgkmcnt(0)
    v_mfma_f32_16x16x32_bf16 v[152:155], v[72:75], v[80:83], v[152:155]
    v_mfma_f32_16x16x32_bf16 v[184:187], v[72:75], v[84:87], v[184:187]
    v_mfma_f32_16x16x32_bf16 v[216:219], v[72:75], v[88:91], v[216:219]
    v_mfma_f32_16x16x32_bf16 v[248:251], v[72:75], v[92:95], v[248:251]
    v_mfma_f32_16x16x32_bf16 v[156:159], v[76:79], v[80:83], v[156:159]
    v_mfma_f32_16x16x32_bf16 v[188:191], v[76:79], v[84:87], v[188:191]
    v_mfma_f32_16x16x32_bf16 v[220:223], v[76:79], v[88:91], v[220:223]
    v_mfma_f32_16x16x32_bf16 v[252:255], v[76:79], v[92:95], v[252:255]
    s_mov_b32 s63, 0
    s_mov_b32 s65, 0x5d800000
    s_lshl_b32 s54, s45, 19
    s_add_u32 s54, s54, s50
    s_mov_b32 s55, s54
    s_load_dwordx2 s[92:93], s[0:1], 64
    s_load_dwordx2 s[94:95], s[0:1], 72
    s_load_dwordx2 s[96:97], s[0:1], 80
    s_lshr_b32 s14, s2, 6
    s_lshl_b32 s14, s14, 1
    s_add_u32 s14, s14, s46
    s_sub_u32 s14, s14, 6
    s_lshl_b32 s14, s14, 3
    s_and_b32 s15, s2, 7
    s_add_u32 s14, s14, s15
    s_cmp_ge_u32 s46, 6
    s_cselect_b32 s14, s14, 255
    s_cmp_lt_u32 s14, 54
    s_cselect_b32 s99, 1, 0
    s_mul_i32 s14, s14, s99
    v_lshrrev_b32 v14, 2, v0
    s_mul_i32 s15, s44, 160
    v_add_u32 v14, s15, v14
    v_mul_u32_u24 v14, 3456, v14
    v_and_b32 v15, 3, v0
    v_lshl_add_u32 v14, v15, 4, v14
    s_lshl_b32 s15, s14, 6
    v_add_u32 v14, s15, v14
    v_mul_lo_u32 v14, v14, s99
    s_mul_i32 s98, s99, 55296
    s_mul_i32 s14, s14, 40960
    s_mul_i32 s15, s44, 10240
    s_add_u32 s14, s14, s15
    v_add_u32 v15, s14, v1
    v_mul_lo_u32 v15, v15, s99
    s_lshl_b32 s99, s99, 12
    s_waitcnt lgkmcnt(0)
    s_waitcnt vmcnt(0)
    s_barrier
    s_cmp_lg_u32 s44, 0
    s_cbranch_scc1 sequential_preLN__compressed_kv_cla__moe_arch_mod__prompt_kernel_kpub
    s_lshl_b32 s14, s45, 3
    s_add_u32 s14, s14, s46
    s_lshl_b32 s14, s14, 2
    s_add_u32 s14, s14, 4096
    v_mov_b32 v12, s3
    v_mov_b32 v13, 0
    s_cmp_eq_u32 s66, 1
    s_cbranch_scc1 sequential_preLN__compressed_kv_cla__moe_arch_mod__prompt_kernel_krel
    buffer_wbl2 sc1
    s_waitcnt vmcnt(0)
    buffer_store_dword v12, v13, s[68:71], s14 offen sc1
    s_branch sequential_preLN__compressed_kv_cla__moe_arch_mod__prompt_kernel_kpub
sequential_preLN__compressed_kv_cla__moe_arch_mod__prompt_kernel_krel:
    buffer_store_dword v12, v13, s[68:71], s14 offen
sequential_preLN__compressed_kv_cla__moe_arch_mod__prompt_kernel_kpub:
    s_lshl_b32 s15, s45, 5
    s_add_u32 s15, s15, 4096
    v_and_b32 v13, 7, v0
    v_lshlrev_b32 v13, 2, v13
    buffer_load_dword v12, v13, s[68:71], s15 offen sc1
    s_nop 7
    v_cvt_pk_bf16_f32 v128, v128, v129
    v_cvt_pk_bf16_f32 v129, v130, v131
    v_cvt_pk_bf16_f32 v130, v132, v133
    v_cvt_pk_bf16_f32 v131, v134, v135
    v_accvgpr_write_b32 a0, v128
    v_accvgpr_write_b32 a1, v129
    v_accvgpr_write_b32 a2, v130
    v_accvgpr_write_b32 a3, v131
    v_cvt_pk_bf16_f32 v136, v136, v137
    v_cvt_pk_bf16_f32 v137, v138, v139
    v_cvt_pk_bf16_f32 v138, v140, v141
    v_cvt_pk_bf16_f32 v139, v142, v143
    v_accvgpr_write_b32 a4, v136
    v_accvgpr_write_b32 a5, v137
    v_accvgpr_write_b32 a6, v138
    v_accvgpr_write_b32 a7, v139
    v_cvt_pk_bf16_f32 v144, v144, v145
    v_cvt_pk_bf16_f32 v145, v146, v147
    v_cvt_pk_bf16_f32 v146, v148, v149
    v_cvt_pk_bf16_f32 v147, v150, v151
    v_accvgpr_write_b32 a8, v144
    v_accvgpr_write_b32 a9, v145
    v_accvgpr_write_b32 a10, v146
    v_accvgpr_write_b32 a11, v147
    v_cvt_pk_bf16_f32 v152, v152, v153
    v_cvt_pk_bf16_f32 v153, v154, v155
    v_cvt_pk_bf16_f32 v154, v156, v157
    v_cvt_pk_bf16_f32 v155, v158, v159
    v_accvgpr_write_b32 a12, v152
    v_accvgpr_write_b32 a13, v153
    v_accvgpr_write_b32 a14, v154
    v_accvgpr_write_b32 a15, v155
    v_cvt_pk_bf16_f32 v160, v160, v161
    v_cvt_pk_bf16_f32 v161, v162, v163
    v_cvt_pk_bf16_f32 v162, v164, v165
    v_cvt_pk_bf16_f32 v163, v166, v167
    v_accvgpr_write_b32 a16, v160
    v_accvgpr_write_b32 a17, v161
    v_accvgpr_write_b32 a18, v162
    v_accvgpr_write_b32 a19, v163
    v_cvt_pk_bf16_f32 v168, v168, v169
    v_cvt_pk_bf16_f32 v169, v170, v171
    v_cvt_pk_bf16_f32 v170, v172, v173
    v_cvt_pk_bf16_f32 v171, v174, v175
    v_accvgpr_write_b32 a20, v168
    v_accvgpr_write_b32 a21, v169
    v_accvgpr_write_b32 a22, v170
    v_accvgpr_write_b32 a23, v171
    v_cvt_pk_bf16_f32 v176, v176, v177
    v_cvt_pk_bf16_f32 v177, v178, v179
    v_cvt_pk_bf16_f32 v178, v180, v181
    v_cvt_pk_bf16_f32 v179, v182, v183
    v_accvgpr_write_b32 a24, v176
    v_accvgpr_write_b32 a25, v177
    v_accvgpr_write_b32 a26, v178
    v_accvgpr_write_b32 a27, v179
    v_cvt_pk_bf16_f32 v184, v184, v185
    v_cvt_pk_bf16_f32 v185, v186, v187
    v_cvt_pk_bf16_f32 v186, v188, v189
    v_cvt_pk_bf16_f32 v187, v190, v191
    v_accvgpr_write_b32 a28, v184
    v_accvgpr_write_b32 a29, v185
    v_accvgpr_write_b32 a30, v186
    v_accvgpr_write_b32 a31, v187
    v_cvt_pk_bf16_f32 v192, v192, v193
    v_cvt_pk_bf16_f32 v193, v194, v195
    v_cvt_pk_bf16_f32 v194, v196, v197
    v_cvt_pk_bf16_f32 v195, v198, v199
    v_accvgpr_write_b32 a32, v192
    v_accvgpr_write_b32 a33, v193
    v_accvgpr_write_b32 a34, v194
    v_accvgpr_write_b32 a35, v195
    v_cvt_pk_bf16_f32 v200, v200, v201
    v_cvt_pk_bf16_f32 v201, v202, v203
    v_cvt_pk_bf16_f32 v202, v204, v205
    v_cvt_pk_bf16_f32 v203, v206, v207
    v_accvgpr_write_b32 a36, v200
    v_accvgpr_write_b32 a37, v201
    v_accvgpr_write_b32 a38, v202
    v_accvgpr_write_b32 a39, v203
    v_cvt_pk_bf16_f32 v208, v208, v209
    v_cvt_pk_bf16_f32 v209, v210, v211
    v_cvt_pk_bf16_f32 v210, v212, v213
    v_cvt_pk_bf16_f32 v211, v214, v215
    v_accvgpr_write_b32 a40, v208
    v_accvgpr_write_b32 a41, v209
    v_accvgpr_write_b32 a42, v210
    v_accvgpr_write_b32 a43, v211
    v_cvt_pk_bf16_f32 v216, v216, v217
    v_cvt_pk_bf16_f32 v217, v218, v219
    v_cvt_pk_bf16_f32 v218, v220, v221
    v_cvt_pk_bf16_f32 v219, v222, v223
    v_accvgpr_write_b32 a44, v216
    v_accvgpr_write_b32 a45, v217
    v_accvgpr_write_b32 a46, v218
    v_accvgpr_write_b32 a47, v219
    v_cvt_pk_bf16_f32 v224, v224, v225
    v_cvt_pk_bf16_f32 v225, v226, v227
    v_cvt_pk_bf16_f32 v226, v228, v229
    v_cvt_pk_bf16_f32 v227, v230, v231
    v_accvgpr_write_b32 a48, v224
    v_accvgpr_write_b32 a49, v225
    v_accvgpr_write_b32 a50, v226
    v_accvgpr_write_b32 a51, v227
    v_cvt_pk_bf16_f32 v232, v232, v233
    v_cvt_pk_bf16_f32 v233, v234, v235
    v_cvt_pk_bf16_f32 v234, v236, v237
    v_cvt_pk_bf16_f32 v235, v238, v239
    v_accvgpr_write_b32 a52, v232
    v_accvgpr_write_b32 a53, v233
    v_accvgpr_write_b32 a54, v234
    v_accvgpr_write_b32 a55, v235
    v_cvt_pk_bf16_f32 v240, v240, v241
    v_cvt_pk_bf16_f32 v241, v242, v243
    v_cvt_pk_bf16_f32 v242, v244, v245
    v_cvt_pk_bf16_f32 v243, v246, v247
    v_accvgpr_write_b32 a56, v240
    v_accvgpr_write_b32 a57, v241
    v_accvgpr_write_b32 a58, v242
    v_accvgpr_write_b32 a59, v243
    v_cvt_pk_bf16_f32 v248, v248, v249
    v_cvt_pk_bf16_f32 v249, v250, v251
    v_cvt_pk_bf16_f32 v250, v252, v253
    v_cvt_pk_bf16_f32 v251, v254, v255
    v_accvgpr_write_b32 a60, v248
    v_accvgpr_write_b32 a61, v249
    v_accvgpr_write_b32 a62, v250
    v_accvgpr_write_b32 a63, v251
    v_mov_b32 v9, 0x3f803f80
    v_accvgpr_write_b32 a128, v9
    v_accvgpr_write_b32 a129, v9
    v_accvgpr_write_b32 a130, v9
    v_accvgpr_write_b32 a131, v9
    v_and_b32 v9, 15, v0
    v_lshrrev_b32 v10, 4, v0
    v_lshlrev_b32 v10, 2, v10
    v_sub_u32 v9, v9, v10
    v_cmp_le_i32 s[36:37], 0, v9
    v_cmp_le_i32 s[38:39], 1, v9
    v_cmp_le_i32 s[40:41], 2, v9
    v_cmp_le_i32 s[42:43], 3, v9
    v_mov_b32 v3, 0xff800000
    v_mov_b32 v16, 0
    v_mov_b32 v17, 0
    v_mov_b32 v18, 0
    v_mov_b32 v19, 0
    v_mov_b32 v20, 0
    v_mov_b32 v21, 0
    v_mov_b32 v22, 0
    v_mov_b32 v23, 0
    v_mov_b32 v24, 0
    v_mov_b32 v25, 0
    v_mov_b32 v26, 0
    v_mov_b32 v27, 0
    v_mov_b32 v28, 0
    v_mov_b32 v29, 0
    v_mov_b32 v30, 0
    v_mov_b32 v31, 0
    v_mov_b32 v116, 0
    v_mov_b32 v117, 0
    v_mov_b32 v118, 0
    v_mov_b32 v119, 0
    v_mov_b32 v128, 0
    v_mov_b32 v129, 0
    v_mov_b32 v130, 0
    v_mov_b32 v131, 0
    v_mov_b32 v132, 0
    v_mov_b32 v133, 0
    v_mov_b32 v134, 0
    v_mov_b32 v135, 0
    v_mov_b32 v136, 0
    v_mov_b32 v137, 0
    v_mov_b32 v138, 0
    v_mov_b32 v139, 0
    v_mov_b32 v140, 0
    v_mov_b32 v141, 0
    v_mov_b32 v142, 0
    v_mov_b32 v143, 0
    v_mov_b32 v144, 0
    v_mov_b32 v145, 0
    v_mov_b32 v146, 0
    v_mov_b32 v147, 0
    v_mov_b32 v148, 0
    v_mov_b32 v149, 0
    v_mov_b32 v150, 0
    v_mov_b32 v151, 0
    v_mov_b32 v152, 0
    v_mov_b32 v153, 0
    v_mov_b32 v154, 0
    v_mov_b32 v155, 0
    v_mov_b32 v156, 0
    v_mov_b32 v157, 0
    v_mov_b32 v158, 0
    v_mov_b32 v159, 0
    v_mov_b32 v160, 0
    v_mov_b32 v161, 0
    v_mov_b32 v162, 0
    v_mov_b32 v163, 0
    v_mov_b32 v164, 0
    v_mov_b32 v165, 0
    v_mov_b32 v166, 0
    v_mov_b32 v167, 0
    v_mov_b32 v168, 0
    v_mov_b32 v169, 0
    v_mov_b32 v170, 0
    v_mov_b32 v171, 0
    v_mov_b32 v172, 0
    v_mov_b32 v173, 0
    v_mov_b32 v174, 0
    v_mov_b32 v175, 0
    v_mov_b32 v176, 0
    v_mov_b32 v177, 0
    v_mov_b32 v178, 0
    v_mov_b32 v179, 0
    v_mov_b32 v180, 0
    v_mov_b32 v181, 0
    v_mov_b32 v182, 0
    v_mov_b32 v183, 0
    v_mov_b32 v184, 0
    v_mov_b32 v185, 0
    v_mov_b32 v186, 0
    v_mov_b32 v187, 0
    v_mov_b32 v188, 0
    v_mov_b32 v189, 0
    v_mov_b32 v190, 0
    v_mov_b32 v191, 0
    s_waitcnt vmcnt(0) lgkmcnt(0)
    s_cmp_lg_u32 s44, 0
    s_cbranch_scc1 sequential_preLN__compressed_kv_cla__moe_arch_mod__prompt_kernel_kok
    s_mov_b32 s14, 0
sequential_preLN__compressed_kv_cla__moe_arch_mod__prompt_kernel_kpoll:
    v_cmp_ne_u32 vcc, s3, v12
    s_add_u32 s14, s14, 1
    s_cbranch_vccz sequential_preLN__compressed_kv_cla__moe_arch_mod__prompt_kernel_kok2
    s_cmp_ge_u32 s14, 65536
    s_cbranch_scc1 sequential_preLN__compressed_kv_cla__moe_arch_mod__prompt_kernel_kok2
    buffer_load_dword v12, v13, s[68:71], s15 offen sc1
    s_waitcnt vmcnt(0)
    s_branch sequential_preLN__compressed_kv_cla__moe_arch_mod__prompt_kernel_kpoll
sequential_preLN__compressed_kv_cla__moe_arch_mod__prompt_kernel_kok2:
    s_cmp_eq_u32 s66, 1
    s_cbranch_scc1 sequential_preLN__compressed_kv_cla__moe_arch_mod__prompt_kernel_kok
    buffer_inv sc1
    s_waitcnt vmcnt(0)
sequential_preLN__compressed_kv_cla__moe_arch_mod__prompt_kernel_kok:
    s_barrier
    s_add_u32 m0, s50, 0
    s_nop 0
    buffer_load_dwordx4 v1, s[24:27], s54 offen offset:0 lds
    buffer_load_dwordx4 v1, s[24:27], s54 offen offset:1024 lds
    buffer_load_dwordx4 v1, s[24:27], s54 offen offset:2048 lds
    buffer_load_dwordx4 v1, s[24:27], s54 offen offset:3072 lds
    s_add_u32 s54, s54, 16384
    s_add_u32 m0, s50, 32768
    s_nop 0
    buffer_load_dwordx4 v1, s[24:27], s54 offen offset:0 lds
    buffer_load_dwordx4 v1, s[24:27], s54 offen offset:1024 lds
    buffer_load_dwordx4 v1, s[24:27], s54 offen offset:2048 lds
    buffer_load_dwordx4 v1, s[24:27], s54 offen offset:3072 lds
    s_add_u32 s54, s54, 16384
    s_add_u32 m0, s50, 49152
    s_nop 0
    buffer_load_dwordx4 v1, s[28:31], s55 offen offset:0 lds
    buffer_load_dwordx4 v1, s[28:31], s55 offen offset:1024 lds
    buffer_load_dwordx4 v1, s[28:31], s55 offen offset:2048 lds
    buffer_load_dwordx4 v1, s[28:31], s55 offen offset:3072 lds
    s_add_u32 s55, s55, 16384
    s_mov_b32 s58, 0
    v_mov_b32 v2, v1
    v_mov_b32 v192, 0
    v_mov_b32 v193, 0
    v_mov_b32 v194, 0
    v_mov_b32 v195, 0
    v_mov_b32 v196, 0
    v_mov_b32 v197, 0
    v_mov_b32 v198, 0
    v_mov_b32 v199, 0
    v_mov_b32 v200, 0
    v_mov_b32 v201, 0
    v_mov_b32 v202, 0
    v_mov_b32 v203, 0
    v_mov_b32 v204, 0
    v_mov_b32 v205, 0
    v_mov_b32 v206, 0
    v_mov_b32 v207, 0
    v_mov_b32 v208, 0
    v_mov_b32 v209, 0
    v_mov_b32 v210, 0
    v_mov_b32 v211, 0
    v_mov_b32 v212, 0
    v_mov_b32 v213, 0
    v_mov_b32 v214, 0
    v_mov_b32 v215, 0
    v_mov_b32 v216, 0
    v_mov_b32 v217, 0
    v_mov_b32 v218, 0
    v_mov_b32 v219, 0
    v_mov_b32 v220, 0
    v_mov_b32 v221, 0
    v_mov_b32 v222, 0
    v_mov_b32 v223, 0
    v_mov_b32 v224, 0
    v_mov_b32 v225, 0
    v_mov_b32 v226, 0
    v_mov_b32 v227, 0
    v_mov_b32 v228, 0
    v_mov_b32 v229, 0
    v_mov_b32 v230, 0
    v_mov_b32 v231, 0
    v_mov_b32 v232, 0
    v_mov_b32 v233, 0
    v_mov_b32 v234, 0
    v_mov_b32 v235, 0
    v_mov_b32 v236, 0
    v_mov_b32 v237, 0
    v_mov_b32 v238, 0
    v_mov_b32 v239, 0
    v_mov_b32 v240, 0
    v_mov_b32 v241, 0
    v_mov_b32 v242, 0
    v_mov_b32 v243, 0
    v_mov_b32 v244, 0
    v_mov_b32 v245, 0
    v_mov_b32 v246, 0
    v_mov_b32 v247, 0
    v_mov_b32 v248, 0
    v_mov_b32 v249, 0
    v_mov_b32 v250, 0
    v_mov_b32 v251, 0
    v_mov_b32 v252, 0
    v_mov_b32 v253, 0
    v_mov_b32 v254, 0
    v_mov_b32 v255, 0
    s_lshl_b32 s62, s60, 2
    s_add_u32 s62, s62, s44
    s_sub_u32 s62, 0, s62
    s_cmp_lt_i32 s62, 0
    s_cselect_b64 s[14:15], -1, 0
    s_cmp_eq_u32 s62, 0
    s_cselect_b64 s[4:5], s[36:37], s[14:15]
    s_cselect_b64 s[6:7], s[38:39], s[14:15]
    s_cselect_b64 s[8:9], s[40:41], s[14:15]
    s_cselect_b64 s[10:11], s[42:43], s[14:15]
    s_cmp_le_i32 s62, 0
    s_cselect_b64 s[12:13], -1, 0
    v_cndmask_b32 v32, v3, v24, s[4:5]
    v_cndmask_b32 v33, v3, v25, s[6:7]
    v_cndmask_b32 v34, v3, v26, s[8:9]
    v_cndmask_b32 v35, v3, v27, s[10:11]
    v_cndmask_b32 v36, v3, v24, s[14:15]
    v_cndmask_b32 v37, v3, v25, s[14:15]
    v_cndmask_b32 v38, v3, v26, s[14:15]
    v_cndmask_b32 v39, v3, v27, s[14:15]
    v_cndmask_b32 v40, v3, v28, s[12:13]
    v_cndmask_b32 v41, v3, v29, s[12:13]
    v_cndmask_b32 v42, v3, v30, s[12:13]
    v_cndmask_b32 v43, v3, v31, s[12:13]
    v_cndmask_b32 v44, v3, v28, s[4:5]
    v_cndmask_b32 v45, v3, v29, s[6:7]
    v_cndmask_b32 v46, v3, v30, s[8:9]
    v_cndmask_b32 v47, v3, v31, s[10:11]
    s_waitcnt vmcnt(8)
    s_barrier
    ds_read_b128 a[64:67], v2 offset:0
    ds_read_b128 a[68:71], v2 offset:1024
    ds_read_b128 a[72:75], v2 offset:2048
    ds_read_b128 a[76:79], v2 offset:3072
    ds_read_b128 a[80:83], v2 offset:4096
    ds_read_b128 a[84:87], v2 offset:5120
    ds_read_b128 a[88:91], v2 offset:6144
    ds_read_b128 a[92:95], v2 offset:7168
    s_waitcnt lgkmcnt(0)
    v_mfma_f32_16x16x32_bf16 v[48:51], a[64:67], a[0:3], v[16:19]
    s_add_u32 m0, s50, 65536
    v_mfma_f32_16x16x32_bf16 v[48:51], a[68:71], a[4:7], v[48:51]
    buffer_load_dwordx4 v1, s[24:27], s54 offen offset:0 lds
    v_mfma_f32_16x16x32_bf16 v[48:51], a[72:75], a[8:11], v[48:51]
    v_mfma_f32_16x16x32_bf16 v[48:51], a[76:79], a[12:15], v[48:51]
    buffer_load_dwordx4 v1, s[24:27], s54 offen offset:1024 lds
    v_mfma_f32_16x16x32_bf16 v[52:55], a[80:83], a[0:3], v[16:19]
    v_mfma_f32_16x16x32_bf16 v[52:55], a[84:87], a[4:7], v[52:55]
    v_mfma_f32_16x16x32_bf16 v[52:55], a[88:91], a[8:11], v[52:55]
    buffer_load_dwordx4 v1, s[24:27], s54 offen offset:2048 lds
    v_mfma_f32_16x16x32_bf16 v[52:55], a[92:95], a[12:15], v[52:55]
    v_mfma_f32_16x16x32_bf16 v[56:59], a[64:67], a[16:19], v[20:23]
    v_mfma_f32_16x16x32_bf16 v[56:59], a[68:71], a[20:23], v[56:59]
    buffer_load_dwordx4 v1, s[24:27], s54 offen offset:3072 lds
    v_mfma_f32_16x16x32_bf16 v[56:59], a[72:75], a[24:27], v[56:59]
    s_add_u32 s54, s54, 16384
    s_add_u32 m0, s50, 81920
    v_mfma_f32_16x16x32_bf16 v[56:59], a[76:79], a[28:31], v[56:59]
    v_mfma_f32_16x16x32_bf16 v[60:63], a[80:83], a[16:19], v[20:23]
    buffer_load_dwordx4 v1, s[28:31], s55 offen offset:0 lds
    v_mfma_f32_16x16x32_bf16 v[60:63], a[84:87], a[20:23], v[60:63]
    v_mfma_f32_16x16x32_bf16 v[60:63], a[88:91], a[24:27], v[60:63]
    v_mfma_f32_16x16x32_bf16 v[60:63], a[92:95], a[28:31], v[60:63]
    buffer_load_dwordx4 v1, s[28:31], s55 offen offset:1024 lds
    v_mfma_f32_16x16x32_bf16 v[64:67], a[64:67], a[32:35], v[32:35]
    v_mfma_f32_16x16x32_bf16 v[64:67], a[68:71], a[36:39], v[64:67]
    v_mfma_f32_16x16x32_bf16 v[64:67], a[72:75], a[40:43], v[64:67]
    buffer_load_dwordx4 v1, s[28:31], s55 offen offset:2048 lds
    v_mfma_f32_16x16x32_bf16 v[64:67], a[76:79], a[44:47], v[64:67]
    v_mfma_f32_16x16x32_bf16 v[68:71], a[80:83], a[32:35], v[36:39]
    v_mfma_f32_16x16x32_bf16 v[68:71], a[84:87], a[36:39], v[68:71]
    buffer_load_dwordx4 v1, s[28:31], s55 offen offset:3072 lds
    v_mfma_f32_16x16x32_bf16 v[68:71], a[88:91], a[40:43], v[68:71]
    s_add_u32 s55, s55, 16384
    v_mfma_f32_16x16x32_bf16 v[68:71], a[92:95], a[44:47], v[68:71]
    v_mfma_f32_16x16x32_bf16 v[72:75], a[64:67], a[48:51], v[40:43]
    v_mfma_f32_16x16x32_bf16 v[72:75], a[68:71], a[52:55], v[72:75]
    v_mfma_f32_16x16x32_bf16 v[72:75], a[72:75], a[56:59], v[72:75]
    v_mfma_f32_16x16x32_bf16 v[72:75], a[76:79], a[60:63], v[72:75]
    v_mfma_f32_16x16x32_bf16 v[76:79], a[80:83], a[48:51], v[44:47]
    v_mfma_f32_16x16x32_bf16 v[76:79], a[84:87], a[52:55], v[76:79]
    v_mfma_f32_16x16x32_bf16 v[76:79], a[88:91], a[56:59], v[76:79]
    v_mfma_f32_16x16x32_bf16 v[76:79], a[92:95], a[60:63], v[76:79]
    s_add_u32 s57, s50, 131072
    ds_read_b128 a[64:67], v2 offset:8192
    ds_read_b128 a[68:71], v2 offset:9216
    ds_read_b128 a[72:75], v2 offset:10240
    ds_read_b128 a[76:79], v2 offset:11264
    ds_read_b128 a[80:83], v2 offset:12288
    ds_read_b128 a[84:87], v2 offset:13312
    ds_read_b128 a[88:91], v2 offset:14336
    ds_read_b128 a[92:95], v2 offset:15360
    v_max3_f32 v120, v48, v49, v50
    v_max3_f32 v121, v56, v57, v58
    v_max3_f32 v122, v64, v65, v66
    v_max3_f32 v123, v72, v73, v74
    v_max3_f32 v120, v120, v51, v52
    v_max3_f32 v121, v121, v59, v60
    v_max3_f32 v122, v122, v67, v68
    v_max3_f32 v123, v123, v75, v76
    v_max3_f32 v120, v120, v53, v54
    v_max3_f32 v121, v121, v61, v62
    v_max3_f32 v122, v122, v69, v70
    v_max3_f32 v123, v123, v77, v78
    v_max_f32 v120, v120, v55
    v_max_f32 v121, v121, v63
    v_max_f32 v122, v122, v71
    v_max_f32 v123, v123, v79
    v_mov_b32 v124, v120
    v_mov_b32 v125, v121
    v_mov_b32 v126, v122
    v_mov_b32 v127, v123
    v_permlane16_swap_b32 v120, v124
    v_permlane16_swap_b32 v121, v125
    v_permlane16_swap_b32 v122, v126
    v_permlane16_swap_b32 v123, v127
    s_nop 0
    v_max_f32 v120, v120, v124
    v_max_f32 v121, v121, v125
    v_max_f32 v122, v122, v126
    v_max_f32 v123, v123, v127
    v_mov_b32 v124, v120
    v_mov_b32 v125, v121
    v_mov_b32 v126, v122
    v_mov_b32 v127, v123
    v_permlane32_swap_b32 v120, v124
    v_permlane32_swap_b32 v121, v125
    v_permlane32_swap_b32 v122, v126
    v_permlane32_swap_b32 v123, v127
    s_nop 0
    v_max_f32 v120, v120, v124
    v_max_f32 v121, v121, v125
    v_max_f32 v122, v122, v126
    v_max_f32 v123, v123, v127
    v_sub_f32 v48, v48, v120
    v_sub_f32 v56, v56, v121
    v_sub_f32 v64, v64, v122
    v_sub_f32 v72, v72, v123
    v_sub_f32 v49, v49, v120
    v_sub_f32 v57, v57, v121
    v_sub_f32 v65, v65, v122
    v_sub_f32 v73, v73, v123
    v_sub_f32 v50, v50, v120
    v_sub_f32 v58, v58, v121
    v_sub_f32 v66, v66, v122
    v_sub_f32 v74, v74, v123
    v_sub_f32 v51, v51, v120
    v_sub_f32 v59, v59, v121
    v_sub_f32 v67, v67, v122
    v_sub_f32 v75, v75, v123
    v_sub_f32 v52, v52, v120
    v_sub_f32 v60, v60, v121
    v_sub_f32 v68, v68, v122
    v_sub_f32 v76, v76, v123
    v_sub_f32 v53, v53, v120
    v_sub_f32 v61, v61, v121
    v_sub_f32 v69, v69, v122
    v_sub_f32 v77, v77, v123
    v_sub_f32 v54, v54, v120
    v_sub_f32 v62, v62, v121
    v_sub_f32 v70, v70, v122
    v_sub_f32 v78, v78, v123
    v_sub_f32 v55, v55, v120
    v_sub_f32 v63, v63, v121
    v_sub_f32 v71, v71, v122
    v_sub_f32 v79, v79, v123
    v_sub_f32 v16, 0, v120
    v_sub_f32 v17, 0, v120
    v_sub_f32 v18, 0, v120
    v_sub_f32 v19, 0, v120
    v_sub_f32 v20, 0, v121
    v_sub_f32 v21, 0, v121
    v_sub_f32 v22, 0, v121
    v_sub_f32 v23, 0, v121
    v_sub_f32 v24, 0, v122
    v_sub_f32 v25, 0, v122
    v_sub_f32 v26, 0, v122
    v_sub_f32 v27, 0, v122
    v_sub_f32 v28, 0, v123
    v_sub_f32 v29, 0, v123
    v_sub_f32 v30, 0, v123
    v_sub_f32 v31, 0, v123
    v_exp_f32 v48, v48
    v_exp_f32 v56, v56
    v_exp_f32 v64, v64
    s_add_u32 m0, s50, 98304
    s_nop 0
    buffer_load_dwordx4 v1, s[24:27], s54 offen offset:0 lds
    v_exp_f32 v49, v49
    v_exp_f32 v57, v57
    v_exp_f32 v65, v65
    buffer_load_dwordx4 v1, s[24:27], s54 offen offset:1024 lds
    v_exp_f32 v50, v50
    v_exp_f32 v58, v58
    v_exp_f32 v66, v66
    buffer_load_dwordx4 v1, s[24:27], s54 offen offset:2048 lds
    v_exp_f32 v51, v51
    v_exp_f32 v59, v59
    v_exp_f32 v67, v67
    buffer_load_dwordx4 v1, s[24:27], s54 offen offset:3072 lds
    v_exp_f32 v52, v52
    v_exp_f32 v60, v60
    v_exp_f32 v68, v68
    s_add_u32 s54, s54, 16384
    s_add_u32 m0, s50, 114688
    s_nop 0
    buffer_load_dwordx4 v1, s[28:31], s55 offen offset:0 lds
    v_exp_f32 v53, v53
    v_exp_f32 v61, v61
    v_exp_f32 v69, v69
    buffer_load_dwordx4 v1, s[28:31], s55 offen offset:1024 lds
    v_exp_f32 v54, v54
    v_exp_f32 v62, v62
    v_exp_f32 v70, v70
    buffer_load_dwordx4 v1, s[28:31], s55 offen offset:2048 lds
    v_exp_f32 v55, v55
    v_exp_f32 v63, v63
    v_exp_f32 v71, v71
    buffer_load_dwordx4 v1, s[28:31], s55 offen offset:3072 lds
    s_add_u32 s55, s55, 16384
    s_nop 0
    v_add_f32 v116, v116, v48
    v_add_f32 v117, v117, v56
    v_add_f32 v118, v118, v64
    v_add_f32 v116, v116, v49
    v_add_f32 v117, v117, v57
    v_add_f32 v118, v118, v65
    v_add_f32 v116, v116, v50
    v_add_f32 v117, v117, v58
    v_add_f32 v118, v118, v66
    v_add_f32 v116, v116, v51
    v_add_f32 v117, v117, v59
    v_add_f32 v118, v118, v67
    v_add_f32 v116, v116, v52
    v_add_f32 v117, v117, v60
    v_add_f32 v118, v118, v68
    v_add_f32 v116, v116, v53
    v_add_f32 v117, v117, v61
    v_add_f32 v118, v118, v69
    v_add_f32 v116, v116, v54
    v_add_f32 v117, v117, v62
    v_add_f32 v118, v118, v70
    v_add_f32 v116, v116, v55
    v_add_f32 v117, v117, v63
    v_add_f32 v118, v118, v71
    v_cvt_pk_bf16_f32 v80, v48, v49
    v_cvt_pk_bf16_f32 v84, v56, v57
    v_cvt_pk_bf16_f32 v88, v64, v65
    v_cvt_pk_bf16_f32 v81, v50, v51
    v_cvt_pk_bf16_f32 v85, v58, v59
    v_cvt_pk_bf16_f32 v89, v66, v67
    v_cvt_pk_bf16_f32 v82, v52, v53
    v_cvt_pk_bf16_f32 v86, v60, v61
    v_cvt_pk_bf16_f32 v90, v68, v69
    v_cvt_pk_bf16_f32 v83, v54, v55
    v_cvt_pk_bf16_f32 v87, v62, v63
    v_cvt_pk_bf16_f32 v91, v70, v71
    s_mov_b32 s58, 32768
    v_add_u32 v2, s58, v1
    s_cmp_eq_u32 s60, 0
    s_cbranch_scc1 sequential_preLN__compressed_kv_cla__moe_arch_mod__prompt_kernel_t0
    s_lshl_b32 s61, s60, 1
    s_sub_u32 s61, s61, 1
sequential_preLN__compressed_kv_cla__moe_arch_mod__prompt_kernel_dn:
    s_waitcnt lgkmcnt(4)
    v_mfma_f32_16x16x32_bf16 v[48:51], a[64:67], a[0:3], v[16:19]
    s_waitcnt vmcnt(16)
    s_barrier
    v_exp_f32 v112, v72
    v_mfma_f32_16x16x32_bf16 v[48:51], a[68:71], a[4:7], v[48:51]
    v_exp_f32 v113, v73
    v_mfma_f32_16x16x32_bf16 v[48:51], a[72:75], a[8:11], v[48:51]
    s_mov_b32 m0, s57
    ds_read_b128 a[96:99], v2 offset:16384
    v_add_f32 v119, v119, v112
    v_mfma_f32_16x16x32_bf16 v[48:51], a[76:79], a[12:15], v[48:51]
    s_waitcnt lgkmcnt(1)
    buffer_load_dwordx4 v1, s[24:27], s54 offen offset:0 lds
    v_add_f32 v119, v119, v113
    v_cvt_pk_bf16_f32 v92, v112, v113
    v_mfma_f32_16x16x32_bf16 v[52:55], a[80:83], a[0:3], v[16:19]
    v_exp_f32 v114, v74
    v_mfma_f32_16x16x32_bf16 v[52:55], a[84:87], a[4:7], v[52:55]
    v_exp_f32 v115, v75
    v_mfma_f32_16x16x32_bf16 v[52:55], a[88:91], a[8:11], v[52:55]
    ds_read_b128 a[100:103], v2 offset:17408
    v_add_f32 v119, v119, v114
    v_mfma_f32_16x16x32_bf16 v[52:55], a[92:95], a[12:15], v[52:55]
    buffer_load_dwordx4 v1, s[24:27], s54 offen offset:1024 lds
    v_add_f32 v119, v119, v115
    v_cvt_pk_bf16_f32 v93, v114, v115
    v_mfma_f32_16x16x32_bf16 v[56:59], a[64:67], a[16:19], v[20:23]
    v_exp_f32 v112, v76
    v_mfma_f32_16x16x32_bf16 v[56:59], a[68:71], a[20:23], v[56:59]
    v_exp_f32 v113, v77
    v_mfma_f32_16x16x32_bf16 v[56:59], a[72:75], a[24:27], v[56:59]
    ds_read_b128 a[104:107], v2 offset:18432
    v_add_f32 v119, v119, v112
    v_mfma_f32_16x16x32_bf16 v[56:59], a[76:79], a[28:31], v[56:59]
    buffer_load_dwordx4 v1, s[24:27], s54 offen offset:2048 lds
    v_add_f32 v119, v119, v113
    v_cvt_pk_bf16_f32 v94, v112, v113
    v_mfma_f32_16x16x32_bf16 v[60:63], a[80:83], a[16:19], v[20:23]
    v_exp_f32 v114, v78
    v_mfma_f32_16x16x32_bf16 v[60:63], a[84:87], a[20:23], v[60:63]
    v_exp_f32 v115, v79
    v_mfma_f32_16x16x32_bf16 v[60:63], a[88:91], a[24:27], v[60:63]
    ds_read_b128 a[108:111], v2 offset:19456
    v_add_f32 v119, v119, v114
    v_mfma_f32_16x16x32_bf16 v[60:63], a[92:95], a[28:31], v[60:63]
    buffer_load_dwordx4 v1, s[24:27], s54 offen offset:3072 lds
    v_add_f32 v119, v119, v115
    v_cvt_pk_bf16_f32 v95, v114, v115
    v_mfma_f32_16x16x32_bf16 v[64:67], a[64:67], a[32:35], v[24:27]
    s_add_u32 s54, s54, 16384
    v_exp_f32 v112, v48
    v_mfma_f32_16x16x32_bf16 v[64:67], a[68:71], a[36:39], v[64:67]
    v_exp_f32 v113, v49
    v_mfma_f32_16x16x32_bf16 v[64:67], a[72:75], a[40:43], v[64:67]
    ds_read_b128 a[112:115], v2 offset:20480
    v_add_f32 v116, v116, v112
    v_mfma_f32_16x16x32_bf16 v[64:67], a[76:79], a[44:47], v[64:67]
    v_add_f32 v116, v116, v113
    v_cvt_pk_bf16_f32 v96, v112, v113
    v_mfma_f32_16x16x32_bf16 v[68:71], a[80:83], a[32:35], v[24:27]
    v_exp_f32 v114, v50
    v_mfma_f32_16x16x32_bf16 v[68:71], a[84:87], a[36:39], v[68:71]
    v_exp_f32 v115, v51
    v_mfma_f32_16x16x32_bf16 v[68:71], a[88:91], a[40:43], v[68:71]
    ds_read_b128 a[116:119], v2 offset:21504
    v_add_f32 v116, v116, v114
    v_mfma_f32_16x16x32_bf16 v[68:71], a[92:95], a[44:47], v[68:71]
    v_add_f32 v116, v116, v115
    v_cvt_pk_bf16_f32 v97, v114, v115
    v_mfma_f32_16x16x32_bf16 v[72:75], a[64:67], a[48:51], v[28:31]
    v_exp_f32 v112, v52
    v_mfma_f32_16x16x32_bf16 v[72:75], a[68:71], a[52:55], v[72:75]
    v_exp_f32 v113, v53
    v_mfma_f32_16x16x32_bf16 v[72:75], a[72:75], a[56:59], v[72:75]
    ds_read_b128 a[120:123], v2 offset:22528
    v_add_f32 v116, v116, v112
    v_mfma_f32_16x16x32_bf16 v[72:75], a[76:79], a[60:63], v[72:75]
    v_add_f32 v116, v116, v113
    v_cvt_pk_bf16_f32 v98, v112, v113
    v_mfma_f32_16x16x32_bf16 v[76:79], a[80:83], a[48:51], v[28:31]
    v_exp_f32 v114, v54
    v_mfma_f32_16x16x32_bf16 v[76:79], a[84:87], a[52:55], v[76:79]
    v_exp_f32 v115, v55
    v_mfma_f32_16x16x32_bf16 v[76:79], a[88:91], a[56:59], v[76:79]
    ds_read_b128 a[124:127], v2 offset:23552
    v_add_f32 v116, v116, v114
    v_mfma_f32_16x16x32_bf16 v[76:79], a[92:95], a[60:63], v[76:79]
    v_add_f32 v116, v116, v115
    v_cvt_pk_bf16_f32 v99, v114, v115
    s_waitcnt lgkmcnt(4)
    v_mfma_f32_16x16x32_bf16 v[128:131], a[96:99], v[80:83], v[128:131]
    v_exp_f32 v112, v56
    v_mfma_f32_16x16x32_bf16 v[132:135], a[100:103], v[80:83], v[132:135]
    v_exp_f32 v113, v57
    v_mfma_f32_16x16x32_bf16 v[136:139], a[104:107], v[80:83], v[136:139]
    ds_read_b128 a[64:67], v2 offset:0
    v_add_f32 v117, v117, v112
    v_mfma_f32_16x16x32_bf16 v[140:143], a[108:111], v[80:83], v[140:143]
    s_waitcnt lgkmcnt(1)
    v_add_f32 v117, v117, v113
    v_cvt_pk_bf16_f32 v100, v112, v113
    v_mfma_f32_16x16x32_bf16 v[144:147], a[112:115], v[80:83], v[144:147]
    v_exp_f32 v114, v58
    v_mfma_f32_16x16x32_bf16 v[148:151], a[116:119], v[80:83], v[148:151]
    v_exp_f32 v115, v59
    v_mfma_f32_16x16x32_bf16 v[152:155], a[120:123], v[80:83], v[152:155]
    ds_read_b128 a[68:71], v2 offset:1024
    v_add_f32 v117, v117, v114
    v_mfma_f32_16x16x32_bf16 v[156:159], a[124:127], v[80:83], v[156:159]
    v_add_f32 v117, v117, v115
    v_cvt_pk_bf16_f32 v101, v114, v115
    v_mfma_f32_16x16x32_bf16 v[160:163], a[96:99], v[84:87], v[160:163]
    v_exp_f32 v112, v60
    v_mfma_f32_16x16x32_bf16 v[164:167], a[100:103], v[84:87], v[164:167]
    v_exp_f32 v113, v61
    v_mfma_f32_16x16x32_bf16 v[168:171], a[104:107], v[84:87], v[168:171]
    ds_read_b128 a[72:75], v2 offset:2048
    v_add_f32 v117, v117, v112
    v_mfma_f32_16x16x32_bf16 v[172:175], a[108:111], v[84:87], v[172:175]
    v_add_f32 v117, v117, v113
    v_cvt_pk_bf16_f32 v102, v112, v113
    v_mfma_f32_16x16x32_bf16 v[176:179], a[112:115], v[84:87], v[176:179]
    v_exp_f32 v114, v62
    v_mfma_f32_16x16x32_bf16 v[180:183], a[116:119], v[84:87], v[180:183]
    v_exp_f32 v115, v63
    v_mfma_f32_16x16x32_bf16 v[184:187], a[120:123], v[84:87], v[184:187]
    ds_read_b128 a[76:79], v2 offset:3072
    v_add_f32 v117, v117, v114
    v_mfma_f32_16x16x32_bf16 v[188:191], a[124:127], v[84:87], v[188:191]
    v_add_f32 v117, v117, v115
    v_cvt_pk_bf16_f32 v103, v114, v115
    v_mfma_f32_16x16x32_bf16 v[192:195], a[96:99], v[88:91], v[192:195]
    v_exp_f32 v112, v64
    v_mfma_f32_16x16x32_bf16 v[196:199], a[100:103], v[88:91], v[196:199]
    v_exp_f32 v113, v65
    v_mfma_f32_16x16x32_bf16 v[200:203], a[104:107], v[88:91], v[200:203]
    ds_read_b128 a[80:83], v2 offset:4096
    v_add_f32 v118, v118, v112
    v_mfma_f32_16x16x32_bf16 v[204:207], a[108:111], v[88:91], v[204:207]
    v_add_f32 v118, v118, v113
    v_cvt_pk_bf16_f32 v104, v112, v113
    v_mfma_f32_16x16x32_bf16 v[208:211], a[112:115], v[88:91], v[208:211]
    v_exp_f32 v114, v66
    v_mfma_f32_16x16x32_bf16 v[212:215], a[116:119], v[88:91], v[212:215]
    v_exp_f32 v115, v67
    v_mfma_f32_16x16x32_bf16 v[216:219], a[120:123], v[88:91], v[216:219]
    ds_read_b128 a[84:87], v2 offset:5120
    v_add_f32 v118, v118, v114
    v_mfma_f32_16x16x32_bf16 v[220:223], a[124:127], v[88:91], v[220:223]
    v_add_f32 v118, v118, v115
    v_cvt_pk_bf16_f32 v105, v114, v115
    v_mfma_f32_16x16x32_bf16 v[224:227], a[96:99], v[92:95], v[224:227]
    v_exp_f32 v112, v68
    v_mfma_f32_16x16x32_bf16 v[228:231], a[100:103], v[92:95], v[228:231]
    v_exp_f32 v113, v69
    v_mfma_f32_16x16x32_bf16 v[232:235], a[104:107], v[92:95], v[232:235]
    ds_read_b128 a[88:91], v2 offset:6144
    v_add_f32 v118, v118, v112
    v_mfma_f32_16x16x32_bf16 v[236:239], a[108:111], v[92:95], v[236:239]
    v_add_f32 v118, v118, v113
    v_cvt_pk_bf16_f32 v106, v112, v113
    v_mfma_f32_16x16x32_bf16 v[240:243], a[112:115], v[92:95], v[240:243]
    v_exp_f32 v114, v70
    v_mfma_f32_16x16x32_bf16 v[244:247], a[116:119], v[92:95], v[244:247]
    v_exp_f32 v115, v71
    v_mfma_f32_16x16x32_bf16 v[248:251], a[120:123], v[92:95], v[248:251]
    ds_read_b128 a[92:95], v2 offset:7168
    v_add_f32 v118, v118, v114
    v_mfma_f32_16x16x32_bf16 v[252:255], a[124:127], v[92:95], v[252:255]
    v_add_f32 v118, v118, v115
    v_cvt_pk_bf16_f32 v107, v114, v115
    s_waitcnt lgkmcnt(4)
    v_mfma_f32_16x16x32_bf16 v[48:51], a[64:67], a[0:3], v[16:19]
    v_exp_f32 v112, v72
    v_mfma_f32_16x16x32_bf16 v[48:51], a[68:71], a[4:7], v[48:51]
    v_exp_f32 v113, v73
    v_mfma_f32_16x16x32_bf16 v[48:51], a[72:75], a[8:11], v[48:51]
    s_add_u32 m0, s57, 16384
    ds_read_b128 a[96:99], v2 offset:24576
    v_add_f32 v119, v119, v112
    v_mfma_f32_16x16x32_bf16 v[48:51], a[76:79], a[12:15], v[48:51]
    s_waitcnt lgkmcnt(1)
    buffer_load_dwordx4 v1, s[28:31], s55 offen offset:0 lds
    v_add_f32 v119, v119, v113
    v_cvt_pk_bf16_f32 v108, v112, v113
    v_mfma_f32_16x16x32_bf16 v[52:55], a[80:83], a[0:3], v[16:19]
    v_exp_f32 v114, v74
    v_mfma_f32_16x16x32_bf16 v[52:55], a[84:87], a[4:7], v[52:55]
    v_exp_f32 v115, v75
    v_mfma_f32_16x16x32_bf16 v[52:55], a[88:91], a[8:11], v[52:55]
    ds_read_b128 a[100:103], v2 offset:25600
    v_add_f32 v119, v119, v114
    v_mfma_f32_16x16x32_bf16 v[52:55], a[92:95], a[12:15], v[52:55]
    buffer_load_dwordx4 v1, s[28:31], s55 offen offset:1024 lds
    v_add_f32 v119, v119, v115
    v_cvt_pk_bf16_f32 v109, v114, v115
    v_mfma_f32_16x16x32_bf16 v[56:59], a[64:67], a[16:19], v[20:23]
    v_exp_f32 v112, v76
    v_mfma_f32_16x16x32_bf16 v[56:59], a[68:71], a[20:23], v[56:59]
    v_exp_f32 v113, v77
    v_mfma_f32_16x16x32_bf16 v[56:59], a[72:75], a[24:27], v[56:59]
    ds_read_b128 a[104:107], v2 offset:26624
    v_add_f32 v119, v119, v112
    v_mfma_f32_16x16x32_bf16 v[56:59], a[76:79], a[28:31], v[56:59]
    buffer_load_dwordx4 v1, s[28:31], s55 offen offset:2048 lds
    v_add_f32 v119, v119, v113
    v_cvt_pk_bf16_f32 v110, v112, v113
    v_mfma_f32_16x16x32_bf16 v[60:63], a[80:83], a[16:19], v[20:23]
    v_exp_f32 v114, v78
    v_mfma_f32_16x16x32_bf16 v[60:63], a[84:87], a[20:23], v[60:63]
    v_exp_f32 v115, v79
    v_mfma_f32_16x16x32_bf16 v[60:63], a[88:91], a[24:27], v[60:63]
    ds_read_b128 a[108:111], v2 offset:27648
    v_add_f32 v119, v119, v114
    v_mfma_f32_16x16x32_bf16 v[60:63], a[92:95], a[28:31], v[60:63]
    buffer_load_dwordx4 v1, s[28:31], s55 offen offset:3072 lds
    v_add_f32 v119, v119, v115
    v_cvt_pk_bf16_f32 v111, v114, v115
    v_mfma_f32_16x16x32_bf16 v[64:67], a[64:67], a[32:35], v[24:27]
    s_add_u32 s55, s55, 16384
    v_exp_f32 v112, v48
    v_mfma_f32_16x16x32_bf16 v[64:67], a[68:71], a[36:39], v[64:67]
    s_add_u32 s57, s57, 32768
    v_exp_f32 v113, v49
    v_mfma_f32_16x16x32_bf16 v[64:67], a[72:75], a[40:43], v[64:67]
    s_cmp_ge_u32 s57, 163840
    s_cselect_b32 s57, s50, s57
    ds_read_b128 a[112:115], v2 offset:28672
    v_add_f32 v116, v116, v112
    v_mfma_f32_16x16x32_bf16 v[64:67], a[76:79], a[44:47], v[64:67]
    v_add_f32 v116, v116, v113
    v_cvt_pk_bf16_f32 v80, v112, v113
    v_mfma_f32_16x16x32_bf16 v[68:71], a[80:83], a[32:35], v[24:27]
    v_exp_f32 v114, v50
    v_mfma_f32_16x16x32_bf16 v[68:71], a[84:87], a[36:39], v[68:71]
    v_exp_f32 v115, v51
    v_mfma_f32_16x16x32_bf16 v[68:71], a[88:91], a[40:43], v[68:71]
    ds_read_b128 a[116:119], v2 offset:29696
    v_add_f32 v116, v116, v114
    v_mfma_f32_16x16x32_bf16 v[68:71], a[92:95], a[44:47], v[68:71]
    v_add_f32 v116, v116, v115
    v_cvt_pk_bf16_f32 v81, v114, v115
    v_mfma_f32_16x16x32_bf16 v[72:75], a[64:67], a[48:51], v[28:31]
    v_exp_f32 v112, v52
    v_mfma_f32_16x16x32_bf16 v[72:75], a[68:71], a[52:55], v[72:75]
    v_exp_f32 v113, v53
    v_mfma_f32_16x16x32_bf16 v[72:75], a[72:75], a[56:59], v[72:75]
    ds_read_b128 a[120:123], v2 offset:30720
    v_add_f32 v116, v116, v112
    v_mfma_f32_16x16x32_bf16 v[72:75], a[76:79], a[60:63], v[72:75]
    v_add_f32 v116, v116, v113
    v_cvt_pk_bf16_f32 v82, v112, v113
    v_mfma_f32_16x16x32_bf16 v[76:79], a[80:83], a[48:51], v[28:31]
    v_exp_f32 v114, v54
    v_mfma_f32_16x16x32_bf16 v[76:79], a[84:87], a[52:55], v[76:79]
    v_exp_f32 v115, v55
    v_mfma_f32_16x16x32_bf16 v[76:79], a[88:91], a[56:59], v[76:79]
    ds_read_b128 a[124:127], v2 offset:31744
    v_add_f32 v116, v116, v114
    v_mfma_f32_16x16x32_bf16 v[76:79], a[92:95], a[60:63], v[76:79]
    v_add_f32 v116, v116, v115
    v_cvt_pk_bf16_f32 v83, v114, v115
    s_waitcnt lgkmcnt(4)
    v_mfma_f32_16x16x32_bf16 v[128:131], a[96:99], v[96:99], v[128:131]
    v_exp_f32 v112, v56
    v_mfma_f32_16x16x32_bf16 v[132:135], a[100:103], v[96:99], v[132:135]
    v_exp_f32 v113, v57
    v_mfma_f32_16x16x32_bf16 v[136:139], a[104:107], v[96:99], v[136:139]
    ds_read_b128 a[64:67], v2 offset:8192
    v_add_f32 v117, v117, v112
    v_mfma_f32_16x16x32_bf16 v[140:143], a[108:111], v[96:99], v[140:143]
    s_waitcnt lgkmcnt(1)
    v_add_f32 v117, v117, v113
    v_cvt_pk_bf16_f32 v84, v112, v113
    v_mfma_f32_16x16x32_bf16 v[144:147], a[112:115], v[96:99], v[144:147]
    v_exp_f32 v114, v58
    v_mfma_f32_16x16x32_bf16 v[148:151], a[116:119], v[96:99], v[148:151]
    v_exp_f32 v115, v59
    v_mfma_f32_16x16x32_bf16 v[152:155], a[120:123], v[96:99], v[152:155]
    ds_read_b128 a[68:71], v2 offset:9216
    v_add_f32 v117, v117, v114
    v_mfma_f32_16x16x32_bf16 v[156:159], a[124:127], v[96:99], v[156:159]
    v_add_f32 v117, v117, v115
    v_cvt_pk_bf16_f32 v85, v114, v115
    v_mfma_f32_16x16x32_bf16 v[160:163], a[96:99], v[100:103], v[160:163]
    s_add_u32 s58, s58, 32768
    v_exp_f32 v112, v60
    v_mfma_f32_16x16x32_bf16 v[164:167], a[100:103], v[100:103], v[164:167]
    s_cmp_ge_u32 s58, 163840
    s_cselect_b32 s58, 0, s58
    v_exp_f32 v113, v61
    v_mfma_f32_16x16x32_bf16 v[168:171], a[104:107], v[100:103], v[168:171]
    ds_read_b128 a[72:75], v2 offset:10240
    v_add_f32 v117, v117, v112
    v_mfma_f32_16x16x32_bf16 v[172:175], a[108:111], v[100:103], v[172:175]
    v_add_f32 v117, v117, v113
    v_cvt_pk_bf16_f32 v86, v112, v113
    v_mfma_f32_16x16x32_bf16 v[176:179], a[112:115], v[100:103], v[176:179]
    v_exp_f32 v114, v62
    v_mfma_f32_16x16x32_bf16 v[180:183], a[116:119], v[100:103], v[180:183]
    v_exp_f32 v115, v63
    v_mfma_f32_16x16x32_bf16 v[184:187], a[120:123], v[100:103], v[184:187]
    ds_read_b128 a[76:79], v2 offset:11264
    v_add_f32 v117, v117, v114
    v_mfma_f32_16x16x32_bf16 v[188:191], a[124:127], v[100:103], v[188:191]
    v_add_f32 v117, v117, v115
    v_cvt_pk_bf16_f32 v87, v114, v115
    v_mfma_f32_16x16x32_bf16 v[192:195], a[96:99], v[104:107], v[192:195]
    v_exp_f32 v112, v64
    v_mfma_f32_16x16x32_bf16 v[196:199], a[100:103], v[104:107], v[196:199]
    v_exp_f32 v113, v65
    v_mfma_f32_16x16x32_bf16 v[200:203], a[104:107], v[104:107], v[200:203]
    ds_read_b128 a[80:83], v2 offset:12288
    v_add_f32 v118, v118, v112
    v_mfma_f32_16x16x32_bf16 v[204:207], a[108:111], v[104:107], v[204:207]
    v_add_f32 v118, v118, v113
    v_cvt_pk_bf16_f32 v88, v112, v113
    v_mfma_f32_16x16x32_bf16 v[208:211], a[112:115], v[104:107], v[208:211]
    v_exp_f32 v114, v66
    v_mfma_f32_16x16x32_bf16 v[212:215], a[116:119], v[104:107], v[212:215]
    v_exp_f32 v115, v67
    v_mfma_f32_16x16x32_bf16 v[216:219], a[120:123], v[104:107], v[216:219]
    ds_read_b128 a[84:87], v2 offset:13312
    v_add_f32 v118, v118, v114
    v_mfma_f32_16x16x32_bf16 v[220:223], a[124:127], v[104:107], v[220:223]
    v_add_f32 v118, v118, v115
    v_cvt_pk_bf16_f32 v89, v114, v115
    v_mfma_f32_16x16x32_bf16 v[224:227], a[96:99], v[108:111], v[224:227]
    v_exp_f32 v112, v68
    v_mfma_f32_16x16x32_bf16 v[228:231], a[100:103], v[108:111], v[228:231]
    v_exp_f32 v113, v69
    v_mfma_f32_16x16x32_bf16 v[232:235], a[104:107], v[108:111], v[232:235]
    ds_read_b128 a[88:91], v2 offset:14336
    v_add_f32 v118, v118, v112
    v_mfma_f32_16x16x32_bf16 v[236:239], a[108:111], v[108:111], v[236:239]
    v_add_f32 v118, v118, v113
    v_cvt_pk_bf16_f32 v90, v112, v113
    v_mfma_f32_16x16x32_bf16 v[240:243], a[112:115], v[108:111], v[240:243]
    v_exp_f32 v114, v70
    v_mfma_f32_16x16x32_bf16 v[244:247], a[116:119], v[108:111], v[244:247]
    s_sub_u32 s61, s61, 1
    v_exp_f32 v115, v71
    v_mfma_f32_16x16x32_bf16 v[248:251], a[120:123], v[108:111], v[248:251]
    ds_read_b128 a[92:95], v2 offset:15360
    v_add_f32 v118, v118, v114
    v_mfma_f32_16x16x32_bf16 v[252:255], a[124:127], v[108:111], v[252:255]
    v_add_f32 v118, v118, v115
    v_cvt_pk_bf16_f32 v91, v114, v115
    v_add_u32 v2, s58, v1
    s_cmp_lg_u32 s61, 0
    s_cbranch_scc1 sequential_preLN__compressed_kv_cla__moe_arch_mod__prompt_kernel_dn
    s_sub_u32 s62, -1, s44
    s_waitcnt lgkmcnt(4)
    v_mfma_f32_16x16x32_bf16 v[48:51], a[64:67], a[0:3], v[16:19]
    s_waitcnt vmcnt(16)
    s_barrier
    v_exp_f32 v112, v72
    v_mfma_f32_16x16x32_bf16 v[48:51], a[68:71], a[4:7], v[48:51]
    v_exp_f32 v113, v73
    v_mfma_f32_16x16x32_bf16 v[48:51], a[72:75], a[8:11], v[48:51]
    s_mov_b32 m0, s57
    ds_read_b128 a[96:99], v2 offset:16384
    v_add_f32 v119, v119, v112
    v_mfma_f32_16x16x32_bf16 v[48:51], a[76:79], a[12:15], v[48:51]
    s_waitcnt lgkmcnt(1)
    buffer_load_dwordx4 v1, s[24:27], s54 offen offset:0 lds
    v_add_f32 v119, v119, v113
    v_cvt_pk_bf16_f32 v92, v112, v113
    v_mfma_f32_16x16x32_bf16 v[52:55], a[80:83], a[0:3], v[16:19]
    v_exp_f32 v114, v74
    v_mfma_f32_16x16x32_bf16 v[52:55], a[84:87], a[4:7], v[52:55]
    v_exp_f32 v115, v75
    v_mfma_f32_16x16x32_bf16 v[52:55], a[88:91], a[8:11], v[52:55]
    ds_read_b128 a[100:103], v2 offset:17408
    v_add_f32 v119, v119, v114
    v_mfma_f32_16x16x32_bf16 v[52:55], a[92:95], a[12:15], v[52:55]
    buffer_load_dwordx4 v1, s[24:27], s54 offen offset:1024 lds
    v_add_f32 v119, v119, v115
    v_cvt_pk_bf16_f32 v93, v114, v115
    v_mfma_f32_16x16x32_bf16 v[56:59], a[64:67], a[16:19], v[20:23]
    v_exp_f32 v112, v76
    v_mfma_f32_16x16x32_bf16 v[56:59], a[68:71], a[20:23], v[56:59]
    v_exp_f32 v113, v77
    v_mfma_f32_16x16x32_bf16 v[56:59], a[72:75], a[24:27], v[56:59]
    ds_read_b128 a[104:107], v2 offset:18432
    v_add_f32 v119, v119, v112
    v_mfma_f32_16x16x32_bf16 v[56:59], a[76:79], a[28:31], v[56:59]
    buffer_load_dwordx4 v1, s[24:27], s54 offen offset:2048 lds
    v_add_f32 v119, v119, v113
    v_cvt_pk_bf16_f32 v94, v112, v113
    v_mfma_f32_16x16x32_bf16 v[60:63], a[80:83], a[16:19], v[20:23]
    v_exp_f32 v114, v78
    v_mfma_f32_16x16x32_bf16 v[60:63], a[84:87], a[20:23], v[60:63]
    v_exp_f32 v115, v79
    v_mfma_f32_16x16x32_bf16 v[60:63], a[88:91], a[24:27], v[60:63]
    ds_read_b128 a[108:111], v2 offset:19456
    v_add_f32 v119, v119, v114
    v_mfma_f32_16x16x32_bf16 v[60:63], a[92:95], a[28:31], v[60:63]
    buffer_load_dwordx4 v1, s[24:27], s54 offen offset:3072 lds
    v_add_f32 v119, v119, v115
    v_cvt_pk_bf16_f32 v95, v114, v115
    v_mfma_f32_16x16x32_bf16 v[64:67], a[64:67], a[32:35], v[24:27]
    s_add_u32 s54, s54, 16384
    v_exp_f32 v112, v48
    v_mfma_f32_16x16x32_bf16 v[64:67], a[68:71], a[36:39], v[64:67]
    v_exp_f32 v113, v49
    v_mfma_f32_16x16x32_bf16 v[64:67], a[72:75], a[40:43], v[64:67]
    ds_read_b128 a[112:115], v2 offset:20480
    v_add_f32 v116, v116, v112
    v_mfma_f32_16x16x32_bf16 v[64:67], a[76:79], a[44:47], v[64:67]
    v_add_f32 v116, v116, v113
    v_cvt_pk_bf16_f32 v96, v112, v113
    v_mfma_f32_16x16x32_bf16 v[68:71], a[80:83], a[32:35], v[24:27]
    v_exp_f32 v114, v50
    v_mfma_f32_16x16x32_bf16 v[68:71], a[84:87], a[36:39], v[68:71]
    v_exp_f32 v115, v51
    v_mfma_f32_16x16x32_bf16 v[68:71], a[88:91], a[40:43], v[68:71]
    ds_read_b128 a[116:119], v2 offset:21504
    v_add_f32 v116, v116, v114
    v_mfma_f32_16x16x32_bf16 v[68:71], a[92:95], a[44:47], v[68:71]
    v_add_f32 v116, v116, v115
    v_cvt_pk_bf16_f32 v97, v114, v115
    v_mfma_f32_16x16x32_bf16 v[72:75], a[64:67], a[48:51], v[28:31]
    v_exp_f32 v112, v52
    v_mfma_f32_16x16x32_bf16 v[72:75], a[68:71], a[52:55], v[72:75]
    v_exp_f32 v113, v53
    v_mfma_f32_16x16x32_bf16 v[72:75], a[72:75], a[56:59], v[72:75]
    ds_read_b128 a[120:123], v2 offset:22528
    v_add_f32 v116, v116, v112
    v_mfma_f32_16x16x32_bf16 v[72:75], a[76:79], a[60:63], v[72:75]
    v_add_f32 v116, v116, v113
    v_cvt_pk_bf16_f32 v98, v112, v113
    v_mfma_f32_16x16x32_bf16 v[76:79], a[80:83], a[48:51], v[28:31]
    v_exp_f32 v114, v54
    v_mfma_f32_16x16x32_bf16 v[76:79], a[84:87], a[52:55], v[76:79]
    v_exp_f32 v115, v55
    v_mfma_f32_16x16x32_bf16 v[76:79], a[88:91], a[56:59], v[76:79]
    ds_read_b128 a[124:127], v2 offset:23552
    v_add_f32 v116, v116, v114
    v_mfma_f32_16x16x32_bf16 v[76:79], a[92:95], a[60:63], v[76:79]
    v_add_f32 v116, v116, v115
    v_cvt_pk_bf16_f32 v99, v114, v115
    s_waitcnt lgkmcnt(4)
    v_mfma_f32_16x16x32_bf16 v[128:131], a[96:99], v[80:83], v[128:131]
    s_add_u32 s62, s62, 1
    s_cmp_lt_i32 s62, 0
    s_cselect_b64 s[14:15], -1, 0
    s_cmp_eq_u32 s62, 0
    s_cselect_b64 s[4:5], s[36:37], s[14:15]
    s_cselect_b64 s[6:7], s[38:39], s[14:15]
    s_cselect_b64 s[8:9], s[40:41], s[14:15]
    s_cselect_b64 s[10:11], s[42:43], s[14:15]
    s_cmp_le_i32 s62, 0
    s_cselect_b64 s[12:13], -1, 0
    v_exp_f32 v112, v56
    v_cndmask_b32 v32, v3, v24, s[4:5]
    v_cndmask_b32 v33, v3, v25, s[6:7]
    v_cndmask_b32 v34, v3, v26, s[8:9]
    v_cndmask_b32 v35, v3, v27, s[10:11]
    v_cndmask_b32 v36, v3, v24, s[14:15]
    v_cndmask_b32 v37, v3, v25, s[14:15]
    v_cndmask_b32 v38, v3, v26, s[14:15]
    v_cndmask_b32 v39, v3, v27, s[14:15]
    v_cndmask_b32 v40, v3, v28, s[12:13]
    v_cndmask_b32 v41, v3, v29, s[12:13]
    v_cndmask_b32 v42, v3, v30, s[12:13]
    v_cndmask_b32 v43, v3, v31, s[12:13]
    v_cndmask_b32 v44, v3, v28, s[4:5]
    v_cndmask_b32 v45, v3, v29, s[6:7]
    v_cndmask_b32 v46, v3, v30, s[8:9]
    v_cndmask_b32 v47, v3, v31, s[10:11]
    v_mfma_f32_16x16x32_bf16 v[132:135], a[100:103], v[80:83], v[132:135]
    v_exp_f32 v113, v57
    v_mfma_f32_16x16x32_bf16 v[136:139], a[104:107], v[80:83], v[136:139]
    ds_read_b128 a[64:67], v2 offset:0
    v_add_f32 v117, v117, v112
    v_mfma_f32_16x16x32_bf16 v[140:143], a[108:111], v[80:83], v[140:143]
    s_waitcnt lgkmcnt(1)
    v_add_f32 v117, v117, v113
    v_cvt_pk_bf16_f32 v100, v112, v113
    v_mfma_f32_16x16x32_bf16 v[144:147], a[112:115], v[80:83], v[144:147]
    v_exp_f32 v114, v58
    v_mfma_f32_16x16x32_bf16 v[148:151], a[116:119], v[80:83], v[148:151]
    v_exp_f32 v115, v59
    v_mfma_f32_16x16x32_bf16 v[152:155], a[120:123], v[80:83], v[152:155]
    ds_read_b128 a[68:71], v2 offset:1024
    v_add_f32 v117, v117, v114
    v_mfma_f32_16x16x32_bf16 v[156:159], a[124:127], v[80:83], v[156:159]
    v_add_f32 v117, v117, v115
    v_cvt_pk_bf16_f32 v101, v114, v115
    v_mfma_f32_16x16x32_bf16 v[160:163], a[96:99], v[84:87], v[160:163]
    v_exp_f32 v112, v60
    v_mfma_f32_16x16x32_bf16 v[164:167], a[100:103], v[84:87], v[164:167]
    v_exp_f32 v113, v61
    v_mfma_f32_16x16x32_bf16 v[168:171], a[104:107], v[84:87], v[168:171]
    ds_read_b128 a[72:75], v2 offset:2048
    v_add_f32 v117, v117, v112
    v_mfma_f32_16x16x32_bf16 v[172:175], a[108:111], v[84:87], v[172:175]
    v_add_f32 v117, v117, v113
    v_cvt_pk_bf16_f32 v102, v112, v113
    v_mfma_f32_16x16x32_bf16 v[176:179], a[112:115], v[84:87], v[176:179]
    v_exp_f32 v114, v62
    v_mfma_f32_16x16x32_bf16 v[180:183], a[116:119], v[84:87], v[180:183]
    v_exp_f32 v115, v63
    v_mfma_f32_16x16x32_bf16 v[184:187], a[120:123], v[84:87], v[184:187]
    ds_read_b128 a[76:79], v2 offset:3072
    v_add_f32 v117, v117, v114
    v_mfma_f32_16x16x32_bf16 v[188:191], a[124:127], v[84:87], v[188:191]
    v_add_f32 v117, v117, v115
    v_cvt_pk_bf16_f32 v103, v114, v115
    v_mfma_f32_16x16x32_bf16 v[192:195], a[96:99], v[88:91], v[192:195]
    v_exp_f32 v112, v64
    v_mfma_f32_16x16x32_bf16 v[196:199], a[100:103], v[88:91], v[196:199]
    v_exp_f32 v113, v65
    v_mfma_f32_16x16x32_bf16 v[200:203], a[104:107], v[88:91], v[200:203]
    ds_read_b128 a[80:83], v2 offset:4096
    v_add_f32 v118, v118, v112
    v_mfma_f32_16x16x32_bf16 v[204:207], a[108:111], v[88:91], v[204:207]
    v_add_f32 v118, v118, v113
    v_cvt_pk_bf16_f32 v104, v112, v113
    v_mfma_f32_16x16x32_bf16 v[208:211], a[112:115], v[88:91], v[208:211]
    v_exp_f32 v114, v66
    v_mfma_f32_16x16x32_bf16 v[212:215], a[116:119], v[88:91], v[212:215]
    v_exp_f32 v115, v67
    v_mfma_f32_16x16x32_bf16 v[216:219], a[120:123], v[88:91], v[216:219]
    ds_read_b128 a[84:87], v2 offset:5120
    v_add_f32 v118, v118, v114
    v_mfma_f32_16x16x32_bf16 v[220:223], a[124:127], v[88:91], v[220:223]
    v_add_f32 v118, v118, v115
    v_cvt_pk_bf16_f32 v105, v114, v115
    v_mfma_f32_16x16x32_bf16 v[224:227], a[96:99], v[92:95], v[224:227]
    v_exp_f32 v112, v68
    v_mfma_f32_16x16x32_bf16 v[228:231], a[100:103], v[92:95], v[228:231]
    v_exp_f32 v113, v69
    v_mfma_f32_16x16x32_bf16 v[232:235], a[104:107], v[92:95], v[232:235]
    ds_read_b128 a[88:91], v2 offset:6144
    v_add_f32 v118, v118, v112
    v_mfma_f32_16x16x32_bf16 v[236:239], a[108:111], v[92:95], v[236:239]
    v_add_f32 v118, v118, v113
    v_cvt_pk_bf16_f32 v106, v112, v113
    v_mfma_f32_16x16x32_bf16 v[240:243], a[112:115], v[92:95], v[240:243]
    v_exp_f32 v114, v70
    v_mfma_f32_16x16x32_bf16 v[244:247], a[116:119], v[92:95], v[244:247]
    v_exp_f32 v115, v71
    v_mfma_f32_16x16x32_bf16 v[248:251], a[120:123], v[92:95], v[248:251]
    ds_read_b128 a[92:95], v2 offset:7168
    v_add_f32 v118, v118, v114
    v_mfma_f32_16x16x32_bf16 v[252:255], a[124:127], v[92:95], v[252:255]
    v_add_f32 v118, v118, v115
    v_cvt_pk_bf16_f32 v107, v114, v115
    s_waitcnt lgkmcnt(4)
    v_mfma_f32_16x16x32_bf16 v[48:51], a[64:67], a[0:3], v[16:19]
    v_exp_f32 v112, v72
    v_mfma_f32_16x16x32_bf16 v[48:51], a[68:71], a[4:7], v[48:51]
    v_exp_f32 v113, v73
    v_mfma_f32_16x16x32_bf16 v[48:51], a[72:75], a[8:11], v[48:51]
    s_add_u32 m0, s57, 16384
    ds_read_b128 a[96:99], v2 offset:24576
    v_add_f32 v119, v119, v112
    v_mfma_f32_16x16x32_bf16 v[48:51], a[76:79], a[12:15], v[48:51]
    s_waitcnt lgkmcnt(1)
    buffer_load_dwordx4 v1, s[28:31], s55 offen offset:0 lds
    v_add_f32 v119, v119, v113
    v_cvt_pk_bf16_f32 v108, v112, v113
    v_mfma_f32_16x16x32_bf16 v[52:55], a[80:83], a[0:3], v[16:19]
    v_exp_f32 v114, v74
    v_mfma_f32_16x16x32_bf16 v[52:55], a[84:87], a[4:7], v[52:55]
    v_exp_f32 v115, v75
    v_mfma_f32_16x16x32_bf16 v[52:55], a[88:91], a[8:11], v[52:55]
    ds_read_b128 a[100:103], v2 offset:25600
    v_add_f32 v119, v119, v114
    v_mfma_f32_16x16x32_bf16 v[52:55], a[92:95], a[12:15], v[52:55]
    buffer_load_dwordx4 v1, s[28:31], s55 offen offset:1024 lds
    v_add_f32 v119, v119, v115
    v_cvt_pk_bf16_f32 v109, v114, v115
    v_mfma_f32_16x16x32_bf16 v[56:59], a[64:67], a[16:19], v[20:23]
    v_exp_f32 v112, v76
    v_mfma_f32_16x16x32_bf16 v[56:59], a[68:71], a[20:23], v[56:59]
    v_exp_f32 v113, v77
    v_mfma_f32_16x16x32_bf16 v[56:59], a[72:75], a[24:27], v[56:59]
    ds_read_b128 a[104:107], v2 offset:26624
    v_add_f32 v119, v119, v112
    v_mfma_f32_16x16x32_bf16 v[56:59], a[76:79], a[28:31], v[56:59]
    buffer_load_dwordx4 v1, s[28:31], s55 offen offset:2048 lds
    v_add_f32 v119, v119, v113
    v_cvt_pk_bf16_f32 v110, v112, v113
    v_mfma_f32_16x16x32_bf16 v[60:63], a[80:83], a[16:19], v[20:23]
    v_exp_f32 v114, v78
    v_mfma_f32_16x16x32_bf16 v[60:63], a[84:87], a[20:23], v[60:63]
    v_exp_f32 v115, v79
    v_mfma_f32_16x16x32_bf16 v[60:63], a[88:91], a[24:27], v[60:63]
    ds_read_b128 a[108:111], v2 offset:27648
    v_add_f32 v119, v119, v114
    v_mfma_f32_16x16x32_bf16 v[60:63], a[92:95], a[28:31], v[60:63]
    buffer_load_dwordx4 v1, s[28:31], s55 offen offset:3072 lds
    v_add_f32 v119, v119, v115
    v_cvt_pk_bf16_f32 v111, v114, v115
    v_mfma_f32_16x16x32_bf16 v[64:67], a[64:67], a[32:35], v[32:35]
    s_add_u32 s55, s55, 16384
    v_exp_f32 v112, v48
    v_mfma_f32_16x16x32_bf16 v[64:67], a[68:71], a[36:39], v[64:67]
    s_add_u32 s57, s57, 32768
    v_exp_f32 v113, v49
    v_mfma_f32_16x16x32_bf16 v[64:67], a[72:75], a[40:43], v[64:67]
    s_cmp_ge_u32 s57, 163840
    s_cselect_b32 s57, s50, s57
    ds_read_b128 a[112:115], v2 offset:28672
    v_add_f32 v116, v116, v112
    v_mfma_f32_16x16x32_bf16 v[64:67], a[76:79], a[44:47], v[64:67]
    v_add_f32 v116, v116, v113
    v_cvt_pk_bf16_f32 v80, v112, v113
    v_mfma_f32_16x16x32_bf16 v[68:71], a[80:83], a[32:35], v[36:39]
    v_exp_f32 v114, v50
    v_mfma_f32_16x16x32_bf16 v[68:71], a[84:87], a[36:39], v[68:71]
    v_exp_f32 v115, v51
    v_mfma_f32_16x16x32_bf16 v[68:71], a[88:91], a[40:43], v[68:71]
    ds_read_b128 a[116:119], v2 offset:29696
    v_add_f32 v116, v116, v114
    v_mfma_f32_16x16x32_bf16 v[68:71], a[92:95], a[44:47], v[68:71]
    v_add_f32 v116, v116, v115
    v_cvt_pk_bf16_f32 v81, v114, v115
    v_mfma_f32_16x16x32_bf16 v[72:75], a[64:67], a[48:51], v[40:43]
    v_exp_f32 v112, v52
    v_mfma_f32_16x16x32_bf16 v[72:75], a[68:71], a[52:55], v[72:75]
    v_exp_f32 v113, v53
    v_mfma_f32_16x16x32_bf16 v[72:75], a[72:75], a[56:59], v[72:75]
    ds_read_b128 a[120:123], v2 offset:30720
    v_add_f32 v116, v116, v112
    v_mfma_f32_16x16x32_bf16 v[72:75], a[76:79], a[60:63], v[72:75]
    v_add_f32 v116, v116, v113
    v_cvt_pk_bf16_f32 v82, v112, v113
    v_mfma_f32_16x16x32_bf16 v[76:79], a[80:83], a[48:51], v[44:47]
    v_exp_f32 v114, v54
    v_mfma_f32_16x16x32_bf16 v[76:79], a[84:87], a[52:55], v[76:79]
    v_exp_f32 v115, v55
    v_mfma_f32_16x16x32_bf16 v[76:79], a[88:91], a[56:59], v[76:79]
    ds_read_b128 a[124:127], v2 offset:31744
    v_add_f32 v116, v116, v114
    v_mfma_f32_16x16x32_bf16 v[76:79], a[92:95], a[60:63], v[76:79]
    v_add_f32 v116, v116, v115
    v_cvt_pk_bf16_f32 v83, v114, v115
    s_waitcnt lgkmcnt(4)
    v_mfma_f32_16x16x32_bf16 v[128:131], a[96:99], v[96:99], v[128:131]
    s_add_u32 s62, s62, 1
    s_cmp_lt_i32 s62, 0
    s_cselect_b64 s[14:15], -1, 0
    s_cmp_eq_u32 s62, 0
    s_cselect_b64 s[4:5], s[36:37], s[14:15]
    s_cselect_b64 s[6:7], s[38:39], s[14:15]
    s_cselect_b64 s[8:9], s[40:41], s[14:15]
    s_cselect_b64 s[10:11], s[42:43], s[14:15]
    s_cmp_le_i32 s62, 0
    s_cselect_b64 s[12:13], -1, 0
    v_exp_f32 v112, v56
    v_cndmask_b32 v32, v3, v24, s[4:5]
    v_cndmask_b32 v33, v3, v25, s[6:7]
    v_cndmask_b32 v34, v3, v26, s[8:9]
    v_cndmask_b32 v35, v3, v27, s[10:11]
    v_cndmask_b32 v36, v3, v24, s[14:15]
    v_cndmask_b32 v37, v3, v25, s[14:15]
    v_cndmask_b32 v38, v3, v26, s[14:15]
    v_cndmask_b32 v39, v3, v27, s[14:15]
    v_cndmask_b32 v40, v3, v28, s[12:13]
    v_cndmask_b32 v41, v3, v29, s[12:13]
    v_cndmask_b32 v42, v3, v30, s[12:13]
    v_cndmask_b32 v43, v3, v31, s[12:13]
    v_cndmask_b32 v44, v3, v28, s[4:5]
    v_cndmask_b32 v45, v3, v29, s[6:7]
    v_cndmask_b32 v46, v3, v30, s[8:9]
    v_cndmask_b32 v47, v3, v31, s[10:11]
    v_mfma_f32_16x16x32_bf16 v[132:135], a[100:103], v[96:99], v[132:135]
    v_exp_f32 v113, v57
    v_mfma_f32_16x16x32_bf16 v[136:139], a[104:107], v[96:99], v[136:139]
    ds_read_b128 a[64:67], v2 offset:8192
    v_add_f32 v117, v117, v112
    v_mfma_f32_16x16x32_bf16 v[140:143], a[108:111], v[96:99], v[140:143]
    s_waitcnt lgkmcnt(1)
    v_add_f32 v117, v117, v113
    v_cvt_pk_bf16_f32 v84, v112, v113
    v_mfma_f32_16x16x32_bf16 v[144:147], a[112:115], v[96:99], v[144:147]
    v_exp_f32 v114, v58
    v_mfma_f32_16x16x32_bf16 v[148:151], a[116:119], v[96:99], v[148:151]
    v_exp_f32 v115, v59
    v_mfma_f32_16x16x32_bf16 v[152:155], a[120:123], v[96:99], v[152:155]
    ds_read_b128 a[68:71], v2 offset:9216
    v_add_f32 v117, v117, v114
    v_mfma_f32_16x16x32_bf16 v[156:159], a[124:127], v[96:99], v[156:159]
    v_add_f32 v117, v117, v115
    v_cvt_pk_bf16_f32 v85, v114, v115
    v_mfma_f32_16x16x32_bf16 v[160:163], a[96:99], v[100:103], v[160:163]
    s_add_u32 s58, s58, 32768
    v_exp_f32 v112, v60
    v_mfma_f32_16x16x32_bf16 v[164:167], a[100:103], v[100:103], v[164:167]
    s_cmp_ge_u32 s58, 163840
    s_cselect_b32 s58, 0, s58
    v_exp_f32 v113, v61
    v_mfma_f32_16x16x32_bf16 v[168:171], a[104:107], v[100:103], v[168:171]
    ds_read_b128 a[72:75], v2 offset:10240
    v_add_f32 v117, v117, v112
    v_mfma_f32_16x16x32_bf16 v[172:175], a[108:111], v[100:103], v[172:175]
    v_add_f32 v117, v117, v113
    v_cvt_pk_bf16_f32 v86, v112, v113
    v_mfma_f32_16x16x32_bf16 v[176:179], a[112:115], v[100:103], v[176:179]
    v_exp_f32 v114, v62
    v_mfma_f32_16x16x32_bf16 v[180:183], a[116:119], v[100:103], v[180:183]
    v_exp_f32 v115, v63
    v_mfma_f32_16x16x32_bf16 v[184:187], a[120:123], v[100:103], v[184:187]
    ds_read_b128 a[76:79], v2 offset:11264
    v_add_f32 v117, v117, v114
    v_mfma_f32_16x16x32_bf16 v[188:191], a[124:127], v[100:103], v[188:191]
    v_add_f32 v117, v117, v115
    v_cvt_pk_bf16_f32 v87, v114, v115
    v_mfma_f32_16x16x32_bf16 v[192:195], a[96:99], v[104:107], v[192:195]
    v_exp_f32 v112, v64
    v_mfma_f32_16x16x32_bf16 v[196:199], a[100:103], v[104:107], v[196:199]
    v_exp_f32 v113, v65
    v_mfma_f32_16x16x32_bf16 v[200:203], a[104:107], v[104:107], v[200:203]
    ds_read_b128 a[80:83], v2 offset:12288
    v_add_f32 v118, v118, v112
    v_mfma_f32_16x16x32_bf16 v[204:207], a[108:111], v[104:107], v[204:207]
    v_add_f32 v118, v118, v113
    v_cvt_pk_bf16_f32 v88, v112, v113
    v_mfma_f32_16x16x32_bf16 v[208:211], a[112:115], v[104:107], v[208:211]
    v_exp_f32 v114, v66
    v_mfma_f32_16x16x32_bf16 v[212:215], a[116:119], v[104:107], v[212:215]
    v_exp_f32 v115, v67
    v_mfma_f32_16x16x32_bf16 v[216:219], a[120:123], v[104:107], v[216:219]
    ds_read_b128 a[84:87], v2 offset:13312
    v_add_f32 v118, v118, v114
    v_mfma_f32_16x16x32_bf16 v[220:223], a[124:127], v[104:107], v[220:223]
    v_add_f32 v118, v118, v115
    v_cvt_pk_bf16_f32 v89, v114, v115
    v_mfma_f32_16x16x32_bf16 v[224:227], a[96:99], v[108:111], v[224:227]
    v_exp_f32 v112, v68
    v_mfma_f32_16x16x32_bf16 v[228:231], a[100:103], v[108:111], v[228:231]
    v_exp_f32 v113, v69
    v_mfma_f32_16x16x32_bf16 v[232:235], a[104:107], v[108:111], v[232:235]
    ds_read_b128 a[88:91], v2 offset:14336
    v_add_f32 v118, v118, v112
    v_mfma_f32_16x16x32_bf16 v[236:239], a[108:111], v[108:111], v[236:239]
    v_add_f32 v118, v118, v113
    v_cvt_pk_bf16_f32 v90, v112, v113
    v_mfma_f32_16x16x32_bf16 v[240:243], a[112:115], v[108:111], v[240:243]
    v_exp_f32 v114, v70
    v_mfma_f32_16x16x32_bf16 v[244:247], a[116:119], v[108:111], v[244:247]
    v_exp_f32 v115, v71
    v_mfma_f32_16x16x32_bf16 v[248:251], a[120:123], v[108:111], v[248:251]
    ds_read_b128 a[92:95], v2 offset:15360
    v_add_f32 v118, v118, v114
    v_mfma_f32_16x16x32_bf16 v[252:255], a[124:127], v[108:111], v[252:255]
    v_add_f32 v118, v118, v115
    v_cvt_pk_bf16_f32 v91, v114, v115
    v_add_u32 v2, s58, v1
    s_branch sequential_preLN__compressed_kv_cla__moe_arch_mod__prompt_kernel_db
sequential_preLN__compressed_kv_cla__moe_arch_mod__prompt_kernel_t0:
    s_sub_u32 s62, 1, s44
    s_cmp_lt_i32 s62, 0
    s_cselect_b64 s[14:15], -1, 0
    s_cmp_eq_u32 s62, 0
    s_cselect_b64 s[4:5], s[36:37], s[14:15]
    s_cselect_b64 s[6:7], s[38:39], s[14:15]
    s_cselect_b64 s[8:9], s[40:41], s[14:15]
    s_cselect_b64 s[10:11], s[42:43], s[14:15]
    s_cmp_le_i32 s62, 0
    s_cselect_b64 s[12:13], -1, 0
    v_cndmask_b32 v32, v3, v24, s[4:5]
    v_cndmask_b32 v33, v3, v25, s[6:7]
    v_cndmask_b32 v34, v3, v26, s[8:9]
    v_cndmask_b32 v35, v3, v27, s[10:11]
    v_cndmask_b32 v36, v3, v24, s[14:15]
    v_cndmask_b32 v37, v3, v25, s[14:15]
    v_cndmask_b32 v38, v3, v26, s[14:15]
    v_cndmask_b32 v39, v3, v27, s[14:15]
    v_cndmask_b32 v40, v3, v28, s[12:13]
    v_cndmask_b32 v41, v3, v29, s[12:13]
    v_cndmask_b32 v42, v3, v30, s[12:13]
    v_cndmask_b32 v43, v3, v31, s[12:13]
    v_cndmask_b32 v44, v3, v28, s[4:5]
    v_cndmask_b32 v45, v3, v29, s[6:7]
    v_cndmask_b32 v46, v3, v30, s[8:9]
    v_cndmask_b32 v47, v3, v31, s[10:11]
    s_nop 1
sequential_preLN__compressed_kv_cla__moe_arch_mod__prompt_kernel_db:
    s_waitcnt lgkmcnt(4)
    v_mfma_f32_16x16x32_bf16 v[48:51], a[64:67], a[0:3], v[16:19]
    s_waitcnt vmcnt(16)
    s_barrier
    v_exp_f32 v112, v72
    v_mfma_f32_16x16x32_bf16 v[48:51], a[68:71], a[4:7], v[48:51]
    v_exp_f32 v113, v73
    v_mfma_f32_16x16x32_bf16 v[48:51], a[72:75], a[8:11], v[48:51]
    s_mov_b32 m0, s57
    ds_read_b128 a[96:99], v2 offset:16384
    v_add_f32 v119, v119, v112
    v_mfma_f32_16x16x32_bf16 v[48:51], a[76:79], a[12:15], v[48:51]
    s_waitcnt lgkmcnt(1)
    buffer_load_dwordx4 v1, s[24:27], s54 offen offset:0 lds
    v_add_f32 v119, v119, v113
    v_cvt_pk_bf16_f32 v92, v112, v113
    v_mfma_f32_16x16x32_bf16 v[52:55], a[80:83], a[0:3], v[16:19]
    v_exp_f32 v114, v74
    v_mfma_f32_16x16x32_bf16 v[52:55], a[84:87], a[4:7], v[52:55]
    v_exp_f32 v115, v75
    v_mfma_f32_16x16x32_bf16 v[52:55], a[88:91], a[8:11], v[52:55]
    ds_read_b128 a[100:103], v2 offset:17408
    v_add_f32 v119, v119, v114
    v_mfma_f32_16x16x32_bf16 v[52:55], a[92:95], a[12:15], v[52:55]
    buffer_load_dwordx4 v1, s[24:27], s54 offen offset:1024 lds
    v_add_f32 v119, v119, v115
    v_cvt_pk_bf16_f32 v93, v114, v115
    v_mfma_f32_16x16x32_bf16 v[56:59], a[64:67], a[16:19], v[20:23]
    global_load_dwordx4 a[132:135], v14, s[92:93]
    v_exp_f32 v112, v76
    v_mfma_f32_16x16x32_bf16 v[56:59], a[68:71], a[20:23], v[56:59]
    v_exp_f32 v113, v77
    v_mfma_f32_16x16x32_bf16 v[56:59], a[72:75], a[24:27], v[56:59]
    ds_read_b128 a[104:107], v2 offset:18432
    v_add_f32 v119, v119, v112
    v_mfma_f32_16x16x32_bf16 v[56:59], a[76:79], a[28:31], v[56:59]
    buffer_load_dwordx4 v1, s[24:27], s54 offen offset:2048 lds
    v_add_f32 v119, v119, v113
    v_cvt_pk_bf16_f32 v94, v112, v113
    v_mfma_f32_16x16x32_bf16 v[60:63], a[80:83], a[16:19], v[20:23]
    v_exp_f32 v114, v78
    v_mfma_f32_16x16x32_bf16 v[60:63], a[84:87], a[20:23], v[60:63]
    v_exp_f32 v115, v79
    v_mfma_f32_16x16x32_bf16 v[60:63], a[88:91], a[24:27], v[60:63]
    ds_read_b128 a[108:111], v2 offset:19456
    v_add_f32 v119, v119, v114
    v_mfma_f32_16x16x32_bf16 v[60:63], a[92:95], a[28:31], v[60:63]
    buffer_load_dwordx4 v1, s[24:27], s54 offen offset:3072 lds
    v_add_f32 v119, v119, v115
    v_cvt_pk_bf16_f32 v95, v114, v115
    v_mfma_f32_16x16x32_bf16 v[64:67], a[64:67], a[32:35], v[32:35]
    s_add_u32 s54, s54, 16384
    global_load_dwordx4 a[172:175], v14, s[94:95]
    v_exp_f32 v112, v48
    v_add_u32 v14, s98, v14
    v_mfma_f32_16x16x32_bf16 v[64:67], a[68:71], a[36:39], v[64:67]
    v_exp_f32 v113, v49
    v_mfma_f32_16x16x32_bf16 v[64:67], a[72:75], a[40:43], v[64:67]
    ds_read_b128 a[112:115], v2 offset:20480
    v_add_f32 v116, v116, v112
    v_mfma_f32_16x16x32_bf16 v[64:67], a[76:79], a[44:47], v[64:67]
    v_add_f32 v116, v116, v113
    v_cvt_pk_bf16_f32 v96, v112, v113
    v_mfma_f32_16x16x32_bf16 v[68:71], a[80:83], a[32:35], v[36:39]
    global_load_dwordx4 a[136:139], v14, s[92:93]
    v_exp_f32 v114, v50
    v_mfma_f32_16x16x32_bf16 v[68:71], a[84:87], a[36:39], v[68:71]
    v_exp_f32 v115, v51
    v_mfma_f32_16x16x32_bf16 v[68:71], a[88:91], a[40:43], v[68:71]
    ds_read_b128 a[116:119], v2 offset:21504
    v_add_f32 v116, v116, v114
    v_mfma_f32_16x16x32_bf16 v[68:71], a[92:95], a[44:47], v[68:71]
    v_add_f32 v116, v116, v115
    v_cvt_pk_bf16_f32 v97, v114, v115
    v_mfma_f32_16x16x32_bf16 v[72:75], a[64:67], a[48:51], v[40:43]
    v_exp_f32 v112, v52
    v_mfma_f32_16x16x32_bf16 v[72:75], a[68:71], a[52:55], v[72:75]
    global_load_dwordx4 a[176:179], v14, s[94:95]
    v_exp_f32 v113, v53
    v_add_u32 v14, s98, v14
    v_mfma_f32_16x16x32_bf16 v[72:75], a[72:75], a[56:59], v[72:75]
    ds_read_b128 a[120:123], v2 offset:22528
    v_add_f32 v116, v116, v112
    v_mfma_f32_16x16x32_bf16 v[72:75], a[76:79], a[60:63], v[72:75]
    v_add_f32 v116, v116, v113
    v_cvt_pk_bf16_f32 v98, v112, v113
    v_mfma_f32_16x16x32_bf16 v[76:79], a[80:83], a[48:51], v[44:47]
    v_exp_f32 v114, v54
    v_mfma_f32_16x16x32_bf16 v[76:79], a[84:87], a[52:55], v[76:79]
    v_exp_f32 v115, v55
    v_mfma_f32_16x16x32_bf16 v[76:79], a[88:91], a[56:59], v[76:79]
    ds_read_b128 a[124:127], v2 offset:23552
    v_add_f32 v116, v116, v114
    v_mfma_f32_16x16x32_bf16 v[76:79], a[92:95], a[60:63], v[76:79]
    v_add_f32 v116, v116, v115
    v_cvt_pk_bf16_f32 v99, v114, v115
    s_waitcnt lgkmcnt(4)
    v_mfma_f32_16x16x32_bf16 v[128:131], a[96:99], v[80:83], v[128:131]
    s_add_u32 s62, s62, 1
    s_cmp_lt_i32 s62, 0
    s_cselect_b64 s[14:15], -1, 0
    s_cmp_eq_u32 s62, 0
    s_cselect_b64 s[4:5], s[36:37], s[14:15]
    s_cselect_b64 s[6:7], s[38:39], s[14:15]
    s_cselect_b64 s[8:9], s[40:41], s[14:15]
    s_cselect_b64 s[10:11], s[42:43], s[14:15]
    s_cmp_le_i32 s62, 0
    s_cselect_b64 s[12:13], -1, 0
    v_exp_f32 v112, v56
    v_cndmask_b32 v32, v3, v24, s[4:5]
    v_cndmask_b32 v33, v3, v25, s[6:7]
    v_cndmask_b32 v34, v3, v26, s[8:9]
    v_cndmask_b32 v35, v3, v27, s[10:11]
    v_cndmask_b32 v36, v3, v24, s[14:15]
    v_cndmask_b32 v37, v3, v25, s[14:15]
    v_cndmask_b32 v38, v3, v26, s[14:15]
    v_cndmask_b32 v39, v3, v27, s[14:15]
    v_cndmask_b32 v40, v3, v28, s[12:13]
    v_cndmask_b32 v41, v3, v29, s[12:13]
    v_cndmask_b32 v42, v3, v30, s[12:13]
    v_cndmask_b32 v43, v3, v31, s[12:13]
    v_cndmask_b32 v44, v3, v28, s[4:5]
    v_cndmask_b32 v45, v3, v29, s[6:7]
    v_cndmask_b32 v46, v3, v30, s[8:9]
    v_cndmask_b32 v47, v3, v31, s[10:11]
    v_mfma_f32_16x16x32_bf16 v[132:135], a[100:103], v[80:83], v[132:135]
    v_exp_f32 v113, v57
    v_mfma_f32_16x16x32_bf16 v[136:139], a[104:107], v[80:83], v[136:139]
    ds_read_b128 a[64:67], v2 offset:0
    v_add_f32 v117, v117, v112
    v_mfma_f32_16x16x32_bf16 v[140:143], a[108:111], v[80:83], v[140:143]
    s_waitcnt lgkmcnt(1)
    v_add_f32 v117, v117, v113
    v_cvt_pk_bf16_f32 v100, v112, v113
    v_mfma_f32_16x16x32_bf16 v[144:147], a[112:115], v[80:83], v[144:147]
    v_exp_f32 v114, v58
    v_mfma_f32_16x16x32_bf16 v[148:151], a[116:119], v[80:83], v[148:151]
    v_exp_f32 v115, v59
    v_mfma_f32_16x16x32_bf16 v[152:155], a[120:123], v[80:83], v[152:155]
    ds_read_b128 a[68:71], v2 offset:1024
    v_add_f32 v117, v117, v114
    v_mfma_f32_16x16x32_bf16 v[156:159], a[124:127], v[80:83], v[156:159]
    global_load_dwordx4 a[140:143], v14, s[92:93]
    v_add_f32 v117, v117, v115
    v_cvt_pk_bf16_f32 v101, v114, v115
    v_mfma_f32_16x16x32_bf16 v[160:163], a[96:99], v[84:87], v[160:163]
    v_exp_f32 v112, v60
    v_mfma_f32_16x16x32_bf16 v[164:167], a[100:103], v[84:87], v[164:167]
    v_exp_f32 v113, v61
    v_mfma_f32_16x16x32_bf16 v[168:171], a[104:107], v[84:87], v[168:171]
    ds_read_b128 a[72:75], v2 offset:2048
    v_add_f32 v117, v117, v112
    v_mfma_f32_16x16x32_bf16 v[172:175], a[108:111], v[84:87], v[172:175]
    v_add_f32 v117, v117, v113
    v_cvt_pk_bf16_f32 v102, v112, v113
    v_mfma_f32_16x16x32_bf16 v[176:179], a[112:115], v[84:87], v[176:179]
    global_load_dwordx4 a[180:183], v14, s[94:95]
    v_exp_f32 v114, v62
    v_add_u32 v14, s98, v14
    v_mfma_f32_16x16x32_bf16 v[180:183], a[116:119], v[84:87], v[180:183]
    v_exp_f32 v115, v63
    v_mfma_f32_16x16x32_bf16 v[184:187], a[120:123], v[84:87], v[184:187]
    ds_read_b128 a[76:79], v2 offset:3072
    v_add_f32 v117, v117, v114
    v_mfma_f32_16x16x32_bf16 v[188:191], a[124:127], v[84:87], v[188:191]
    v_add_f32 v117, v117, v115
    v_cvt_pk_bf16_f32 v103, v114, v115
    v_mfma_f32_16x16x32_bf16 v[192:195], a[96:99], v[88:91], v[192:195]
    v_exp_f32 v112, v64
    v_mfma_f32_16x16x32_bf16 v[196:199], a[100:103], v[88:91], v[196:199]
    v_exp_f32 v113, v65
    v_mfma_f32_16x16x32_bf16 v[200:203], a[104:107], v[88:91], v[200:203]
    ds_read_b128 a[80:83], v2 offset:4096
    v_add_f32 v118, v118, v112
    v_mfma_f32_16x16x32_bf16 v[204:207], a[108:111], v[88:91], v[204:207]
    global_load_dwordx4 a[144:147], v14, s[92:93]
    v_add_f32 v118, v118, v113
    v_cvt_pk_bf16_f32 v104, v112, v113
    v_mfma_f32_16x16x32_bf16 v[208:211], a[112:115], v[88:91], v[208:211]
    v_exp_f32 v114, v66
    v_mfma_f32_16x16x32_bf16 v[212:215], a[116:119], v[88:91], v[212:215]
    v_exp_f32 v115, v67
    v_mfma_f32_16x16x32_bf16 v[216:219], a[120:123], v[88:91], v[216:219]
    ds_read_b128 a[84:87], v2 offset:5120
    v_add_f32 v118, v118, v114
    v_mfma_f32_16x16x32_bf16 v[220:223], a[124:127], v[88:91], v[220:223]
    v_add_f32 v118, v118, v115
    v_cvt_pk_bf16_f32 v105, v114, v115
    v_mfma_f32_16x16x32_bf16 v[224:227], a[96:99], v[92:95], v[224:227]
    global_load_dwordx4 a[184:187], v14, s[94:95]
    v_exp_f32 v112, v68
    v_add_u32 v14, s98, v14
    v_mfma_f32_16x16x32_bf16 v[228:231], a[100:103], v[92:95], v[228:231]
    v_exp_f32 v113, v69
    v_mfma_f32_16x16x32_bf16 v[232:235], a[104:107], v[92:95], v[232:235]
    ds_read_b128 a[88:91], v2 offset:6144
    v_add_f32 v118, v118, v112
    v_mfma_f32_16x16x32_bf16 v[236:239], a[108:111], v[92:95], v[236:239]
    v_add_f32 v118, v118, v113
    v_cvt_pk_bf16_f32 v106, v112, v113
    v_mfma_f32_16x16x32_bf16 v[240:243], a[112:115], v[92:95], v[240:243]
    v_exp_f32 v114, v70
    v_mfma_f32_16x16x32_bf16 v[244:247], a[116:119], v[92:95], v[244:247]
    v_exp_f32 v115, v71
    v_mfma_f32_16x16x32_bf16 v[248:251], a[120:123], v[92:95], v[248:251]
    ds_read_b128 a[92:95], v2 offset:7168
    v_add_f32 v118, v118, v114
    v_mfma_f32_16x16x32_bf16 v[252:255], a[124:127], v[92:95], v[252:255]
    v_add_f32 v118, v118, v115
    v_cvt_pk_bf16_f32 v107, v114, v115
    s_waitcnt lgkmcnt(4)
    v_mfma_f32_16x16x32_bf16 v[48:51], a[64:67], a[0:3], v[16:19]
    v_exp_f32 v112, v72
    v_mfma_f32_16x16x32_bf16 v[48:51], a[68:71], a[4:7], v[48:51]
    v_exp_f32 v113, v73
    v_mfma_f32_16x16x32_bf16 v[48:51], a[72:75], a[8:11], v[48:51]
    s_add_u32 m0, s57, 16384
    ds_read_b128 a[96:99], v2 offset:24576
    v_add_f32 v119, v119, v112
    v_mfma_f32_16x16x32_bf16 v[48:51], a[76:79], a[12:15], v[48:51]
    s_waitcnt lgkmcnt(1)
    buffer_load_dwordx4 v1, s[28:31], s55 offen offset:0 lds
    v_add_f32 v119, v119, v113
    v_cvt_pk_bf16_f32 v108, v112, v113
    v_mfma_f32_16x16x32_bf16 v[52:55], a[80:83], a[0:3], v[16:19]
    v_exp_f32 v114, v74
    v_mfma_f32_16x16x32_bf16 v[52:55], a[84:87], a[4:7], v[52:55]
    v_exp_f32 v115, v75
    v_mfma_f32_16x16x32_bf16 v[52:55], a[88:91], a[8:11], v[52:55]
    ds_read_b128 a[100:103], v2 offset:25600
    v_add_f32 v119, v119, v114
    v_mfma_f32_16x16x32_bf16 v[52:55], a[92:95], a[12:15], v[52:55]
    buffer_load_dwordx4 v1, s[28:31], s55 offen offset:1024 lds
    v_add_f32 v119, v119, v115
    v_cvt_pk_bf16_f32 v109, v114, v115
    v_mfma_f32_16x16x32_bf16 v[56:59], a[64:67], a[16:19], v[20:23]
    global_load_dwordx4 a[148:151], v14, s[92:93]
    v_exp_f32 v112, v76
    v_mfma_f32_16x16x32_bf16 v[56:59], a[68:71], a[20:23], v[56:59]
    v_exp_f32 v113, v77
    v_mfma_f32_16x16x32_bf16 v[56:59], a[72:75], a[24:27], v[56:59]
    ds_read_b128 a[104:107], v2 offset:26624
    v_add_f32 v119, v119, v112
    v_mfma_f32_16x16x32_bf16 v[56:59], a[76:79], a[28:31], v[56:59]
    buffer_load_dwordx4 v1, s[28:31], s55 offen offset:2048 lds
    v_add_f32 v119, v119, v113
    v_cvt_pk_bf16_f32 v110, v112, v113
    v_mfma_f32_16x16x32_bf16 v[60:63], a[80:83], a[16:19], v[20:23]
    v_exp_f32 v114, v78
    v_mfma_f32_16x16x32_bf16 v[60:63], a[84:87], a[20:23], v[60:63]
    v_exp_f32 v115, v79
    v_mfma_f32_16x16x32_bf16 v[60:63], a[88:91], a[24:27], v[60:63]
    ds_read_b128 a[108:111], v2 offset:27648
    v_add_f32 v119, v119, v114
    v_mfma_f32_16x16x32_bf16 v[60:63], a[92:95], a[28:31], v[60:63]
    buffer_load_dwordx4 v1, s[28:31], s55 offen offset:3072 lds
    v_add_f32 v119, v119, v115
    v_cvt_pk_bf16_f32 v111, v114, v115
    v_mfma_f32_16x16x32_bf16 v[64:67], a[64:67], a[32:35], v[32:35]
    s_add_u32 s55, s55, 16384
    global_load_dwordx4 a[188:191], v14, s[94:95]
    v_exp_f32 v112, v48
    v_add_u32 v14, s98, v14
    v_mfma_f32_16x16x32_bf16 v[64:67], a[68:71], a[36:39], v[64:67]
    s_add_u32 s57, s57, 32768
    v_exp_f32 v113, v49
    v_mfma_f32_16x16x32_bf16 v[64:67], a[72:75], a[40:43], v[64:67]
    s_cmp_ge_u32 s57, 163840
    s_cselect_b32 s57, s50, s57
    ds_read_b128 a[112:115], v2 offset:28672
    v_add_f32 v116, v116, v112
    v_mfma_f32_16x16x32_bf16 v[64:67], a[76:79], a[44:47], v[64:67]
    v_add_f32 v116, v116, v113
    v_cvt_pk_bf16_f32 v80, v112, v113
    v_mfma_f32_16x16x32_bf16 v[68:71], a[80:83], a[32:35], v[36:39]
    global_load_dwordx4 a[152:155], v14, s[92:93]
    v_exp_f32 v114, v50
    v_mfma_f32_16x16x32_bf16 v[68:71], a[84:87], a[36:39], v[68:71]
    v_exp_f32 v115, v51
    v_mfma_f32_16x16x32_bf16 v[68:71], a[88:91], a[40:43], v[68:71]
    ds_read_b128 a[116:119], v2 offset:29696
    v_add_f32 v116, v116, v114
    v_mfma_f32_16x16x32_bf16 v[68:71], a[92:95], a[44:47], v[68:71]
    v_add_f32 v116, v116, v115
    v_cvt_pk_bf16_f32 v81, v114, v115
    v_mfma_f32_16x16x32_bf16 v[72:75], a[64:67], a[48:51], v[40:43]
    v_exp_f32 v112, v52
    v_mfma_f32_16x16x32_bf16 v[72:75], a[68:71], a[52:55], v[72:75]
    global_load_dwordx4 a[192:195], v14, s[94:95]
    v_exp_f32 v113, v53
    v_add_u32 v14, s98, v14
    v_mfma_f32_16x16x32_bf16 v[72:75], a[72:75], a[56:59], v[72:75]
    ds_read_b128 a[120:123], v2 offset:30720
    v_add_f32 v116, v116, v112
    v_mfma_f32_16x16x32_bf16 v[72:75], a[76:79], a[60:63], v[72:75]
    v_add_f32 v116, v116, v113
    v_cvt_pk_bf16_f32 v82, v112, v113
    v_mfma_f32_16x16x32_bf16 v[76:79], a[80:83], a[48:51], v[44:47]
    v_exp_f32 v114, v54
    v_mfma_f32_16x16x32_bf16 v[76:79], a[84:87], a[52:55], v[76:79]
    v_exp_f32 v115, v55
    v_mfma_f32_16x16x32_bf16 v[76:79], a[88:91], a[56:59], v[76:79]
    ds_read_b128 a[124:127], v2 offset:31744
    v_add_f32 v116, v116, v114
    v_mfma_f32_16x16x32_bf16 v[76:79], a[92:95], a[60:63], v[76:79]
    v_add_f32 v116, v116, v115
    v_cvt_pk_bf16_f32 v83, v114, v115
    s_waitcnt lgkmcnt(4)
    v_mfma_f32_16x16x32_bf16 v[128:131], a[96:99], v[96:99], v[128:131]
    s_add_u32 s62, s62, 1
    s_cmp_lt_i32 s62, 0
    s_cselect_b64 s[14:15], -1, 0
    s_cmp_eq_u32 s62, 0
    s_cselect_b64 s[4:5], s[36:37], s[14:15]
    s_cselect_b64 s[6:7], s[38:39], s[14:15]
    s_cselect_b64 s[8:9], s[40:41], s[14:15]
    s_cselect_b64 s[10:11], s[42:43], s[14:15]
    s_cmp_le_i32 s62, 0
    s_cselect_b64 s[12:13], -1, 0
    v_exp_f32 v112, v56
    v_cndmask_b32 v32, v3, v24, s[4:5]
    v_cndmask_b32 v33, v3, v25, s[6:7]
    v_cndmask_b32 v34, v3, v26, s[8:9]
    v_cndmask_b32 v35, v3, v27, s[10:11]
    v_cndmask_b32 v36, v3, v24, s[14:15]
    v_cndmask_b32 v37, v3, v25, s[14:15]
    v_cndmask_b32 v38, v3, v26, s[14:15]
    v_cndmask_b32 v39, v3, v27, s[14:15]
    v_cndmask_b32 v40, v3, v28, s[12:13]
    v_cndmask_b32 v41, v3, v29, s[12:13]
    v_cndmask_b32 v42, v3, v30, s[12:13]
    v_cndmask_b32 v43, v3, v31, s[12:13]
    v_cndmask_b32 v44, v3, v28, s[4:5]
    v_cndmask_b32 v45, v3, v29, s[6:7]
    v_cndmask_b32 v46, v3, v30, s[8:9]
    v_cndmask_b32 v47, v3, v31, s[10:11]
    v_mfma_f32_16x16x32_bf16 v[132:135], a[100:103], v[96:99], v[132:135]
    v_exp_f32 v113, v57
    v_mfma_f32_16x16x32_bf16 v[136:139], a[104:107], v[96:99], v[136:139]
    ds_read_b128 a[64:67], v2 offset:8192
    v_add_f32 v117, v117, v112
    v_mfma_f32_16x16x32_bf16 v[140:143], a[108:111], v[96:99], v[140:143]
    s_waitcnt lgkmcnt(1)
    v_add_f32 v117, v117, v113
    v_cvt_pk_bf16_f32 v84, v112, v113
    v_mfma_f32_16x16x32_bf16 v[144:147], a[112:115], v[96:99], v[144:147]
    v_exp_f32 v114, v58
    v_mfma_f32_16x16x32_bf16 v[148:151], a[116:119], v[96:99], v[148:151]
    v_exp_f32 v115, v59
    v_mfma_f32_16x16x32_bf16 v[152:155], a[120:123], v[96:99], v[152:155]
    ds_read_b128 a[68:71], v2 offset:9216
    v_add_f32 v117, v117, v114
    v_mfma_f32_16x16x32_bf16 v[156:159], a[124:127], v[96:99], v[156:159]
    global_load_dwordx4 a[156:159], v14, s[92:93]
    v_add_f32 v117, v117, v115
    v_cvt_pk_bf16_f32 v85, v114, v115
    v_mfma_f32_16x16x32_bf16 v[160:163], a[96:99], v[100:103], v[160:163]
    s_add_u32 s58, s58, 32768
    v_exp_f32 v112, v60
    v_mfma_f32_16x16x32_bf16 v[164:167], a[100:103], v[100:103], v[164:167]
    s_cmp_ge_u32 s58, 163840
    s_cselect_b32 s58, 0, s58
    v_exp_f32 v113, v61
    v_mfma_f32_16x16x32_bf16 v[168:171], a[104:107], v[100:103], v[168:171]
    ds_read_b128 a[72:75], v2 offset:10240
    v_add_f32 v117, v117, v112
    v_mfma_f32_16x16x32_bf16 v[172:175], a[108:111], v[100:103], v[172:175]
    v_add_f32 v117, v117, v113
    v_cvt_pk_bf16_f32 v86, v112, v113
    v_mfma_f32_16x16x32_bf16 v[176:179], a[112:115], v[100:103], v[176:179]
    global_load_dwordx4 a[196:199], v14, s[94:95]
    v_exp_f32 v114, v62
    v_add_u32 v14, s98, v14
    v_mfma_f32_16x16x32_bf16 v[180:183], a[116:119], v[100:103], v[180:183]
    v_exp_f32 v115, v63
    v_mfma_f32_16x16x32_bf16 v[184:187], a[120:123], v[100:103], v[184:187]
    ds_read_b128 a[76:79], v2 offset:11264
    v_add_f32 v117, v117, v114
    v_mfma_f32_16x16x32_bf16 v[188:191], a[124:127], v[100:103], v[188:191]
    v_add_f32 v117, v117, v115
    v_cvt_pk_bf16_f32 v87, v114, v115
    v_mfma_f32_16x16x32_bf16 v[192:195], a[96:99], v[104:107], v[192:195]
    v_exp_f32 v112, v64
    v_mfma_f32_16x16x32_bf16 v[196:199], a[100:103], v[104:107], v[196:199]
    v_exp_f32 v113, v65
    v_mfma_f32_16x16x32_bf16 v[200:203], a[104:107], v[104:107], v[200:203]
    ds_read_b128 a[80:83], v2 offset:12288
    v_add_f32 v118, v118, v112
    v_mfma_f32_16x16x32_bf16 v[204:207], a[108:111], v[104:107], v[204:207]
    global_load_dwordx4 a[160:163], v14, s[92:93]
    v_add_f32 v118, v118, v113
    v_cvt_pk_bf16_f32 v88, v112, v113
    v_mfma_f32_16x16x32_bf16 v[208:211], a[112:115], v[104:107], v[208:211]
    v_exp_f32 v114, v66
    v_mfma_f32_16x16x32_bf16 v[212:215], a[116:119], v[104:107], v[212:215]
    v_exp_f32 v115, v67
    v_mfma_f32_16x16x32_bf16 v[216:219], a[120:123], v[104:107], v[216:219]
    ds_read_b128 a[84:87], v2 offset:13312
    v_add_f32 v118, v118, v114
    v_mfma_f32_16x16x32_bf16 v[220:223], a[124:127], v[104:107], v[220:223]
    v_add_f32 v118, v118, v115
    v_cvt_pk_bf16_f32 v89, v114, v115
    v_mfma_f32_16x16x32_bf16 v[224:227], a[96:99], v[108:111], v[224:227]
    global_load_dwordx4 a[200:203], v14, s[94:95]
    v_exp_f32 v112, v68
    v_add_u32 v14, s98, v14
    v_mfma_f32_16x16x32_bf16 v[228:231], a[100:103], v[108:111], v[228:231]
    v_exp_f32 v113, v69
    v_mfma_f32_16x16x32_bf16 v[232:235], a[104:107], v[108:111], v[232:235]
    ds_read_b128 a[88:91], v2 offset:14336
    v_add_f32 v118, v118, v112
    v_mfma_f32_16x16x32_bf16 v[236:239], a[108:111], v[108:111], v[236:239]
    v_add_f32 v118, v118, v113
    v_cvt_pk_bf16_f32 v90, v112, v113
    v_mfma_f32_16x16x32_bf16 v[240:243], a[112:115], v[108:111], v[240:243]
    v_exp_f32 v114, v70
    v_mfma_f32_16x16x32_bf16 v[244:247], a[116:119], v[108:111], v[244:247]
    v_exp_f32 v115, v71
    v_mfma_f32_16x16x32_bf16 v[248:251], a[120:123], v[108:111], v[248:251]
    ds_read_b128 a[92:95], v2 offset:15360
    v_add_f32 v118, v118, v114
    v_mfma_f32_16x16x32_bf16 v[252:255], a[124:127], v[108:111], v[252:255]
    v_add_f32 v118, v118, v115
    v_cvt_pk_bf16_f32 v91, v114, v115
    v_add_u32 v2, s58, v1
    s_waitcnt lgkmcnt(4)
    v_mfma_f32_16x16x32_bf16 v[48:51], a[64:67], a[0:3], v[16:19]
    s_waitcnt vmcnt(32)
    s_barrier
    v_exp_f32 v112, v72
    v_mfma_f32_16x16x32_bf16 v[48:51], a[68:71], a[4:7], v[48:51]
    v_exp_f32 v113, v73
    v_mfma_f32_16x16x32_bf16 v[48:51], a[72:75], a[8:11], v[48:51]
    s_mov_b32 m0, s57
    ds_read_b128 a[96:99], v2 offset:16384
    v_add_f32 v119, v119, v112
    v_mfma_f32_16x16x32_bf16 v[48:51], a[76:79], a[12:15], v[48:51]
    s_waitcnt lgkmcnt(1)
    buffer_load_dwordx4 v1, s[24:27], s54 offen offset:0 lds
    v_add_f32 v119, v119, v113
    v_cvt_pk_bf16_f32 v92, v112, v113
    v_mfma_f32_16x16x32_bf16 v[52:55], a[80:83], a[0:3], v[16:19]
    v_exp_f32 v114, v74
    v_mfma_f32_16x16x32_bf16 v[52:55], a[84:87], a[4:7], v[52:55]
    v_exp_f32 v115, v75
    v_mfma_f32_16x16x32_bf16 v[52:55], a[88:91], a[8:11], v[52:55]
    ds_read_b128 a[100:103], v2 offset:17408
    v_add_f32 v119, v119, v114
    v_mfma_f32_16x16x32_bf16 v[52:55], a[92:95], a[12:15], v[52:55]
    buffer_load_dwordx4 v1, s[24:27], s54 offen offset:1024 lds
    v_add_f32 v119, v119, v115
    v_cvt_pk_bf16_f32 v93, v114, v115
    v_mfma_f32_16x16x32_bf16 v[56:59], a[64:67], a[16:19], v[20:23]
    global_load_dwordx4 a[164:167], v14, s[92:93]
    v_exp_f32 v112, v76
    v_mfma_f32_16x16x32_bf16 v[56:59], a[68:71], a[20:23], v[56:59]
    v_exp_f32 v113, v77
    v_mfma_f32_16x16x32_bf16 v[56:59], a[72:75], a[24:27], v[56:59]
    ds_read_b128 a[104:107], v2 offset:18432
    v_add_f32 v119, v119, v112
    v_mfma_f32_16x16x32_bf16 v[56:59], a[76:79], a[28:31], v[56:59]
    buffer_load_dwordx4 v1, s[24:27], s54 offen offset:2048 lds
    v_add_f32 v119, v119, v113
    v_cvt_pk_bf16_f32 v94, v112, v113
    v_mfma_f32_16x16x32_bf16 v[60:63], a[80:83], a[16:19], v[20:23]
    v_exp_f32 v114, v78
    v_mfma_f32_16x16x32_bf16 v[60:63], a[84:87], a[20:23], v[60:63]
    v_exp_f32 v115, v79
    v_mfma_f32_16x16x32_bf16 v[60:63], a[88:91], a[24:27], v[60:63]
    ds_read_b128 a[108:111], v2 offset:19456
    v_add_f32 v119, v119, v114
    v_mfma_f32_16x16x32_bf16 v[60:63], a[92:95], a[28:31], v[60:63]
    buffer_load_dwordx4 v1, s[24:27], s54 offen offset:3072 lds
    v_add_f32 v119, v119, v115
    v_cvt_pk_bf16_f32 v95, v114, v115
    v_mfma_f32_16x16x32_bf16 v[64:67], a[64:67], a[32:35], v[32:35]
    s_add_u32 s54, s54, 16384
    global_load_dwordx4 a[204:207], v14, s[94:95]
    v_exp_f32 v112, v48
    v_add_u32 v14, s98, v14
    v_mfma_f32_16x16x32_bf16 v[64:67], a[68:71], a[36:39], v[64:67]
    v_exp_f32 v113, v49
    v_mfma_f32_16x16x32_bf16 v[64:67], a[72:75], a[40:43], v[64:67]
    ds_read_b128 a[112:115], v2 offset:20480
    v_add_f32 v116, v116, v112
    v_mfma_f32_16x16x32_bf16 v[64:67], a[76:79], a[44:47], v[64:67]
    v_add_f32 v116, v116, v113
    v_cvt_pk_bf16_f32 v96, v112, v113
    v_mfma_f32_16x16x32_bf16 v[68:71], a[80:83], a[32:35], v[36:39]
    global_load_dwordx4 a[168:171], v14, s[92:93]
    v_exp_f32 v114, v50
    v_mfma_f32_16x16x32_bf16 v[68:71], a[84:87], a[36:39], v[68:71]
    v_exp_f32 v115, v51
    v_mfma_f32_16x16x32_bf16 v[68:71], a[88:91], a[40:43], v[68:71]
    ds_read_b128 a[116:119], v2 offset:21504
    v_add_f32 v116, v116, v114
    v_mfma_f32_16x16x32_bf16 v[68:71], a[92:95], a[44:47], v[68:71]
    v_add_f32 v116, v116, v115
    v_cvt_pk_bf16_f32 v97, v114, v115
    v_mfma_f32_16x16x32_bf16 v[72:75], a[64:67], a[48:51], v[40:43]
    v_exp_f32 v112, v52
    v_mfma_f32_16x16x32_bf16 v[72:75], a[68:71], a[52:55], v[72:75]
    global_load_dwordx4 a[208:211], v14, s[94:95]
    v_exp_f32 v113, v53
    v_add_u32 v14, s98, v14
    v_mfma_f32_16x16x32_bf16 v[72:75], a[72:75], a[56:59], v[72:75]
    ds_read_b128 a[120:123], v2 offset:22528
    v_add_f32 v116, v116, v112
    v_mfma_f32_16x16x32_bf16 v[72:75], a[76:79], a[60:63], v[72:75]
    v_add_f32 v116, v116, v113
    v_cvt_pk_bf16_f32 v98, v112, v113
    v_mfma_f32_16x16x32_bf16 v[76:79], a[80:83], a[48:51], v[44:47]
    v_exp_f32 v114, v54
    v_mfma_f32_16x16x32_bf16 v[76:79], a[84:87], a[52:55], v[76:79]
    v_exp_f32 v115, v55
    v_mfma_f32_16x16x32_bf16 v[76:79], a[88:91], a[56:59], v[76:79]
    ds_read_b128 a[124:127], v2 offset:23552
    v_add_f32 v116, v116, v114
    v_mfma_f32_16x16x32_bf16 v[76:79], a[92:95], a[60:63], v[76:79]
    v_add_f32 v116, v116, v115
    v_cvt_pk_bf16_f32 v99, v114, v115
    s_sub_u32 s62, s60, s59
    s_lshl_b32 s62, s62, 2
    s_add_u32 s62, s62, 4
    s_sub_u32 s62, s62, s44
    s_waitcnt lgkmcnt(4)
    v_mfma_f32_16x16x32_bf16 v[128:131], a[96:99], v[80:83], v[128:131]
    s_cmp_lt_i32 s62, 0
    s_cselect_b64 s[14:15], -1, 0
    s_cmp_eq_u32 s62, 0
    s_cselect_b64 s[4:5], s[36:37], s[14:15]
    s_cselect_b64 s[6:7], s[38:39], s[14:15]
    s_cselect_b64 s[8:9], s[40:41], s[14:15]
    s_cselect_b64 s[10:11], s[42:43], s[14:15]
    s_cmp_le_i32 s62, 0
    s_cselect_b64 s[12:13], -1, 0
    v_exp_f32 v112, v56
    v_cndmask_b32 v32, v3, v16, s[4:5]
    v_cndmask_b32 v33, v3, v17, s[6:7]
    v_cndmask_b32 v34, v3, v18, s[8:9]
    v_cndmask_b32 v35, v3, v19, s[10:11]
    v_cndmask_b32 v36, v3, v16, s[14:15]
    v_cndmask_b32 v37, v3, v17, s[14:15]
    v_cndmask_b32 v38, v3, v18, s[14:15]
    v_cndmask_b32 v39, v3, v19, s[14:15]
    v_cndmask_b32 v40, v3, v20, s[12:13]
    v_cndmask_b32 v41, v3, v21, s[12:13]
    v_cndmask_b32 v42, v3, v22, s[12:13]
    v_cndmask_b32 v43, v3, v23, s[12:13]
    v_cndmask_b32 v44, v3, v20, s[4:5]
    v_cndmask_b32 v45, v3, v21, s[6:7]
    v_cndmask_b32 v46, v3, v22, s[8:9]
    v_cndmask_b32 v47, v3, v23, s[10:11]
    v_mfma_f32_16x16x32_bf16 v[132:135], a[100:103], v[80:83], v[132:135]
    v_exp_f32 v113, v57
    v_mfma_f32_16x16x32_bf16 v[136:139], a[104:107], v[80:83], v[136:139]
    ds_read_b128 a[64:67], v2 offset:0
    v_add_f32 v117, v117, v112
    v_mfma_f32_16x16x32_bf16 v[140:143], a[108:111], v[80:83], v[140:143]
    s_waitcnt lgkmcnt(1)
    v_add_f32 v117, v117, v113
    v_cvt_pk_bf16_f32 v100, v112, v113
    v_mfma_f32_16x16x32_bf16 v[144:147], a[112:115], v[80:83], v[144:147]
    v_exp_f32 v114, v58
    v_mfma_f32_16x16x32_bf16 v[148:151], a[116:119], v[80:83], v[148:151]
    v_exp_f32 v115, v59
    v_mfma_f32_16x16x32_bf16 v[152:155], a[120:123], v[80:83], v[152:155]
    ds_read_b128 a[68:71], v2 offset:1024
    v_add_f32 v117, v117, v114
    v_mfma_f32_16x16x32_bf16 v[156:159], a[124:127], v[80:83], v[156:159]
    global_load_dwordx4 a[212:215], v15, s[96:97] offset:0
    v_add_f32 v117, v117, v115
    v_cvt_pk_bf16_f32 v101, v114, v115
    v_mfma_f32_16x16x32_bf16 v[160:163], a[96:99], v[84:87], v[160:163]
    v_exp_f32 v112, v60
    v_mfma_f32_16x16x32_bf16 v[164:167], a[100:103], v[84:87], v[164:167]
    v_exp_f32 v113, v61
    v_mfma_f32_16x16x32_bf16 v[168:171], a[104:107], v[84:87], v[168:171]
    ds_read_b128 a[72:75], v2 offset:2048
    v_add_f32 v117, v117, v112
    v_mfma_f32_16x16x32_bf16 v[172:175], a[108:111], v[84:87], v[172:175]
    v_add_f32 v117, v117, v113
    v_cvt_pk_bf16_f32 v102, v112, v113
    v_mfma_f32_16x16x32_bf16 v[176:179], a[112:115], v[84:87], v[176:179]
    global_load_dwordx4 a[216:219], v15, s[96:97] offset:1024
    v_exp_f32 v114, v62
    v_mfma_f32_16x16x32_bf16 v[180:183], a[116:119], v[84:87], v[180:183]
    v_exp_f32 v115, v63
    v_mfma_f32_16x16x32_bf16 v[184:187], a[120:123], v[84:87], v[184:187]
    ds_read_b128 a[76:79], v2 offset:3072
    v_add_f32 v117, v117, v114
    v_mfma_f32_16x16x32_bf16 v[188:191], a[124:127], v[84:87], v[188:191]
    v_add_f32 v117, v117, v115
    v_cvt_pk_bf16_f32 v103, v114, v115
    v_mfma_f32_16x16x32_bf16 v[192:195], a[96:99], v[88:91], v[192:195]
    v_exp_f32 v112, v64
    v_mfma_f32_16x16x32_bf16 v[196:199], a[100:103], v[88:91], v[196:199]
    v_exp_f32 v113, v65
    v_mfma_f32_16x16x32_bf16 v[200:203], a[104:107], v[88:91], v[200:203]
    ds_read_b128 a[80:83], v2 offset:4096
    v_add_f32 v118, v118, v112
    v_mfma_f32_16x16x32_bf16 v[204:207], a[108:111], v[88:91], v[204:207]
    global_load_dwordx4 a[220:223], v15, s[96:97] offset:2048
    v_add_f32 v118, v118, v113
    v_cvt_pk_bf16_f32 v104, v112, v113
    v_mfma_f32_16x16x32_bf16 v[208:211], a[112:115], v[88:91], v[208:211]
    v_exp_f32 v114, v66
    v_mfma_f32_16x16x32_bf16 v[212:215], a[116:119], v[88:91], v[212:215]
    v_exp_f32 v115, v67
    v_mfma_f32_16x16x32_bf16 v[216:219], a[120:123], v[88:91], v[216:219]
    ds_read_b128 a[84:87], v2 offset:5120
    v_add_f32 v118, v118, v114
    v_mfma_f32_16x16x32_bf16 v[220:223], a[124:127], v[88:91], v[220:223]
    v_add_f32 v118, v118, v115
    v_cvt_pk_bf16_f32 v105, v114, v115
    v_mfma_f32_16x16x32_bf16 v[224:227], a[96:99], v[92:95], v[224:227]
    global_load_dwordx4 a[224:227], v15, s[96:97] offset:3072
    v_exp_f32 v112, v68
    v_add_u32 v15, s99, v15
    v_mfma_f32_16x16x32_bf16 v[228:231], a[100:103], v[92:95], v[228:231]
    v_exp_f32 v113, v69
    v_mfma_f32_16x16x32_bf16 v[232:235], a[104:107], v[92:95], v[232:235]
    ds_read_b128 a[88:91], v2 offset:6144
    v_add_f32 v118, v118, v112
    v_mfma_f32_16x16x32_bf16 v[236:239], a[108:111], v[92:95], v[236:239]
    v_add_f32 v118, v118, v113
    v_cvt_pk_bf16_f32 v106, v112, v113
    v_mfma_f32_16x16x32_bf16 v[240:243], a[112:115], v[92:95], v[240:243]
    v_exp_f32 v114, v70
    v_mfma_f32_16x16x32_bf16 v[244:247], a[116:119], v[92:95], v[244:247]
    v_exp_f32 v115, v71
    v_mfma_f32_16x16x32_bf16 v[248:251], a[120:123], v[92:95], v[248:251]
    ds_read_b128 a[92:95], v2 offset:7168
    v_add_f32 v118, v118, v114
    v_mfma_f32_16x16x32_bf16 v[252:255], a[124:127], v[92:95], v[252:255]
    v_add_f32 v118, v118, v115
    v_cvt_pk_bf16_f32 v107, v114, v115
    s_waitcnt lgkmcnt(4)
    v_mfma_f32_16x16x32_bf16 v[48:51], a[64:67], a[0:3], v[32:35]
    s_add_u32 m0, s57, 16384
    v_exp_f32 v112, v72
    v_mfma_f32_16x16x32_bf16 v[48:51], a[68:71], a[4:7], v[48:51]
    buffer_load_dwordx4 v1, s[28:31], s55 offen offset:0 lds
    v_exp_f32 v113, v73
    v_mfma_f32_16x16x32_bf16 v[48:51], a[72:75], a[8:11], v[48:51]
    ds_read_b128 a[96:99], v2 offset:24576
    v_add_f32 v119, v119, v112
    v_mfma_f32_16x16x32_bf16 v[48:51], a[76:79], a[12:15], v[48:51]
    s_waitcnt lgkmcnt(1)
    ds_read_b128 a[100:103], v2 offset:25600
    v_add_f32 v119, v119, v113
    v_cvt_pk_bf16_f32 v108, v112, v113
    v_mfma_f32_16x16x32_bf16 v[52:55], a[80:83], a[0:3], v[36:39]
    global_load_dwordx4 a[228:231], v15, s[96:97] offset:0
    v_exp_f32 v114, v74
    v_mfma_f32_16x16x32_bf16 v[52:55], a[84:87], a[4:7], v[52:55]
    buffer_load_dwordx4 v1, s[28:31], s55 offen offset:1024 lds
    v_exp_f32 v115, v75
    v_mfma_f32_16x16x32_bf16 v[52:55], a[88:91], a[8:11], v[52:55]
    ds_read_b128 a[104:107], v2 offset:26624
    v_add_f32 v119, v119, v114
    v_mfma_f32_16x16x32_bf16 v[52:55], a[92:95], a[12:15], v[52:55]
    ds_read_b128 a[108:111], v2 offset:27648
    v_add_f32 v119, v119, v115
    v_cvt_pk_bf16_f32 v109, v114, v115
    v_mfma_f32_16x16x32_bf16 v[56:59], a[64:67], a[16:19], v[40:43]
    global_load_dwordx4 a[232:235], v15, s[96:97] offset:1024
    global_load_dwordx4 a[236:239], v15, s[96:97] offset:2048
    v_exp_f32 v112, v76
    v_mfma_f32_16x16x32_bf16 v[56:59], a[68:71], a[20:23], v[56:59]
    buffer_load_dwordx4 v1, s[28:31], s55 offen offset:2048 lds
    v_exp_f32 v113, v77
    v_mfma_f32_16x16x32_bf16 v[56:59], a[72:75], a[24:27], v[56:59]
    ds_read_b128 a[112:115], v2 offset:28672
    v_add_f32 v119, v119, v112
    v_mfma_f32_16x16x32_bf16 v[56:59], a[76:79], a[28:31], v[56:59]
    ds_read_b128 a[116:119], v2 offset:29696
    v_add_f32 v119, v119, v113
    v_cvt_pk_bf16_f32 v110, v112, v113
    v_mfma_f32_16x16x32_bf16 v[60:63], a[80:83], a[16:19], v[44:47]
    global_load_dwordx4 a[240:243], v15, s[96:97] offset:3072
    v_exp_f32 v114, v78
    v_add_u32 v15, s99, v15
    v_mfma_f32_16x16x32_bf16 v[60:63], a[84:87], a[20:23], v[60:63]
    buffer_load_dwordx4 v1, s[28:31], s55 offen offset:3072 lds
    v_exp_f32 v115, v79
    v_mfma_f32_16x16x32_bf16 v[60:63], a[88:91], a[24:27], v[60:63]
    s_add_u32 s55, s55, 16384
    ds_read_b128 a[120:123], v2 offset:30720
    v_add_f32 v119, v119, v114
    v_mfma_f32_16x16x32_bf16 v[60:63], a[92:95], a[28:31], v[60:63]
    s_add_u32 s57, s57, 32768
    ds_read_b128 a[124:127], v2 offset:31744
    v_add_f32 v119, v119, v115
    v_cvt_pk_bf16_f32 v111, v114, v115
    s_cmp_ge_u32 s57, 163840
    s_cselect_b32 s57, s50, s57
    s_waitcnt lgkmcnt(4)
    v_mfma_f32_16x16x32_bf16 v[128:131], a[96:99], v[96:99], v[128:131]
    v_exp_f32 v112, v48
    v_mfma_f32_16x16x32_bf16 v[132:135], a[100:103], v[96:99], v[132:135]
    v_exp_f32 v113, v49
    v_mfma_f32_16x16x32_bf16 v[136:139], a[104:107], v[96:99], v[136:139]
    ds_read_b128 a[64:67], v2 offset:8192
    v_cvt_pk_bf16_f32 v80, v112, v113
    v_mfma_f32_16x16x32_bf16 v[140:143], a[108:111], v[96:99], v[140:143]
    s_waitcnt lgkmcnt(1)
    v_mov_b32 v88, 0
    v_mov_b32 v89, 0
    v_mfma_f32_16x16x32_bf16 v[144:147], a[112:115], v[96:99], v[144:147]
    v_exp_f32 v114, v50
    v_mfma_f32_16x16x32_bf16 v[148:151], a[116:119], v[96:99], v[148:151]
    v_exp_f32 v115, v51
    v_mfma_f32_16x16x32_bf16 v[152:155], a[120:123], v[96:99], v[152:155]
    ds_read_b128 a[68:71], v2 offset:9216
    v_cvt_pk_bf16_f32 v81, v114, v115
    v_mfma_f32_16x16x32_bf16 v[156:159], a[124:127], v[96:99], v[156:159]
    v_mov_b32 v90, 0
    v_mov_b32 v91, 0
    v_mfma_f32_16x16x32_bf16 v[160:163], a[96:99], v[100:103], v[160:163]
    s_add_u32 s58, s58, 32768
    v_exp_f32 v112, v52
    v_mfma_f32_16x16x32_bf16 v[164:167], a[100:103], v[100:103], v[164:167]
    s_cmp_ge_u32 s58, 163840
    s_cselect_b32 s58, 0, s58
    v_exp_f32 v113, v53
    v_mfma_f32_16x16x32_bf16 v[168:171], a[104:107], v[100:103], v[168:171]
    ds_read_b128 a[72:75], v2 offset:10240
    v_cvt_pk_bf16_f32 v82, v112, v113
    v_mfma_f32_16x16x32_bf16 v[172:175], a[108:111], v[100:103], v[172:175]
    global_load_dwordx4 a[244:247], v15, s[96:97] offset:0
    v_mov_b32 v92, 0
    v_mov_b32 v93, 0
    v_mfma_f32_16x16x32_bf16 v[176:179], a[112:115], v[100:103], v[176:179]
    v_exp_f32 v114, v54
    v_mfma_f32_16x16x32_bf16 v[180:183], a[116:119], v[100:103], v[180:183]
    v_exp_f32 v115, v55
    v_mfma_f32_16x16x32_bf16 v[184:187], a[120:123], v[100:103], v[184:187]
    ds_read_b128 a[76:79], v2 offset:11264
    v_cvt_pk_bf16_f32 v83, v114, v115
    v_mfma_f32_16x16x32_bf16 v[188:191], a[124:127], v[100:103], v[188:191]
    s_add_u32 s62, s62, 1
    v_mov_b32 v94, 0
    v_mov_b32 v95, 0
    v_mfma_f32_16x16x32_bf16 v[192:195], a[96:99], v[104:107], v[192:195]
    s_cmp_lt_i32 s62, 0
    s_cselect_b64 s[14:15], -1, 0
    s_cmp_eq_u32 s62, 0
    s_cselect_b64 s[4:5], s[36:37], s[14:15]
    s_cselect_b64 s[6:7], s[38:39], s[14:15]
    s_cselect_b64 s[8:9], s[40:41], s[14:15]
    s_cselect_b64 s[10:11], s[42:43], s[14:15]
    v_mfma_f32_16x16x32_bf16 v[196:199], a[100:103], v[104:107], v[196:199]
    s_cmp_le_i32 s62, 0
    s_cselect_b64 s[12:13], -1, 0
    v_cndmask_b32 v32, v3, v16, s[4:5]
    v_mfma_f32_16x16x32_bf16 v[200:203], a[104:107], v[104:107], v[200:203]
    ds_read_b128 a[80:83], v2 offset:12288
    v_cndmask_b32 v33, v3, v17, s[6:7]
    v_mfma_f32_16x16x32_bf16 v[204:207], a[108:111], v[104:107], v[204:207]
    v_cndmask_b32 v34, v3, v18, s[8:9]
    v_cndmask_b32 v35, v3, v19, s[10:11]
    v_mfma_f32_16x16x32_bf16 v[208:211], a[112:115], v[104:107], v[208:211]
    global_load_dwordx4 a[248:251], v15, s[96:97] offset:1024
    v_cndmask_b32 v36, v3, v16, s[14:15]
    v_cndmask_b32 v37, v3, v17, s[14:15]
    v_mfma_f32_16x16x32_bf16 v[212:215], a[116:119], v[104:107], v[212:215]
    v_cndmask_b32 v38, v3, v18, s[14:15]
    v_cndmask_b32 v39, v3, v19, s[14:15]
    v_mfma_f32_16x16x32_bf16 v[216:219], a[120:123], v[104:107], v[216:219]
    ds_read_b128 a[84:87], v2 offset:13312
    v_cndmask_b32 v40, v3, v20, s[12:13]
    v_mfma_f32_16x16x32_bf16 v[220:223], a[124:127], v[104:107], v[220:223]
    v_cndmask_b32 v41, v3, v21, s[12:13]
    v_cndmask_b32 v42, v3, v22, s[12:13]
    v_mfma_f32_16x16x32_bf16 v[224:227], a[96:99], v[108:111], v[224:227]
    v_cndmask_b32 v43, v3, v23, s[12:13]
    v_cndmask_b32 v44, v3, v20, s[4:5]
    v_mfma_f32_16x16x32_bf16 v[228:231], a[100:103], v[108:111], v[228:231]
    v_cndmask_b32 v45, v3, v21, s[6:7]
    v_cndmask_b32 v46, v3, v22, s[8:9]
    v_mfma_f32_16x16x32_bf16 v[232:235], a[104:107], v[108:111], v[232:235]
    ds_read_b128 a[88:91], v2 offset:14336
    v_cndmask_b32 v47, v3, v23, s[10:11]
    v_mfma_f32_16x16x32_bf16 v[236:239], a[108:111], v[108:111], v[236:239]
    v_mfma_f32_16x16x32_bf16 v[240:243], a[112:115], v[108:111], v[240:243]
    v_mfma_f32_16x16x32_bf16 v[244:247], a[116:119], v[108:111], v[244:247]
    v_mfma_f32_16x16x32_bf16 v[248:251], a[120:123], v[108:111], v[248:251]
    ds_read_b128 a[92:95], v2 offset:15360
    v_mfma_f32_16x16x32_bf16 v[252:255], a[124:127], v[108:111], v[252:255]
    v_add_u32 v2, s58, v1
    s_nop 7
    v_mov_b32 v120, v118
    s_nop 1
    v_permlane16_swap_b32 v118, v120
    s_nop 1
    v_add_f32 v118, v118, v120
    v_mov_b32 v120, v118
    s_nop 1
    v_permlane32_swap_b32 v118, v120
    s_nop 1
    v_add_f32 v118, v118, v120
    v_mov_b32 v120, v119
    s_nop 1
    v_permlane16_swap_b32 v119, v120
    s_nop 1
    v_add_f32 v119, v119, v120
    v_mov_b32 v120, v119
    s_nop 1
    v_permlane32_swap_b32 v119, v120
    s_nop 1
    v_add_f32 v119, v119, v120
    v_max_f32 v120, v118, v119
    v_cmp_nge_f32 vcc, s65, v120
    s_nop 1
    s_cmp_lg_u64 vcc, 0
    s_cselect_b32 s47, 2, 0
    s_or_b32 s63, s63, s47
    v_rcp_f32 v118, v118
    v_rcp_f32 v119, v119
    s_lshl_b32 s64, s60, 3
    s_lshl_b32 s47, s44, 1
    s_add_u32 s64, s64, s47
    s_lshl_b32 s64, s64, 5
    s_add_u32 s64, s64, s45
    s_lshl_b32 s64, s64, 12
    s_add_u32 s48, s64, 131072
    v_mul_f32 v192, v192, v118
    v_mul_f32 v193, v193, v118
    v_mul_f32 v194, v194, v118
    v_mul_f32 v195, v195, v118
    v_mul_f32 v196, v196, v118
    v_mul_f32 v197, v197, v118
    v_mul_f32 v198, v198, v118
    v_mul_f32 v199, v199, v118
    v_cvt_pk_bf16_f32 v192, v192, v193
    v_cvt_pk_bf16_f32 v193, v194, v195
    v_cvt_pk_bf16_f32 v194, v196, v197
    v_cvt_pk_bf16_f32 v195, v198, v199
    buffer_store_dwordx4 v[192:195], v1, s[32:35], s64 offen offset:0 sc1
    v_mul_f32 v200, v200, v118
    v_mul_f32 v201, v201, v118
    v_mul_f32 v202, v202, v118
    v_mul_f32 v203, v203, v118
    v_mul_f32 v204, v204, v118
    v_mul_f32 v205, v205, v118
    v_mul_f32 v206, v206, v118
    v_mul_f32 v207, v207, v118
    v_cvt_pk_bf16_f32 v200, v200, v201
    v_cvt_pk_bf16_f32 v201, v202, v203
    v_cvt_pk_bf16_f32 v202, v204, v205
    v_cvt_pk_bf16_f32 v203, v206, v207
    buffer_store_dwordx4 v[200:203], v1, s[32:35], s64 offen offset:1024 sc1
    v_mul_f32 v208, v208, v118
    v_mul_f32 v209, v209, v118
    v_mul_f32 v210, v210, v118
    v_mul_f32 v211, v211, v118
    v_mul_f32 v212, v212, v118
    v_mul_f32 v213, v213, v118
    v_mul_f32 v214, v214, v118
    v_mul_f32 v215, v215, v118
    v_cvt_pk_bf16_f32 v208, v208, v209
    v_cvt_pk_bf16_f32 v209, v210, v211
    v_cvt_pk_bf16_f32 v210, v212, v213
    v_cvt_pk_bf16_f32 v211, v214, v215
    buffer_store_dwordx4 v[208:211], v1, s[32:35], s64 offen offset:2048 sc1
    v_mul_f32 v216, v216, v118
    v_mul_f32 v217, v217, v118
    v_mul_f32 v218, v218, v118
    v_mul_f32 v219, v219, v118
    v_mul_f32 v220, v220, v118
    v_mul_f32 v221, v221, v118
    v_mul_f32 v222, v222, v118
    v_mul_f32 v223, v223, v118
    v_cvt_pk_bf16_f32 v216, v216, v217
    v_cvt_pk_bf16_f32 v217, v218, v219
    v_cvt_pk_bf16_f32 v218, v220, v221
    v_cvt_pk_bf16_f32 v219, v222, v223
    buffer_store_dwordx4 v[216:219], v1, s[32:35], s64 offen offset:3072 sc1
    v_mul_f32 v224, v224, v119
    v_mul_f32 v225, v225, v119
    v_mul_f32 v226, v226, v119
    v_mul_f32 v227, v227, v119
    v_mul_f32 v228, v228, v119
    v_mul_f32 v229, v229, v119
    v_mul_f32 v230, v230, v119
    v_mul_f32 v231, v231, v119
    v_cvt_pk_bf16_f32 v224, v224, v225
    v_cvt_pk_bf16_f32 v225, v226, v227
    v_cvt_pk_bf16_f32 v226, v228, v229
    v_cvt_pk_bf16_f32 v227, v230, v231
    buffer_store_dwordx4 v[224:227], v1, s[32:35], s48 offen offset:0 sc1
    v_mul_f32 v232, v232, v119
    v_mul_f32 v233, v233, v119
    v_mul_f32 v234, v234, v119
    v_mul_f32 v235, v235, v119
    v_mul_f32 v236, v236, v119
    v_mul_f32 v237, v237, v119
    v_mul_f32 v238, v238, v119
    v_mul_f32 v239, v239, v119
    v_cvt_pk_bf16_f32 v232, v232, v233
    v_cvt_pk_bf16_f32 v233, v234, v235
    v_cvt_pk_bf16_f32 v234, v236, v237
    v_cvt_pk_bf16_f32 v235, v238, v239
    buffer_store_dwordx4 v[232:235], v1, s[32:35], s48 offen offset:1024 sc1
    v_mul_f32 v240, v240, v119
    v_mul_f32 v241, v241, v119
    v_mul_f32 v242, v242, v119
    v_mul_f32 v243, v243, v119
    v_mul_f32 v244, v244, v119
    v_mul_f32 v245, v245, v119
    v_mul_f32 v246, v246, v119
    v_mul_f32 v247, v247, v119
    v_cvt_pk_bf16_f32 v240, v240, v241
    v_cvt_pk_bf16_f32 v241, v242, v243
    v_cvt_pk_bf16_f32 v242, v244, v245
    v_cvt_pk_bf16_f32 v243, v246, v247
    buffer_store_dwordx4 v[240:243], v1, s[32:35], s48 offen offset:2048 sc1
    v_mul_f32 v248, v248, v119
    v_mul_f32 v249, v249, v119
    v_mul_f32 v250, v250, v119
    v_mul_f32 v251, v251, v119
    v_mul_f32 v252, v252, v119
    v_mul_f32 v253, v253, v119
    v_mul_f32 v254, v254, v119
    v_mul_f32 v255, v255, v119
    v_cvt_pk_bf16_f32 v248, v248, v249
    v_cvt_pk_bf16_f32 v249, v250, v251
    v_cvt_pk_bf16_f32 v250, v252, v253
    v_cvt_pk_bf16_f32 v251, v254, v255
    buffer_store_dwordx4 v[248:251], v1, s[32:35], s48 offen offset:3072 sc1
    s_sub_u32 s61, s59, s60
    s_cmp_eq_u32 s61, 1
    s_cbranch_scc1 sequential_preLN__compressed_kv_cla__moe_arch_mod__prompt_kernel_sb
    s_sub_u32 s61, s61, 2
    s_waitcnt lgkmcnt(4)
    v_mfma_f32_16x16x32_bf16 v[64:67], a[64:67], a[0:3], v[16:19]
    s_waitcnt vmcnt(16)
    s_barrier
    v_exp_f32 v112, v56
    v_mfma_f32_16x16x32_bf16 v[64:67], a[68:71], a[4:7], v[64:67]
    v_exp_f32 v113, v57
    v_mfma_f32_16x16x32_bf16 v[64:67], a[72:75], a[8:11], v[64:67]
    ds_read_b128 a[96:99], v2 offset:16384
    v_cvt_pk_bf16_f32 v84, v112, v113
    v_mfma_f32_16x16x32_bf16 v[64:67], a[76:79], a[12:15], v[64:67]
    s_waitcnt lgkmcnt(1)
    ds_read_b128 a[100:103], v2 offset:17408
    v_mfma_f32_16x16x32_bf16 v[68:71], a[80:83], a[0:3], v[16:19]
    v_exp_f32 v114, v58
    v_mfma_f32_16x16x32_bf16 v[68:71], a[84:87], a[4:7], v[68:71]
    v_exp_f32 v115, v59
    v_mfma_f32_16x16x32_bf16 v[68:71], a[88:91], a[8:11], v[68:71]
    ds_read_b128 a[104:107], v2 offset:18432
    v_cvt_pk_bf16_f32 v85, v114, v115
    v_mfma_f32_16x16x32_bf16 v[68:71], a[92:95], a[12:15], v[68:71]
    ds_read_b128 a[108:111], v2 offset:19456
    v_mfma_f32_16x16x32_bf16 v[72:75], a[64:67], a[16:19], v[20:23]
    v_exp_f32 v112, v60
    v_mfma_f32_16x16x32_bf16 v[72:75], a[68:71], a[20:23], v[72:75]
    v_exp_f32 v113, v61
    v_mfma_f32_16x16x32_bf16 v[72:75], a[72:75], a[24:27], v[72:75]
    ds_read_b128 a[112:115], v2 offset:20480
    v_cvt_pk_bf16_f32 v86, v112, v113
    v_mfma_f32_16x16x32_bf16 v[72:75], a[76:79], a[28:31], v[72:75]
    ds_read_b128 a[116:119], v2 offset:21504
    v_mfma_f32_16x16x32_bf16 v[76:79], a[80:83], a[16:19], v[20:23]
    v_exp_f32 v114, v62
    v_mfma_f32_16x16x32_bf16 v[76:79], a[84:87], a[20:23], v[76:79]
    v_exp_f32 v115, v63
    v_mfma_f32_16x16x32_bf16 v[76:79], a[88:91], a[24:27], v[76:79]
    ds_read_b128 a[120:123], v2 offset:22528
    v_cvt_pk_bf16_f32 v87, v114, v115
    v_mfma_f32_16x16x32_bf16 v[76:79], a[92:95], a[28:31], v[76:79]
    ds_read_b128 a[124:127], v2 offset:23552
    s_waitcnt lgkmcnt(4)
    v_mfma_f32_16x16x32_bf16 v[128:131], a[96:99], v[80:83], v[128:131]
    v_exp_f32 v112, v64
    v_mfma_f32_16x16x32_bf16 v[132:135], a[100:103], v[80:83], v[132:135]
    v_exp_f32 v113, v65
    v_mfma_f32_16x16x32_bf16 v[136:139], a[104:107], v[80:83], v[136:139]
    ds_read_b128 a[64:67], v2 offset:0
    v_cvt_pk_bf16_f32 v96, v112, v113
    v_mfma_f32_16x16x32_bf16 v[140:143], a[108:111], v[80:83], v[140:143]
    s_waitcnt lgkmcnt(1)
    ds_read_b128 a[68:71], v2 offset:1024
    v_mfma_f32_16x16x32_bf16 v[144:147], a[112:115], v[80:83], v[144:147]
    s_mov_b32 m0, s57
    v_exp_f32 v114, v66
    v_mfma_f32_16x16x32_bf16 v[148:151], a[116:119], v[80:83], v[148:151]
    buffer_load_dwordx4 v1, s[24:27], s54 offen offset:0 lds
    v_exp_f32 v115, v67
    v_mfma_f32_16x16x32_bf16 v[152:155], a[120:123], v[80:83], v[152:155]
    ds_read_b128 a[72:75], v2 offset:2048
    v_cvt_pk_bf16_f32 v97, v114, v115
    v_mfma_f32_16x16x32_bf16 v[156:159], a[124:127], v[80:83], v[156:159]
    ds_read_b128 a[76:79], v2 offset:3072
    v_mfma_f32_16x16x32_bf16 v[160:163], a[96:99], v[84:87], v[160:163]
    v_exp_f32 v112, v68
    v_mfma_f32_16x16x32_bf16 v[164:167], a[100:103], v[84:87], v[164:167]
    buffer_load_dwordx4 v1, s[24:27], s54 offen offset:1024 lds
    v_exp_f32 v113, v69
    v_mfma_f32_16x16x32_bf16 v[168:171], a[104:107], v[84:87], v[168:171]
    ds_read_b128 a[80:83], v2 offset:4096
    v_cvt_pk_bf16_f32 v98, v112, v113
    v_mfma_f32_16x16x32_bf16 v[172:175], a[108:111], v[84:87], v[172:175]
    ds_read_b128 a[84:87], v2 offset:5120
    v_mfma_f32_16x16x32_bf16 v[176:179], a[112:115], v[84:87], v[176:179]
    v_exp_f32 v114, v70
    v_mfma_f32_16x16x32_bf16 v[180:183], a[116:119], v[84:87], v[180:183]
    buffer_load_dwordx4 v1, s[24:27], s54 offen offset:2048 lds
    v_exp_f32 v115, v71
    v_mfma_f32_16x16x32_bf16 v[184:187], a[120:123], v[84:87], v[184:187]
    ds_read_b128 a[88:91], v2 offset:6144
    v_cvt_pk_bf16_f32 v99, v114, v115
    v_mfma_f32_16x16x32_bf16 v[188:191], a[124:127], v[84:87], v[188:191]
    ds_read_b128 a[92:95], v2 offset:7168
    v_mfma_f32_16x16x32_bf16 v[88:91], a[128:131], v[80:83], v[88:91]
    buffer_load_dwordx4 v1, s[24:27], s54 offen offset:3072 lds
    v_mfma_f32_16x16x32_bf16 v[92:95], a[128:131], v[84:87], v[92:95]
    s_add_u32 s54, s54, 16384
    s_waitcnt lgkmcnt(4)
    v_mfma_f32_16x16x32_bf16 v[48:51], a[64:67], a[0:3], v[16:19]
    v_exp_f32 v112, v72
    v_mfma_f32_16x16x32_bf16 v[48:51], a[68:71], a[4:7], v[48:51]
    v_exp_f32 v113, v73
    v_mfma_f32_16x16x32_bf16 v[48:51], a[72:75], a[8:11], v[48:51]
    ds_read_b128 a[96:99], v2 offset:24576
    v_cvt_pk_bf16_f32 v100, v112, v113
    v_mfma_f32_16x16x32_bf16 v[48:51], a[76:79], a[12:15], v[48:51]
    s_waitcnt lgkmcnt(1)
    ds_read_b128 a[100:103], v2 offset:25600
    v_mfma_f32_16x16x32_bf16 v[52:55], a[80:83], a[0:3], v[16:19]
    v_exp_f32 v114, v74
    v_mfma_f32_16x16x32_bf16 v[52:55], a[84:87], a[4:7], v[52:55]
    v_exp_f32 v115, v75
    v_mfma_f32_16x16x32_bf16 v[52:55], a[88:91], a[8:11], v[52:55]
    ds_read_b128 a[104:107], v2 offset:26624
    v_cvt_pk_bf16_f32 v101, v114, v115
    v_mfma_f32_16x16x32_bf16 v[52:55], a[92:95], a[12:15], v[52:55]
    ds_read_b128 a[108:111], v2 offset:27648
    v_mfma_f32_16x16x32_bf16 v[56:59], a[64:67], a[16:19], v[20:23]
    v_exp_f32 v112, v76
    v_mfma_f32_16x16x32_bf16 v[56:59], a[68:71], a[20:23], v[56:59]
    v_exp_f32 v113, v77
    v_mfma_f32_16x16x32_bf16 v[56:59], a[72:75], a[24:27], v[56:59]
    ds_read_b128 a[112:115], v2 offset:28672
    v_cvt_pk_bf16_f32 v102, v112, v113
    v_mfma_f32_16x16x32_bf16 v[56:59], a[76:79], a[28:31], v[56:59]
    ds_read_b128 a[116:119], v2 offset:29696
    v_mfma_f32_16x16x32_bf16 v[60:63], a[80:83], a[16:19], v[20:23]
    v_exp_f32 v114, v78
    v_mfma_f32_16x16x32_bf16 v[60:63], a[84:87], a[20:23], v[60:63]
    v_exp_f32 v115, v79
    v_mfma_f32_16x16x32_bf16 v[60:63], a[88:91], a[24:27], v[60:63]
    ds_read_b128 a[120:123], v2 offset:30720
    v_cvt_pk_bf16_f32 v103, v114, v115
    v_mfma_f32_16x16x32_bf16 v[60:63], a[92:95], a[28:31], v[60:63]
    ds_read_b128 a[124:127], v2 offset:31744
    s_waitcnt lgkmcnt(4)
    v_mfma_f32_16x16x32_bf16 v[128:131], a[96:99], v[96:99], v[128:131]
    v_exp_f32 v112, v48
    v_mfma_f32_16x16x32_bf16 v[132:135], a[100:103], v[96:99], v[132:135]
    v_exp_f32 v113, v49
    v_mfma_f32_16x16x32_bf16 v[136:139], a[104:107], v[96:99], v[136:139]
    s_add_u32 m0, s57, 16384
    ds_read_b128 a[64:67], v2 offset:8192
    v_cvt_pk_bf16_f32 v80, v112, v113
    v_mfma_f32_16x16x32_bf16 v[140:143], a[108:111], v[96:99], v[140:143]
    s_waitcnt lgkmcnt(1)
    s_add_u32 s57, s57, 32768
    ds_read_b128 a[68:71], v2 offset:9216
    v_mfma_f32_16x16x32_bf16 v[144:147], a[112:115], v[96:99], v[144:147]
    s_cmp_ge_u32 s57, 163840
    s_cselect_b32 s57, s50, s57
    v_exp_f32 v114, v50
    v_mfma_f32_16x16x32_bf16 v[148:151], a[116:119], v[96:99], v[148:151]
    buffer_load_dwordx4 v1, s[28:31], s55 offen offset:0 lds
    v_exp_f32 v115, v51
    v_mfma_f32_16x16x32_bf16 v[152:155], a[120:123], v[96:99], v[152:155]
    ds_read_b128 a[72:75], v2 offset:10240
    v_cvt_pk_bf16_f32 v81, v114, v115
    v_mfma_f32_16x16x32_bf16 v[156:159], a[124:127], v[96:99], v[156:159]
    ds_read_b128 a[76:79], v2 offset:11264
    v_mfma_f32_16x16x32_bf16 v[160:163], a[96:99], v[100:103], v[160:163]
    s_add_u32 s58, s58, 32768
    v_exp_f32 v112, v52
    v_mfma_f32_16x16x32_bf16 v[164:167], a[100:103], v[100:103], v[164:167]
    s_cmp_ge_u32 s58, 163840
    s_cselect_b32 s58, 0, s58
    buffer_load_dwordx4 v1, s[28:31], s55 offen offset:1024 lds
    v_exp_f32 v113, v53
    v_mfma_f32_16x16x32_bf16 v[168:171], a[104:107], v[100:103], v[168:171]
    ds_read_b128 a[80:83], v2 offset:12288
    v_cvt_pk_bf16_f32 v82, v112, v113
    v_mfma_f32_16x16x32_bf16 v[172:175], a[108:111], v[100:103], v[172:175]
    ds_read_b128 a[84:87], v2 offset:13312
    v_mfma_f32_16x16x32_bf16 v[176:179], a[112:115], v[100:103], v[176:179]
    v_exp_f32 v114, v54
    v_mfma_f32_16x16x32_bf16 v[180:183], a[116:119], v[100:103], v[180:183]
    buffer_load_dwordx4 v1, s[28:31], s55 offen offset:2048 lds
    v_exp_f32 v115, v55
    v_mfma_f32_16x16x32_bf16 v[184:187], a[120:123], v[100:103], v[184:187]
    ds_read_b128 a[88:91], v2 offset:14336
    v_cvt_pk_bf16_f32 v83, v114, v115
    v_mfma_f32_16x16x32_bf16 v[188:191], a[124:127], v[100:103], v[188:191]
    ds_read_b128 a[92:95], v2 offset:15360
    v_mfma_f32_16x16x32_bf16 v[88:91], a[128:131], v[96:99], v[88:91]
    buffer_load_dwordx4 v1, s[28:31], s55 offen offset:3072 lds
    v_mfma_f32_16x16x32_bf16 v[92:95], a[128:131], v[100:103], v[92:95]
    s_add_u32 s55, s55, 16384
    v_add_u32 v2, s58, v1
sequential_preLN__compressed_kv_cla__moe_arch_mod__prompt_kernel_sn:
    s_waitcnt lgkmcnt(4)
    v_mfma_f32_16x16x32_bf16 v[64:67], a[64:67], a[0:3], v[16:19]
    s_waitcnt vmcnt(8)
    s_barrier
    v_exp_f32 v112, v56
    v_mfma_f32_16x16x32_bf16 v[64:67], a[68:71], a[4:7], v[64:67]
    v_exp_f32 v113, v57
    v_mfma_f32_16x16x32_bf16 v[64:67], a[72:75], a[8:11], v[64:67]
    ds_read_b128 a[96:99], v2 offset:16384
    v_cvt_pk_bf16_f32 v84, v112, v113
    v_mfma_f32_16x16x32_bf16 v[64:67], a[76:79], a[12:15], v[64:67]
    s_waitcnt lgkmcnt(1)
    ds_read_b128 a[100:103], v2 offset:17408
    v_mfma_f32_16x16x32_bf16 v[68:71], a[80:83], a[0:3], v[16:19]
    v_exp_f32 v114, v58
    v_mfma_f32_16x16x32_bf16 v[68:71], a[84:87], a[4:7], v[68:71]
    v_exp_f32 v115, v59
    v_mfma_f32_16x16x32_bf16 v[68:71], a[88:91], a[8:11], v[68:71]
    ds_read_b128 a[104:107], v2 offset:18432
    v_cvt_pk_bf16_f32 v85, v114, v115
    v_mfma_f32_16x16x32_bf16 v[68:71], a[92:95], a[12:15], v[68:71]
    ds_read_b128 a[108:111], v2 offset:19456
    v_mfma_f32_16x16x32_bf16 v[72:75], a[64:67], a[16:19], v[20:23]
    v_exp_f32 v112, v60
    v_mfma_f32_16x16x32_bf16 v[72:75], a[68:71], a[20:23], v[72:75]
    v_exp_f32 v113, v61
    v_mfma_f32_16x16x32_bf16 v[72:75], a[72:75], a[24:27], v[72:75]
    ds_read_b128 a[112:115], v2 offset:20480
    v_cvt_pk_bf16_f32 v86, v112, v113
    v_mfma_f32_16x16x32_bf16 v[72:75], a[76:79], a[28:31], v[72:75]
    ds_read_b128 a[116:119], v2 offset:21504
    v_mfma_f32_16x16x32_bf16 v[76:79], a[80:83], a[16:19], v[20:23]
    v_exp_f32 v114, v62
    v_mfma_f32_16x16x32_bf16 v[76:79], a[84:87], a[20:23], v[76:79]
    v_exp_f32 v115, v63
    v_mfma_f32_16x16x32_bf16 v[76:79], a[88:91], a[24:27], v[76:79]
    ds_read_b128 a[120:123], v2 offset:22528
    v_cvt_pk_bf16_f32 v87, v114, v115
    v_mfma_f32_16x16x32_bf16 v[76:79], a[92:95], a[28:31], v[76:79]
    ds_read_b128 a[124:127], v2 offset:23552
    s_waitcnt lgkmcnt(4)
    v_mfma_f32_16x16x32_bf16 v[128:131], a[96:99], v[80:83], v[128:131]
    v_exp_f32 v112, v64
    v_mfma_f32_16x16x32_bf16 v[132:135], a[100:103], v[80:83], v[132:135]
    v_exp_f32 v113, v65
    v_mfma_f32_16x16x32_bf16 v[136:139], a[104:107], v[80:83], v[136:139]
    ds_read_b128 a[64:67], v2 offset:0
    v_cvt_pk_bf16_f32 v96, v112, v113
    v_mfma_f32_16x16x32_bf16 v[140:143], a[108:111], v[80:83], v[140:143]
    s_waitcnt lgkmcnt(1)
    ds_read_b128 a[68:71], v2 offset:1024
    v_mfma_f32_16x16x32_bf16 v[144:147], a[112:115], v[80:83], v[144:147]
    s_mov_b32 m0, s57
    v_exp_f32 v114, v66
    v_mfma_f32_16x16x32_bf16 v[148:151], a[116:119], v[80:83], v[148:151]
    buffer_load_dwordx4 v1, s[24:27], s54 offen offset:0 lds
    v_exp_f32 v115, v67
    v_mfma_f32_16x16x32_bf16 v[152:155], a[120:123], v[80:83], v[152:155]
    ds_read_b128 a[72:75], v2 offset:2048
    v_cvt_pk_bf16_f32 v97, v114, v115
    v_mfma_f32_16x16x32_bf16 v[156:159], a[124:127], v[80:83], v[156:159]
    ds_read_b128 a[76:79], v2 offset:3072
    v_mfma_f32_16x16x32_bf16 v[160:163], a[96:99], v[84:87], v[160:163]
    v_exp_f32 v112, v68
    v_mfma_f32_16x16x32_bf16 v[164:167], a[100:103], v[84:87], v[164:167]
    buffer_load_dwordx4 v1, s[24:27], s54 offen offset:1024 lds
    v_exp_f32 v113, v69
    v_mfma_f32_16x16x32_bf16 v[168:171], a[104:107], v[84:87], v[168:171]
    ds_read_b128 a[80:83], v2 offset:4096
    v_cvt_pk_bf16_f32 v98, v112, v113
    v_mfma_f32_16x16x32_bf16 v[172:175], a[108:111], v[84:87], v[172:175]
    ds_read_b128 a[84:87], v2 offset:5120
    v_mfma_f32_16x16x32_bf16 v[176:179], a[112:115], v[84:87], v[176:179]
    v_exp_f32 v114, v70
    v_mfma_f32_16x16x32_bf16 v[180:183], a[116:119], v[84:87], v[180:183]
    buffer_load_dwordx4 v1, s[24:27], s54 offen offset:2048 lds
    v_exp_f32 v115, v71
    v_mfma_f32_16x16x32_bf16 v[184:187], a[120:123], v[84:87], v[184:187]
    ds_read_b128 a[88:91], v2 offset:6144
    v_cvt_pk_bf16_f32 v99, v114, v115
    v_mfma_f32_16x16x32_bf16 v[188:191], a[124:127], v[84:87], v[188:191]
    ds_read_b128 a[92:95], v2 offset:7168
    v_mfma_f32_16x16x32_bf16 v[88:91], a[128:131], v[80:83], v[88:91]
    buffer_load_dwordx4 v1, s[24:27], s54 offen offset:3072 lds
    v_mfma_f32_16x16x32_bf16 v[92:95], a[128:131], v[84:87], v[92:95]
    s_add_u32 s54, s54, 16384
    s_waitcnt lgkmcnt(4)
    v_mfma_f32_16x16x32_bf16 v[48:51], a[64:67], a[0:3], v[16:19]
    v_exp_f32 v112, v72
    v_mfma_f32_16x16x32_bf16 v[48:51], a[68:71], a[4:7], v[48:51]
    v_exp_f32 v113, v73
    v_mfma_f32_16x16x32_bf16 v[48:51], a[72:75], a[8:11], v[48:51]
    ds_read_b128 a[96:99], v2 offset:24576
    v_cvt_pk_bf16_f32 v100, v112, v113
    v_mfma_f32_16x16x32_bf16 v[48:51], a[76:79], a[12:15], v[48:51]
    s_waitcnt lgkmcnt(1)
    ds_read_b128 a[100:103], v2 offset:25600
    v_mfma_f32_16x16x32_bf16 v[52:55], a[80:83], a[0:3], v[16:19]
    v_exp_f32 v114, v74
    v_mfma_f32_16x16x32_bf16 v[52:55], a[84:87], a[4:7], v[52:55]
    v_exp_f32 v115, v75
    v_mfma_f32_16x16x32_bf16 v[52:55], a[88:91], a[8:11], v[52:55]
    ds_read_b128 a[104:107], v2 offset:26624
    v_cvt_pk_bf16_f32 v101, v114, v115
    v_mfma_f32_16x16x32_bf16 v[52:55], a[92:95], a[12:15], v[52:55]
    ds_read_b128 a[108:111], v2 offset:27648
    v_mfma_f32_16x16x32_bf16 v[56:59], a[64:67], a[16:19], v[20:23]
    v_exp_f32 v112, v76
    v_mfma_f32_16x16x32_bf16 v[56:59], a[68:71], a[20:23], v[56:59]
    v_exp_f32 v113, v77
    v_mfma_f32_16x16x32_bf16 v[56:59], a[72:75], a[24:27], v[56:59]
    ds_read_b128 a[112:115], v2 offset:28672
    v_cvt_pk_bf16_f32 v102, v112, v113
    v_mfma_f32_16x16x32_bf16 v[56:59], a[76:79], a[28:31], v[56:59]
    ds_read_b128 a[116:119], v2 offset:29696
    v_mfma_f32_16x16x32_bf16 v[60:63], a[80:83], a[16:19], v[20:23]
    v_exp_f32 v114, v78
    v_mfma_f32_16x16x32_bf16 v[60:63], a[84:87], a[20:23], v[60:63]
    v_exp_f32 v115, v79
    v_mfma_f32_16x16x32_bf16 v[60:63], a[88:91], a[24:27], v[60:63]
    ds_read_b128 a[120:123], v2 offset:30720
    v_cvt_pk_bf16_f32 v103, v114, v115
    v_mfma_f32_16x16x32_bf16 v[60:63], a[92:95], a[28:31], v[60:63]
    ds_read_b128 a[124:127], v2 offset:31744
    s_waitcnt lgkmcnt(4)
    v_mfma_f32_16x16x32_bf16 v[128:131], a[96:99], v[96:99], v[128:131]
    v_exp_f32 v112, v48
    v_mfma_f32_16x16x32_bf16 v[132:135], a[100:103], v[96:99], v[132:135]
    v_exp_f32 v113, v49
    v_mfma_f32_16x16x32_bf16 v[136:139], a[104:107], v[96:99], v[136:139]
    s_add_u32 m0, s57, 16384
    ds_read_b128 a[64:67], v2 offset:8192
    v_cvt_pk_bf16_f32 v80, v112, v113
    v_mfma_f32_16x16x32_bf16 v[140:143], a[108:111], v[96:99], v[140:143]
    s_waitcnt lgkmcnt(1)
    s_add_u32 s57, s57, 32768
    ds_read_b128 a[68:71], v2 offset:9216
    v_mfma_f32_16x16x32_bf16 v[144:147], a[112:115], v[96:99], v[144:147]
    s_cmp_ge_u32 s57, 163840
    s_cselect_b32 s57, s50, s57
    v_exp_f32 v114, v50
    v_mfma_f32_16x16x32_bf16 v[148:151], a[116:119], v[96:99], v[148:151]
    buffer_load_dwordx4 v1, s[28:31], s55 offen offset:0 lds
    v_exp_f32 v115, v51
    v_mfma_f32_16x16x32_bf16 v[152:155], a[120:123], v[96:99], v[152:155]
    ds_read_b128 a[72:75], v2 offset:10240
    v_cvt_pk_bf16_f32 v81, v114, v115
    v_mfma_f32_16x16x32_bf16 v[156:159], a[124:127], v[96:99], v[156:159]
    ds_read_b128 a[76:79], v2 offset:11264
    v_mfma_f32_16x16x32_bf16 v[160:163], a[96:99], v[100:103], v[160:163]
    s_add_u32 s58, s58, 32768
    v_exp_f32 v112, v52
    v_mfma_f32_16x16x32_bf16 v[164:167], a[100:103], v[100:103], v[164:167]
    s_cmp_ge_u32 s58, 163840
    s_cselect_b32 s58, 0, s58
    buffer_load_dwordx4 v1, s[28:31], s55 offen offset:1024 lds
    v_exp_f32 v113, v53
    v_mfma_f32_16x16x32_bf16 v[168:171], a[104:107], v[100:103], v[168:171]
    ds_read_b128 a[80:83], v2 offset:12288
    v_cvt_pk_bf16_f32 v82, v112, v113
    v_mfma_f32_16x16x32_bf16 v[172:175], a[108:111], v[100:103], v[172:175]
    ds_read_b128 a[84:87], v2 offset:13312
    v_mfma_f32_16x16x32_bf16 v[176:179], a[112:115], v[100:103], v[176:179]
    v_exp_f32 v114, v54
    v_mfma_f32_16x16x32_bf16 v[180:183], a[116:119], v[100:103], v[180:183]
    buffer_load_dwordx4 v1, s[28:31], s55 offen offset:2048 lds
    v_exp_f32 v115, v55
    v_mfma_f32_16x16x32_bf16 v[184:187], a[120:123], v[100:103], v[184:187]
    ds_read_b128 a[88:91], v2 offset:14336
    v_cvt_pk_bf16_f32 v83, v114, v115
    v_mfma_f32_16x16x32_bf16 v[188:191], a[124:127], v[100:103], v[188:191]
    ds_read_b128 a[92:95], v2 offset:15360
    v_mfma_f32_16x16x32_bf16 v[88:91], a[128:131], v[96:99], v[88:91]
    buffer_load_dwordx4 v1, s[28:31], s55 offen offset:3072 lds
    v_mfma_f32_16x16x32_bf16 v[92:95], a[128:131], v[100:103], v[92:95]
    s_add_u32 s55, s55, 16384
    v_add_u32 v2, s58, v1
    s_waitcnt lgkmcnt(4)
    v_mfma_f32_16x16x32_bf16 v[64:67], a[64:67], a[0:3], v[16:19]
    v_exp_f32 v112, v56
    v_mfma_f32_16x16x32_bf16 v[64:67], a[68:71], a[4:7], v[64:67]
    v_exp_f32 v113, v57
    v_mfma_f32_16x16x32_bf16 v[64:67], a[72:75], a[8:11], v[64:67]
    ds_read_b128 a[96:99], v2 offset:16384
    v_cvt_pk_bf16_f32 v84, v112, v113
    v_mfma_f32_16x16x32_bf16 v[64:67], a[76:79], a[12:15], v[64:67]
    s_waitcnt lgkmcnt(1)
    ds_read_b128 a[100:103], v2 offset:17408
    v_mfma_f32_16x16x32_bf16 v[68:71], a[80:83], a[0:3], v[16:19]
    v_exp_f32 v114, v58
    v_mfma_f32_16x16x32_bf16 v[68:71], a[84:87], a[4:7], v[68:71]
    v_exp_f32 v115, v59
    v_mfma_f32_16x16x32_bf16 v[68:71], a[88:91], a[8:11], v[68:71]
    ds_read_b128 a[104:107], v2 offset:18432
    v_cvt_pk_bf16_f32 v85, v114, v115
    v_mfma_f32_16x16x32_bf16 v[68:71], a[92:95], a[12:15], v[68:71]
    ds_read_b128 a[108:111], v2 offset:19456
    v_mfma_f32_16x16x32_bf16 v[72:75], a[64:67], a[16:19], v[20:23]
    v_exp_f32 v112, v60
    v_mfma_f32_16x16x32_bf16 v[72:75], a[68:71], a[20:23], v[72:75]
    v_exp_f32 v113, v61
    v_mfma_f32_16x16x32_bf16 v[72:75], a[72:75], a[24:27], v[72:75]
    ds_read_b128 a[112:115], v2 offset:20480
    v_cvt_pk_bf16_f32 v86, v112, v113
    v_mfma_f32_16x16x32_bf16 v[72:75], a[76:79], a[28:31], v[72:75]
    ds_read_b128 a[116:119], v2 offset:21504
    v_mfma_f32_16x16x32_bf16 v[76:79], a[80:83], a[16:19], v[20:23]
    v_exp_f32 v114, v62
    v_mfma_f32_16x16x32_bf16 v[76:79], a[84:87], a[20:23], v[76:79]
    v_exp_f32 v115, v63
    v_mfma_f32_16x16x32_bf16 v[76:79], a[88:91], a[24:27], v[76:79]
    ds_read_b128 a[120:123], v2 offset:22528
    v_cvt_pk_bf16_f32 v87, v114, v115
    v_mfma_f32_16x16x32_bf16 v[76:79], a[92:95], a[28:31], v[76:79]
    ds_read_b128 a[124:127], v2 offset:23552
    s_waitcnt lgkmcnt(4)
    v_mfma_f32_16x16x32_bf16 v[128:131], a[96:99], v[80:83], v[128:131]
    v_exp_f32 v112, v64
    v_mfma_f32_16x16x32_bf16 v[132:135], a[100:103], v[80:83], v[132:135]
    v_exp_f32 v113, v65
    v_mfma_f32_16x16x32_bf16 v[136:139], a[104:107], v[80:83], v[136:139]
    ds_read_b128 a[64:67], v2 offset:0
    v_cvt_pk_bf16_f32 v96, v112, v113
    v_mfma_f32_16x16x32_bf16 v[140:143], a[108:111], v[80:83], v[140:143]
    s_waitcnt lgkmcnt(1)
    ds_read_b128 a[68:71], v2 offset:1024
    v_mfma_f32_16x16x32_bf16 v[144:147], a[112:115], v[80:83], v[144:147]
    s_mov_b32 m0, s57
    v_exp_f32 v114, v66
    v_mfma_f32_16x16x32_bf16 v[148:151], a[116:119], v[80:83], v[148:151]
    buffer_load_dwordx4 v1, s[24:27], s54 offen offset:0 lds
    v_exp_f32 v115, v67
    v_mfma_f32_16x16x32_bf16 v[152:155], a[120:123], v[80:83], v[152:155]
    ds_read_b128 a[72:75], v2 offset:2048
    v_cvt_pk_bf16_f32 v97, v114, v115
    v_mfma_f32_16x16x32_bf16 v[156:159], a[124:127], v[80:83], v[156:159]
    ds_read_b128 a[76:79], v2 offset:3072
    v_mfma_f32_16x16x32_bf16 v[160:163], a[96:99], v[84:87], v[160:163]
    v_exp_f32 v112, v68
    v_mfma_f32_16x16x32_bf16 v[164:167], a[100:103], v[84:87], v[164:167]
    buffer_load_dwordx4 v1, s[24:27], s54 offen offset:1024 lds
    v_exp_f32 v113, v69
    v_mfma_f32_16x16x32_bf16 v[168:171], a[104:107], v[84:87], v[168:171]
    ds_read_b128 a[80:83], v2 offset:4096
    v_cvt_pk_bf16_f32 v98, v112, v113
    v_mfma_f32_16x16x32_bf16 v[172:175], a[108:111], v[84:87], v[172:175]
    ds_read_b128 a[84:87], v2 offset:5120
    v_mfma_f32_16x16x32_bf16 v[176:179], a[112:115], v[84:87], v[176:179]
    v_exp_f32 v114, v70
    v_mfma_f32_16x16x32_bf16 v[180:183], a[116:119], v[84:87], v[180:183]
    buffer_load_dwordx4 v1, s[24:27], s54 offen offset:2048 lds
    v_exp_f32 v115, v71
    v_mfma_f32_16x16x32_bf16 v[184:187], a[120:123], v[84:87], v[184:187]
    ds_read_b128 a[88:91], v2 offset:6144
    v_cvt_pk_bf16_f32 v99, v114, v115
    v_mfma_f32_16x16x32_bf16 v[188:191], a[124:127], v[84:87], v[188:191]
    ds_read_b128 a[92:95], v2 offset:7168
    v_mfma_f32_16x16x32_bf16 v[88:91], a[128:131], v[80:83], v[88:91]
    buffer_load_dwordx4 v1, s[24:27], s54 offen offset:3072 lds
    v_mfma_f32_16x16x32_bf16 v[92:95], a[128:131], v[84:87], v[92:95]
    s_add_u32 s54, s54, 16384
    s_waitcnt lgkmcnt(4)
    v_mfma_f32_16x16x32_bf16 v[48:51], a[64:67], a[0:3], v[16:19]
    v_exp_f32 v112, v72
    v_mfma_f32_16x16x32_bf16 v[48:51], a[68:71], a[4:7], v[48:51]
    v_exp_f32 v113, v73
    v_mfma_f32_16x16x32_bf16 v[48:51], a[72:75], a[8:11], v[48:51]
    ds_read_b128 a[96:99], v2 offset:24576
    v_cvt_pk_bf16_f32 v100, v112, v113
    v_mfma_f32_16x16x32_bf16 v[48:51], a[76:79], a[12:15], v[48:51]
    s_waitcnt lgkmcnt(1)
    ds_read_b128 a[100:103], v2 offset:25600
    v_mfma_f32_16x16x32_bf16 v[52:55], a[80:83], a[0:3], v[16:19]
    v_exp_f32 v114, v74
    v_mfma_f32_16x16x32_bf16 v[52:55], a[84:87], a[4:7], v[52:55]
    v_exp_f32 v115, v75
    v_mfma_f32_16x16x32_bf16 v[52:55], a[88:91], a[8:11], v[52:55]
    ds_read_b128 a[104:107], v2 offset:26624
    v_cvt_pk_bf16_f32 v101, v114, v115
    v_mfma_f32_16x16x32_bf16 v[52:55], a[92:95], a[12:15], v[52:55]
    ds_read_b128 a[108:111], v2 offset:27648
    v_mfma_f32_16x16x32_bf16 v[56:59], a[64:67], a[16:19], v[20:23]
    v_exp_f32 v112, v76
    v_mfma_f32_16x16x32_bf16 v[56:59], a[68:71], a[20:23], v[56:59]
    v_exp_f32 v113, v77
    v_mfma_f32_16x16x32_bf16 v[56:59], a[72:75], a[24:27], v[56:59]
    ds_read_b128 a[112:115], v2 offset:28672
    v_cvt_pk_bf16_f32 v102, v112, v113
    v_mfma_f32_16x16x32_bf16 v[56:59], a[76:79], a[28:31], v[56:59]
    ds_read_b128 a[116:119], v2 offset:29696
    v_mfma_f32_16x16x32_bf16 v[60:63], a[80:83], a[16:19], v[20:23]
    v_exp_f32 v114, v78
    v_mfma_f32_16x16x32_bf16 v[60:63], a[84:87], a[20:23], v[60:63]
    v_exp_f32 v115, v79
    v_mfma_f32_16x16x32_bf16 v[60:63], a[88:91], a[24:27], v[60:63]
    ds_read_b128 a[120:123], v2 offset:30720
    v_cvt_pk_bf16_f32 v103, v114, v115
    v_mfma_f32_16x16x32_bf16 v[60:63], a[92:95], a[28:31], v[60:63]
    ds_read_b128 a[124:127], v2 offset:31744
    s_waitcnt lgkmcnt(4)
    v_mfma_f32_16x16x32_bf16 v[128:131], a[96:99], v[96:99], v[128:131]
    v_exp_f32 v112, v48
    v_mfma_f32_16x16x32_bf16 v[132:135], a[100:103], v[96:99], v[132:135]
    v_exp_f32 v113, v49
    v_mfma_f32_16x16x32_bf16 v[136:139], a[104:107], v[96:99], v[136:139]
    s_add_u32 m0, s57, 16384
    ds_read_b128 a[64:67], v2 offset:8192
    v_cvt_pk_bf16_f32 v80, v112, v113
    v_mfma_f32_16x16x32_bf16 v[140:143], a[108:111], v[96:99], v[140:143]
    s_waitcnt lgkmcnt(1)
    s_add_u32 s57, s57, 32768
    ds_read_b128 a[68:71], v2 offset:9216
    v_mfma_f32_16x16x32_bf16 v[144:147], a[112:115], v[96:99], v[144:147]
    s_cmp_ge_u32 s57, 163840
    s_cselect_b32 s57, s50, s57
    v_exp_f32 v114, v50
    v_mfma_f32_16x16x32_bf16 v[148:151], a[116:119], v[96:99], v[148:151]
    buffer_load_dwordx4 v1, s[28:31], s55 offen offset:0 lds
    v_exp_f32 v115, v51
    v_mfma_f32_16x16x32_bf16 v[152:155], a[120:123], v[96:99], v[152:155]
    ds_read_b128 a[72:75], v2 offset:10240
    v_cvt_pk_bf16_f32 v81, v114, v115
    v_mfma_f32_16x16x32_bf16 v[156:159], a[124:127], v[96:99], v[156:159]
    ds_read_b128 a[76:79], v2 offset:11264
    v_mfma_f32_16x16x32_bf16 v[160:163], a[96:99], v[100:103], v[160:163]
    s_add_u32 s58, s58, 32768
    v_exp_f32 v112, v52
    v_mfma_f32_16x16x32_bf16 v[164:167], a[100:103], v[100:103], v[164:167]
    s_cmp_ge_u32 s58, 163840
    s_cselect_b32 s58, 0, s58
    buffer_load_dwordx4 v1, s[28:31], s55 offen offset:1024 lds
    v_exp_f32 v113, v53
    v_mfma_f32_16x16x32_bf16 v[168:171], a[104:107], v[100:103], v[168:171]
    ds_read_b128 a[80:83], v2 offset:12288
    v_cvt_pk_bf16_f32 v82, v112, v113
    v_mfma_f32_16x16x32_bf16 v[172:175], a[108:111], v[100:103], v[172:175]
    ds_read_b128 a[84:87], v2 offset:13312
    v_mfma_f32_16x16x32_bf16 v[176:179], a[112:115], v[100:103], v[176:179]
    v_exp_f32 v114, v54
    v_mfma_f32_16x16x32_bf16 v[180:183], a[116:119], v[100:103], v[180:183]
    buffer_load_dwordx4 v1, s[28:31], s55 offen offset:2048 lds
    v_exp_f32 v115, v55
    v_mfma_f32_16x16x32_bf16 v[184:187], a[120:123], v[100:103], v[184:187]
    ds_read_b128 a[88:91], v2 offset:14336
    v_cvt_pk_bf16_f32 v83, v114, v115
    v_mfma_f32_16x16x32_bf16 v[188:191], a[124:127], v[100:103], v[188:191]
    s_sub_u32 s61, s61, 1
    ds_read_b128 a[92:95], v2 offset:15360
    v_mfma_f32_16x16x32_bf16 v[88:91], a[128:131], v[96:99], v[88:91]
    buffer_load_dwordx4 v1, s[28:31], s55 offen offset:3072 lds
    v_mfma_f32_16x16x32_bf16 v[92:95], a[128:131], v[100:103], v[92:95]
    s_add_u32 s55, s55, 16384
    v_add_u32 v2, s58, v1
    s_cmp_lg_u32 s61, 0
    s_cbranch_scc1 sequential_preLN__compressed_kv_cla__moe_arch_mod__prompt_kernel_sn
    s_sub_u32 s62, -1, s44
    s_waitcnt lgkmcnt(4)
    v_mfma_f32_16x16x32_bf16 v[64:67], a[64:67], a[0:3], v[16:19]
    s_waitcnt vmcnt(16)
    s_barrier
    v_exp_f32 v112, v56
    v_mfma_f32_16x16x32_bf16 v[64:67], a[68:71], a[4:7], v[64:67]
    v_exp_f32 v113, v57
    v_mfma_f32_16x16x32_bf16 v[64:67], a[72:75], a[8:11], v[64:67]
    ds_read_b128 a[96:99], v2 offset:16384
    v_cvt_pk_bf16_f32 v84, v112, v113
    v_mfma_f32_16x16x32_bf16 v[64:67], a[76:79], a[12:15], v[64:67]
    s_waitcnt lgkmcnt(1)
    ds_read_b128 a[100:103], v2 offset:17408
    v_mfma_f32_16x16x32_bf16 v[68:71], a[80:83], a[0:3], v[16:19]
    v_exp_f32 v114, v58
    v_mfma_f32_16x16x32_bf16 v[68:71], a[84:87], a[4:7], v[68:71]
    v_exp_f32 v115, v59
    v_mfma_f32_16x16x32_bf16 v[68:71], a[88:91], a[8:11], v[68:71]
    ds_read_b128 a[104:107], v2 offset:18432
    v_cvt_pk_bf16_f32 v85, v114, v115
    v_mfma_f32_16x16x32_bf16 v[68:71], a[92:95], a[12:15], v[68:71]
    ds_read_b128 a[108:111], v2 offset:19456
    v_mfma_f32_16x16x32_bf16 v[72:75], a[64:67], a[16:19], v[20:23]
    v_exp_f32 v112, v60
    v_mfma_f32_16x16x32_bf16 v[72:75], a[68:71], a[20:23], v[72:75]
    v_exp_f32 v113, v61
    v_mfma_f32_16x16x32_bf16 v[72:75], a[72:75], a[24:27], v[72:75]
    ds_read_b128 a[112:115], v2 offset:20480
    v_cvt_pk_bf16_f32 v86, v112, v113
    v_mfma_f32_16x16x32_bf16 v[72:75], a[76:79], a[28:31], v[72:75]
    ds_read_b128 a[116:119], v2 offset:21504
    v_mfma_f32_16x16x32_bf16 v[76:79], a[80:83], a[16:19], v[20:23]
    v_exp_f32 v114, v62
    v_mfma_f32_16x16x32_bf16 v[76:79], a[84:87], a[20:23], v[76:79]
    v_exp_f32 v115, v63
    v_mfma_f32_16x16x32_bf16 v[76:79], a[88:91], a[24:27], v[76:79]
    ds_read_b128 a[120:123], v2 offset:22528
    v_cvt_pk_bf16_f32 v87, v114, v115
    v_mfma_f32_16x16x32_bf16 v[76:79], a[92:95], a[28:31], v[76:79]
    ds_read_b128 a[124:127], v2 offset:23552
    s_waitcnt lgkmcnt(4)
    v_mfma_f32_16x16x32_bf16 v[128:131], a[96:99], v[80:83], v[128:131]
    s_add_u32 s62, s62, 1
    v_exp_f32 v112, v64
    v_mfma_f32_16x16x32_bf16 v[132:135], a[100:103], v[80:83], v[132:135]
    v_exp_f32 v113, v65
    v_mfma_f32_16x16x32_bf16 v[136:139], a[104:107], v[80:83], v[136:139]
    ds_read_b128 a[64:67], v2 offset:0
    v_cvt_pk_bf16_f32 v96, v112, v113
    v_mfma_f32_16x16x32_bf16 v[140:143], a[108:111], v[80:83], v[140:143]
    s_waitcnt lgkmcnt(1)
    s_cmp_lt_i32 s62, 0
    s_cselect_b64 s[14:15], -1, 0
    s_cmp_eq_u32 s62, 0
    s_cselect_b64 s[4:5], s[36:37], s[14:15]
    s_cselect_b64 s[6:7], s[38:39], s[14:15]
    s_cselect_b64 s[8:9], s[40:41], s[14:15]
    s_cselect_b64 s[10:11], s[42:43], s[14:15]
    ds_read_b128 a[68:71], v2 offset:1024
    v_mfma_f32_16x16x32_bf16 v[144:147], a[112:115], v[80:83], v[144:147]
    s_mov_b32 m0, s57
    v_exp_f32 v114, v66
    v_mfma_f32_16x16x32_bf16 v[148:151], a[116:119], v[80:83], v[148:151]
    buffer_load_dwordx4 v1, s[24:27], s54 offen offset:0 lds
    v_exp_f32 v115, v67
    v_mfma_f32_16x16x32_bf16 v[152:155], a[120:123], v[80:83], v[152:155]
    ds_read_b128 a[72:75], v2 offset:2048
    v_cvt_pk_bf16_f32 v97, v114, v115
    v_mfma_f32_16x16x32_bf16 v[156:159], a[124:127], v[80:83], v[156:159]
    s_cmp_le_i32 s62, 0
    s_cselect_b64 s[12:13], -1, 0
    ds_read_b128 a[76:79], v2 offset:3072
    v_mfma_f32_16x16x32_bf16 v[160:163], a[96:99], v[84:87], v[160:163]
    v_exp_f32 v112, v68
    v_mfma_f32_16x16x32_bf16 v[164:167], a[100:103], v[84:87], v[164:167]
    buffer_load_dwordx4 v1, s[24:27], s54 offen offset:1024 lds
    v_exp_f32 v113, v69
    v_mfma_f32_16x16x32_bf16 v[168:171], a[104:107], v[84:87], v[168:171]
    ds_read_b128 a[80:83], v2 offset:4096
    v_cvt_pk_bf16_f32 v98, v112, v113
    v_mfma_f32_16x16x32_bf16 v[172:175], a[108:111], v[84:87], v[172:175]
    ds_read_b128 a[84:87], v2 offset:5120
    v_cndmask_b32 v32, v3, v16, s[4:5]
    v_mfma_f32_16x16x32_bf16 v[176:179], a[112:115], v[84:87], v[176:179]
    v_exp_f32 v114, v70
    v_mfma_f32_16x16x32_bf16 v[180:183], a[116:119], v[84:87], v[180:183]
    buffer_load_dwordx4 v1, s[24:27], s54 offen offset:2048 lds
    v_exp_f32 v115, v71
    v_mfma_f32_16x16x32_bf16 v[184:187], a[120:123], v[84:87], v[184:187]
    ds_read_b128 a[88:91], v2 offset:6144
    v_cvt_pk_bf16_f32 v99, v114, v115
    v_mfma_f32_16x16x32_bf16 v[188:191], a[124:127], v[84:87], v[188:191]
    ds_read_b128 a[92:95], v2 offset:7168
    v_cndmask_b32 v33, v3, v17, s[6:7]
    v_mfma_f32_16x16x32_bf16 v[88:91], a[128:131], v[80:83], v[88:91]
    buffer_load_dwordx4 v1, s[24:27], s54 offen offset:3072 lds
    v_cndmask_b32 v34, v3, v18, s[8:9]
    v_cndmask_b32 v35, v3, v19, s[10:11]
    v_cndmask_b32 v36, v3, v16, s[14:15]
    v_cndmask_b32 v37, v3, v17, s[14:15]
    v_cndmask_b32 v38, v3, v18, s[14:15]
    v_cndmask_b32 v39, v3, v19, s[14:15]
    v_cndmask_b32 v40, v3, v20, s[12:13]
    v_cndmask_b32 v41, v3, v21, s[12:13]
    v_cndmask_b32 v42, v3, v22, s[12:13]
    v_cndmask_b32 v43, v3, v23, s[12:13]
    v_cndmask_b32 v44, v3, v20, s[4:5]
    v_cndmask_b32 v45, v3, v21, s[6:7]
    v_cndmask_b32 v46, v3, v22, s[8:9]
    v_cndmask_b32 v47, v3, v23, s[10:11]
    v_mfma_f32_16x16x32_bf16 v[92:95], a[128:131], v[84:87], v[92:95]
    s_add_u32 s54, s54, 16384
    s_waitcnt lgkmcnt(4)
    v_mfma_f32_16x16x32_bf16 v[48:51], a[64:67], a[0:3], v[32:35]
    v_exp_f32 v112, v72
    v_mfma_f32_16x16x32_bf16 v[48:51], a[68:71], a[4:7], v[48:51]
    v_exp_f32 v113, v73
    v_mfma_f32_16x16x32_bf16 v[48:51], a[72:75], a[8:11], v[48:51]
    ds_read_b128 a[96:99], v2 offset:24576
    v_cvt_pk_bf16_f32 v100, v112, v113
    v_mfma_f32_16x16x32_bf16 v[48:51], a[76:79], a[12:15], v[48:51]
    s_waitcnt lgkmcnt(1)
    ds_read_b128 a[100:103], v2 offset:25600
    v_mfma_f32_16x16x32_bf16 v[52:55], a[80:83], a[0:3], v[36:39]
    v_exp_f32 v114, v74
    v_mfma_f32_16x16x32_bf16 v[52:55], a[84:87], a[4:7], v[52:55]
    v_exp_f32 v115, v75
    v_mfma_f32_16x16x32_bf16 v[52:55], a[88:91], a[8:11], v[52:55]
    ds_read_b128 a[104:107], v2 offset:26624
    v_cvt_pk_bf16_f32 v101, v114, v115
    v_mfma_f32_16x16x32_bf16 v[52:55], a[92:95], a[12:15], v[52:55]
    ds_read_b128 a[108:111], v2 offset:27648
    v_mfma_f32_16x16x32_bf16 v[56:59], a[64:67], a[16:19], v[40:43]
    v_exp_f32 v112, v76
    v_mfma_f32_16x16x32_bf16 v[56:59], a[68:71], a[20:23], v[56:59]
    v_exp_f32 v113, v77
    v_mfma_f32_16x16x32_bf16 v[56:59], a[72:75], a[24:27], v[56:59]
    ds_read_b128 a[112:115], v2 offset:28672
    v_cvt_pk_bf16_f32 v102, v112, v113
    v_mfma_f32_16x16x32_bf16 v[56:59], a[76:79], a[28:31], v[56:59]
    ds_read_b128 a[116:119], v2 offset:29696
    v_mfma_f32_16x16x32_bf16 v[60:63], a[80:83], a[16:19], v[44:47]
    v_exp_f32 v114, v78
    v_mfma_f32_16x16x32_bf16 v[60:63], a[84:87], a[20:23], v[60:63]
    v_exp_f32 v115, v79
    v_mfma_f32_16x16x32_bf16 v[60:63], a[88:91], a[24:27], v[60:63]
    ds_read_b128 a[120:123], v2 offset:30720
    v_cvt_pk_bf16_f32 v103, v114, v115
    v_mfma_f32_16x16x32_bf16 v[60:63], a[92:95], a[28:31], v[60:63]
    ds_read_b128 a[124:127], v2 offset:31744
    s_waitcnt lgkmcnt(4)
    v_mfma_f32_16x16x32_bf16 v[128:131], a[96:99], v[96:99], v[128:131]
    s_add_u32 s62, s62, 1
    v_exp_f32 v112, v48
    v_mfma_f32_16x16x32_bf16 v[132:135], a[100:103], v[96:99], v[132:135]
    v_exp_f32 v113, v49
    v_mfma_f32_16x16x32_bf16 v[136:139], a[104:107], v[96:99], v[136:139]
    s_add_u32 m0, s57, 16384
    ds_read_b128 a[64:67], v2 offset:8192
    v_cvt_pk_bf16_f32 v80, v112, v113
    v_mfma_f32_16x16x32_bf16 v[140:143], a[108:111], v[96:99], v[140:143]
    s_waitcnt lgkmcnt(1)
    s_add_u32 s57, s57, 32768
    ds_read_b128 a[68:71], v2 offset:9216
    v_mfma_f32_16x16x32_bf16 v[144:147], a[112:115], v[96:99], v[144:147]
    s_cmp_ge_u32 s57, 163840
    s_cselect_b32 s57, s50, s57
    v_exp_f32 v114, v50
    v_mfma_f32_16x16x32_bf16 v[148:151], a[116:119], v[96:99], v[148:151]
    buffer_load_dwordx4 v1, s[28:31], s55 offen offset:0 lds
    v_exp_f32 v115, v51
    v_mfma_f32_16x16x32_bf16 v[152:155], a[120:123], v[96:99], v[152:155]
    ds_read_b128 a[72:75], v2 offset:10240
    v_cvt_pk_bf16_f32 v81, v114, v115
    v_mfma_f32_16x16x32_bf16 v[156:159], a[124:127], v[96:99], v[156:159]
    s_cmp_lt_i32 s62, 0
    s_cselect_b64 s[14:15], -1, 0
    s_cmp_eq_u32 s62, 0
    s_cselect_b64 s[4:5], s[36:37], s[14:15]
    s_cselect_b64 s[6:7], s[38:39], s[14:15]
    s_cselect_b64 s[8:9], s[40:41], s[14:15]
    s_cselect_b64 s[10:11], s[42:43], s[14:15]
    ds_read_b128 a[76:79], v2 offset:11264
    v_mfma_f32_16x16x32_bf16 v[160:163], a[96:99], v[100:103], v[160:163]
    s_add_u32 s58, s58, 32768
    v_exp_f32 v112, v52
    v_mfma_f32_16x16x32_bf16 v[164:167], a[100:103], v[100:103], v[164:167]
    s_cmp_ge_u32 s58, 163840
    s_cselect_b32 s58, 0, s58
    buffer_load_dwordx4 v1, s[28:31], s55 offen offset:1024 lds
    v_exp_f32 v113, v53
    v_mfma_f32_16x16x32_bf16 v[168:171], a[104:107], v[100:103], v[168:171]
    ds_read_b128 a[80:83], v2 offset:12288
    v_cvt_pk_bf16_f32 v82, v112, v113
    v_mfma_f32_16x16x32_bf16 v[172:175], a[108:111], v[100:103], v[172:175]
    s_cmp_le_i32 s62, 0
    s_cselect_b64 s[12:13], -1, 0
    ds_read_b128 a[84:87], v2 offset:13312
    v_mfma_f32_16x16x32_bf16 v[176:179], a[112:115], v[100:103], v[176:179]
    v_exp_f32 v114, v54
    v_mfma_f32_16x16x32_bf16 v[180:183], a[116:119], v[100:103], v[180:183]
    buffer_load_dwordx4 v1, s[28:31], s55 offen offset:2048 lds
    v_exp_f32 v115, v55
    v_mfma_f32_16x16x32_bf16 v[184:187], a[120:123], v[100:103], v[184:187]
    ds_read_b128 a[88:91], v2 offset:14336
    v_cvt_pk_bf16_f32 v83, v114, v115
    v_mfma_f32_16x16x32_bf16 v[188:191], a[124:127], v[100:103], v[188:191]
    ds_read_b128 a[92:95], v2 offset:15360
    v_cndmask_b32 v32, v3, v16, s[4:5]
    v_mfma_f32_16x16x32_bf16 v[88:91], a[128:131], v[96:99], v[88:91]
    buffer_load_dwordx4 v1, s[28:31], s55 offen offset:3072 lds
    v_cndmask_b32 v33, v3, v17, s[6:7]
    v_cndmask_b32 v34, v3, v18, s[8:9]
    v_cndmask_b32 v35, v3, v19, s[10:11]
    v_cndmask_b32 v36, v3, v16, s[14:15]
    v_cndmask_b32 v37, v3, v17, s[14:15]
    v_cndmask_b32 v38, v3, v18, s[14:15]
    v_cndmask_b32 v39, v3, v19, s[14:15]
    v_cndmask_b32 v40, v3, v20, s[12:13]
    v_cndmask_b32 v41, v3, v21, s[12:13]
    v_cndmask_b32 v42, v3, v22, s[12:13]
    v_cndmask_b32 v43, v3, v23, s[12:13]
    v_cndmask_b32 v44, v3, v20, s[4:5]
    v_cndmask_b32 v45, v3, v21, s[6:7]
    v_cndmask_b32 v46, v3, v22, s[8:9]
    v_cndmask_b32 v47, v3, v23, s[10:11]
    v_mfma_f32_16x16x32_bf16 v[92:95], a[128:131], v[100:103], v[92:95]
    s_add_u32 s55, s55, 16384
    v_add_u32 v2, s58, v1
sequential_preLN__compressed_kv_cla__moe_arch_mod__prompt_kernel_sb:
    s_waitcnt lgkmcnt(4)
    v_mfma_f32_16x16x32_bf16 v[64:67], a[64:67], a[0:3], v[32:35]
    s_waitcnt vmcnt(16)
    s_barrier
    v_exp_f32 v112, v56
    v_mfma_f32_16x16x32_bf16 v[64:67], a[68:71], a[4:7], v[64:67]
    v_exp_f32 v113, v57
    v_mfma_f32_16x16x32_bf16 v[64:67], a[72:75], a[8:11], v[64:67]
    ds_read_b128 a[96:99], v2 offset:16384
    v_cvt_pk_bf16_f32 v84, v112, v113
    v_mfma_f32_16x16x32_bf16 v[64:67], a[76:79], a[12:15], v[64:67]
    s_waitcnt lgkmcnt(1)
    ds_read_b128 a[100:103], v2 offset:17408
    v_mfma_f32_16x16x32_bf16 v[68:71], a[80:83], a[0:3], v[36:39]
    v_exp_f32 v114, v58
    v_mfma_f32_16x16x32_bf16 v[68:71], a[84:87], a[4:7], v[68:71]
    v_exp_f32 v115, v59
    v_mfma_f32_16x16x32_bf16 v[68:71], a[88:91], a[8:11], v[68:71]
    ds_read_b128 a[104:107], v2 offset:18432
    v_cvt_pk_bf16_f32 v85, v114, v115
    v_mfma_f32_16x16x32_bf16 v[68:71], a[92:95], a[12:15], v[68:71]
    ds_read_b128 a[108:111], v2 offset:19456
    v_mfma_f32_16x16x32_bf16 v[72:75], a[64:67], a[16:19], v[40:43]
    v_exp_f32 v112, v60
    v_mfma_f32_16x16x32_bf16 v[72:75], a[68:71], a[20:23], v[72:75]
    v_exp_f32 v113, v61
    v_mfma_f32_16x16x32_bf16 v[72:75], a[72:75], a[24:27], v[72:75]
    ds_read_b128 a[112:115], v2 offset:20480
    v_cvt_pk_bf16_f32 v86, v112, v113
    v_mfma_f32_16x16x32_bf16 v[72:75], a[76:79], a[28:31], v[72:75]
    ds_read_b128 a[116:119], v2 offset:21504
    v_mfma_f32_16x16x32_bf16 v[76:79], a[80:83], a[16:19], v[44:47]
    v_exp_f32 v114, v62
    v_mfma_f32_16x16x32_bf16 v[76:79], a[84:87], a[20:23], v[76:79]
    v_exp_f32 v115, v63
    v_mfma_f32_16x16x32_bf16 v[76:79], a[88:91], a[24:27], v[76:79]
    ds_read_b128 a[120:123], v2 offset:22528
    v_cvt_pk_bf16_f32 v87, v114, v115
    v_mfma_f32_16x16x32_bf16 v[76:79], a[92:95], a[28:31], v[76:79]
    ds_read_b128 a[124:127], v2 offset:23552
    s_waitcnt lgkmcnt(4)
    v_mfma_f32_16x16x32_bf16 v[128:131], a[96:99], v[80:83], v[128:131]
    s_add_u32 s62, s62, 1
    v_exp_f32 v112, v64
    v_mfma_f32_16x16x32_bf16 v[132:135], a[100:103], v[80:83], v[132:135]
    v_exp_f32 v113, v65
    v_mfma_f32_16x16x32_bf16 v[136:139], a[104:107], v[80:83], v[136:139]
    ds_read_b128 a[64:67], v2 offset:0
    v_cvt_pk_bf16_f32 v96, v112, v113
    v_mfma_f32_16x16x32_bf16 v[140:143], a[108:111], v[80:83], v[140:143]
    s_waitcnt lgkmcnt(1)
    s_cmp_lt_i32 s62, 0
    s_cselect_b64 s[14:15], -1, 0
    s_cmp_eq_u32 s62, 0
    s_cselect_b64 s[4:5], s[36:37], s[14:15]
    s_cselect_b64 s[6:7], s[38:39], s[14:15]
    s_cselect_b64 s[8:9], s[40:41], s[14:15]
    s_cselect_b64 s[10:11], s[42:43], s[14:15]
    ds_read_b128 a[68:71], v2 offset:1024
    v_mfma_f32_16x16x32_bf16 v[144:147], a[112:115], v[80:83], v[144:147]
    s_mov_b32 m0, s57
    v_exp_f32 v114, v66
    v_mfma_f32_16x16x32_bf16 v[148:151], a[116:119], v[80:83], v[148:151]
    buffer_load_dwordx4 v1, s[24:27], s54 offen offset:0 lds
    v_exp_f32 v115, v67
    v_mfma_f32_16x16x32_bf16 v[152:155], a[120:123], v[80:83], v[152:155]
    ds_read_b128 a[72:75], v2 offset:2048
    v_cvt_pk_bf16_f32 v97, v114, v115
    v_mfma_f32_16x16x32_bf16 v[156:159], a[124:127], v[80:83], v[156:159]
    s_cmp_le_i32 s62, 0
    s_cselect_b64 s[12:13], -1, 0
    ds_read_b128 a[76:79], v2 offset:3072
    v_mfma_f32_16x16x32_bf16 v[160:163], a[96:99], v[84:87], v[160:163]
    v_exp_f32 v112, v68
    v_mfma_f32_16x16x32_bf16 v[164:167], a[100:103], v[84:87], v[164:167]
    buffer_load_dwordx4 v1, s[24:27], s54 offen offset:1024 lds
    v_exp_f32 v113, v69
    v_mfma_f32_16x16x32_bf16 v[168:171], a[104:107], v[84:87], v[168:171]
    ds_read_b128 a[80:83], v2 offset:4096
    v_cvt_pk_bf16_f32 v98, v112, v113
    v_mfma_f32_16x16x32_bf16 v[172:175], a[108:111], v[84:87], v[172:175]
    ds_read_b128 a[84:87], v2 offset:5120
    v_cndmask_b32 v32, v3, v16, s[4:5]
    v_mfma_f32_16x16x32_bf16 v[176:179], a[112:115], v[84:87], v[176:179]
    v_exp_f32 v114, v70
    v_mfma_f32_16x16x32_bf16 v[180:183], a[116:119], v[84:87], v[180:183]
    buffer_load_dwordx4 v1, s[24:27], s54 offen offset:2048 lds
    v_exp_f32 v115, v71
    v_mfma_f32_16x16x32_bf16 v[184:187], a[120:123], v[84:87], v[184:187]
    ds_read_b128 a[88:91], v2 offset:6144
    v_cvt_pk_bf16_f32 v99, v114, v115
    v_mfma_f32_16x16x32_bf16 v[188:191], a[124:127], v[84:87], v[188:191]
    ds_read_b128 a[92:95], v2 offset:7168
    v_cndmask_b32 v33, v3, v17, s[6:7]
    v_mfma_f32_16x16x32_bf16 v[88:91], a[128:131], v[80:83], v[88:91]
    buffer_load_dwordx4 v1, s[24:27], s54 offen offset:3072 lds
    v_cndmask_b32 v34, v3, v18, s[8:9]
    v_cndmask_b32 v35, v3, v19, s[10:11]
    v_cndmask_b32 v36, v3, v16, s[14:15]
    v_cndmask_b32 v37, v3, v17, s[14:15]
    v_cndmask_b32 v38, v3, v18, s[14:15]
    v_cndmask_b32 v39, v3, v19, s[14:15]
    v_cndmask_b32 v40, v3, v20, s[12:13]
    v_cndmask_b32 v41, v3, v21, s[12:13]
    v_cndmask_b32 v42, v3, v22, s[12:13]
    v_cndmask_b32 v43, v3, v23, s[12:13]
    v_cndmask_b32 v44, v3, v20, s[4:5]
    v_cndmask_b32 v45, v3, v21, s[6:7]
    v_cndmask_b32 v46, v3, v22, s[8:9]
    v_cndmask_b32 v47, v3, v23, s[10:11]
    v_mfma_f32_16x16x32_bf16 v[92:95], a[128:131], v[84:87], v[92:95]
    s_add_u32 s54, s54, 16384
    s_waitcnt lgkmcnt(4)
    v_mfma_f32_16x16x32_bf16 v[48:51], a[64:67], a[0:3], v[32:35]
    v_exp_f32 v112, v72
    v_mfma_f32_16x16x32_bf16 v[48:51], a[68:71], a[4:7], v[48:51]
    v_exp_f32 v113, v73
    v_mfma_f32_16x16x32_bf16 v[48:51], a[72:75], a[8:11], v[48:51]
    ds_read_b128 a[96:99], v2 offset:24576
    v_cvt_pk_bf16_f32 v100, v112, v113
    v_mfma_f32_16x16x32_bf16 v[48:51], a[76:79], a[12:15], v[48:51]
    s_waitcnt lgkmcnt(1)
    ds_read_b128 a[100:103], v2 offset:25600
    v_mfma_f32_16x16x32_bf16 v[52:55], a[80:83], a[0:3], v[36:39]
    v_exp_f32 v114, v74
    v_mfma_f32_16x16x32_bf16 v[52:55], a[84:87], a[4:7], v[52:55]
    v_exp_f32 v115, v75
    v_mfma_f32_16x16x32_bf16 v[52:55], a[88:91], a[8:11], v[52:55]
    ds_read_b128 a[104:107], v2 offset:26624
    v_cvt_pk_bf16_f32 v101, v114, v115
    v_mfma_f32_16x16x32_bf16 v[52:55], a[92:95], a[12:15], v[52:55]
    ds_read_b128 a[108:111], v2 offset:27648
    v_mfma_f32_16x16x32_bf16 v[56:59], a[64:67], a[16:19], v[40:43]
    v_exp_f32 v112, v76
    v_mfma_f32_16x16x32_bf16 v[56:59], a[68:71], a[20:23], v[56:59]
    v_exp_f32 v113, v77
    v_mfma_f32_16x16x32_bf16 v[56:59], a[72:75], a[24:27], v[56:59]
    ds_read_b128 a[112:115], v2 offset:28672
    v_cvt_pk_bf16_f32 v102, v112, v113
    v_mfma_f32_16x16x32_bf16 v[56:59], a[76:79], a[28:31], v[56:59]
    ds_read_b128 a[116:119], v2 offset:29696
    v_mfma_f32_16x16x32_bf16 v[60:63], a[80:83], a[16:19], v[44:47]
    v_exp_f32 v114, v78
    v_mfma_f32_16x16x32_bf16 v[60:63], a[84:87], a[20:23], v[60:63]
    v_exp_f32 v115, v79
    v_mfma_f32_16x16x32_bf16 v[60:63], a[88:91], a[24:27], v[60:63]
    ds_read_b128 a[120:123], v2 offset:30720
    v_cvt_pk_bf16_f32 v103, v114, v115
    v_mfma_f32_16x16x32_bf16 v[60:63], a[92:95], a[28:31], v[60:63]
    ds_read_b128 a[124:127], v2 offset:31744
    s_waitcnt lgkmcnt(4)
    v_mfma_f32_16x16x32_bf16 v[128:131], a[96:99], v[96:99], v[128:131]
    s_add_u32 s62, s62, 1
    v_exp_f32 v112, v48
    v_mfma_f32_16x16x32_bf16 v[132:135], a[100:103], v[96:99], v[132:135]
    v_exp_f32 v113, v49
    v_mfma_f32_16x16x32_bf16 v[136:139], a[104:107], v[96:99], v[136:139]
    s_add_u32 m0, s57, 16384
    ds_read_b128 a[64:67], v2 offset:8192
    v_cvt_pk_bf16_f32 v80, v112, v113
    v_mfma_f32_16x16x32_bf16 v[140:143], a[108:111], v[96:99], v[140:143]
    s_waitcnt lgkmcnt(1)
    s_add_u32 s57, s57, 32768
    ds_read_b128 a[68:71], v2 offset:9216
    v_mfma_f32_16x16x32_bf16 v[144:147], a[112:115], v[96:99], v[144:147]
    s_cmp_ge_u32 s57, 163840
    s_cselect_b32 s57, s50, s57
    v_exp_f32 v114, v50
    v_mfma_f32_16x16x32_bf16 v[148:151], a[116:119], v[96:99], v[148:151]
    buffer_load_dwordx4 v1, s[28:31], s55 offen offset:0 lds
    v_exp_f32 v115, v51
    v_mfma_f32_16x16x32_bf16 v[152:155], a[120:123], v[96:99], v[152:155]
    ds_read_b128 a[72:75], v2 offset:10240
    v_cvt_pk_bf16_f32 v81, v114, v115
    v_mfma_f32_16x16x32_bf16 v[156:159], a[124:127], v[96:99], v[156:159]
    s_cmp_lt_i32 s62, 0
    s_cselect_b64 s[14:15], -1, 0
    s_cmp_eq_u32 s62, 0
    s_cselect_b64 s[4:5], s[36:37], s[14:15]
    s_cselect_b64 s[6:7], s[38:39], s[14:15]
    s_cselect_b64 s[8:9], s[40:41], s[14:15]
    s_cselect_b64 s[10:11], s[42:43], s[14:15]
    ds_read_b128 a[76:79], v2 offset:11264
    v_mfma_f32_16x16x32_bf16 v[160:163], a[96:99], v[100:103], v[160:163]
    s_add_u32 s58, s58, 32768
    v_exp_f32 v112, v52
    v_mfma_f32_16x16x32_bf16 v[164:167], a[100:103], v[100:103], v[164:167]
    s_cmp_ge_u32 s58, 163840
    s_cselect_b32 s58, 0, s58
    buffer_load_dwordx4 v1, s[28:31], s55 offen offset:1024 lds
    v_exp_f32 v113, v53
    v_mfma_f32_16x16x32_bf16 v[168:171], a[104:107], v[100:103], v[168:171]
    ds_read_b128 a[80:83], v2 offset:12288
    v_cvt_pk_bf16_f32 v82, v112, v113
    v_mfma_f32_16x16x32_bf16 v[172:175], a[108:111], v[100:103], v[172:175]
    s_cmp_le_i32 s62, 0
    s_cselect_b64 s[12:13], -1, 0
    ds_read_b128 a[84:87], v2 offset:13312
    v_mfma_f32_16x16x32_bf16 v[176:179], a[112:115], v[100:103], v[176:179]
    v_exp_f32 v114, v54
    v_mfma_f32_16x16x32_bf16 v[180:183], a[116:119], v[100:103], v[180:183]
    buffer_load_dwordx4 v1, s[28:31], s55 offen offset:2048 lds
    v_exp_f32 v115, v55
    v_mfma_f32_16x16x32_bf16 v[184:187], a[120:123], v[100:103], v[184:187]
    ds_read_b128 a[88:91], v2 offset:14336
    v_cvt_pk_bf16_f32 v83, v114, v115
    v_mfma_f32_16x16x32_bf16 v[188:191], a[124:127], v[100:103], v[188:191]
    ds_read_b128 a[92:95], v2 offset:15360
    v_cndmask_b32 v32, v3, v16, s[4:5]
    v_mfma_f32_16x16x32_bf16 v[88:91], a[128:131], v[96:99], v[88:91]
    buffer_load_dwordx4 v1, s[28:31], s55 offen offset:3072 lds
    v_cndmask_b32 v33, v3, v17, s[6:7]
    v_cndmask_b32 v34, v3, v18, s[8:9]
    v_cndmask_b32 v35, v3, v19, s[10:11]
    v_cndmask_b32 v36, v3, v16, s[14:15]
    v_cndmask_b32 v37, v3, v17, s[14:15]
    v_cndmask_b32 v38, v3, v18, s[14:15]
    v_cndmask_b32 v39, v3, v19, s[14:15]
    v_cndmask_b32 v40, v3, v20, s[12:13]
    v_cndmask_b32 v41, v3, v21, s[12:13]
    v_cndmask_b32 v42, v3, v22, s[12:13]
    v_cndmask_b32 v43, v3, v23, s[12:13]
    v_cndmask_b32 v44, v3, v20, s[4:5]
    v_cndmask_b32 v45, v3, v21, s[6:7]
    v_cndmask_b32 v46, v3, v22, s[8:9]
    v_cndmask_b32 v47, v3, v23, s[10:11]
    v_mfma_f32_16x16x32_bf16 v[92:95], a[128:131], v[100:103], v[92:95]
    s_add_u32 s55, s55, 16384
    v_add_u32 v2, s58, v1
    s_waitcnt lgkmcnt(4)
    v_mfma_f32_16x16x32_bf16 v[64:67], a[64:67], a[0:3], v[32:35]
    s_waitcnt vmcnt(16)
    s_barrier
    v_exp_f32 v112, v56
    v_mfma_f32_16x16x32_bf16 v[64:67], a[68:71], a[4:7], v[64:67]
    v_exp_f32 v113, v57
    v_mfma_f32_16x16x32_bf16 v[64:67], a[72:75], a[8:11], v[64:67]
    ds_read_b128 a[96:99], v2 offset:16384
    v_cvt_pk_bf16_f32 v84, v112, v113
    v_mfma_f32_16x16x32_bf16 v[64:67], a[76:79], a[12:15], v[64:67]
    s_waitcnt lgkmcnt(1)
    ds_read_b128 a[100:103], v2 offset:17408
    v_mfma_f32_16x16x32_bf16 v[68:71], a[80:83], a[0:3], v[36:39]
    v_exp_f32 v114, v58
    v_mfma_f32_16x16x32_bf16 v[68:71], a[84:87], a[4:7], v[68:71]
    v_exp_f32 v115, v59
    v_mfma_f32_16x16x32_bf16 v[68:71], a[88:91], a[8:11], v[68:71]
    ds_read_b128 a[104:107], v2 offset:18432
    v_cvt_pk_bf16_f32 v85, v114, v115
    v_mfma_f32_16x16x32_bf16 v[68:71], a[92:95], a[12:15], v[68:71]
    ds_read_b128 a[108:111], v2 offset:19456
    v_mfma_f32_16x16x32_bf16 v[72:75], a[64:67], a[16:19], v[40:43]
    v_exp_f32 v112, v60
    v_mfma_f32_16x16x32_bf16 v[72:75], a[68:71], a[20:23], v[72:75]
    v_exp_f32 v113, v61
    v_mfma_f32_16x16x32_bf16 v[72:75], a[72:75], a[24:27], v[72:75]
    ds_read_b128 a[112:115], v2 offset:20480
    v_cvt_pk_bf16_f32 v86, v112, v113
    v_mfma_f32_16x16x32_bf16 v[72:75], a[76:79], a[28:31], v[72:75]
    ds_read_b128 a[116:119], v2 offset:21504
    v_mfma_f32_16x16x32_bf16 v[76:79], a[80:83], a[16:19], v[44:47]
    v_exp_f32 v114, v62
    v_mfma_f32_16x16x32_bf16 v[76:79], a[84:87], a[20:23], v[76:79]
    v_exp_f32 v115, v63
    v_mfma_f32_16x16x32_bf16 v[76:79], a[88:91], a[24:27], v[76:79]
    ds_read_b128 a[120:123], v2 offset:22528
    v_cvt_pk_bf16_f32 v87, v114, v115
    v_mfma_f32_16x16x32_bf16 v[76:79], a[92:95], a[28:31], v[76:79]
    ds_read_b128 a[124:127], v2 offset:23552
    s_waitcnt lgkmcnt(4)
    v_mfma_f32_16x16x32_bf16 v[128:131], a[96:99], v[80:83], v[128:131]
    v_exp_f32 v112, v64
    v_mfma_f32_16x16x32_bf16 v[132:135], a[100:103], v[80:83], v[132:135]
    v_exp_f32 v113, v65
    v_mfma_f32_16x16x32_bf16 v[136:139], a[104:107], v[80:83], v[136:139]
    v_cvt_pk_bf16_f32 v96, v112, v113
    v_mfma_f32_16x16x32_bf16 v[140:143], a[108:111], v[80:83], v[140:143]
    s_waitcnt lgkmcnt(0)
    v_mfma_f32_16x16x32_bf16 v[144:147], a[112:115], v[80:83], v[144:147]
    s_mov_b32 m0, s57
    v_exp_f32 v114, v66
    v_mfma_f32_16x16x32_bf16 v[148:151], a[116:119], v[80:83], v[148:151]
    buffer_load_dwordx4 v1, s[24:27], s54 offen offset:0 lds
    v_exp_f32 v115, v67
    v_mfma_f32_16x16x32_bf16 v[152:155], a[120:123], v[80:83], v[152:155]
    v_cvt_pk_bf16_f32 v97, v114, v115
    v_mfma_f32_16x16x32_bf16 v[156:159], a[124:127], v[80:83], v[156:159]
    v_mfma_f32_16x16x32_bf16 v[160:163], a[96:99], v[84:87], v[160:163]
    v_exp_f32 v112, v68
    v_mfma_f32_16x16x32_bf16 v[164:167], a[100:103], v[84:87], v[164:167]
    buffer_load_dwordx4 v1, s[24:27], s54 offen offset:1024 lds
    v_exp_f32 v113, v69
    v_mfma_f32_16x16x32_bf16 v[168:171], a[104:107], v[84:87], v[168:171]
    v_cvt_pk_bf16_f32 v98, v112, v113
    v_mfma_f32_16x16x32_bf16 v[172:175], a[108:111], v[84:87], v[172:175]
    v_mfma_f32_16x16x32_bf16 v[176:179], a[112:115], v[84:87], v[176:179]
    v_exp_f32 v114, v70
    v_mfma_f32_16x16x32_bf16 v[180:183], a[116:119], v[84:87], v[180:183]
    buffer_load_dwordx4 v1, s[24:27], s54 offen offset:2048 lds
    v_exp_f32 v115, v71
    v_mfma_f32_16x16x32_bf16 v[184:187], a[120:123], v[84:87], v[184:187]
    v_cvt_pk_bf16_f32 v99, v114, v115
    v_mfma_f32_16x16x32_bf16 v[188:191], a[124:127], v[84:87], v[188:191]
    v_mfma_f32_16x16x32_bf16 v[88:91], a[128:131], v[80:83], v[88:91]
    buffer_load_dwordx4 v1, s[24:27], s54 offen offset:3072 lds
    v_mfma_f32_16x16x32_bf16 v[92:95], a[128:131], v[84:87], v[92:95]
    s_add_u32 s54, s54, 16384
    ds_read_b128 a[96:99], v2 offset:24576
    ds_read_b128 a[100:103], v2 offset:25600
    ds_read_b128 a[104:107], v2 offset:26624
    ds_read_b128 a[108:111], v2 offset:27648
    ds_read_b128 a[112:115], v2 offset:28672
    ds_read_b128 a[116:119], v2 offset:29696
    ds_read_b128 a[120:123], v2 offset:30720
    ds_read_b128 a[124:127], v2 offset:31744
    s_add_u32 m0, s57, 16384
    s_add_u32 s57, s57, 32768
    s_cmp_ge_u32 s57, 163840
    s_cselect_b32 s57, s50, s57
    buffer_load_dwordx4 v1, s[28:31], s55 offen offset:0 lds
    buffer_load_dwordx4 v1, s[28:31], s55 offen offset:1024 lds
    buffer_load_dwordx4 v1, s[28:31], s55 offen offset:2048 lds
    buffer_load_dwordx4 v1, s[28:31], s55 offen offset:3072 lds
    s_add_u32 s55, s55, 16384
    v_exp_f32 v112, v72
    s_nop 0
    v_exp_f32 v113, v73
    s_nop 0
    v_cvt_pk_bf16_f32 v100, v112, v113
    v_exp_f32 v114, v74
    s_nop 0
    v_exp_f32 v115, v75
    s_nop 0
    v_cvt_pk_bf16_f32 v101, v114, v115
    v_exp_f32 v112, v76
    s_nop 0
    v_exp_f32 v113, v77
    s_nop 0
    v_cvt_pk_bf16_f32 v102, v112, v113
    v_exp_f32 v114, v78
    s_nop 0
    v_exp_f32 v115, v79
    s_nop 0
    v_cvt_pk_bf16_f32 v103, v114, v115
    s_waitcnt lgkmcnt(0)
    s_nop 1
    v_mfma_f32_16x16x32_bf16 v[128:131], a[96:99], v[96:99], v[128:131]
    v_mfma_f32_16x16x32_bf16 v[132:135], a[100:103], v[96:99], v[132:135]
    v_mfma_f32_16x16x32_bf16 v[136:139], a[104:107], v[96:99], v[136:139]
    v_mfma_f32_16x16x32_bf16 v[140:143], a[108:111], v[96:99], v[140:143]
    v_mfma_f32_16x16x32_bf16 v[144:147], a[112:115], v[96:99], v[144:147]
    v_mfma_f32_16x16x32_bf16 v[148:151], a[116:119], v[96:99], v[148:151]
    v_mfma_f32_16x16x32_bf16 v[152:155], a[120:123], v[96:99], v[152:155]
    v_mfma_f32_16x16x32_bf16 v[156:159], a[124:127], v[96:99], v[156:159]
    v_mfma_f32_16x16x32_bf16 v[160:163], a[96:99], v[100:103], v[160:163]
    v_mfma_f32_16x16x32_bf16 v[164:167], a[100:103], v[100:103], v[164:167]
    v_mfma_f32_16x16x32_bf16 v[168:171], a[104:107], v[100:103], v[168:171]
    v_mfma_f32_16x16x32_bf16 v[172:175], a[108:111], v[100:103], v[172:175]
    v_mfma_f32_16x16x32_bf16 v[176:179], a[112:115], v[100:103], v[176:179]
    v_mfma_f32_16x16x32_bf16 v[180:183], a[116:119], v[100:103], v[180:183]
    v_mfma_f32_16x16x32_bf16 v[184:187], a[120:123], v[100:103], v[184:187]
    v_mfma_f32_16x16x32_bf16 v[188:191], a[124:127], v[100:103], v[188:191]
    v_mfma_f32_16x16x32_bf16 v[88:91], a[128:131], v[96:99], v[88:91]
    v_mfma_f32_16x16x32_bf16 v[92:95], a[128:131], v[100:103], v[92:95]
    s_nop 7
    v_mov_b32 v120, v116
    s_nop 1
    v_permlane16_swap_b32 v116, v120
    s_nop 1
    v_add_f32 v116, v116, v120
    v_mov_b32 v120, v116
    s_nop 1
    v_permlane32_swap_b32 v116, v120
    s_nop 1
    v_add_f32 v116, v116, v120
    v_mov_b32 v120, v117
    s_nop 1
    v_permlane16_swap_b32 v117, v120
    s_nop 1
    v_add_f32 v117, v117, v120
    v_mov_b32 v120, v117
    s_nop 1
    v_permlane32_swap_b32 v117, v120
    s_nop 1
    v_add_f32 v117, v117, v120
    v_add_f32 v116, v116, v88
    v_add_f32 v117, v117, v92
    v_max_f32 v120, v116, v117
    v_cmp_nge_f32 vcc, s65, v120
    s_nop 1
    s_cmp_lg_u64 vcc, 0
    s_cselect_b32 s47, 1, 0
    s_or_b32 s63, s63, s47
    v_rcp_f32 v116, v116
    v_rcp_f32 v117, v117
    s_lshl_b32 s64, s59, 3
    s_lshl_b32 s47, s44, 1
    s_add_u32 s64, s64, s47
    s_lshl_b32 s64, s64, 5
    s_add_u32 s64, s64, s45
    s_lshl_b32 s64, s64, 12
    s_add_u32 s48, s64, 131072
    v_mul_f32 v128, v128, v116
    v_mul_f32 v129, v129, v116
    v_mul_f32 v130, v130, v116
    v_mul_f32 v131, v131, v116
    v_mul_f32 v132, v132, v116
    v_mul_f32 v133, v133, v116
    v_mul_f32 v134, v134, v116
    v_mul_f32 v135, v135, v116
    v_cvt_pk_bf16_f32 v128, v128, v129
    v_cvt_pk_bf16_f32 v129, v130, v131
    v_cvt_pk_bf16_f32 v130, v132, v133
    v_cvt_pk_bf16_f32 v131, v134, v135
    buffer_store_dwordx4 v[128:131], v1, s[32:35], s64 offen offset:0 sc1
    v_mul_f32 v136, v136, v116
    v_mul_f32 v137, v137, v116
    v_mul_f32 v138, v138, v116
    v_mul_f32 v139, v139, v116
    v_mul_f32 v140, v140, v116
    v_mul_f32 v141, v141, v116
    v_mul_f32 v142, v142, v116
    v_mul_f32 v143, v143, v116
    v_cvt_pk_bf16_f32 v136, v136, v137
    v_cvt_pk_bf16_f32 v137, v138, v139
    v_cvt_pk_bf16_f32 v138, v140, v141
    v_cvt_pk_bf16_f32 v139, v142, v143
    buffer_store_dwordx4 v[136:139], v1, s[32:35], s64 offen offset:1024 sc1
    v_mul_f32 v144, v144, v116
    v_mul_f32 v145, v145, v116
    v_mul_f32 v146, v146, v116
    v_mul_f32 v147, v147, v116
    v_mul_f32 v148, v148, v116
    v_mul_f32 v149, v149, v116
    v_mul_f32 v150, v150, v116
    v_mul_f32 v151, v151, v116
    v_cvt_pk_bf16_f32 v144, v144, v145
    v_cvt_pk_bf16_f32 v145, v146, v147
    v_cvt_pk_bf16_f32 v146, v148, v149
    v_cvt_pk_bf16_f32 v147, v150, v151
    buffer_store_dwordx4 v[144:147], v1, s[32:35], s64 offen offset:2048 sc1
    v_mul_f32 v152, v152, v116
    v_mul_f32 v153, v153, v116
    v_mul_f32 v154, v154, v116
    v_mul_f32 v155, v155, v116
    v_mul_f32 v156, v156, v116
    v_mul_f32 v157, v157, v116
    v_mul_f32 v158, v158, v116
    v_mul_f32 v159, v159, v116
    v_cvt_pk_bf16_f32 v152, v152, v153
    v_cvt_pk_bf16_f32 v153, v154, v155
    v_cvt_pk_bf16_f32 v154, v156, v157
    v_cvt_pk_bf16_f32 v155, v158, v159
    buffer_store_dwordx4 v[152:155], v1, s[32:35], s64 offen offset:3072 sc1
    v_mul_f32 v160, v160, v117
    v_mul_f32 v161, v161, v117
    v_mul_f32 v162, v162, v117
    v_mul_f32 v163, v163, v117
    v_mul_f32 v164, v164, v117
    v_mul_f32 v165, v165, v117
    v_mul_f32 v166, v166, v117
    v_mul_f32 v167, v167, v117
    v_cvt_pk_bf16_f32 v160, v160, v161
    v_cvt_pk_bf16_f32 v161, v162, v163
    v_cvt_pk_bf16_f32 v162, v164, v165
    v_cvt_pk_bf16_f32 v163, v166, v167
    buffer_store_dwordx4 v[160:163], v1, s[32:35], s48 offen offset:0 sc1
    v_mul_f32 v168, v168, v117
    v_mul_f32 v169, v169, v117
    v_mul_f32 v170, v170, v117
    v_mul_f32 v171, v171, v117
    v_mul_f32 v172, v172, v117
    v_mul_f32 v173, v173, v117
    v_mul_f32 v174, v174, v117
    v_mul_f32 v175, v175, v117
    v_cvt_pk_bf16_f32 v168, v168, v169
    v_cvt_pk_bf16_f32 v169, v170, v171
    v_cvt_pk_bf16_f32 v170, v172, v173
    v_cvt_pk_bf16_f32 v171, v174, v175
    buffer_store_dwordx4 v[168:171], v1, s[32:35], s48 offen offset:1024 sc1
    v_mul_f32 v176, v176, v117
    v_mul_f32 v177, v177, v117
    v_mul_f32 v178, v178, v117
    v_mul_f32 v179, v179, v117
    v_mul_f32 v180, v180, v117
    v_mul_f32 v181, v181, v117
    v_mul_f32 v182, v182, v117
    v_mul_f32 v183, v183, v117
    v_cvt_pk_bf16_f32 v176, v176, v177
    v_cvt_pk_bf16_f32 v177, v178, v179
    v_cvt_pk_bf16_f32 v178, v180, v181
    v_cvt_pk_bf16_f32 v179, v182, v183
    buffer_store_dwordx4 v[176:179], v1, s[32:35], s48 offen offset:2048 sc1
    v_mul_f32 v184, v184, v117
    v_mul_f32 v185, v185, v117
    v_mul_f32 v186, v186, v117
    v_mul_f32 v187, v187, v117
    v_mul_f32 v188, v188, v117
    v_mul_f32 v189, v189, v117
    v_mul_f32 v190, v190, v117
    v_mul_f32 v191, v191, v117
    v_cvt_pk_bf16_f32 v184, v184, v185
    v_cvt_pk_bf16_f32 v185, v186, v187
    v_cvt_pk_bf16_f32 v186, v188, v189
    v_cvt_pk_bf16_f32 v187, v190, v191
    buffer_store_dwordx4 v[184:187], v1, s[32:35], s48 offen offset:3072 sc1
    s_cmp_eq_u32 s63, 0
    s_cbranch_scc1 sequential_preLN__compressed_kv_cla__moe_arch_mod__prompt_kernel_fin
    s_waitcnt vmcnt(0) lgkmcnt(0)
    s_and_b32 s47, s63, 2
    s_cmp_eq_u32 s47, 0
    s_cbranch_scc1 sequential_preLN__compressed_kv_cla__moe_arch_mod__prompt_kernel_fbskipS
    v_mov_b32 v118, 0
    v_mov_b32 v192, 0
    v_mov_b32 v193, 0
    v_mov_b32 v194, 0
    v_mov_b32 v195, 0
    v_mov_b32 v196, 0
    v_mov_b32 v197, 0
    v_mov_b32 v198, 0
    v_mov_b32 v199, 0
    v_mov_b32 v200, 0
    v_mov_b32 v201, 0
    v_mov_b32 v202, 0
    v_mov_b32 v203, 0
    v_mov_b32 v204, 0
    v_mov_b32 v205, 0
    v_mov_b32 v206, 0
    v_mov_b32 v207, 0
    v_mov_b32 v208, 0
    v_mov_b32 v209, 0
    v_mov_b32 v210, 0
    v_mov_b32 v211, 0
    v_mov_b32 v212, 0
    v_mov_b32 v213, 0
    v_mov_b32 v214, 0
    v_mov_b32 v215, 0
    v_mov_b32 v216, 0
    v_mov_b32 v217, 0
    v_mov_b32 v218, 0
    v_mov_b32 v219, 0
    v_mov_b32 v220, 0
    v_mov_b32 v221, 0
    v_mov_b32 v222, 0
    v_mov_b32 v223, 0
    v_mov_b32 v24, 0
    v_mov_b32 v25, 0
    v_mov_b32 v26, 0
    v_mov_b32 v27, 0
    v_mov_b32 v119, 0
    v_mov_b32 v224, 0
    v_mov_b32 v225, 0
    v_mov_b32 v226, 0
    v_mov_b32 v227, 0
    v_mov_b32 v228, 0
    v_mov_b32 v229, 0
    v_mov_b32 v230, 0
    v_mov_b32 v231, 0
    v_mov_b32 v232, 0
    v_mov_b32 v233, 0
    v_mov_b32 v234, 0
    v_mov_b32 v235, 0
    v_mov_b32 v236, 0
    v_mov_b32 v237, 0
    v_mov_b32 v238, 0
    v_mov_b32 v239, 0
    v_mov_b32 v240, 0
    v_mov_b32 v241, 0
    v_mov_b32 v242, 0
    v_mov_b32 v243, 0
    v_mov_b32 v244, 0
    v_mov_b32 v245, 0
    v_mov_b32 v246, 0
    v_mov_b32 v247, 0
    v_mov_b32 v248, 0
    v_mov_b32 v249, 0
    v_mov_b32 v250, 0
    v_mov_b32 v251, 0
    v_mov_b32 v252, 0
    v_mov_b32 v253, 0
    v_mov_b32 v254, 0
    v_mov_b32 v255, 0
    v_mov_b32 v28, 0
    v_mov_b32 v29, 0
    v_mov_b32 v30, 0
    v_mov_b32 v31, 0
    v_mov_b32 v124, v3
    v_mov_b32 v125, v3
    s_lshl_b32 s62, s60, 2
    s_add_u32 s62, s62, s44
    s_add_u32 s61, s62, 1
    s_sub_u32 s62, 0, s62
    s_lshl_b32 s49, s45, 19
sequential_preLN__compressed_kv_cla__moe_arch_mod__prompt_kernel_fbS_fbloop:
    s_add_u32 s48, s49, 0
    buffer_load_dwordx4 a[64:67], v1, s[24:27], s48 offen offset:0
    buffer_load_dwordx4 a[96:99], v1, s[28:31], s48 offen offset:0
    s_add_u32 s48, s49, 0
    buffer_load_dwordx4 a[68:71], v1, s[24:27], s48 offen offset:1024
    buffer_load_dwordx4 a[100:103], v1, s[28:31], s48 offen offset:1024
    s_add_u32 s48, s49, 0
    buffer_load_dwordx4 a[72:75], v1, s[24:27], s48 offen offset:2048
    buffer_load_dwordx4 a[104:107], v1, s[28:31], s48 offen offset:2048
    s_add_u32 s48, s49, 0
    buffer_load_dwordx4 a[76:79], v1, s[24:27], s48 offen offset:3072
    buffer_load_dwordx4 a[108:111], v1, s[28:31], s48 offen offset:3072
    s_add_u32 s48, s49, 4096
    buffer_load_dwordx4 a[80:83], v1, s[24:27], s48 offen offset:0
    buffer_load_dwordx4 a[112:115], v1, s[28:31], s48 offen offset:0
    s_add_u32 s48, s49, 4096
    buffer_load_dwordx4 a[84:87], v1, s[24:27], s48 offen offset:1024
    buffer_load_dwordx4 a[116:119], v1, s[28:31], s48 offen offset:1024
    s_add_u32 s48, s49, 4096
    buffer_load_dwordx4 a[88:91], v1, s[24:27], s48 offen offset:2048
    buffer_load_dwordx4 a[120:123], v1, s[28:31], s48 offen offset:2048
    s_add_u32 s48, s49, 4096
    buffer_load_dwordx4 a[92:95], v1, s[24:27], s48 offen offset:3072
    buffer_load_dwordx4 a[124:127], v1, s[28:31], s48 offen offset:3072
    s_cmp_lt_i32 s62, 0
    s_cselect_b64 s[14:15], -1, 0
    s_cmp_eq_u32 s62, 0
    s_cselect_b64 s[4:5], s[36:37], s[14:15]
    s_cselect_b64 s[6:7], s[38:39], s[14:15]
    s_cselect_b64 s[8:9], s[40:41], s[14:15]
    s_cselect_b64 s[10:11], s[42:43], s[14:15]
    s_cmp_le_i32 s62, 0
    s_cselect_b64 s[12:13], -1, 0
    v_cndmask_b32 v32, v3, v24, s[4:5]
    v_cndmask_b32 v33, v3, v25, s[6:7]
    v_cndmask_b32 v34, v3, v26, s[8:9]
    v_cndmask_b32 v35, v3, v27, s[10:11]
    v_cndmask_b32 v36, v3, v24, s[14:15]
    v_cndmask_b32 v37, v3, v25, s[14:15]
    v_cndmask_b32 v38, v3, v26, s[14:15]
    v_cndmask_b32 v39, v3, v27, s[14:15]
    v_cndmask_b32 v40, v3, v28, s[12:13]
    v_cndmask_b32 v41, v3, v29, s[12:13]
    v_cndmask_b32 v42, v3, v30, s[12:13]
    v_cndmask_b32 v43, v3, v31, s[12:13]
    v_cndmask_b32 v44, v3, v28, s[4:5]
    v_cndmask_b32 v45, v3, v29, s[6:7]
    v_cndmask_b32 v46, v3, v30, s[8:9]
    v_cndmask_b32 v47, v3, v31, s[10:11]
    s_waitcnt vmcnt(0)
    s_nop 1
    v_mfma_f32_16x16x32_bf16 v[48:51], a[64:67], a[32:35], v[32:35]
    v_mfma_f32_16x16x32_bf16 v[48:51], a[68:71], a[36:39], v[48:51]
    v_mfma_f32_16x16x32_bf16 v[48:51], a[72:75], a[40:43], v[48:51]
    v_mfma_f32_16x16x32_bf16 v[48:51], a[76:79], a[44:47], v[48:51]
    v_mfma_f32_16x16x32_bf16 v[52:55], a[80:83], a[32:35], v[36:39]
    v_mfma_f32_16x16x32_bf16 v[52:55], a[84:87], a[36:39], v[52:55]
    v_mfma_f32_16x16x32_bf16 v[52:55], a[88:91], a[40:43], v[52:55]
    v_mfma_f32_16x16x32_bf16 v[52:55], a[92:95], a[44:47], v[52:55]
    v_mfma_f32_16x16x32_bf16 v[56:59], a[64:67], a[48:51], v[40:43]
    v_mfma_f32_16x16x32_bf16 v[56:59], a[68:71], a[52:55], v[56:59]
    v_mfma_f32_16x16x32_bf16 v[56:59], a[72:75], a[56:59], v[56:59]
    v_mfma_f32_16x16x32_bf16 v[56:59], a[76:79], a[60:63], v[56:59]
    v_mfma_f32_16x16x32_bf16 v[60:63], a[80:83], a[48:51], v[44:47]
    v_mfma_f32_16x16x32_bf16 v[60:63], a[84:87], a[52:55], v[60:63]
    v_mfma_f32_16x16x32_bf16 v[60:63], a[88:91], a[56:59], v[60:63]
    v_mfma_f32_16x16x32_bf16 v[60:63], a[92:95], a[60:63], v[60:63]
    s_nop 7
    v_max3_f32 v120, v48, v49, v50
    v_max3_f32 v120, v120, v51, v52
    v_max3_f32 v120, v120, v53, v54
    v_max_f32 v120, v120, v55
    v_mov_b32 v126, v120
    s_nop 1
    v_permlane16_swap_b32 v120, v126
    s_nop 1
    v_max_f32 v120, v120, v126
    v_mov_b32 v126, v120
    s_nop 1
    v_permlane32_swap_b32 v120, v126
    s_nop 1
    v_max_f32 v120, v120, v126
    v_max_f32 v120, v120, v124
    v_sub_f32 v126, v124, v120
    v_exp_f32 v126, v126
    v_mov_b32 v124, v120
    v_mul_f32 v118, v118, v126
    v_mul_f32 v192, v192, v126
    v_mul_f32 v193, v193, v126
    v_mul_f32 v194, v194, v126
    v_mul_f32 v195, v195, v126
    v_mul_f32 v196, v196, v126
    v_mul_f32 v197, v197, v126
    v_mul_f32 v198, v198, v126
    v_mul_f32 v199, v199, v126
    v_mul_f32 v200, v200, v126
    v_mul_f32 v201, v201, v126
    v_mul_f32 v202, v202, v126
    v_mul_f32 v203, v203, v126
    v_mul_f32 v204, v204, v126
    v_mul_f32 v205, v205, v126
    v_mul_f32 v206, v206, v126
    v_mul_f32 v207, v207, v126
    v_mul_f32 v208, v208, v126
    v_mul_f32 v209, v209, v126
    v_mul_f32 v210, v210, v126
    v_mul_f32 v211, v211, v126
    v_mul_f32 v212, v212, v126
    v_mul_f32 v213, v213, v126
    v_mul_f32 v214, v214, v126
    v_mul_f32 v215, v215, v126
    v_mul_f32 v216, v216, v126
    v_mul_f32 v217, v217, v126
    v_mul_f32 v218, v218, v126
    v_mul_f32 v219, v219, v126
    v_mul_f32 v220, v220, v126
    v_mul_f32 v221, v221, v126
    v_mul_f32 v222, v222, v126
    v_mul_f32 v223, v223, v126
    v_sub_f32 v48, v48, v120
    v_sub_f32 v49, v49, v120
    v_sub_f32 v50, v50, v120
    v_sub_f32 v51, v51, v120
    v_sub_f32 v52, v52, v120
    v_sub_f32 v53, v53, v120
    v_sub_f32 v54, v54, v120
    v_sub_f32 v55, v55, v120
    v_exp_f32 v48, v48
    v_exp_f32 v49, v49
    v_exp_f32 v50, v50
    v_exp_f32 v51, v51
    v_exp_f32 v52, v52
    v_exp_f32 v53, v53
    v_exp_f32 v54, v54
    v_exp_f32 v55, v55
    s_nop 0
    v_add_f32 v118, v118, v48
    v_add_f32 v118, v118, v49
    v_add_f32 v118, v118, v50
    v_add_f32 v118, v118, v51
    v_add_f32 v118, v118, v52
    v_add_f32 v118, v118, v53
    v_add_f32 v118, v118, v54
    v_add_f32 v118, v118, v55
    v_cvt_pk_bf16_f32 v88, v48, v49
    v_cvt_pk_bf16_f32 v89, v50, v51
    v_cvt_pk_bf16_f32 v90, v52, v53
    v_cvt_pk_bf16_f32 v91, v54, v55
    v_max3_f32 v121, v56, v57, v58
    v_max3_f32 v121, v121, v59, v60
    v_max3_f32 v121, v121, v61, v62
    v_max_f32 v121, v121, v63
    v_mov_b32 v126, v121
    s_nop 1
    v_permlane16_swap_b32 v121, v126
    s_nop 1
    v_max_f32 v121, v121, v126
    v_mov_b32 v126, v121
    s_nop 1
    v_permlane32_swap_b32 v121, v126
    s_nop 1
    v_max_f32 v121, v121, v126
    v_max_f32 v121, v121, v125
    v_sub_f32 v126, v125, v121
    v_exp_f32 v126, v126
    v_mov_b32 v125, v121
    v_mul_f32 v119, v119, v126
    v_mul_f32 v224, v224, v126
    v_mul_f32 v225, v225, v126
    v_mul_f32 v226, v226, v126
    v_mul_f32 v227, v227, v126
    v_mul_f32 v228, v228, v126
    v_mul_f32 v229, v229, v126
    v_mul_f32 v230, v230, v126
    v_mul_f32 v231, v231, v126
    v_mul_f32 v232, v232, v126
    v_mul_f32 v233, v233, v126
    v_mul_f32 v234, v234, v126
    v_mul_f32 v235, v235, v126
    v_mul_f32 v236, v236, v126
    v_mul_f32 v237, v237, v126
    v_mul_f32 v238, v238, v126
    v_mul_f32 v239, v239, v126
    v_mul_f32 v240, v240, v126
    v_mul_f32 v241, v241, v126
    v_mul_f32 v242, v242, v126
    v_mul_f32 v243, v243, v126
    v_mul_f32 v244, v244, v126
    v_mul_f32 v245, v245, v126
    v_mul_f32 v246, v246, v126
    v_mul_f32 v247, v247, v126
    v_mul_f32 v248, v248, v126
    v_mul_f32 v249, v249, v126
    v_mul_f32 v250, v250, v126
    v_mul_f32 v251, v251, v126
    v_mul_f32 v252, v252, v126
    v_mul_f32 v253, v253, v126
    v_mul_f32 v254, v254, v126
    v_mul_f32 v255, v255, v126
    v_sub_f32 v56, v56, v121
    v_sub_f32 v57, v57, v121
    v_sub_f32 v58, v58, v121
    v_sub_f32 v59, v59, v121
    v_sub_f32 v60, v60, v121
    v_sub_f32 v61, v61, v121
    v_sub_f32 v62, v62, v121
    v_sub_f32 v63, v63, v121
    v_exp_f32 v56, v56
    v_exp_f32 v57, v57
    v_exp_f32 v58, v58
    v_exp_f32 v59, v59
    v_exp_f32 v60, v60
    v_exp_f32 v61, v61
    v_exp_f32 v62, v62
    v_exp_f32 v63, v63
    s_nop 0
    v_add_f32 v119, v119, v56
    v_add_f32 v119, v119, v57
    v_add_f32 v119, v119, v58
    v_add_f32 v119, v119, v59
    v_add_f32 v119, v119, v60
    v_add_f32 v119, v119, v61
    v_add_f32 v119, v119, v62
    v_add_f32 v119, v119, v63
    v_cvt_pk_bf16_f32 v92, v56, v57
    v_cvt_pk_bf16_f32 v93, v58, v59
    v_cvt_pk_bf16_f32 v94, v60, v61
    v_cvt_pk_bf16_f32 v95, v62, v63
    s_nop 1
    v_mfma_f32_16x16x32_bf16 v[192:195], a[96:99], v[88:91], v[192:195]
    v_mfma_f32_16x16x32_bf16 v[196:199], a[100:103], v[88:91], v[196:199]
    v_mfma_f32_16x16x32_bf16 v[200:203], a[104:107], v[88:91], v[200:203]
    v_mfma_f32_16x16x32_bf16 v[204:207], a[108:111], v[88:91], v[204:207]
    v_mfma_f32_16x16x32_bf16 v[208:211], a[112:115], v[88:91], v[208:211]
    v_mfma_f32_16x16x32_bf16 v[212:215], a[116:119], v[88:91], v[212:215]
    v_mfma_f32_16x16x32_bf16 v[216:219], a[120:123], v[88:91], v[216:219]
    v_mfma_f32_16x16x32_bf16 v[220:223], a[124:127], v[88:91], v[220:223]
    v_mfma_f32_16x16x32_bf16 v[224:227], a[96:99], v[92:95], v[224:227]
    v_mfma_f32_16x16x32_bf16 v[228:231], a[100:103], v[92:95], v[228:231]
    v_mfma_f32_16x16x32_bf16 v[232:235], a[104:107], v[92:95], v[232:235]
    v_mfma_f32_16x16x32_bf16 v[236:239], a[108:111], v[92:95], v[236:239]
    v_mfma_f32_16x16x32_bf16 v[240:243], a[112:115], v[92:95], v[240:243]
    v_mfma_f32_16x16x32_bf16 v[244:247], a[116:119], v[92:95], v[244:247]
    v_mfma_f32_16x16x32_bf16 v[248:251], a[120:123], v[92:95], v[248:251]
    v_mfma_f32_16x16x32_bf16 v[252:255], a[124:127], v[92:95], v[252:255]
    s_nop 7
    s_add_u32 s49, s49, 8192
    s_add_u32 s62, s62, 1
    s_sub_u32 s61, s61, 1
    s_cmp_lg_u32 s61, 0
    s_cbranch_scc1 sequential_preLN__compressed_kv_cla__moe_arch_mod__prompt_kernel_fbS_fbloop
    v_mov_b32 v120, v118
    s_nop 1
    v_permlane16_swap_b32 v118, v120
    s_nop 1
    v_add_f32 v118, v118, v120
    v_mov_b32 v120, v118
    s_nop 1
    v_permlane32_swap_b32 v118, v120
    s_nop 1
    v_add_f32 v118, v118, v120
    v_mov_b32 v120, v119
    s_nop 1
    v_permlane16_swap_b32 v119, v120
    s_nop 1
    v_add_f32 v119, v119, v120
    v_mov_b32 v120, v119
    s_nop 1
    v_permlane32_swap_b32 v119, v120
    s_nop 1
    v_add_f32 v119, v119, v120
    v_rcp_f32 v118, v118
    v_rcp_f32 v119, v119
    s_lshl_b32 s64, s60, 3
    s_lshl_b32 s47, s44, 1
    s_add_u32 s64, s64, s47
    s_lshl_b32 s64, s64, 5
    s_add_u32 s64, s64, s45
    s_lshl_b32 s64, s64, 12
    s_add_u32 s48, s64, 131072
    v_mul_f32 v192, v192, v118
    v_mul_f32 v193, v193, v118
    v_mul_f32 v194, v194, v118
    v_mul_f32 v195, v195, v118
    v_mul_f32 v196, v196, v118
    v_mul_f32 v197, v197, v118
    v_mul_f32 v198, v198, v118
    v_mul_f32 v199, v199, v118
    v_cvt_pk_bf16_f32 v192, v192, v193
    v_cvt_pk_bf16_f32 v193, v194, v195
    v_cvt_pk_bf16_f32 v194, v196, v197
    v_cvt_pk_bf16_f32 v195, v198, v199
    buffer_store_dwordx4 v[192:195], v1, s[32:35], s64 offen offset:0 sc1
    v_mul_f32 v200, v200, v118
    v_mul_f32 v201, v201, v118
    v_mul_f32 v202, v202, v118
    v_mul_f32 v203, v203, v118
    v_mul_f32 v204, v204, v118
    v_mul_f32 v205, v205, v118
    v_mul_f32 v206, v206, v118
    v_mul_f32 v207, v207, v118
    v_cvt_pk_bf16_f32 v200, v200, v201
    v_cvt_pk_bf16_f32 v201, v202, v203
    v_cvt_pk_bf16_f32 v202, v204, v205
    v_cvt_pk_bf16_f32 v203, v206, v207
    buffer_store_dwordx4 v[200:203], v1, s[32:35], s64 offen offset:1024 sc1
    v_mul_f32 v208, v208, v118
    v_mul_f32 v209, v209, v118
    v_mul_f32 v210, v210, v118
    v_mul_f32 v211, v211, v118
    v_mul_f32 v212, v212, v118
    v_mul_f32 v213, v213, v118
    v_mul_f32 v214, v214, v118
    v_mul_f32 v215, v215, v118
    v_cvt_pk_bf16_f32 v208, v208, v209
    v_cvt_pk_bf16_f32 v209, v210, v211
    v_cvt_pk_bf16_f32 v210, v212, v213
    v_cvt_pk_bf16_f32 v211, v214, v215
    buffer_store_dwordx4 v[208:211], v1, s[32:35], s64 offen offset:2048 sc1
    v_mul_f32 v216, v216, v118
    v_mul_f32 v217, v217, v118
    v_mul_f32 v218, v218, v118
    v_mul_f32 v219, v219, v118
    v_mul_f32 v220, v220, v118
    v_mul_f32 v221, v221, v118
    v_mul_f32 v222, v222, v118
    v_mul_f32 v223, v223, v118
    v_cvt_pk_bf16_f32 v216, v216, v217
    v_cvt_pk_bf16_f32 v217, v218, v219
    v_cvt_pk_bf16_f32 v218, v220, v221
    v_cvt_pk_bf16_f32 v219, v222, v223
    buffer_store_dwordx4 v[216:219], v1, s[32:35], s64 offen offset:3072 sc1
    v_mul_f32 v224, v224, v119
    v_mul_f32 v225, v225, v119
    v_mul_f32 v226, v226, v119
    v_mul_f32 v227, v227, v119
    v_mul_f32 v228, v228, v119
    v_mul_f32 v229, v229, v119
    v_mul_f32 v230, v230, v119
    v_mul_f32 v231, v231, v119
    v_cvt_pk_bf16_f32 v224, v224, v225
    v_cvt_pk_bf16_f32 v225, v226, v227
    v_cvt_pk_bf16_f32 v226, v228, v229
    v_cvt_pk_bf16_f32 v227, v230, v231
    buffer_store_dwordx4 v[224:227], v1, s[32:35], s48 offen offset:0 sc1
    v_mul_f32 v232, v232, v119
    v_mul_f32 v233, v233, v119
    v_mul_f32 v234, v234, v119
    v_mul_f32 v235, v235, v119
    v_mul_f32 v236, v236, v119
    v_mul_f32 v237, v237, v119
    v_mul_f32 v238, v238, v119
    v_mul_f32 v239, v239, v119
    v_cvt_pk_bf16_f32 v232, v232, v233
    v_cvt_pk_bf16_f32 v233, v234, v235
    v_cvt_pk_bf16_f32 v234, v236, v237
    v_cvt_pk_bf16_f32 v235, v238, v239
    buffer_store_dwordx4 v[232:235], v1, s[32:35], s48 offen offset:1024 sc1
    v_mul_f32 v240, v240, v119
    v_mul_f32 v241, v241, v119
    v_mul_f32 v242, v242, v119
    v_mul_f32 v243, v243, v119
    v_mul_f32 v244, v244, v119
    v_mul_f32 v245, v245, v119
    v_mul_f32 v246, v246, v119
    v_mul_f32 v247, v247, v119
    v_cvt_pk_bf16_f32 v240, v240, v241
    v_cvt_pk_bf16_f32 v241, v242, v243
    v_cvt_pk_bf16_f32 v242, v244, v245
    v_cvt_pk_bf16_f32 v243, v246, v247
    buffer_store_dwordx4 v[240:243], v1, s[32:35], s48 offen offset:2048 sc1
    v_mul_f32 v248, v248, v119
    v_mul_f32 v249, v249, v119
    v_mul_f32 v250, v250, v119
    v_mul_f32 v251, v251, v119
    v_mul_f32 v252, v252, v119
    v_mul_f32 v253, v253, v119
    v_mul_f32 v254, v254, v119
    v_mul_f32 v255, v255, v119
    v_cvt_pk_bf16_f32 v248, v248, v249
    v_cvt_pk_bf16_f32 v249, v250, v251
    v_cvt_pk_bf16_f32 v250, v252, v253
    v_cvt_pk_bf16_f32 v251, v254, v255
    buffer_store_dwordx4 v[248:251], v1, s[32:35], s48 offen offset:3072 sc1
sequential_preLN__compressed_kv_cla__moe_arch_mod__prompt_kernel_fbskipS:
    s_and_b32 s47, s63, 1
    s_cmp_eq_u32 s47, 0
    s_cbranch_scc1 sequential_preLN__compressed_kv_cla__moe_arch_mod__prompt_kernel_fbskipL
    v_mov_b32 v116, 0
    v_mov_b32 v128, 0
    v_mov_b32 v129, 0
    v_mov_b32 v130, 0
    v_mov_b32 v131, 0
    v_mov_b32 v132, 0
    v_mov_b32 v133, 0
    v_mov_b32 v134, 0
    v_mov_b32 v135, 0
    v_mov_b32 v136, 0
    v_mov_b32 v137, 0
    v_mov_b32 v138, 0
    v_mov_b32 v139, 0
    v_mov_b32 v140, 0
    v_mov_b32 v141, 0
    v_mov_b32 v142, 0
    v_mov_b32 v143, 0
    v_mov_b32 v144, 0
    v_mov_b32 v145, 0
    v_mov_b32 v146, 0
    v_mov_b32 v147, 0
    v_mov_b32 v148, 0
    v_mov_b32 v149, 0
    v_mov_b32 v150, 0
    v_mov_b32 v151, 0
    v_mov_b32 v152, 0
    v_mov_b32 v153, 0
    v_mov_b32 v154, 0
    v_mov_b32 v155, 0
    v_mov_b32 v156, 0
    v_mov_b32 v157, 0
    v_mov_b32 v158, 0
    v_mov_b32 v159, 0
    v_mov_b32 v16, 0
    v_mov_b32 v17, 0
    v_mov_b32 v18, 0
    v_mov_b32 v19, 0
    v_mov_b32 v117, 0
    v_mov_b32 v160, 0
    v_mov_b32 v161, 0
    v_mov_b32 v162, 0
    v_mov_b32 v163, 0
    v_mov_b32 v164, 0
    v_mov_b32 v165, 0
    v_mov_b32 v166, 0
    v_mov_b32 v167, 0
    v_mov_b32 v168, 0
    v_mov_b32 v169, 0
    v_mov_b32 v170, 0
    v_mov_b32 v171, 0
    v_mov_b32 v172, 0
    v_mov_b32 v173, 0
    v_mov_b32 v174, 0
    v_mov_b32 v175, 0
    v_mov_b32 v176, 0
    v_mov_b32 v177, 0
    v_mov_b32 v178, 0
    v_mov_b32 v179, 0
    v_mov_b32 v180, 0
    v_mov_b32 v181, 0
    v_mov_b32 v182, 0
    v_mov_b32 v183, 0
    v_mov_b32 v184, 0
    v_mov_b32 v185, 0
    v_mov_b32 v186, 0
    v_mov_b32 v187, 0
    v_mov_b32 v188, 0
    v_mov_b32 v189, 0
    v_mov_b32 v190, 0
    v_mov_b32 v191, 0
    v_mov_b32 v20, 0
    v_mov_b32 v21, 0
    v_mov_b32 v22, 0
    v_mov_b32 v23, 0
    v_mov_b32 v124, v3
    v_mov_b32 v125, v3
    s_lshl_b32 s62, s59, 2
    s_add_u32 s62, s62, s44
    s_add_u32 s61, s62, 1
    s_sub_u32 s62, 0, s62
    s_lshl_b32 s49, s45, 19
sequential_preLN__compressed_kv_cla__moe_arch_mod__prompt_kernel_fbL_fbloop:
    s_add_u32 s48, s49, 0
    buffer_load_dwordx4 a[64:67], v1, s[24:27], s48 offen offset:0
    buffer_load_dwordx4 a[96:99], v1, s[28:31], s48 offen offset:0
    s_add_u32 s48, s49, 0
    buffer_load_dwordx4 a[68:71], v1, s[24:27], s48 offen offset:1024
    buffer_load_dwordx4 a[100:103], v1, s[28:31], s48 offen offset:1024
    s_add_u32 s48, s49, 0
    buffer_load_dwordx4 a[72:75], v1, s[24:27], s48 offen offset:2048
    buffer_load_dwordx4 a[104:107], v1, s[28:31], s48 offen offset:2048
    s_add_u32 s48, s49, 0
    buffer_load_dwordx4 a[76:79], v1, s[24:27], s48 offen offset:3072
    buffer_load_dwordx4 a[108:111], v1, s[28:31], s48 offen offset:3072
    s_add_u32 s48, s49, 4096
    buffer_load_dwordx4 a[80:83], v1, s[24:27], s48 offen offset:0
    buffer_load_dwordx4 a[112:115], v1, s[28:31], s48 offen offset:0
    s_add_u32 s48, s49, 4096
    buffer_load_dwordx4 a[84:87], v1, s[24:27], s48 offen offset:1024
    buffer_load_dwordx4 a[116:119], v1, s[28:31], s48 offen offset:1024
    s_add_u32 s48, s49, 4096
    buffer_load_dwordx4 a[88:91], v1, s[24:27], s48 offen offset:2048
    buffer_load_dwordx4 a[120:123], v1, s[28:31], s48 offen offset:2048
    s_add_u32 s48, s49, 4096
    buffer_load_dwordx4 a[92:95], v1, s[24:27], s48 offen offset:3072
    buffer_load_dwordx4 a[124:127], v1, s[28:31], s48 offen offset:3072
    s_cmp_lt_i32 s62, 0
    s_cselect_b64 s[14:15], -1, 0
    s_cmp_eq_u32 s62, 0
    s_cselect_b64 s[4:5], s[36:37], s[14:15]
    s_cselect_b64 s[6:7], s[38:39], s[14:15]
    s_cselect_b64 s[8:9], s[40:41], s[14:15]
    s_cselect_b64 s[10:11], s[42:43], s[14:15]
    s_cmp_le_i32 s62, 0
    s_cselect_b64 s[12:13], -1, 0
    v_cndmask_b32 v32, v3, v16, s[4:5]
    v_cndmask_b32 v33, v3, v17, s[6:7]
    v_cndmask_b32 v34, v3, v18, s[8:9]
    v_cndmask_b32 v35, v3, v19, s[10:11]
    v_cndmask_b32 v36, v3, v16, s[14:15]
    v_cndmask_b32 v37, v3, v17, s[14:15]
    v_cndmask_b32 v38, v3, v18, s[14:15]
    v_cndmask_b32 v39, v3, v19, s[14:15]
    v_cndmask_b32 v40, v3, v20, s[12:13]
    v_cndmask_b32 v41, v3, v21, s[12:13]
    v_cndmask_b32 v42, v3, v22, s[12:13]
    v_cndmask_b32 v43, v3, v23, s[12:13]
    v_cndmask_b32 v44, v3, v20, s[4:5]
    v_cndmask_b32 v45, v3, v21, s[6:7]
    v_cndmask_b32 v46, v3, v22, s[8:9]
    v_cndmask_b32 v47, v3, v23, s[10:11]
    s_waitcnt vmcnt(0)
    s_nop 1
    v_mfma_f32_16x16x32_bf16 v[48:51], a[64:67], a[0:3], v[32:35]
    v_mfma_f32_16x16x32_bf16 v[48:51], a[68:71], a[4:7], v[48:51]
    v_mfma_f32_16x16x32_bf16 v[48:51], a[72:75], a[8:11], v[48:51]
    v_mfma_f32_16x16x32_bf16 v[48:51], a[76:79], a[12:15], v[48:51]
    v_mfma_f32_16x16x32_bf16 v[52:55], a[80:83], a[0:3], v[36:39]
    v_mfma_f32_16x16x32_bf16 v[52:55], a[84:87], a[4:7], v[52:55]
    v_mfma_f32_16x16x32_bf16 v[52:55], a[88:91], a[8:11], v[52:55]
    v_mfma_f32_16x16x32_bf16 v[52:55], a[92:95], a[12:15], v[52:55]
    v_mfma_f32_16x16x32_bf16 v[56:59], a[64:67], a[16:19], v[40:43]
    v_mfma_f32_16x16x32_bf16 v[56:59], a[68:71], a[20:23], v[56:59]
    v_mfma_f32_16x16x32_bf16 v[56:59], a[72:75], a[24:27], v[56:59]
    v_mfma_f32_16x16x32_bf16 v[56:59], a[76:79], a[28:31], v[56:59]
    v_mfma_f32_16x16x32_bf16 v[60:63], a[80:83], a[16:19], v[44:47]
    v_mfma_f32_16x16x32_bf16 v[60:63], a[84:87], a[20:23], v[60:63]
    v_mfma_f32_16x16x32_bf16 v[60:63], a[88:91], a[24:27], v[60:63]
    v_mfma_f32_16x16x32_bf16 v[60:63], a[92:95], a[28:31], v[60:63]
    s_nop 7
    v_max3_f32 v120, v48, v49, v50
    v_max3_f32 v120, v120, v51, v52
    v_max3_f32 v120, v120, v53, v54
    v_max_f32 v120, v120, v55
    v_mov_b32 v126, v120
    s_nop 1
    v_permlane16_swap_b32 v120, v126
    s_nop 1
    v_max_f32 v120, v120, v126
    v_mov_b32 v126, v120
    s_nop 1
    v_permlane32_swap_b32 v120, v126
    s_nop 1
    v_max_f32 v120, v120, v126
    v_max_f32 v120, v120, v124
    v_sub_f32 v126, v124, v120
    v_exp_f32 v126, v126
    v_mov_b32 v124, v120
    v_mul_f32 v116, v116, v126
    v_mul_f32 v128, v128, v126
    v_mul_f32 v129, v129, v126
    v_mul_f32 v130, v130, v126
    v_mul_f32 v131, v131, v126
    v_mul_f32 v132, v132, v126
    v_mul_f32 v133, v133, v126
    v_mul_f32 v134, v134, v126
    v_mul_f32 v135, v135, v126
    v_mul_f32 v136, v136, v126
    v_mul_f32 v137, v137, v126
    v_mul_f32 v138, v138, v126
    v_mul_f32 v139, v139, v126
    v_mul_f32 v140, v140, v126
    v_mul_f32 v141, v141, v126
    v_mul_f32 v142, v142, v126
    v_mul_f32 v143, v143, v126
    v_mul_f32 v144, v144, v126
    v_mul_f32 v145, v145, v126
    v_mul_f32 v146, v146, v126
    v_mul_f32 v147, v147, v126
    v_mul_f32 v148, v148, v126
    v_mul_f32 v149, v149, v126
    v_mul_f32 v150, v150, v126
    v_mul_f32 v151, v151, v126
    v_mul_f32 v152, v152, v126
    v_mul_f32 v153, v153, v126
    v_mul_f32 v154, v154, v126
    v_mul_f32 v155, v155, v126
    v_mul_f32 v156, v156, v126
    v_mul_f32 v157, v157, v126
    v_mul_f32 v158, v158, v126
    v_mul_f32 v159, v159, v126
    v_sub_f32 v48, v48, v120
    v_sub_f32 v49, v49, v120
    v_sub_f32 v50, v50, v120
    v_sub_f32 v51, v51, v120
    v_sub_f32 v52, v52, v120
    v_sub_f32 v53, v53, v120
    v_sub_f32 v54, v54, v120
    v_sub_f32 v55, v55, v120
    v_exp_f32 v48, v48
    v_exp_f32 v49, v49
    v_exp_f32 v50, v50
    v_exp_f32 v51, v51
    v_exp_f32 v52, v52
    v_exp_f32 v53, v53
    v_exp_f32 v54, v54
    v_exp_f32 v55, v55
    s_nop 0
    v_add_f32 v116, v116, v48
    v_add_f32 v116, v116, v49
    v_add_f32 v116, v116, v50
    v_add_f32 v116, v116, v51
    v_add_f32 v116, v116, v52
    v_add_f32 v116, v116, v53
    v_add_f32 v116, v116, v54
    v_add_f32 v116, v116, v55
    v_cvt_pk_bf16_f32 v80, v48, v49
    v_cvt_pk_bf16_f32 v81, v50, v51
    v_cvt_pk_bf16_f32 v82, v52, v53
    v_cvt_pk_bf16_f32 v83, v54, v55
    v_max3_f32 v121, v56, v57, v58
    v_max3_f32 v121, v121, v59, v60
    v_max3_f32 v121, v121, v61, v62
    v_max_f32 v121, v121, v63
    v_mov_b32 v126, v121
    s_nop 1
    v_permlane16_swap_b32 v121, v126
    s_nop 1
    v_max_f32 v121, v121, v126
    v_mov_b32 v126, v121
    s_nop 1
    v_permlane32_swap_b32 v121, v126
    s_nop 1
    v_max_f32 v121, v121, v126
    v_max_f32 v121, v121, v125
    v_sub_f32 v126, v125, v121
    v_exp_f32 v126, v126
    v_mov_b32 v125, v121
    v_mul_f32 v117, v117, v126
    v_mul_f32 v160, v160, v126
    v_mul_f32 v161, v161, v126
    v_mul_f32 v162, v162, v126
    v_mul_f32 v163, v163, v126
    v_mul_f32 v164, v164, v126
    v_mul_f32 v165, v165, v126
    v_mul_f32 v166, v166, v126
    v_mul_f32 v167, v167, v126
    v_mul_f32 v168, v168, v126
    v_mul_f32 v169, v169, v126
    v_mul_f32 v170, v170, v126
    v_mul_f32 v171, v171, v126
    v_mul_f32 v172, v172, v126
    v_mul_f32 v173, v173, v126
    v_mul_f32 v174, v174, v126
    v_mul_f32 v175, v175, v126
    v_mul_f32 v176, v176, v126
    v_mul_f32 v177, v177, v126
    v_mul_f32 v178, v178, v126
    v_mul_f32 v179, v179, v126
    v_mul_f32 v180, v180, v126
    v_mul_f32 v181, v181, v126
    v_mul_f32 v182, v182, v126
    v_mul_f32 v183, v183, v126
    v_mul_f32 v184, v184, v126
    v_mul_f32 v185, v185, v126
    v_mul_f32 v186, v186, v126
    v_mul_f32 v187, v187, v126
    v_mul_f32 v188, v188, v126
    v_mul_f32 v189, v189, v126
    v_mul_f32 v190, v190, v126
    v_mul_f32 v191, v191, v126
    v_sub_f32 v56, v56, v121
    v_sub_f32 v57, v57, v121
    v_sub_f32 v58, v58, v121
    v_sub_f32 v59, v59, v121
    v_sub_f32 v60, v60, v121
    v_sub_f32 v61, v61, v121
    v_sub_f32 v62, v62, v121
    v_sub_f32 v63, v63, v121
    v_exp_f32 v56, v56
    v_exp_f32 v57, v57
    v_exp_f32 v58, v58
    v_exp_f32 v59, v59
    v_exp_f32 v60, v60
    v_exp_f32 v61, v61
    v_exp_f32 v62, v62
    v_exp_f32 v63, v63
    s_nop 0
    v_add_f32 v117, v117, v56
    v_add_f32 v117, v117, v57
    v_add_f32 v117, v117, v58
    v_add_f32 v117, v117, v59
    v_add_f32 v117, v117, v60
    v_add_f32 v117, v117, v61
    v_add_f32 v117, v117, v62
    v_add_f32 v117, v117, v63
    v_cvt_pk_bf16_f32 v84, v56, v57
    v_cvt_pk_bf16_f32 v85, v58, v59
    v_cvt_pk_bf16_f32 v86, v60, v61
    v_cvt_pk_bf16_f32 v87, v62, v63
    s_nop 1
    v_mfma_f32_16x16x32_bf16 v[128:131], a[96:99], v[80:83], v[128:131]
    v_mfma_f32_16x16x32_bf16 v[132:135], a[100:103], v[80:83], v[132:135]
    v_mfma_f32_16x16x32_bf16 v[136:139], a[104:107], v[80:83], v[136:139]
    v_mfma_f32_16x16x32_bf16 v[140:143], a[108:111], v[80:83], v[140:143]
    v_mfma_f32_16x16x32_bf16 v[144:147], a[112:115], v[80:83], v[144:147]
    v_mfma_f32_16x16x32_bf16 v[148:151], a[116:119], v[80:83], v[148:151]
    v_mfma_f32_16x16x32_bf16 v[152:155], a[120:123], v[80:83], v[152:155]
    v_mfma_f32_16x16x32_bf16 v[156:159], a[124:127], v[80:83], v[156:159]
    v_mfma_f32_16x16x32_bf16 v[160:163], a[96:99], v[84:87], v[160:163]
    v_mfma_f32_16x16x32_bf16 v[164:167], a[100:103], v[84:87], v[164:167]
    v_mfma_f32_16x16x32_bf16 v[168:171], a[104:107], v[84:87], v[168:171]
    v_mfma_f32_16x16x32_bf16 v[172:175], a[108:111], v[84:87], v[172:175]
    v_mfma_f32_16x16x32_bf16 v[176:179], a[112:115], v[84:87], v[176:179]
    v_mfma_f32_16x16x32_bf16 v[180:183], a[116:119], v[84:87], v[180:183]
    v_mfma_f32_16x16x32_bf16 v[184:187], a[120:123], v[84:87], v[184:187]
    v_mfma_f32_16x16x32_bf16 v[188:191], a[124:127], v[84:87], v[188:191]
    s_nop 7
    s_add_u32 s49, s49, 8192
    s_add_u32 s62, s62, 1
    s_sub_u32 s61, s61, 1
    s_cmp_lg_u32 s61, 0
    s_cbranch_scc1 sequential_preLN__compressed_kv_cla__moe_arch_mod__prompt_kernel_fbL_fbloop
    v_mov_b32 v120, v116
    s_nop 1
    v_permlane16_swap_b32 v116, v120
    s_nop 1
    v_add_f32 v116, v116, v120
    v_mov_b32 v120, v116
    s_nop 1
    v_permlane32_swap_b32 v116, v120
    s_nop 1
    v_add_f32 v116, v116, v120
    v_mov_b32 v120, v117
    s_nop 1
    v_permlane16_swap_b32 v117, v120
    s_nop 1
    v_add_f32 v117, v117, v120
    v_mov_b32 v120, v117
    s_nop 1
    v_permlane32_swap_b32 v117, v120
    s_nop 1
    v_add_f32 v117, v117, v120
    v_rcp_f32 v116, v116
    v_rcp_f32 v117, v117
    s_lshl_b32 s64, s59, 3
    s_lshl_b32 s47, s44, 1
    s_add_u32 s64, s64, s47
    s_lshl_b32 s64, s64, 5
    s_add_u32 s64, s64, s45
    s_lshl_b32 s64, s64, 12
    s_add_u32 s48, s64, 131072
    v_mul_f32 v128, v128, v116
    v_mul_f32 v129, v129, v116
    v_mul_f32 v130, v130, v116
    v_mul_f32 v131, v131, v116
    v_mul_f32 v132, v132, v116
    v_mul_f32 v133, v133, v116
    v_mul_f32 v134, v134, v116
    v_mul_f32 v135, v135, v116
    v_cvt_pk_bf16_f32 v128, v128, v129
    v_cvt_pk_bf16_f32 v129, v130, v131
    v_cvt_pk_bf16_f32 v130, v132, v133
    v_cvt_pk_bf16_f32 v131, v134, v135
    buffer_store_dwordx4 v[128:131], v1, s[32:35], s64 offen offset:0 sc1
    v_mul_f32 v136, v136, v116
    v_mul_f32 v137, v137, v116
    v_mul_f32 v138, v138, v116
    v_mul_f32 v139, v139, v116
    v_mul_f32 v140, v140, v116
    v_mul_f32 v141, v141, v116
    v_mul_f32 v142, v142, v116
    v_mul_f32 v143, v143, v116
    v_cvt_pk_bf16_f32 v136, v136, v137
    v_cvt_pk_bf16_f32 v137, v138, v139
    v_cvt_pk_bf16_f32 v138, v140, v141
    v_cvt_pk_bf16_f32 v139, v142, v143
    buffer_store_dwordx4 v[136:139], v1, s[32:35], s64 offen offset:1024 sc1
    v_mul_f32 v144, v144, v116
    v_mul_f32 v145, v145, v116
    v_mul_f32 v146, v146, v116
    v_mul_f32 v147, v147, v116
    v_mul_f32 v148, v148, v116
    v_mul_f32 v149, v149, v116
    v_mul_f32 v150, v150, v116
    v_mul_f32 v151, v151, v116
    v_cvt_pk_bf16_f32 v144, v144, v145
    v_cvt_pk_bf16_f32 v145, v146, v147
    v_cvt_pk_bf16_f32 v146, v148, v149
    v_cvt_pk_bf16_f32 v147, v150, v151
    buffer_store_dwordx4 v[144:147], v1, s[32:35], s64 offen offset:2048 sc1
    v_mul_f32 v152, v152, v116
    v_mul_f32 v153, v153, v116
    v_mul_f32 v154, v154, v116
    v_mul_f32 v155, v155, v116
    v_mul_f32 v156, v156, v116
    v_mul_f32 v157, v157, v116
    v_mul_f32 v158, v158, v116
    v_mul_f32 v159, v159, v116
    v_cvt_pk_bf16_f32 v152, v152, v153
    v_cvt_pk_bf16_f32 v153, v154, v155
    v_cvt_pk_bf16_f32 v154, v156, v157
    v_cvt_pk_bf16_f32 v155, v158, v159
    buffer_store_dwordx4 v[152:155], v1, s[32:35], s64 offen offset:3072 sc1
    v_mul_f32 v160, v160, v117
    v_mul_f32 v161, v161, v117
    v_mul_f32 v162, v162, v117
    v_mul_f32 v163, v163, v117
    v_mul_f32 v164, v164, v117
    v_mul_f32 v165, v165, v117
    v_mul_f32 v166, v166, v117
    v_mul_f32 v167, v167, v117
    v_cvt_pk_bf16_f32 v160, v160, v161
    v_cvt_pk_bf16_f32 v161, v162, v163
    v_cvt_pk_bf16_f32 v162, v164, v165
    v_cvt_pk_bf16_f32 v163, v166, v167
    buffer_store_dwordx4 v[160:163], v1, s[32:35], s48 offen offset:0 sc1
    v_mul_f32 v168, v168, v117
    v_mul_f32 v169, v169, v117
    v_mul_f32 v170, v170, v117
    v_mul_f32 v171, v171, v117
    v_mul_f32 v172, v172, v117
    v_mul_f32 v173, v173, v117
    v_mul_f32 v174, v174, v117
    v_mul_f32 v175, v175, v117
    v_cvt_pk_bf16_f32 v168, v168, v169
    v_cvt_pk_bf16_f32 v169, v170, v171
    v_cvt_pk_bf16_f32 v170, v172, v173
    v_cvt_pk_bf16_f32 v171, v174, v175
    buffer_store_dwordx4 v[168:171], v1, s[32:35], s48 offen offset:1024 sc1
    v_mul_f32 v176, v176, v117
    v_mul_f32 v177, v177, v117
    v_mul_f32 v178, v178, v117
    v_mul_f32 v179, v179, v117
    v_mul_f32 v180, v180, v117
    v_mul_f32 v181, v181, v117
    v_mul_f32 v182, v182, v117
    v_mul_f32 v183, v183, v117
    v_cvt_pk_bf16_f32 v176, v176, v177
    v_cvt_pk_bf16_f32 v177, v178, v179
    v_cvt_pk_bf16_f32 v178, v180, v181
    v_cvt_pk_bf16_f32 v179, v182, v183
    buffer_store_dwordx4 v[176:179], v1, s[32:35], s48 offen offset:2048 sc1
    v_mul_f32 v184, v184, v117
    v_mul_f32 v185, v185, v117
    v_mul_f32 v186, v186, v117
    v_mul_f32 v187, v187, v117
    v_mul_f32 v188, v188, v117
    v_mul_f32 v189, v189, v117
    v_mul_f32 v190, v190, v117
    v_mul_f32 v191, v191, v117
    v_cvt_pk_bf16_f32 v184, v184, v185
    v_cvt_pk_bf16_f32 v185, v186, v187
    v_cvt_pk_bf16_f32 v186, v188, v189
    v_cvt_pk_bf16_f32 v187, v190, v191
    buffer_store_dwordx4 v[184:187], v1, s[32:35], s48 offen offset:3072 sc1
sequential_preLN__compressed_kv_cla__moe_arch_mod__prompt_kernel_fbskipL:
sequential_preLN__compressed_kv_cla__moe_arch_mod__prompt_kernel_fin:
    s_load_dwordx2 s[4:5], s[0:1], 40
    s_load_dwordx4 s[8:11], s[0:1], 88
    s_load_dwordx2 s[12:13], s[0:1], 104
    s_load_dwordx2 s[6:7], s[0:1], 0
    s_and_b32 s14, s2, 7
    s_lshr_b32 s15, s2, 3
    s_lshr_b32 s45, s14, 1
    s_and_b32 s14, s14, 1
    s_lshl_b32 s14, s14, 3
    s_and_b32 s46, s15, 7
    s_add_u32 s46, s46, s14
    s_lshr_b32 s47, s15, 3
    s_lshr_b32 s14, s2, 3
    s_and_b32 s62, s14, 7
    s_lshr_b32 s14, s14, 3
    s_lshl_b32 s14, s14, 1
    s_add_u32 s14, s14, s62
    s_sub_u32 s14, s14, 6
    s_lshl_b32 s14, s14, 3
    s_and_b32 s15, s2, 7
    s_add_u32 s14, s14, s15
    s_cmp_ge_u32 s62, 6
    s_cselect_b32 s62, s14, 255
    s_lshr_b32 s15, s2, 3
    s_lshl_b32 s48, s46, 3
    s_lshl_b32 s49, s44, 1
    s_add_u32 s48, s48, s49
    s_lshl_b32 s48, s48, 2
    s_add_u32 s48, s48, s45
    s_lshl_b32 s52, s48, 15
    s_lshl_b32 s54, s44, 12
    s_add_u32 s54, s54, 20480
    s_mul_i32 s51, s45, 1310720
    s_mul_i32 s48, s47, 320
    s_add_u32 s51, s51, s48
    s_mul_i32 s53, s44, 5120
    s_mul_i32 s48, s44, 320
    v_add_u32 v13, s48, v0
    v_mul_u32_u24 v14, 3277, v13
    v_lshrrev_b32 v14, 16, v14
    v_mul_u32_u24 v15, 20, v14
    v_sub_u32 v15, v13, v15
    v_bfe_u32 v16, v14, 2, 1
    v_lshlrev_b32 v16, 1, v16
    v_xor_b32 v15, v15, v16
    v_mul_u32_u24 v14, 1280, v14
    v_lshl_add_u32 v2, v15, 4, v14
    v_add_u32 v13, 64, v13
    v_mul_u32_u24 v14, 3277, v13
    v_lshrrev_b32 v14, 16, v14
    v_mul_u32_u24 v15, 20, v14
    v_sub_u32 v15, v13, v15
    v_bfe_u32 v16, v14, 2, 1
    v_lshlrev_b32 v16, 1, v16
    v_xor_b32 v15, v15, v16
    v_mul_u32_u24 v14, 1280, v14
    v_lshl_add_u32 v3, v15, 4, v14
    v_subrev_u32 v3, 1024, v3
    v_add_u32 v13, 64, v13
    v_mul_u32_u24 v14, 3277, v13
    v_lshrrev_b32 v14, 16, v14
    v_mul_u32_u24 v15, 20, v14
    v_sub_u32 v15, v13, v15
    v_bfe_u32 v16, v14, 2, 1
    v_lshlrev_b32 v16, 1, v16
    v_xor_b32 v15, v15, v16
    v_mul_u32_u24 v14, 1280, v14
    v_lshl_add_u32 v4, v15, 4, v14
    v_subrev_u32 v4, 2048, v4
    v_add_u32 v13, 64, v13
    v_mul_u32_u24 v14, 3277, v13
    v_lshrrev_b32 v14, 16, v14
    v_mul_u32_u24 v15, 20, v14
    v_sub_u32 v15, v13, v15
    v_bfe_u32 v16, v14, 2, 1
    v_lshlrev_b32 v16, 1, v16
    v_xor_b32 v15, v15, v16
    v_mul_u32_u24 v14, 1280, v14
    v_lshl_add_u32 v5, v15, 4, v14
    v_subrev_u32 v5, 3072, v5
    v_add_u32 v13, 64, v13
    v_mul_u32_u24 v14, 3277, v13
    v_lshrrev_b32 v14, 16, v14
    v_mul_u32_u24 v15, 20, v14
    v_sub_u32 v15, v13, v15
    v_bfe_u32 v16, v14, 2, 1
    v_lshlrev_b32 v16, 1, v16
    v_xor_b32 v15, v15, v16
    v_mul_u32_u24 v14, 1280, v14
    v_lshl_add_u32 v6, v15, 4, v14
    s_waitcnt lgkmcnt(0)
    s_mov_b32 s16, s4
    s_mov_b32 s17, s5
    s_mov_b32 s18, 5242880
    s_mov_b32 s19, 0x00020000
    s_add_u32 s20, s12, 37748736
    s_addc_u32 s21, s13, 0
    s_mov_b32 s22, 16777216
    s_mov_b32 s23, 0x00020000
    v_bfe_u32 v13, v0, 2, 2
    v_lshrrev_b32 v14, 4, v0
    v_lshl_add_u32 v15, v14, 2, v13
    v_mul_u32_u24 v15, 320, v15
    v_and_b32 v16, 3, v0
    v_lshl_add_u32 v15, v16, 3, v15
    v_and_b32 v14, 1, v14
    v_lshlrev_b32 v14, 5, v14
    v_add_u32 v7, v15, v14
    v_sub_u32 v8, v15, v14
    s_lshr_b32 s48, s44, 1
    s_and_b32 s49, s44, 1
    s_cmp_eq_u32 s48, 1
    s_cselect_b64 s[14:15], -1, 0
    v_cndmask_b32 v13, v7, v8, s[14:15]
    v_cndmask_b32 v14, v8, v7, s[14:15]
    s_mul_i32 s50, s48, 160
    v_add_u32 v7, s50, v13
    v_add_u32 v8, s50, v14
    s_lshl_b32 s50, s49, 13
    s_add_u32 s50, s50, 20480
    v_add_u32 v11, s50, v1
    s_lshl_b32 s55, s45, 7
    s_lshl_b32 s50, s46, 3
    s_add_u32 s55, s55, s50
    s_lshl_b32 s49, s49, 2
    s_add_u32 s55, s55, s49
    s_lshl_b32 s55, s55, 3
    s_lshl_b32 s50, s47, 1
    s_add_u32 s55, s55, s50
    s_add_u32 s55, s55, s48
    s_lshl_b32 s60, s45, 6
    s_lshl_b32 s14, s46, 2
    s_add_u32 s60, s60, s14
    s_lshr_b32 s14, s49, 1
    s_add_u32 s60, s60, s14
    s_lshl_b32 s60, s60, 3
    s_add_u32 s60, s60, s50
    s_add_u32 s60, s60, s48
    s_lshl_b32 s60, s60, 10
    s_add_u32 s60, s60, 10485760
    s_mul_i32 s55, s55, 2560
    s_add_u32 s24, s12, 54525952
    s_addc_u32 s25, s13, 0
    s_mov_b32 s26, 12582912
    s_mov_b32 s27, 0x00020000
    s_mov_b32 s32, s6
    s_mov_b32 s33, s7
    s_mov_b32 s34, 2621440
    s_mov_b32 s35, 0x00020000
    s_mov_b32 s36, s8
    s_mov_b32 s37, s9
    s_mov_b32 s38, 2621440
    s_mov_b32 s39, 0x00020000
    s_add_u32 s40, s12, 79691776
    s_addc_u32 s41, s13, 0
    s_mov_b32 s42, 2621440
    s_mov_b32 s43, 0x00020000
    s_add_u32 s56, s12, 83886080
    s_addc_u32 s57, s13, 0
    s_mov_b32 s58, 3145728
    s_mov_b32 s59, 0x00020000
    s_waitcnt vmcnt(0) lgkmcnt(0)
    s_barrier
    s_cmp_lg_u32 s44, 0
    s_cbranch_scc1 sequential_preLN__compressed_kv_cla__moe_arch_mod__prompt_kernel_cpub
    s_lshl_b32 s14, s2, 2
    s_add_u32 s14, s14, 6144
    v_mov_b32 v20, s3
    v_mov_b32 v21, 0
    buffer_store_dword v20, v21, s[68:71], s14 offen sc1
sequential_preLN__compressed_kv_cla__moe_arch_mod__prompt_kernel_cpub:
    s_lshr_b32 s14, s2, 3
    s_and_b32 s15, s14, 7
    s_cmp_lt_u32 s15, 4
    s_cbranch_scc1 sequential_preLN__compressed_kv_cla__moe_arch_mod__prompt_kernel_npf
    s_load_dwordx2 s[92:93], s[0:1], 40
    s_lshr_b32 s14, s14, 3
    s_lshl_b32 s14, s14, 2
    s_add_u32 s14, s14, s15
    s_sub_u32 s14, s14, 4
    s_mul_i32 s14, s14, 81920
    s_and_b32 s15, s2, 7
    s_lshr_b32 s15, s15, 1
    s_mul_i32 s15, s15, 1310720
    s_add_u32 s14, s14, s15
    s_mul_i32 s15, s44, 20480
    s_add_u32 s14, s14, s15
    s_waitcnt lgkmcnt(0)
    v_add_u32 v251, 0, v0
    v_min_u32 v251, 159, v251
    v_lshlrev_b32 v251, 7, v251
    v_add_u32 v251, s14, v251
    global_load_dword v250, v251, s[92:93]
    v_add_u32 v251, 64, v0
    v_min_u32 v251, 159, v251
    v_lshlrev_b32 v251, 7, v251
    v_add_u32 v251, s14, v251
    global_load_dword v250, v251, s[92:93]
    v_add_u32 v251, 128, v0
    v_min_u32 v251, 159, v251
    v_lshlrev_b32 v251, 7, v251
    v_add_u32 v251, s14, v251
    global_load_dword v250, v251, s[92:93]
sequential_preLN__compressed_kv_cla__moe_arch_mod__prompt_kernel_npf:
    s_cmp_eq_u32 s44, 0
    s_cbranch_scc1 sequential_preLN__compressed_kv_cla__moe_arch_mod__prompt_kernel_t_w0first
    s_add_u32 m0, s53, 0
    s_add_u32 s48, s51, 0
    buffer_load_dwordx4 v2, s[16:19], s48 offen offset:0 lds
    buffer_load_dwordx4 v3, s[16:19], s48 offen offset:1024 lds
    buffer_load_dwordx4 v4, s[16:19], s48 offen offset:2048 lds
    buffer_load_dwordx4 v5, s[16:19], s48 offen offset:3072 lds
    s_add_u32 m0, s53, 4096
    s_nop 0
    buffer_load_dwordx4 v6, s[16:19], s48 offen lds
    s_add_u32 m0, s53, 36864
    s_add_u32 s48, s51, 81920
    buffer_load_dwordx4 v2, s[16:19], s48 offen offset:0 lds
    buffer_load_dwordx4 v3, s[16:19], s48 offen offset:1024 lds
    buffer_load_dwordx4 v4, s[16:19], s48 offen offset:2048 lds
    buffer_load_dwordx4 v5, s[16:19], s48 offen offset:3072 lds
    s_add_u32 m0, s53, 40960
    s_nop 0
    buffer_load_dwordx4 v6, s[16:19], s48 offen lds
    s_add_u32 m0, s53, 73728
    s_add_u32 s48, s51, 163840
    buffer_load_dwordx4 v2, s[16:19], s48 offen offset:0 lds
    buffer_load_dwordx4 v3, s[16:19], s48 offen offset:1024 lds
    buffer_load_dwordx4 v4, s[16:19], s48 offen offset:2048 lds
    buffer_load_dwordx4 v5, s[16:19], s48 offen offset:3072 lds
    s_add_u32 m0, s53, 77824
    s_nop 0
    buffer_load_dwordx4 v6, s[16:19], s48 offen lds
    s_branch sequential_preLN__compressed_kv_cla__moe_arch_mod__prompt_kernel_t_cw
sequential_preLN__compressed_kv_cla__moe_arch_mod__prompt_kernel_t_w0first:
    s_sub_u32 s14, 15, s46
    s_min_u32 s14, s14, s46
    s_lshl_b32 s14, s14, 3
    s_lshl_b32 s15, s45, 1
    s_add_u32 s14, s14, s15
    v_and_b32 v13, 3, v0
    v_lshlrev_b32 v13, 6, v13
    v_bfe_u32 v14, v0, 2, 1
    v_add3_u32 v13, v13, v14, s14
    v_lshlrev_b32 v13, 2, v13
    s_mov_b32 s14, 2103296
    s_mov_b32 s15, 0
sequential_preLN__compressed_kv_cla__moe_arch_mod__prompt_kernel_t_pollC_1:
    buffer_load_dword v14, v13, s[56:59], s14 offen sc1
    s_waitcnt vmcnt(0)
    v_cmp_ne_u32 vcc, s3, v14
    s_add_u32 s15, s15, 1
    s_cbranch_vccz sequential_preLN__compressed_kv_cla__moe_arch_mod__prompt_kernel_t_pollC_1_ok
    s_cmp_ge_u32 s15, 65536
    s_cbranch_scc1 sequential_preLN__compressed_kv_cla__moe_arch_mod__prompt_kernel_t_pollC_1_ok
    s_sleep 2
    s_branch sequential_preLN__compressed_kv_cla__moe_arch_mod__prompt_kernel_t_pollC_1
sequential_preLN__compressed_kv_cla__moe_arch_mod__prompt_kernel_t_pollC_1_ok:
    s_add_u32 m0, s53, 0
    s_add_u32 s48, s51, 0
    buffer_load_dwordx4 v2, s[16:19], s48 offen offset:0 lds
    buffer_load_dwordx4 v3, s[16:19], s48 offen offset:1024 lds
    buffer_load_dwordx4 v4, s[16:19], s48 offen offset:2048 lds
    buffer_load_dwordx4 v5, s[16:19], s48 offen offset:3072 lds
    s_add_u32 m0, s53, 4096
    s_nop 0
    buffer_load_dwordx4 v6, s[16:19], s48 offen lds
    s_add_u32 m0, s53, 36864
    s_add_u32 s48, s51, 81920
    buffer_load_dwordx4 v2, s[16:19], s48 offen offset:0 lds
    buffer_load_dwordx4 v3, s[16:19], s48 offen offset:1024 lds
    buffer_load_dwordx4 v4, s[16:19], s48 offen offset:2048 lds
    buffer_load_dwordx4 v5, s[16:19], s48 offen offset:3072 lds
    s_add_u32 m0, s53, 40960
    s_nop 0
    buffer_load_dwordx4 v6, s[16:19], s48 offen lds
    s_add_u32 m0, s53, 73728
    s_add_u32 s48, s51, 163840
    buffer_load_dwordx4 v2, s[16:19], s48 offen offset:0 lds
    buffer_load_dwordx4 v3, s[16:19], s48 offen offset:1024 lds
    buffer_load_dwordx4 v4, s[16:19], s48 offen offset:2048 lds
    buffer_load_dwordx4 v5, s[16:19], s48 offen offset:3072 lds
    s_add_u32 m0, s53, 77824
    s_nop 0
    buffer_load_dwordx4 v6, s[16:19], s48 offen lds
sequential_preLN__compressed_kv_cla__moe_arch_mod__prompt_kernel_t_cw:
    s_barrier
    s_add_u32 s49, s52, 0
    s_add_u32 m0, s54, 0
    s_nop 0
    buffer_load_dwordx4 v1, s[20:23], s49 offen offset:0 lds
    buffer_load_dwordx4 v1, s[20:23], s49 offen offset:1024 lds
    s_add_u32 s49, s52, 131072
    s_add_u32 m0, s54, 2048
    s_nop 0
    buffer_load_dwordx4 v1, s[20:23], s49 offen offset:0 lds
    buffer_load_dwordx4 v1, s[20:23], s49 offen offset:1024 lds
    s_add_u32 s49, s52, 2048
    s_add_u32 m0, s54, 36864
    s_nop 0
    buffer_load_dwordx4 v1, s[20:23], s49 offen offset:0 lds
    buffer_load_dwordx4 v1, s[20:23], s49 offen offset:1024 lds
    s_add_u32 s49, s52, 133120
    s_add_u32 m0, s54, 38912
    s_nop 0
    buffer_load_dwordx4 v1, s[20:23], s49 offen offset:0 lds
    buffer_load_dwordx4 v1, s[20:23], s49 offen offset:1024 lds
    s_add_u32 s49, s52, 4096
    s_add_u32 m0, s54, 73728
    s_nop 0
    buffer_load_dwordx4 v1, s[20:23], s49 offen offset:0 lds
    buffer_load_dwordx4 v1, s[20:23], s49 offen offset:1024 lds
    s_add_u32 s49, s52, 135168
    s_add_u32 m0, s54, 75776
    s_nop 0
    buffer_load_dwordx4 v1, s[20:23], s49 offen offset:0 lds
    buffer_load_dwordx4 v1, s[20:23], s49 offen offset:1024 lds
    v_add_u32 v9, 0, v7
    v_add_u32 v10, 0, v8
    v_add_u32 v12, 0, v11
    s_waitcnt vmcnt(8)
    s_barrier
    ds_read_b128 v[40:43], v12 offset:0
    ds_read_b128 v[44:47], v12 offset:2048
    ds_read_b128 v[48:51], v12 offset:4096
    ds_read_b128 v[52:55], v12 offset:6144
    ds_read_b64_tr_b16 v[20:21], v9 offset:0
    ds_read_b64_tr_b16 v[22:23], v9 offset:5120
    ds_read_b64_tr_b16 v[24:25], v10 offset:32
    ds_read_b64_tr_b16 v[26:27], v10 offset:5152
    ds_read_b64_tr_b16 v[28:29], v9 offset:64
    ds_read_b64_tr_b16 v[30:31], v9 offset:5184
    ds_read_b64_tr_b16 v[32:33], v10 offset:96
    ds_read_b64_tr_b16 v[34:35], v10 offset:5216
    ds_read_b64_tr_b16 v[36:37], v9 offset:128
    ds_read_b64_tr_b16 v[38:39], v9 offset:5248
    s_waitcnt lgkmcnt(8)
    v_mfma_f32_16x16x32_bf16 v[72:75], v[20:23], v[40:43], 0
    ds_read_b128 v[56:59], v12 offset:1024
    v_mfma_f32_16x16x32_bf16 v[92:95], v[20:23], v[44:47], 0
    v_mfma_f32_16x16x32_bf16 v[112:115], v[20:23], v[48:51], 0
    v_mfma_f32_16x16x32_bf16 v[132:135], v[20:23], v[52:55], 0
    s_waitcnt lgkmcnt(7)
    ds_read_b64_tr_b16 v[20:21], v9 offset:10240
    v_mfma_f32_16x16x32_bf16 v[76:79], v[24:27], v[40:43], 0
    ds_read_b64_tr_b16 v[22:23], v9 offset:15360
    v_mfma_f32_16x16x32_bf16 v[96:99], v[24:27], v[44:47], 0
    ds_read_b128 v[60:63], v12 offset:3072
    v_mfma_f32_16x16x32_bf16 v[116:119], v[24:27], v[48:51], 0
    ds_read_b128 v[64:67], v12 offset:5120
    v_mfma_f32_16x16x32_bf16 v[136:139], v[24:27], v[52:55], 0
    s_waitcnt lgkmcnt(9)
    ds_read_b64_tr_b16 v[24:25], v10 offset:10272
    v_mfma_f32_16x16x32_bf16 v[80:83], v[28:31], v[40:43], 0
    ds_read_b64_tr_b16 v[26:27], v10 offset:15392
    v_mfma_f32_16x16x32_bf16 v[100:103], v[28:31], v[44:47], 0
    ds_read_b128 v[68:71], v12 offset:7168
    v_mfma_f32_16x16x32_bf16 v[120:123], v[28:31], v[48:51], 0
    v_mfma_f32_16x16x32_bf16 v[140:143], v[28:31], v[52:55], 0
    s_waitcnt lgkmcnt(10)
    ds_read_b64_tr_b16 v[28:29], v9 offset:10304
    v_mfma_f32_16x16x32_bf16 v[84:87], v[32:35], v[40:43], 0
    ds_read_b64_tr_b16 v[30:31], v9 offset:15424
    v_mfma_f32_16x16x32_bf16 v[104:107], v[32:35], v[44:47], 0
    v_mfma_f32_16x16x32_bf16 v[124:127], v[32:35], v[48:51], 0
    v_mfma_f32_16x16x32_bf16 v[144:147], v[32:35], v[52:55], 0
    s_waitcnt lgkmcnt(10)
    ds_read_b64_tr_b16 v[32:33], v10 offset:10336
    v_mfma_f32_16x16x32_bf16 v[88:91], v[36:39], v[40:43], 0
    ds_read_b64_tr_b16 v[34:35], v10 offset:15456
    v_mfma_f32_16x16x32_bf16 v[108:111], v[36:39], v[44:47], 0
    v_mfma_f32_16x16x32_bf16 v[128:131], v[36:39], v[48:51], 0
    v_mfma_f32_16x16x32_bf16 v[148:151], v[36:39], v[52:55], 0
    s_waitcnt lgkmcnt(4)
    ds_read_b64_tr_b16 v[36:37], v9 offset:10368
    v_mfma_f32_16x16x32_bf16 v[72:75], v[20:23], v[56:59], v[72:75]
    ds_read_b64_tr_b16 v[38:39], v9 offset:15488
    v_mfma_f32_16x16x32_bf16 v[92:95], v[20:23], v[60:63], v[92:95]
    v_add_u32 v9, 36864, v7
    v_add_u32 v10, 36864, v8
    v_mfma_f32_16x16x32_bf16 v[112:115], v[20:23], v[64:67], v[112:115]
    v_add_u32 v12, 36864, v11
    v_mfma_f32_16x16x32_bf16 v[132:135], v[20:23], v[68:71], v[132:135]
    s_waitcnt vmcnt(4) lgkmcnt(0)
    s_barrier
    v_mfma_f32_16x16x32_bf16 v[76:79], v[24:27], v[56:59], v[76:79]
    s_add_u32 s49, s52, 6144
    s_add_u32 m0, s54, 110592
    s_nop 0
    v_mfma_f32_16x16x32_bf16 v[96:99], v[24:27], v[60:63], v[96:99]
    ds_read_b64_tr_b16 v[20:21], v9 offset:0
    v_mfma_f32_16x16x32_bf16 v[116:119], v[24:27], v[64:67], v[116:119]
    ds_read_b64_tr_b16 v[22:23], v9 offset:5120
    v_mfma_f32_16x16x32_bf16 v[136:139], v[24:27], v[68:71], v[136:139]
    ds_read_b64_tr_b16 v[24:25], v10 offset:32
    v_mfma_f32_16x16x32_bf16 v[80:83], v[28:31], v[56:59], v[80:83]
    ds_read_b64_tr_b16 v[26:27], v10 offset:5152
    v_mfma_f32_16x16x32_bf16 v[100:103], v[28:31], v[60:63], v[100:103]
    ds_read_b128 v[40:43], v12 offset:0
    v_mfma_f32_16x16x32_bf16 v[120:123], v[28:31], v[64:67], v[120:123]
    ds_read_b128 v[44:47], v12 offset:2048
    v_mfma_f32_16x16x32_bf16 v[140:143], v[28:31], v[68:71], v[140:143]
    ds_read_b64_tr_b16 v[28:29], v9 offset:64
    v_mfma_f32_16x16x32_bf16 v[84:87], v[32:35], v[56:59], v[84:87]
    ds_read_b64_tr_b16 v[30:31], v9 offset:5184
    v_mfma_f32_16x16x32_bf16 v[104:107], v[32:35], v[60:63], v[104:107]
    ds_read_b128 v[48:51], v12 offset:4096
    v_mfma_f32_16x16x32_bf16 v[124:127], v[32:35], v[64:67], v[124:127]
    ds_read_b128 v[52:55], v12 offset:6144
    v_mfma_f32_16x16x32_bf16 v[144:147], v[32:35], v[68:71], v[144:147]
    ds_read_b64_tr_b16 v[32:33], v10 offset:96
    v_mfma_f32_16x16x32_bf16 v[88:91], v[36:39], v[56:59], v[88:91]
    ds_read_b64_tr_b16 v[34:35], v10 offset:5216
    v_mfma_f32_16x16x32_bf16 v[108:111], v[36:39], v[60:63], v[108:111]
    buffer_load_dwordx4 v1, s[20:23], s49 offen offset:0 lds
    v_mfma_f32_16x16x32_bf16 v[128:131], v[36:39], v[64:67], v[128:131]
    buffer_load_dwordx4 v1, s[20:23], s49 offen offset:1024 lds
    v_mfma_f32_16x16x32_bf16 v[148:151], v[36:39], v[68:71], v[148:151]
    s_waitcnt lgkmcnt(2)
    s_add_u32 s49, s52, 137216
    ds_read_b64_tr_b16 v[36:37], v9 offset:128
    v_mfma_f32_16x16x32_bf16 v[72:75], v[20:23], v[40:43], v[72:75]
    s_add_u32 m0, s54, 112640
    s_nop 0
    ds_read_b64_tr_b16 v[38:39], v9 offset:5248
    v_mfma_f32_16x16x32_bf16 v[92:95], v[20:23], v[44:47], v[92:95]
    ds_read_b128 v[56:59], v12 offset:1024
    v_mfma_f32_16x16x32_bf16 v[112:115], v[20:23], v[48:51], v[112:115]
    buffer_load_dwordx4 v1, s[20:23], s49 offen offset:0 lds
    v_mfma_f32_16x16x32_bf16 v[132:135], v[20:23], v[52:55], v[132:135]
    ds_read_b64_tr_b16 v[20:21], v9 offset:10240
    v_mfma_f32_16x16x32_bf16 v[76:79], v[24:27], v[40:43], v[76:79]
    ds_read_b64_tr_b16 v[22:23], v9 offset:15360
    v_mfma_f32_16x16x32_bf16 v[96:99], v[24:27], v[44:47], v[96:99]
    ds_read_b128 v[60:63], v12 offset:3072
    v_mfma_f32_16x16x32_bf16 v[116:119], v[24:27], v[48:51], v[116:119]
    ds_read_b128 v[64:67], v12 offset:5120
    v_mfma_f32_16x16x32_bf16 v[136:139], v[24:27], v[52:55], v[136:139]
    ds_read_b64_tr_b16 v[24:25], v10 offset:10272
    v_mfma_f32_16x16x32_bf16 v[80:83], v[28:31], v[40:43], v[80:83]
    ds_read_b64_tr_b16 v[26:27], v10 offset:15392
    v_mfma_f32_16x16x32_bf16 v[100:103], v[28:31], v[44:47], v[100:103]
    ds_read_b128 v[68:71], v12 offset:7168
    v_mfma_f32_16x16x32_bf16 v[120:123], v[28:31], v[48:51], v[120:123]
    buffer_load_dwordx4 v1, s[20:23], s49 offen offset:1024 lds
    v_mfma_f32_16x16x32_bf16 v[140:143], v[28:31], v[52:55], v[140:143]
    s_waitcnt lgkmcnt(10)
    s_add_u32 m0, s53, 110592
    ds_read_b64_tr_b16 v[28:29], v9 offset:10304
    v_mfma_f32_16x16x32_bf16 v[84:87], v[32:35], v[40:43], v[84:87]
    s_add_u32 s48, s51, 245760
    ds_read_b64_tr_b16 v[30:31], v9 offset:15424
    v_mfma_f32_16x16x32_bf16 v[104:107], v[32:35], v[44:47], v[104:107]
    buffer_load_dwordx4 v2, s[16:19], s48 offen offset:0 lds
    v_mfma_f32_16x16x32_bf16 v[124:127], v[32:35], v[48:51], v[124:127]
    buffer_load_dwordx4 v3, s[16:19], s48 offen offset:1024 lds
    v_mfma_f32_16x16x32_bf16 v[144:147], v[32:35], v[52:55], v[144:147]
    s_waitcnt lgkmcnt(10)
    ds_read_b64_tr_b16 v[32:33], v10 offset:10336
    v_mfma_f32_16x16x32_bf16 v[88:91], v[36:39], v[40:43], v[88:91]
    ds_read_b64_tr_b16 v[34:35], v10 offset:15456
    v_mfma_f32_16x16x32_bf16 v[108:111], v[36:39], v[44:47], v[108:111]
    buffer_load_dwordx4 v4, s[16:19], s48 offen offset:2048 lds
    v_mfma_f32_16x16x32_bf16 v[128:131], v[36:39], v[48:51], v[128:131]
    buffer_load_dwordx4 v5, s[16:19], s48 offen offset:3072 lds
    v_mfma_f32_16x16x32_bf16 v[148:151], v[36:39], v[52:55], v[148:151]
    s_waitcnt lgkmcnt(4)
    s_add_u32 m0, s53, 114688
    ds_read_b64_tr_b16 v[36:37], v9 offset:10368
    v_mfma_f32_16x16x32_bf16 v[72:75], v[20:23], v[56:59], v[72:75]
    s_nop 0
    ds_read_b64_tr_b16 v[38:39], v9 offset:15488
    v_mfma_f32_16x16x32_bf16 v[92:95], v[20:23], v[60:63], v[92:95]
    v_add_u32 v9, 73728, v7
    v_add_u32 v10, 73728, v8
    v_mfma_f32_16x16x32_bf16 v[112:115], v[20:23], v[64:67], v[112:115]
    buffer_load_dwordx4 v6, s[16:19], s48 offen lds
    v_add_u32 v12, 73728, v11
    v_mfma_f32_16x16x32_bf16 v[132:135], v[20:23], v[68:71], v[132:135]
    s_waitcnt vmcnt(9) lgkmcnt(0)
    s_barrier
    v_mfma_f32_16x16x32_bf16 v[76:79], v[24:27], v[56:59], v[76:79]
    s_add_u32 s49, s52, 8192
    s_add_u32 m0, s54, 0
    s_nop 0
    v_mfma_f32_16x16x32_bf16 v[96:99], v[24:27], v[60:63], v[96:99]
    ds_read_b64_tr_b16 v[20:21], v9 offset:0
    v_mfma_f32_16x16x32_bf16 v[116:119], v[24:27], v[64:67], v[116:119]
    ds_read_b64_tr_b16 v[22:23], v9 offset:5120
    v_mfma_f32_16x16x32_bf16 v[136:139], v[24:27], v[68:71], v[136:139]
    ds_read_b64_tr_b16 v[24:25], v10 offset:32
    v_mfma_f32_16x16x32_bf16 v[80:83], v[28:31], v[56:59], v[80:83]
    ds_read_b64_tr_b16 v[26:27], v10 offset:5152
    v_mfma_f32_16x16x32_bf16 v[100:103], v[28:31], v[60:63], v[100:103]
    ds_read_b128 v[40:43], v12 offset:0
    v_mfma_f32_16x16x32_bf16 v[120:123], v[28:31], v[64:67], v[120:123]
    ds_read_b128 v[44:47], v12 offset:2048
    v_mfma_f32_16x16x32_bf16 v[140:143], v[28:31], v[68:71], v[140:143]
    ds_read_b64_tr_b16 v[28:29], v9 offset:64
    v_mfma_f32_16x16x32_bf16 v[84:87], v[32:35], v[56:59], v[84:87]
    ds_read_b64_tr_b16 v[30:31], v9 offset:5184
    v_mfma_f32_16x16x32_bf16 v[104:107], v[32:35], v[60:63], v[104:107]
    ds_read_b128 v[48:51], v12 offset:4096
    v_mfma_f32_16x16x32_bf16 v[124:127], v[32:35], v[64:67], v[124:127]
    ds_read_b128 v[52:55], v12 offset:6144
    v_mfma_f32_16x16x32_bf16 v[144:147], v[32:35], v[68:71], v[144:147]
    ds_read_b64_tr_b16 v[32:33], v10 offset:96
    v_mfma_f32_16x16x32_bf16 v[88:91], v[36:39], v[56:59], v[88:91]
    ds_read_b64_tr_b16 v[34:35], v10 offset:5216
    v_mfma_f32_16x16x32_bf16 v[108:111], v[36:39], v[60:63], v[108:111]
    buffer_load_dwordx4 v1, s[20:23], s49 offen offset:0 lds
    v_mfma_f32_16x16x32_bf16 v[128:131], v[36:39], v[64:67], v[128:131]
    buffer_load_dwordx4 v1, s[20:23], s49 offen offset:1024 lds
    v_mfma_f32_16x16x32_bf16 v[148:151], v[36:39], v[68:71], v[148:151]
    s_waitcnt lgkmcnt(2)
    s_add_u32 s49, s52, 139264
    ds_read_b64_tr_b16 v[36:37], v9 offset:128
    v_mfma_f32_16x16x32_bf16 v[72:75], v[20:23], v[40:43], v[72:75]
    s_add_u32 m0, s54, 2048
    s_nop 0
    ds_read_b64_tr_b16 v[38:39], v9 offset:5248
    v_mfma_f32_16x16x32_bf16 v[92:95], v[20:23], v[44:47], v[92:95]
    ds_read_b128 v[56:59], v12 offset:1024
    v_mfma_f32_16x16x32_bf16 v[112:115], v[20:23], v[48:51], v[112:115]
    buffer_load_dwordx4 v1, s[20:23], s49 offen offset:0 lds
    v_mfma_f32_16x16x32_bf16 v[132:135], v[20:23], v[52:55], v[132:135]
    ds_read_b64_tr_b16 v[20:21], v9 offset:10240
    v_mfma_f32_16x16x32_bf16 v[76:79], v[24:27], v[40:43], v[76:79]
    ds_read_b64_tr_b16 v[22:23], v9 offset:15360
    v_mfma_f32_16x16x32_bf16 v[96:99], v[24:27], v[44:47], v[96:99]
    ds_read_b128 v[60:63], v12 offset:3072
    v_mfma_f32_16x16x32_bf16 v[116:119], v[24:27], v[48:51], v[116:119]
    ds_read_b128 v[64:67], v12 offset:5120
    v_mfma_f32_16x16x32_bf16 v[136:139], v[24:27], v[52:55], v[136:139]
    ds_read_b64_tr_b16 v[24:25], v10 offset:10272
    v_mfma_f32_16x16x32_bf16 v[80:83], v[28:31], v[40:43], v[80:83]
    ds_read_b64_tr_b16 v[26:27], v10 offset:15392
    v_mfma_f32_16x16x32_bf16 v[100:103], v[28:31], v[44:47], v[100:103]
    ds_read_b128 v[68:71], v12 offset:7168
    v_mfma_f32_16x16x32_bf16 v[120:123], v[28:31], v[48:51], v[120:123]
    buffer_load_dwordx4 v1, s[20:23], s49 offen offset:1024 lds
    v_mfma_f32_16x16x32_bf16 v[140:143], v[28:31], v[52:55], v[140:143]
    s_waitcnt lgkmcnt(10)
    s_add_u32 m0, s53, 0
    ds_read_b64_tr_b16 v[28:29], v9 offset:10304
    v_mfma_f32_16x16x32_bf16 v[84:87], v[32:35], v[40:43], v[84:87]
    s_add_u32 s48, s51, 327680
    ds_read_b64_tr_b16 v[30:31], v9 offset:15424
    v_mfma_f32_16x16x32_bf16 v[104:107], v[32:35], v[44:47], v[104:107]
    buffer_load_dwordx4 v2, s[16:19], s48 offen offset:0 lds
    v_mfma_f32_16x16x32_bf16 v[124:127], v[32:35], v[48:51], v[124:127]
    buffer_load_dwordx4 v3, s[16:19], s48 offen offset:1024 lds
    v_mfma_f32_16x16x32_bf16 v[144:147], v[32:35], v[52:55], v[144:147]
    s_waitcnt lgkmcnt(10)
    ds_read_b64_tr_b16 v[32:33], v10 offset:10336
    v_mfma_f32_16x16x32_bf16 v[88:91], v[36:39], v[40:43], v[88:91]
    ds_read_b64_tr_b16 v[34:35], v10 offset:15456
    v_mfma_f32_16x16x32_bf16 v[108:111], v[36:39], v[44:47], v[108:111]
    buffer_load_dwordx4 v4, s[16:19], s48 offen offset:2048 lds
    v_mfma_f32_16x16x32_bf16 v[128:131], v[36:39], v[48:51], v[128:131]
    buffer_load_dwordx4 v5, s[16:19], s48 offen offset:3072 lds
    v_mfma_f32_16x16x32_bf16 v[148:151], v[36:39], v[52:55], v[148:151]
    s_waitcnt lgkmcnt(4)
    s_add_u32 m0, s53, 4096
    ds_read_b64_tr_b16 v[36:37], v9 offset:10368
    v_mfma_f32_16x16x32_bf16 v[72:75], v[20:23], v[56:59], v[72:75]
    s_nop 0
    ds_read_b64_tr_b16 v[38:39], v9 offset:15488
    v_mfma_f32_16x16x32_bf16 v[92:95], v[20:23], v[60:63], v[92:95]
    v_add_u32 v9, 110592, v7
    v_add_u32 v10, 110592, v8
    v_mfma_f32_16x16x32_bf16 v[112:115], v[20:23], v[64:67], v[112:115]
    buffer_load_dwordx4 v6, s[16:19], s48 offen lds
    v_add_u32 v12, 110592, v11
    v_mfma_f32_16x16x32_bf16 v[132:135], v[20:23], v[68:71], v[132:135]
    s_waitcnt vmcnt(9) lgkmcnt(0)
    s_barrier
    v_mfma_f32_16x16x32_bf16 v[76:79], v[24:27], v[56:59], v[76:79]
    s_add_u32 s49, s52, 10240
    s_add_u32 m0, s54, 36864
    s_nop 0
    v_mfma_f32_16x16x32_bf16 v[96:99], v[24:27], v[60:63], v[96:99]
    ds_read_b64_tr_b16 v[20:21], v9 offset:0
    v_mfma_f32_16x16x32_bf16 v[116:119], v[24:27], v[64:67], v[116:119]
    ds_read_b64_tr_b16 v[22:23], v9 offset:5120
    v_mfma_f32_16x16x32_bf16 v[136:139], v[24:27], v[68:71], v[136:139]
    ds_read_b64_tr_b16 v[24:25], v10 offset:32
    v_mfma_f32_16x16x32_bf16 v[80:83], v[28:31], v[56:59], v[80:83]
    ds_read_b64_tr_b16 v[26:27], v10 offset:5152
    v_mfma_f32_16x16x32_bf16 v[100:103], v[28:31], v[60:63], v[100:103]
    ds_read_b128 v[40:43], v12 offset:0
    v_mfma_f32_16x16x32_bf16 v[120:123], v[28:31], v[64:67], v[120:123]
    ds_read_b128 v[44:47], v12 offset:2048
    v_mfma_f32_16x16x32_bf16 v[140:143], v[28:31], v[68:71], v[140:143]
    ds_read_b64_tr_b16 v[28:29], v9 offset:64
    v_mfma_f32_16x16x32_bf16 v[84:87], v[32:35], v[56:59], v[84:87]
    ds_read_b64_tr_b16 v[30:31], v9 offset:5184
    v_mfma_f32_16x16x32_bf16 v[104:107], v[32:35], v[60:63], v[104:107]
    ds_read_b128 v[48:51], v12 offset:4096
    v_mfma_f32_16x16x32_bf16 v[124:127], v[32:35], v[64:67], v[124:127]
    ds_read_b128 v[52:55], v12 offset:6144
    v_mfma_f32_16x16x32_bf16 v[144:147], v[32:35], v[68:71], v[144:147]
    ds_read_b64_tr_b16 v[32:33], v10 offset:96
    v_mfma_f32_16x16x32_bf16 v[88:91], v[36:39], v[56:59], v[88:91]
    ds_read_b64_tr_b16 v[34:35], v10 offset:5216
    v_mfma_f32_16x16x32_bf16 v[108:111], v[36:39], v[60:63], v[108:111]
    buffer_load_dwordx4 v1, s[20:23], s49 offen offset:0 lds
    v_mfma_f32_16x16x32_bf16 v[128:131], v[36:39], v[64:67], v[128:131]
    buffer_load_dwordx4 v1, s[20:23], s49 offen offset:1024 lds
    v_mfma_f32_16x16x32_bf16 v[148:151], v[36:39], v[68:71], v[148:151]
    s_waitcnt lgkmcnt(2)
    s_add_u32 s49, s52, 141312
    ds_read_b64_tr_b16 v[36:37], v9 offset:128
    v_mfma_f32_16x16x32_bf16 v[72:75], v[20:23], v[40:43], v[72:75]
    s_add_u32 m0, s54, 38912
    s_nop 0
    ds_read_b64_tr_b16 v[38:39], v9 offset:5248
    v_mfma_f32_16x16x32_bf16 v[92:95], v[20:23], v[44:47], v[92:95]
    ds_read_b128 v[56:59], v12 offset:1024
    v_mfma_f32_16x16x32_bf16 v[112:115], v[20:23], v[48:51], v[112:115]
    buffer_load_dwordx4 v1, s[20:23], s49 offen offset:0 lds
    v_mfma_f32_16x16x32_bf16 v[132:135], v[20:23], v[52:55], v[132:135]
    ds_read_b64_tr_b16 v[20:21], v9 offset:10240
    v_mfma_f32_16x16x32_bf16 v[76:79], v[24:27], v[40:43], v[76:79]
    ds_read_b64_tr_b16 v[22:23], v9 offset:15360
    v_mfma_f32_16x16x32_bf16 v[96:99], v[24:27], v[44:47], v[96:99]
    ds_read_b128 v[60:63], v12 offset:3072
    v_mfma_f32_16x16x32_bf16 v[116:119], v[24:27], v[48:51], v[116:119]
    ds_read_b128 v[64:67], v12 offset:5120
    v_mfma_f32_16x16x32_bf16 v[136:139], v[24:27], v[52:55], v[136:139]
    ds_read_b64_tr_b16 v[24:25], v10 offset:10272
    v_mfma_f32_16x16x32_bf16 v[80:83], v[28:31], v[40:43], v[80:83]
    ds_read_b64_tr_b16 v[26:27], v10 offset:15392
    v_mfma_f32_16x16x32_bf16 v[100:103], v[28:31], v[44:47], v[100:103]
    ds_read_b128 v[68:71], v12 offset:7168
    v_mfma_f32_16x16x32_bf16 v[120:123], v[28:31], v[48:51], v[120:123]
    buffer_load_dwordx4 v1, s[20:23], s49 offen offset:1024 lds
    v_mfma_f32_16x16x32_bf16 v[140:143], v[28:31], v[52:55], v[140:143]
    s_waitcnt lgkmcnt(10)
    s_add_u32 m0, s53, 36864
    ds_read_b64_tr_b16 v[28:29], v9 offset:10304
    v_mfma_f32_16x16x32_bf16 v[84:87], v[32:35], v[40:43], v[84:87]
    s_add_u32 s48, s51, 409600
    ds_read_b64_tr_b16 v[30:31], v9 offset:15424
    v_mfma_f32_16x16x32_bf16 v[104:107], v[32:35], v[44:47], v[104:107]
    buffer_load_dwordx4 v2, s[16:19], s48 offen offset:0 lds
    v_mfma_f32_16x16x32_bf16 v[124:127], v[32:35], v[48:51], v[124:127]
    buffer_load_dwordx4 v3, s[16:19], s48 offen offset:1024 lds
    v_mfma_f32_16x16x32_bf16 v[144:147], v[32:35], v[52:55], v[144:147]
    s_waitcnt lgkmcnt(10)
    ds_read_b64_tr_b16 v[32:33], v10 offset:10336
    v_mfma_f32_16x16x32_bf16 v[88:91], v[36:39], v[40:43], v[88:91]
    ds_read_b64_tr_b16 v[34:35], v10 offset:15456
    v_mfma_f32_16x16x32_bf16 v[108:111], v[36:39], v[44:47], v[108:111]
    buffer_load_dwordx4 v4, s[16:19], s48 offen offset:2048 lds
    v_mfma_f32_16x16x32_bf16 v[128:131], v[36:39], v[48:51], v[128:131]
    buffer_load_dwordx4 v5, s[16:19], s48 offen offset:3072 lds
    v_mfma_f32_16x16x32_bf16 v[148:151], v[36:39], v[52:55], v[148:151]
    s_waitcnt lgkmcnt(4)
    s_add_u32 m0, s53, 40960
    ds_read_b64_tr_b16 v[36:37], v9 offset:10368
    v_mfma_f32_16x16x32_bf16 v[72:75], v[20:23], v[56:59], v[72:75]
    s_nop 0
    ds_read_b64_tr_b16 v[38:39], v9 offset:15488
    v_mfma_f32_16x16x32_bf16 v[92:95], v[20:23], v[60:63], v[92:95]
    v_add_u32 v9, 0, v7
    v_add_u32 v10, 0, v8
    v_mfma_f32_16x16x32_bf16 v[112:115], v[20:23], v[64:67], v[112:115]
    buffer_load_dwordx4 v6, s[16:19], s48 offen lds
    v_add_u32 v12, 0, v11
    v_mfma_f32_16x16x32_bf16 v[132:135], v[20:23], v[68:71], v[132:135]
    s_waitcnt vmcnt(9) lgkmcnt(0)
    s_barrier
    v_mfma_f32_16x16x32_bf16 v[76:79], v[24:27], v[56:59], v[76:79]
    s_add_u32 s49, s52, 12288
    s_add_u32 m0, s54, 73728
    s_nop 0
    v_mfma_f32_16x16x32_bf16 v[96:99], v[24:27], v[60:63], v[96:99]
    ds_read_b64_tr_b16 v[20:21], v9 offset:0
    v_mfma_f32_16x16x32_bf16 v[116:119], v[24:27], v[64:67], v[116:119]
    ds_read_b64_tr_b16 v[22:23], v9 offset:5120
    v_mfma_f32_16x16x32_bf16 v[136:139], v[24:27], v[68:71], v[136:139]
    ds_read_b64_tr_b16 v[24:25], v10 offset:32
    v_mfma_f32_16x16x32_bf16 v[80:83], v[28:31], v[56:59], v[80:83]
    ds_read_b64_tr_b16 v[26:27], v10 offset:5152
    v_mfma_f32_16x16x32_bf16 v[100:103], v[28:31], v[60:63], v[100:103]
    ds_read_b128 v[40:43], v12 offset:0
    v_mfma_f32_16x16x32_bf16 v[120:123], v[28:31], v[64:67], v[120:123]
    ds_read_b128 v[44:47], v12 offset:2048
    v_mfma_f32_16x16x32_bf16 v[140:143], v[28:31], v[68:71], v[140:143]
    ds_read_b64_tr_b16 v[28:29], v9 offset:64
    v_mfma_f32_16x16x32_bf16 v[84:87], v[32:35], v[56:59], v[84:87]
    ds_read_b64_tr_b16 v[30:31], v9 offset:5184
    v_mfma_f32_16x16x32_bf16 v[104:107], v[32:35], v[60:63], v[104:107]
    ds_read_b128 v[48:51], v12 offset:4096
    v_mfma_f32_16x16x32_bf16 v[124:127], v[32:35], v[64:67], v[124:127]
    ds_read_b128 v[52:55], v12 offset:6144
    v_mfma_f32_16x16x32_bf16 v[144:147], v[32:35], v[68:71], v[144:147]
    ds_read_b64_tr_b16 v[32:33], v10 offset:96
    v_mfma_f32_16x16x32_bf16 v[88:91], v[36:39], v[56:59], v[88:91]
    ds_read_b64_tr_b16 v[34:35], v10 offset:5216
    v_mfma_f32_16x16x32_bf16 v[108:111], v[36:39], v[60:63], v[108:111]
    buffer_load_dwordx4 v1, s[20:23], s49 offen offset:0 lds
    v_mfma_f32_16x16x32_bf16 v[128:131], v[36:39], v[64:67], v[128:131]
    buffer_load_dwordx4 v1, s[20:23], s49 offen offset:1024 lds
    v_mfma_f32_16x16x32_bf16 v[148:151], v[36:39], v[68:71], v[148:151]
    s_waitcnt lgkmcnt(2)
    s_add_u32 s49, s52, 143360
    ds_read_b64_tr_b16 v[36:37], v9 offset:128
    v_mfma_f32_16x16x32_bf16 v[72:75], v[20:23], v[40:43], v[72:75]
    s_add_u32 m0, s54, 75776
    s_nop 0
    ds_read_b64_tr_b16 v[38:39], v9 offset:5248
    v_mfma_f32_16x16x32_bf16 v[92:95], v[20:23], v[44:47], v[92:95]
    ds_read_b128 v[56:59], v12 offset:1024
    v_mfma_f32_16x16x32_bf16 v[112:115], v[20:23], v[48:51], v[112:115]
    buffer_load_dwordx4 v1, s[20:23], s49 offen offset:0 lds
    v_mfma_f32_16x16x32_bf16 v[132:135], v[20:23], v[52:55], v[132:135]
    ds_read_b64_tr_b16 v[20:21], v9 offset:10240
    v_mfma_f32_16x16x32_bf16 v[76:79], v[24:27], v[40:43], v[76:79]
    ds_read_b64_tr_b16 v[22:23], v9 offset:15360
    v_mfma_f32_16x16x32_bf16 v[96:99], v[24:27], v[44:47], v[96:99]
    ds_read_b128 v[60:63], v12 offset:3072
    v_mfma_f32_16x16x32_bf16 v[116:119], v[24:27], v[48:51], v[116:119]
    ds_read_b128 v[64:67], v12 offset:5120
    v_mfma_f32_16x16x32_bf16 v[136:139], v[24:27], v[52:55], v[136:139]
    ds_read_b64_tr_b16 v[24:25], v10 offset:10272
    v_mfma_f32_16x16x32_bf16 v[80:83], v[28:31], v[40:43], v[80:83]
    ds_read_b64_tr_b16 v[26:27], v10 offset:15392
    v_mfma_f32_16x16x32_bf16 v[100:103], v[28:31], v[44:47], v[100:103]
    ds_read_b128 v[68:71], v12 offset:7168
    v_mfma_f32_16x16x32_bf16 v[120:123], v[28:31], v[48:51], v[120:123]
    buffer_load_dwordx4 v1, s[20:23], s49 offen offset:1024 lds
    v_mfma_f32_16x16x32_bf16 v[140:143], v[28:31], v[52:55], v[140:143]
    s_waitcnt lgkmcnt(10)
    s_add_u32 m0, s53, 73728
    ds_read_b64_tr_b16 v[28:29], v9 offset:10304
    v_mfma_f32_16x16x32_bf16 v[84:87], v[32:35], v[40:43], v[84:87]
    s_add_u32 s48, s51, 491520
    ds_read_b64_tr_b16 v[30:31], v9 offset:15424
    v_mfma_f32_16x16x32_bf16 v[104:107], v[32:35], v[44:47], v[104:107]
    buffer_load_dwordx4 v2, s[16:19], s48 offen offset:0 lds
    v_mfma_f32_16x16x32_bf16 v[124:127], v[32:35], v[48:51], v[124:127]
    buffer_load_dwordx4 v3, s[16:19], s48 offen offset:1024 lds
    v_mfma_f32_16x16x32_bf16 v[144:147], v[32:35], v[52:55], v[144:147]
    s_waitcnt lgkmcnt(10)
    ds_read_b64_tr_b16 v[32:33], v10 offset:10336
    v_mfma_f32_16x16x32_bf16 v[88:91], v[36:39], v[40:43], v[88:91]
    ds_read_b64_tr_b16 v[34:35], v10 offset:15456
    v_mfma_f32_16x16x32_bf16 v[108:111], v[36:39], v[44:47], v[108:111]
    buffer_load_dwordx4 v4, s[16:19], s48 offen offset:2048 lds
    v_mfma_f32_16x16x32_bf16 v[128:131], v[36:39], v[48:51], v[128:131]
    buffer_load_dwordx4 v5, s[16:19], s48 offen offset:3072 lds
    v_mfma_f32_16x16x32_bf16 v[148:151], v[36:39], v[52:55], v[148:151]
    s_waitcnt lgkmcnt(4)
    s_add_u32 m0, s53, 77824
    ds_read_b64_tr_b16 v[36:37], v9 offset:10368
    v_mfma_f32_16x16x32_bf16 v[72:75], v[20:23], v[56:59], v[72:75]
    s_nop 0
    ds_read_b64_tr_b16 v[38:39], v9 offset:15488
    v_mfma_f32_16x16x32_bf16 v[92:95], v[20:23], v[60:63], v[92:95]
    v_add_u32 v9, 36864, v7
    v_add_u32 v10, 36864, v8
    v_mfma_f32_16x16x32_bf16 v[112:115], v[20:23], v[64:67], v[112:115]
    buffer_load_dwordx4 v6, s[16:19], s48 offen lds
    v_add_u32 v12, 36864, v11
    v_mfma_f32_16x16x32_bf16 v[132:135], v[20:23], v[68:71], v[132:135]
    s_waitcnt vmcnt(9) lgkmcnt(0)
    s_barrier
    v_mfma_f32_16x16x32_bf16 v[76:79], v[24:27], v[56:59], v[76:79]
    s_add_u32 s49, s52, 14336
    s_add_u32 m0, s54, 110592
    s_nop 0
    v_mfma_f32_16x16x32_bf16 v[96:99], v[24:27], v[60:63], v[96:99]
    ds_read_b64_tr_b16 v[20:21], v9 offset:0
    v_mfma_f32_16x16x32_bf16 v[116:119], v[24:27], v[64:67], v[116:119]
    ds_read_b64_tr_b16 v[22:23], v9 offset:5120
    v_mfma_f32_16x16x32_bf16 v[136:139], v[24:27], v[68:71], v[136:139]
    ds_read_b64_tr_b16 v[24:25], v10 offset:32
    v_mfma_f32_16x16x32_bf16 v[80:83], v[28:31], v[56:59], v[80:83]
    ds_read_b64_tr_b16 v[26:27], v10 offset:5152
    v_mfma_f32_16x16x32_bf16 v[100:103], v[28:31], v[60:63], v[100:103]
    ds_read_b128 v[40:43], v12 offset:0
    v_mfma_f32_16x16x32_bf16 v[120:123], v[28:31], v[64:67], v[120:123]
    ds_read_b128 v[44:47], v12 offset:2048
    v_mfma_f32_16x16x32_bf16 v[140:143], v[28:31], v[68:71], v[140:143]
    ds_read_b64_tr_b16 v[28:29], v9 offset:64
    v_mfma_f32_16x16x32_bf16 v[84:87], v[32:35], v[56:59], v[84:87]
    ds_read_b64_tr_b16 v[30:31], v9 offset:5184
    v_mfma_f32_16x16x32_bf16 v[104:107], v[32:35], v[60:63], v[104:107]
    ds_read_b128 v[48:51], v12 offset:4096
    v_mfma_f32_16x16x32_bf16 v[124:127], v[32:35], v[64:67], v[124:127]
    ds_read_b128 v[52:55], v12 offset:6144
    v_mfma_f32_16x16x32_bf16 v[144:147], v[32:35], v[68:71], v[144:147]
    ds_read_b64_tr_b16 v[32:33], v10 offset:96
    v_mfma_f32_16x16x32_bf16 v[88:91], v[36:39], v[56:59], v[88:91]
    ds_read_b64_tr_b16 v[34:35], v10 offset:5216
    v_mfma_f32_16x16x32_bf16 v[108:111], v[36:39], v[60:63], v[108:111]
    buffer_load_dwordx4 v1, s[20:23], s49 offen offset:0 lds
    v_mfma_f32_16x16x32_bf16 v[128:131], v[36:39], v[64:67], v[128:131]
    buffer_load_dwordx4 v1, s[20:23], s49 offen offset:1024 lds
    v_mfma_f32_16x16x32_bf16 v[148:151], v[36:39], v[68:71], v[148:151]
    s_waitcnt lgkmcnt(2)
    s_add_u32 s49, s52, 145408
    ds_read_b64_tr_b16 v[36:37], v9 offset:128
    v_mfma_f32_16x16x32_bf16 v[72:75], v[20:23], v[40:43], v[72:75]
    s_add_u32 m0, s54, 112640
    s_nop 0
    ds_read_b64_tr_b16 v[38:39], v9 offset:5248
    v_mfma_f32_16x16x32_bf16 v[92:95], v[20:23], v[44:47], v[92:95]
    ds_read_b128 v[56:59], v12 offset:1024
    v_mfma_f32_16x16x32_bf16 v[112:115], v[20:23], v[48:51], v[112:115]
    buffer_load_dwordx4 v1, s[20:23], s49 offen offset:0 lds
    v_mfma_f32_16x16x32_bf16 v[132:135], v[20:23], v[52:55], v[132:135]
    ds_read_b64_tr_b16 v[20:21], v9 offset:10240
    v_mfma_f32_16x16x32_bf16 v[76:79], v[24:27], v[40:43], v[76:79]
    ds_read_b64_tr_b16 v[22:23], v9 offset:15360
    v_mfma_f32_16x16x32_bf16 v[96:99], v[24:27], v[44:47], v[96:99]
    ds_read_b128 v[60:63], v12 offset:3072
    v_mfma_f32_16x16x32_bf16 v[116:119], v[24:27], v[48:51], v[116:119]
    ds_read_b128 v[64:67], v12 offset:5120
    v_mfma_f32_16x16x32_bf16 v[136:139], v[24:27], v[52:55], v[136:139]
    ds_read_b64_tr_b16 v[24:25], v10 offset:10272
    v_mfma_f32_16x16x32_bf16 v[80:83], v[28:31], v[40:43], v[80:83]
    ds_read_b64_tr_b16 v[26:27], v10 offset:15392
    v_mfma_f32_16x16x32_bf16 v[100:103], v[28:31], v[44:47], v[100:103]
    ds_read_b128 v[68:71], v12 offset:7168
    v_mfma_f32_16x16x32_bf16 v[120:123], v[28:31], v[48:51], v[120:123]
    buffer_load_dwordx4 v1, s[20:23], s49 offen offset:1024 lds
    v_mfma_f32_16x16x32_bf16 v[140:143], v[28:31], v[52:55], v[140:143]
    s_waitcnt lgkmcnt(10)
    s_add_u32 m0, s53, 110592
    ds_read_b64_tr_b16 v[28:29], v9 offset:10304
    v_mfma_f32_16x16x32_bf16 v[84:87], v[32:35], v[40:43], v[84:87]
    s_add_u32 s48, s51, 573440
    ds_read_b64_tr_b16 v[30:31], v9 offset:15424
    v_mfma_f32_16x16x32_bf16 v[104:107], v[32:35], v[44:47], v[104:107]
    buffer_load_dwordx4 v2, s[16:19], s48 offen offset:0 lds
    v_mfma_f32_16x16x32_bf16 v[124:127], v[32:35], v[48:51], v[124:127]
    buffer_load_dwordx4 v3, s[16:19], s48 offen offset:1024 lds
    v_mfma_f32_16x16x32_bf16 v[144:147], v[32:35], v[52:55], v[144:147]
    s_waitcnt lgkmcnt(10)
    ds_read_b64_tr_b16 v[32:33], v10 offset:10336
    v_mfma_f32_16x16x32_bf16 v[88:91], v[36:39], v[40:43], v[88:91]
    ds_read_b64_tr_b16 v[34:35], v10 offset:15456
    v_mfma_f32_16x16x32_bf16 v[108:111], v[36:39], v[44:47], v[108:111]
    buffer_load_dwordx4 v4, s[16:19], s48 offen offset:2048 lds
    v_mfma_f32_16x16x32_bf16 v[128:131], v[36:39], v[48:51], v[128:131]
    buffer_load_dwordx4 v5, s[16:19], s48 offen offset:3072 lds
    v_mfma_f32_16x16x32_bf16 v[148:151], v[36:39], v[52:55], v[148:151]
    s_waitcnt lgkmcnt(4)
    s_add_u32 m0, s53, 114688
    ds_read_b64_tr_b16 v[36:37], v9 offset:10368
    v_mfma_f32_16x16x32_bf16 v[72:75], v[20:23], v[56:59], v[72:75]
    s_nop 0
    ds_read_b64_tr_b16 v[38:39], v9 offset:15488
    v_mfma_f32_16x16x32_bf16 v[92:95], v[20:23], v[60:63], v[92:95]
    v_add_u32 v9, 73728, v7
    v_add_u32 v10, 73728, v8
    v_mfma_f32_16x16x32_bf16 v[112:115], v[20:23], v[64:67], v[112:115]
    buffer_load_dwordx4 v6, s[16:19], s48 offen lds
    v_add_u32 v12, 73728, v11
    v_mfma_f32_16x16x32_bf16 v[132:135], v[20:23], v[68:71], v[132:135]
    s_waitcnt vmcnt(9) lgkmcnt(0)
    s_barrier
    v_mfma_f32_16x16x32_bf16 v[76:79], v[24:27], v[56:59], v[76:79]
    s_add_u32 s49, s52, 16384
    s_add_u32 m0, s54, 0
    s_nop 0
    v_mfma_f32_16x16x32_bf16 v[96:99], v[24:27], v[60:63], v[96:99]
    ds_read_b64_tr_b16 v[20:21], v9 offset:0
    v_mfma_f32_16x16x32_bf16 v[116:119], v[24:27], v[64:67], v[116:119]
    ds_read_b64_tr_b16 v[22:23], v9 offset:5120
    v_mfma_f32_16x16x32_bf16 v[136:139], v[24:27], v[68:71], v[136:139]
    ds_read_b64_tr_b16 v[24:25], v10 offset:32
    v_mfma_f32_16x16x32_bf16 v[80:83], v[28:31], v[56:59], v[80:83]
    ds_read_b64_tr_b16 v[26:27], v10 offset:5152
    v_mfma_f32_16x16x32_bf16 v[100:103], v[28:31], v[60:63], v[100:103]
    ds_read_b128 v[40:43], v12 offset:0
    v_mfma_f32_16x16x32_bf16 v[120:123], v[28:31], v[64:67], v[120:123]
    ds_read_b128 v[44:47], v12 offset:2048
    v_mfma_f32_16x16x32_bf16 v[140:143], v[28:31], v[68:71], v[140:143]
    ds_read_b64_tr_b16 v[28:29], v9 offset:64
    v_mfma_f32_16x16x32_bf16 v[84:87], v[32:35], v[56:59], v[84:87]
    ds_read_b64_tr_b16 v[30:31], v9 offset:5184
    v_mfma_f32_16x16x32_bf16 v[104:107], v[32:35], v[60:63], v[104:107]
    ds_read_b128 v[48:51], v12 offset:4096
    v_mfma_f32_16x16x32_bf16 v[124:127], v[32:35], v[64:67], v[124:127]
    ds_read_b128 v[52:55], v12 offset:6144
    v_mfma_f32_16x16x32_bf16 v[144:147], v[32:35], v[68:71], v[144:147]
    ds_read_b64_tr_b16 v[32:33], v10 offset:96
    v_mfma_f32_16x16x32_bf16 v[88:91], v[36:39], v[56:59], v[88:91]
    ds_read_b64_tr_b16 v[34:35], v10 offset:5216
    v_mfma_f32_16x16x32_bf16 v[108:111], v[36:39], v[60:63], v[108:111]
    buffer_load_dwordx4 v1, s[20:23], s49 offen offset:0 lds
    v_mfma_f32_16x16x32_bf16 v[128:131], v[36:39], v[64:67], v[128:131]
    buffer_load_dwordx4 v1, s[20:23], s49 offen offset:1024 lds
    v_mfma_f32_16x16x32_bf16 v[148:151], v[36:39], v[68:71], v[148:151]
    s_waitcnt lgkmcnt(2)
    s_add_u32 s49, s52, 147456
    ds_read_b64_tr_b16 v[36:37], v9 offset:128
    v_mfma_f32_16x16x32_bf16 v[72:75], v[20:23], v[40:43], v[72:75]
    s_add_u32 m0, s54, 2048
    s_nop 0
    ds_read_b64_tr_b16 v[38:39], v9 offset:5248
    v_mfma_f32_16x16x32_bf16 v[92:95], v[20:23], v[44:47], v[92:95]
    ds_read_b128 v[56:59], v12 offset:1024
    v_mfma_f32_16x16x32_bf16 v[112:115], v[20:23], v[48:51], v[112:115]
    buffer_load_dwordx4 v1, s[20:23], s49 offen offset:0 lds
    v_mfma_f32_16x16x32_bf16 v[132:135], v[20:23], v[52:55], v[132:135]
    ds_read_b64_tr_b16 v[20:21], v9 offset:10240
    v_mfma_f32_16x16x32_bf16 v[76:79], v[24:27], v[40:43], v[76:79]
    ds_read_b64_tr_b16 v[22:23], v9 offset:15360
    v_mfma_f32_16x16x32_bf16 v[96:99], v[24:27], v[44:47], v[96:99]
    ds_read_b128 v[60:63], v12 offset:3072
    v_mfma_f32_16x16x32_bf16 v[116:119], v[24:27], v[48:51], v[116:119]
    ds_read_b128 v[64:67], v12 offset:5120
    v_mfma_f32_16x16x32_bf16 v[136:139], v[24:27], v[52:55], v[136:139]
    ds_read_b64_tr_b16 v[24:25], v10 offset:10272
    v_mfma_f32_16x16x32_bf16 v[80:83], v[28:31], v[40:43], v[80:83]
    ds_read_b64_tr_b16 v[26:27], v10 offset:15392
    v_mfma_f32_16x16x32_bf16 v[100:103], v[28:31], v[44:47], v[100:103]
    ds_read_b128 v[68:71], v12 offset:7168
    v_mfma_f32_16x16x32_bf16 v[120:123], v[28:31], v[48:51], v[120:123]
    buffer_load_dwordx4 v1, s[20:23], s49 offen offset:1024 lds
    v_mfma_f32_16x16x32_bf16 v[140:143], v[28:31], v[52:55], v[140:143]
    s_waitcnt lgkmcnt(10)
    s_add_u32 m0, s53, 0
    ds_read_b64_tr_b16 v[28:29], v9 offset:10304
    v_mfma_f32_16x16x32_bf16 v[84:87], v[32:35], v[40:43], v[84:87]
    s_add_u32 s48, s51, 655360
    ds_read_b64_tr_b16 v[30:31], v9 offset:15424
    v_mfma_f32_16x16x32_bf16 v[104:107], v[32:35], v[44:47], v[104:107]
    buffer_load_dwordx4 v2, s[16:19], s48 offen offset:0 lds
    v_mfma_f32_16x16x32_bf16 v[124:127], v[32:35], v[48:51], v[124:127]
    buffer_load_dwordx4 v3, s[16:19], s48 offen offset:1024 lds
    v_mfma_f32_16x16x32_bf16 v[144:147], v[32:35], v[52:55], v[144:147]
    s_waitcnt lgkmcnt(10)
    ds_read_b64_tr_b16 v[32:33], v10 offset:10336
    v_mfma_f32_16x16x32_bf16 v[88:91], v[36:39], v[40:43], v[88:91]
    ds_read_b64_tr_b16 v[34:35], v10 offset:15456
    v_mfma_f32_16x16x32_bf16 v[108:111], v[36:39], v[44:47], v[108:111]
    buffer_load_dwordx4 v4, s[16:19], s48 offen offset:2048 lds
    v_mfma_f32_16x16x32_bf16 v[128:131], v[36:39], v[48:51], v[128:131]
    buffer_load_dwordx4 v5, s[16:19], s48 offen offset:3072 lds
    v_mfma_f32_16x16x32_bf16 v[148:151], v[36:39], v[52:55], v[148:151]
    s_waitcnt lgkmcnt(4)
    s_add_u32 m0, s53, 4096
    ds_read_b64_tr_b16 v[36:37], v9 offset:10368
    v_mfma_f32_16x16x32_bf16 v[72:75], v[20:23], v[56:59], v[72:75]
    s_nop 0
    ds_read_b64_tr_b16 v[38:39], v9 offset:15488
    v_mfma_f32_16x16x32_bf16 v[92:95], v[20:23], v[60:63], v[92:95]
    v_add_u32 v9, 110592, v7
    v_add_u32 v10, 110592, v8
    v_mfma_f32_16x16x32_bf16 v[112:115], v[20:23], v[64:67], v[112:115]
    buffer_load_dwordx4 v6, s[16:19], s48 offen lds
    v_add_u32 v12, 110592, v11
    v_mfma_f32_16x16x32_bf16 v[132:135], v[20:23], v[68:71], v[132:135]
    s_waitcnt vmcnt(9) lgkmcnt(0)
    s_barrier
    v_mfma_f32_16x16x32_bf16 v[76:79], v[24:27], v[56:59], v[76:79]
    s_add_u32 s49, s52, 18432
    s_add_u32 m0, s54, 36864
    s_nop 0
    v_mfma_f32_16x16x32_bf16 v[96:99], v[24:27], v[60:63], v[96:99]
    ds_read_b64_tr_b16 v[20:21], v9 offset:0
    v_mfma_f32_16x16x32_bf16 v[116:119], v[24:27], v[64:67], v[116:119]
    ds_read_b64_tr_b16 v[22:23], v9 offset:5120
    v_mfma_f32_16x16x32_bf16 v[136:139], v[24:27], v[68:71], v[136:139]
    ds_read_b64_tr_b16 v[24:25], v10 offset:32
    v_mfma_f32_16x16x32_bf16 v[80:83], v[28:31], v[56:59], v[80:83]
    ds_read_b64_tr_b16 v[26:27], v10 offset:5152
    v_mfma_f32_16x16x32_bf16 v[100:103], v[28:31], v[60:63], v[100:103]
    ds_read_b128 v[40:43], v12 offset:0
    v_mfma_f32_16x16x32_bf16 v[120:123], v[28:31], v[64:67], v[120:123]
    ds_read_b128 v[44:47], v12 offset:2048
    v_mfma_f32_16x16x32_bf16 v[140:143], v[28:31], v[68:71], v[140:143]
    ds_read_b64_tr_b16 v[28:29], v9 offset:64
    v_mfma_f32_16x16x32_bf16 v[84:87], v[32:35], v[56:59], v[84:87]
    ds_read_b64_tr_b16 v[30:31], v9 offset:5184
    v_mfma_f32_16x16x32_bf16 v[104:107], v[32:35], v[60:63], v[104:107]
    ds_read_b128 v[48:51], v12 offset:4096
    v_mfma_f32_16x16x32_bf16 v[124:127], v[32:35], v[64:67], v[124:127]
    ds_read_b128 v[52:55], v12 offset:6144
    v_mfma_f32_16x16x32_bf16 v[144:147], v[32:35], v[68:71], v[144:147]
    ds_read_b64_tr_b16 v[32:33], v10 offset:96
    v_mfma_f32_16x16x32_bf16 v[88:91], v[36:39], v[56:59], v[88:91]
    ds_read_b64_tr_b16 v[34:35], v10 offset:5216
    v_mfma_f32_16x16x32_bf16 v[108:111], v[36:39], v[60:63], v[108:111]
    buffer_load_dwordx4 v1, s[20:23], s49 offen offset:0 lds
    v_mfma_f32_16x16x32_bf16 v[128:131], v[36:39], v[64:67], v[128:131]
    buffer_load_dwordx4 v1, s[20:23], s49 offen offset:1024 lds
    v_mfma_f32_16x16x32_bf16 v[148:151], v[36:39], v[68:71], v[148:151]
    s_waitcnt lgkmcnt(2)
    s_add_u32 s49, s52, 149504
    ds_read_b64_tr_b16 v[36:37], v9 offset:128
    v_mfma_f32_16x16x32_bf16 v[72:75], v[20:23], v[40:43], v[72:75]
    s_add_u32 m0, s54, 38912
    s_nop 0
    ds_read_b64_tr_b16 v[38:39], v9 offset:5248
    v_mfma_f32_16x16x32_bf16 v[92:95], v[20:23], v[44:47], v[92:95]
    ds_read_b128 v[56:59], v12 offset:1024
    v_mfma_f32_16x16x32_bf16 v[112:115], v[20:23], v[48:51], v[112:115]
    buffer_load_dwordx4 v1, s[20:23], s49 offen offset:0 lds
    v_mfma_f32_16x16x32_bf16 v[132:135], v[20:23], v[52:55], v[132:135]
    ds_read_b64_tr_b16 v[20:21], v9 offset:10240
    v_mfma_f32_16x16x32_bf16 v[76:79], v[24:27], v[40:43], v[76:79]
    ds_read_b64_tr_b16 v[22:23], v9 offset:15360
    v_mfma_f32_16x16x32_bf16 v[96:99], v[24:27], v[44:47], v[96:99]
    ds_read_b128 v[60:63], v12 offset:3072
    v_mfma_f32_16x16x32_bf16 v[116:119], v[24:27], v[48:51], v[116:119]
    ds_read_b128 v[64:67], v12 offset:5120
    v_mfma_f32_16x16x32_bf16 v[136:139], v[24:27], v[52:55], v[136:139]
    ds_read_b64_tr_b16 v[24:25], v10 offset:10272
    v_mfma_f32_16x16x32_bf16 v[80:83], v[28:31], v[40:43], v[80:83]
    ds_read_b64_tr_b16 v[26:27], v10 offset:15392
    v_mfma_f32_16x16x32_bf16 v[100:103], v[28:31], v[44:47], v[100:103]
    ds_read_b128 v[68:71], v12 offset:7168
    v_mfma_f32_16x16x32_bf16 v[120:123], v[28:31], v[48:51], v[120:123]
    buffer_load_dwordx4 v1, s[20:23], s49 offen offset:1024 lds
    v_mfma_f32_16x16x32_bf16 v[140:143], v[28:31], v[52:55], v[140:143]
    s_waitcnt lgkmcnt(10)
    s_add_u32 m0, s53, 36864
    ds_read_b64_tr_b16 v[28:29], v9 offset:10304
    v_mfma_f32_16x16x32_bf16 v[84:87], v[32:35], v[40:43], v[84:87]
    s_add_u32 s48, s51, 737280
    ds_read_b64_tr_b16 v[30:31], v9 offset:15424
    v_mfma_f32_16x16x32_bf16 v[104:107], v[32:35], v[44:47], v[104:107]
    buffer_load_dwordx4 v2, s[16:19], s48 offen offset:0 lds
    v_mfma_f32_16x16x32_bf16 v[124:127], v[32:35], v[48:51], v[124:127]
    buffer_load_dwordx4 v3, s[16:19], s48 offen offset:1024 lds
    v_mfma_f32_16x16x32_bf16 v[144:147], v[32:35], v[52:55], v[144:147]
    s_waitcnt lgkmcnt(10)
    ds_read_b64_tr_b16 v[32:33], v10 offset:10336
    v_mfma_f32_16x16x32_bf16 v[88:91], v[36:39], v[40:43], v[88:91]
    ds_read_b64_tr_b16 v[34:35], v10 offset:15456
    v_mfma_f32_16x16x32_bf16 v[108:111], v[36:39], v[44:47], v[108:111]
    buffer_load_dwordx4 v4, s[16:19], s48 offen offset:2048 lds
    v_mfma_f32_16x16x32_bf16 v[128:131], v[36:39], v[48:51], v[128:131]
    buffer_load_dwordx4 v5, s[16:19], s48 offen offset:3072 lds
    v_mfma_f32_16x16x32_bf16 v[148:151], v[36:39], v[52:55], v[148:151]
    s_waitcnt lgkmcnt(4)
    s_add_u32 m0, s53, 40960
    ds_read_b64_tr_b16 v[36:37], v9 offset:10368
    v_mfma_f32_16x16x32_bf16 v[72:75], v[20:23], v[56:59], v[72:75]
    s_nop 0
    ds_read_b64_tr_b16 v[38:39], v9 offset:15488
    v_mfma_f32_16x16x32_bf16 v[92:95], v[20:23], v[60:63], v[92:95]
    v_add_u32 v9, 0, v7
    v_add_u32 v10, 0, v8
    v_mfma_f32_16x16x32_bf16 v[112:115], v[20:23], v[64:67], v[112:115]
    buffer_load_dwordx4 v6, s[16:19], s48 offen lds
    v_add_u32 v12, 0, v11
    v_mfma_f32_16x16x32_bf16 v[132:135], v[20:23], v[68:71], v[132:135]
    s_waitcnt vmcnt(9) lgkmcnt(0)
    s_barrier
    v_mfma_f32_16x16x32_bf16 v[76:79], v[24:27], v[56:59], v[76:79]
    s_add_u32 s49, s52, 20480
    s_add_u32 m0, s54, 73728
    s_nop 0
    v_mfma_f32_16x16x32_bf16 v[96:99], v[24:27], v[60:63], v[96:99]
    ds_read_b64_tr_b16 v[20:21], v9 offset:0
    v_mfma_f32_16x16x32_bf16 v[116:119], v[24:27], v[64:67], v[116:119]
    ds_read_b64_tr_b16 v[22:23], v9 offset:5120
    v_mfma_f32_16x16x32_bf16 v[136:139], v[24:27], v[68:71], v[136:139]
    ds_read_b64_tr_b16 v[24:25], v10 offset:32
    v_mfma_f32_16x16x32_bf16 v[80:83], v[28:31], v[56:59], v[80:83]
    ds_read_b64_tr_b16 v[26:27], v10 offset:5152
    v_mfma_f32_16x16x32_bf16 v[100:103], v[28:31], v[60:63], v[100:103]
    ds_read_b128 v[40:43], v12 offset:0
    v_mfma_f32_16x16x32_bf16 v[120:123], v[28:31], v[64:67], v[120:123]
    ds_read_b128 v[44:47], v12 offset:2048
    v_mfma_f32_16x16x32_bf16 v[140:143], v[28:31], v[68:71], v[140:143]
    ds_read_b64_tr_b16 v[28:29], v9 offset:64
    v_mfma_f32_16x16x32_bf16 v[84:87], v[32:35], v[56:59], v[84:87]
    ds_read_b64_tr_b16 v[30:31], v9 offset:5184
    v_mfma_f32_16x16x32_bf16 v[104:107], v[32:35], v[60:63], v[104:107]
    ds_read_b128 v[48:51], v12 offset:4096
    v_mfma_f32_16x16x32_bf16 v[124:127], v[32:35], v[64:67], v[124:127]
    ds_read_b128 v[52:55], v12 offset:6144
    v_mfma_f32_16x16x32_bf16 v[144:147], v[32:35], v[68:71], v[144:147]
    ds_read_b64_tr_b16 v[32:33], v10 offset:96
    v_mfma_f32_16x16x32_bf16 v[88:91], v[36:39], v[56:59], v[88:91]
    ds_read_b64_tr_b16 v[34:35], v10 offset:5216
    v_mfma_f32_16x16x32_bf16 v[108:111], v[36:39], v[60:63], v[108:111]
    buffer_load_dwordx4 v1, s[20:23], s49 offen offset:0 lds
    v_mfma_f32_16x16x32_bf16 v[128:131], v[36:39], v[64:67], v[128:131]
    buffer_load_dwordx4 v1, s[20:23], s49 offen offset:1024 lds
    v_mfma_f32_16x16x32_bf16 v[148:151], v[36:39], v[68:71], v[148:151]
    s_waitcnt lgkmcnt(2)
    s_add_u32 s49, s52, 151552
    ds_read_b64_tr_b16 v[36:37], v9 offset:128
    v_mfma_f32_16x16x32_bf16 v[72:75], v[20:23], v[40:43], v[72:75]
    s_add_u32 m0, s54, 75776
    s_nop 0
    ds_read_b64_tr_b16 v[38:39], v9 offset:5248
    v_mfma_f32_16x16x32_bf16 v[92:95], v[20:23], v[44:47], v[92:95]
    ds_read_b128 v[56:59], v12 offset:1024
    v_mfma_f32_16x16x32_bf16 v[112:115], v[20:23], v[48:51], v[112:115]
    buffer_load_dwordx4 v1, s[20:23], s49 offen offset:0 lds
    v_mfma_f32_16x16x32_bf16 v[132:135], v[20:23], v[52:55], v[132:135]
    ds_read_b64_tr_b16 v[20:21], v9 offset:10240
    v_mfma_f32_16x16x32_bf16 v[76:79], v[24:27], v[40:43], v[76:79]
    ds_read_b64_tr_b16 v[22:23], v9 offset:15360
    v_mfma_f32_16x16x32_bf16 v[96:99], v[24:27], v[44:47], v[96:99]
    ds_read_b128 v[60:63], v12 offset:3072
    v_mfma_f32_16x16x32_bf16 v[116:119], v[24:27], v[48:51], v[116:119]
    ds_read_b128 v[64:67], v12 offset:5120
    v_mfma_f32_16x16x32_bf16 v[136:139], v[24:27], v[52:55], v[136:139]
    ds_read_b64_tr_b16 v[24:25], v10 offset:10272
    v_mfma_f32_16x16x32_bf16 v[80:83], v[28:31], v[40:43], v[80:83]
    ds_read_b64_tr_b16 v[26:27], v10 offset:15392
    v_mfma_f32_16x16x32_bf16 v[100:103], v[28:31], v[44:47], v[100:103]
    ds_read_b128 v[68:71], v12 offset:7168
    v_mfma_f32_16x16x32_bf16 v[120:123], v[28:31], v[48:51], v[120:123]
    buffer_load_dwordx4 v1, s[20:23], s49 offen offset:1024 lds
    v_mfma_f32_16x16x32_bf16 v[140:143], v[28:31], v[52:55], v[140:143]
    s_waitcnt lgkmcnt(10)
    s_add_u32 m0, s53, 73728
    ds_read_b64_tr_b16 v[28:29], v9 offset:10304
    v_mfma_f32_16x16x32_bf16 v[84:87], v[32:35], v[40:43], v[84:87]
    s_add_u32 s48, s51, 819200
    ds_read_b64_tr_b16 v[30:31], v9 offset:15424
    v_mfma_f32_16x16x32_bf16 v[104:107], v[32:35], v[44:47], v[104:107]
    buffer_load_dwordx4 v2, s[16:19], s48 offen offset:0 lds
    v_mfma_f32_16x16x32_bf16 v[124:127], v[32:35], v[48:51], v[124:127]
    buffer_load_dwordx4 v3, s[16:19], s48 offen offset:1024 lds
    v_mfma_f32_16x16x32_bf16 v[144:147], v[32:35], v[52:55], v[144:147]
    s_waitcnt lgkmcnt(10)
    ds_read_b64_tr_b16 v[32:33], v10 offset:10336
    v_mfma_f32_16x16x32_bf16 v[88:91], v[36:39], v[40:43], v[88:91]
    ds_read_b64_tr_b16 v[34:35], v10 offset:15456
    v_mfma_f32_16x16x32_bf16 v[108:111], v[36:39], v[44:47], v[108:111]
    buffer_load_dwordx4 v4, s[16:19], s48 offen offset:2048 lds
    v_mfma_f32_16x16x32_bf16 v[128:131], v[36:39], v[48:51], v[128:131]
    buffer_load_dwordx4 v5, s[16:19], s48 offen offset:3072 lds
    v_mfma_f32_16x16x32_bf16 v[148:151], v[36:39], v[52:55], v[148:151]
    s_waitcnt lgkmcnt(4)
    s_add_u32 m0, s53, 77824
    ds_read_b64_tr_b16 v[36:37], v9 offset:10368
    v_mfma_f32_16x16x32_bf16 v[72:75], v[20:23], v[56:59], v[72:75]
    s_nop 0
    ds_read_b64_tr_b16 v[38:39], v9 offset:15488
    v_mfma_f32_16x16x32_bf16 v[92:95], v[20:23], v[60:63], v[92:95]
    v_add_u32 v9, 36864, v7
    v_add_u32 v10, 36864, v8
    v_mfma_f32_16x16x32_bf16 v[112:115], v[20:23], v[64:67], v[112:115]
    buffer_load_dwordx4 v6, s[16:19], s48 offen lds
    v_add_u32 v12, 36864, v11
    v_mfma_f32_16x16x32_bf16 v[132:135], v[20:23], v[68:71], v[132:135]
    s_waitcnt vmcnt(9) lgkmcnt(0)
    s_barrier
    v_mfma_f32_16x16x32_bf16 v[76:79], v[24:27], v[56:59], v[76:79]
    s_add_u32 s49, s52, 22528
    s_add_u32 m0, s54, 110592
    s_nop 0
    v_mfma_f32_16x16x32_bf16 v[96:99], v[24:27], v[60:63], v[96:99]
    ds_read_b64_tr_b16 v[20:21], v9 offset:0
    v_mfma_f32_16x16x32_bf16 v[116:119], v[24:27], v[64:67], v[116:119]
    ds_read_b64_tr_b16 v[22:23], v9 offset:5120
    v_mfma_f32_16x16x32_bf16 v[136:139], v[24:27], v[68:71], v[136:139]
    ds_read_b64_tr_b16 v[24:25], v10 offset:32
    v_mfma_f32_16x16x32_bf16 v[80:83], v[28:31], v[56:59], v[80:83]
    ds_read_b64_tr_b16 v[26:27], v10 offset:5152
    v_mfma_f32_16x16x32_bf16 v[100:103], v[28:31], v[60:63], v[100:103]
    ds_read_b128 v[40:43], v12 offset:0
    v_mfma_f32_16x16x32_bf16 v[120:123], v[28:31], v[64:67], v[120:123]
    ds_read_b128 v[44:47], v12 offset:2048
    v_mfma_f32_16x16x32_bf16 v[140:143], v[28:31], v[68:71], v[140:143]
    ds_read_b64_tr_b16 v[28:29], v9 offset:64
    v_mfma_f32_16x16x32_bf16 v[84:87], v[32:35], v[56:59], v[84:87]
    ds_read_b64_tr_b16 v[30:31], v9 offset:5184
    v_mfma_f32_16x16x32_bf16 v[104:107], v[32:35], v[60:63], v[104:107]
    ds_read_b128 v[48:51], v12 offset:4096
    v_mfma_f32_16x16x32_bf16 v[124:127], v[32:35], v[64:67], v[124:127]
    ds_read_b128 v[52:55], v12 offset:6144
    v_mfma_f32_16x16x32_bf16 v[144:147], v[32:35], v[68:71], v[144:147]
    ds_read_b64_tr_b16 v[32:33], v10 offset:96
    v_mfma_f32_16x16x32_bf16 v[88:91], v[36:39], v[56:59], v[88:91]
    ds_read_b64_tr_b16 v[34:35], v10 offset:5216
    v_mfma_f32_16x16x32_bf16 v[108:111], v[36:39], v[60:63], v[108:111]
    buffer_load_dwordx4 v1, s[20:23], s49 offen offset:0 lds
    v_mfma_f32_16x16x32_bf16 v[128:131], v[36:39], v[64:67], v[128:131]
    buffer_load_dwordx4 v1, s[20:23], s49 offen offset:1024 lds
    v_mfma_f32_16x16x32_bf16 v[148:151], v[36:39], v[68:71], v[148:151]
    s_waitcnt lgkmcnt(2)
    s_add_u32 s49, s52, 153600
    ds_read_b64_tr_b16 v[36:37], v9 offset:128
    v_mfma_f32_16x16x32_bf16 v[72:75], v[20:23], v[40:43], v[72:75]
    s_add_u32 m0, s54, 112640
    s_nop 0
    ds_read_b64_tr_b16 v[38:39], v9 offset:5248
    v_mfma_f32_16x16x32_bf16 v[92:95], v[20:23], v[44:47], v[92:95]
    ds_read_b128 v[56:59], v12 offset:1024
    v_mfma_f32_16x16x32_bf16 v[112:115], v[20:23], v[48:51], v[112:115]
    buffer_load_dwordx4 v1, s[20:23], s49 offen offset:0 lds
    v_mfma_f32_16x16x32_bf16 v[132:135], v[20:23], v[52:55], v[132:135]
    ds_read_b64_tr_b16 v[20:21], v9 offset:10240
    v_mfma_f32_16x16x32_bf16 v[76:79], v[24:27], v[40:43], v[76:79]
    ds_read_b64_tr_b16 v[22:23], v9 offset:15360
    v_mfma_f32_16x16x32_bf16 v[96:99], v[24:27], v[44:47], v[96:99]
    ds_read_b128 v[60:63], v12 offset:3072
    v_mfma_f32_16x16x32_bf16 v[116:119], v[24:27], v[48:51], v[116:119]
    ds_read_b128 v[64:67], v12 offset:5120
    v_mfma_f32_16x16x32_bf16 v[136:139], v[24:27], v[52:55], v[136:139]
    ds_read_b64_tr_b16 v[24:25], v10 offset:10272
    v_mfma_f32_16x16x32_bf16 v[80:83], v[28:31], v[40:43], v[80:83]
    ds_read_b64_tr_b16 v[26:27], v10 offset:15392
    v_mfma_f32_16x16x32_bf16 v[100:103], v[28:31], v[44:47], v[100:103]
    ds_read_b128 v[68:71], v12 offset:7168
    v_mfma_f32_16x16x32_bf16 v[120:123], v[28:31], v[48:51], v[120:123]
    buffer_load_dwordx4 v1, s[20:23], s49 offen offset:1024 lds
    v_mfma_f32_16x16x32_bf16 v[140:143], v[28:31], v[52:55], v[140:143]
    s_waitcnt lgkmcnt(10)
    s_add_u32 m0, s53, 110592
    ds_read_b64_tr_b16 v[28:29], v9 offset:10304
    v_mfma_f32_16x16x32_bf16 v[84:87], v[32:35], v[40:43], v[84:87]
    s_add_u32 s48, s51, 901120
    ds_read_b64_tr_b16 v[30:31], v9 offset:15424
    v_mfma_f32_16x16x32_bf16 v[104:107], v[32:35], v[44:47], v[104:107]
    buffer_load_dwordx4 v2, s[16:19], s48 offen offset:0 lds
    v_mfma_f32_16x16x32_bf16 v[124:127], v[32:35], v[48:51], v[124:127]
    buffer_load_dwordx4 v3, s[16:19], s48 offen offset:1024 lds
    v_mfma_f32_16x16x32_bf16 v[144:147], v[32:35], v[52:55], v[144:147]
    s_waitcnt lgkmcnt(10)
    ds_read_b64_tr_b16 v[32:33], v10 offset:10336
    v_mfma_f32_16x16x32_bf16 v[88:91], v[36:39], v[40:43], v[88:91]
    ds_read_b64_tr_b16 v[34:35], v10 offset:15456
    v_mfma_f32_16x16x32_bf16 v[108:111], v[36:39], v[44:47], v[108:111]
    buffer_load_dwordx4 v4, s[16:19], s48 offen offset:2048 lds
    v_mfma_f32_16x16x32_bf16 v[128:131], v[36:39], v[48:51], v[128:131]
    buffer_load_dwordx4 v5, s[16:19], s48 offen offset:3072 lds
    v_mfma_f32_16x16x32_bf16 v[148:151], v[36:39], v[52:55], v[148:151]
    s_waitcnt lgkmcnt(4)
    s_add_u32 m0, s53, 114688
    ds_read_b64_tr_b16 v[36:37], v9 offset:10368
    v_mfma_f32_16x16x32_bf16 v[72:75], v[20:23], v[56:59], v[72:75]
    s_nop 0
    ds_read_b64_tr_b16 v[38:39], v9 offset:15488
    v_mfma_f32_16x16x32_bf16 v[92:95], v[20:23], v[60:63], v[92:95]
    v_add_u32 v9, 73728, v7
    v_add_u32 v10, 73728, v8
    v_mfma_f32_16x16x32_bf16 v[112:115], v[20:23], v[64:67], v[112:115]
    buffer_load_dwordx4 v6, s[16:19], s48 offen lds
    v_add_u32 v12, 73728, v11
    v_mfma_f32_16x16x32_bf16 v[132:135], v[20:23], v[68:71], v[132:135]
    s_waitcnt vmcnt(9) lgkmcnt(0)
    s_barrier
    v_mfma_f32_16x16x32_bf16 v[76:79], v[24:27], v[56:59], v[76:79]
    s_add_u32 s49, s52, 24576
    s_add_u32 m0, s54, 0
    s_nop 0
    v_mfma_f32_16x16x32_bf16 v[96:99], v[24:27], v[60:63], v[96:99]
    ds_read_b64_tr_b16 v[20:21], v9 offset:0
    v_mfma_f32_16x16x32_bf16 v[116:119], v[24:27], v[64:67], v[116:119]
    ds_read_b64_tr_b16 v[22:23], v9 offset:5120
    v_mfma_f32_16x16x32_bf16 v[136:139], v[24:27], v[68:71], v[136:139]
    ds_read_b64_tr_b16 v[24:25], v10 offset:32
    v_mfma_f32_16x16x32_bf16 v[80:83], v[28:31], v[56:59], v[80:83]
    ds_read_b64_tr_b16 v[26:27], v10 offset:5152
    v_mfma_f32_16x16x32_bf16 v[100:103], v[28:31], v[60:63], v[100:103]
    ds_read_b128 v[40:43], v12 offset:0
    v_mfma_f32_16x16x32_bf16 v[120:123], v[28:31], v[64:67], v[120:123]
    ds_read_b128 v[44:47], v12 offset:2048
    v_mfma_f32_16x16x32_bf16 v[140:143], v[28:31], v[68:71], v[140:143]
    ds_read_b64_tr_b16 v[28:29], v9 offset:64
    v_mfma_f32_16x16x32_bf16 v[84:87], v[32:35], v[56:59], v[84:87]
    ds_read_b64_tr_b16 v[30:31], v9 offset:5184
    v_mfma_f32_16x16x32_bf16 v[104:107], v[32:35], v[60:63], v[104:107]
    ds_read_b128 v[48:51], v12 offset:4096
    v_mfma_f32_16x16x32_bf16 v[124:127], v[32:35], v[64:67], v[124:127]
    ds_read_b128 v[52:55], v12 offset:6144
    v_mfma_f32_16x16x32_bf16 v[144:147], v[32:35], v[68:71], v[144:147]
    ds_read_b64_tr_b16 v[32:33], v10 offset:96
    v_mfma_f32_16x16x32_bf16 v[88:91], v[36:39], v[56:59], v[88:91]
    ds_read_b64_tr_b16 v[34:35], v10 offset:5216
    v_mfma_f32_16x16x32_bf16 v[108:111], v[36:39], v[60:63], v[108:111]
    buffer_load_dwordx4 v1, s[20:23], s49 offen offset:0 lds
    v_mfma_f32_16x16x32_bf16 v[128:131], v[36:39], v[64:67], v[128:131]
    buffer_load_dwordx4 v1, s[20:23], s49 offen offset:1024 lds
    v_mfma_f32_16x16x32_bf16 v[148:151], v[36:39], v[68:71], v[148:151]
    s_waitcnt lgkmcnt(2)
    s_add_u32 s49, s52, 155648
    ds_read_b64_tr_b16 v[36:37], v9 offset:128
    v_mfma_f32_16x16x32_bf16 v[72:75], v[20:23], v[40:43], v[72:75]
    s_add_u32 m0, s54, 2048
    s_nop 0
    ds_read_b64_tr_b16 v[38:39], v9 offset:5248
    v_mfma_f32_16x16x32_bf16 v[92:95], v[20:23], v[44:47], v[92:95]
    ds_read_b128 v[56:59], v12 offset:1024
    v_mfma_f32_16x16x32_bf16 v[112:115], v[20:23], v[48:51], v[112:115]
    buffer_load_dwordx4 v1, s[20:23], s49 offen offset:0 lds
    v_mfma_f32_16x16x32_bf16 v[132:135], v[20:23], v[52:55], v[132:135]
    ds_read_b64_tr_b16 v[20:21], v9 offset:10240
    v_mfma_f32_16x16x32_bf16 v[76:79], v[24:27], v[40:43], v[76:79]
    ds_read_b64_tr_b16 v[22:23], v9 offset:15360
    v_mfma_f32_16x16x32_bf16 v[96:99], v[24:27], v[44:47], v[96:99]
    ds_read_b128 v[60:63], v12 offset:3072
    v_mfma_f32_16x16x32_bf16 v[116:119], v[24:27], v[48:51], v[116:119]
    ds_read_b128 v[64:67], v12 offset:5120
    v_mfma_f32_16x16x32_bf16 v[136:139], v[24:27], v[52:55], v[136:139]
    ds_read_b64_tr_b16 v[24:25], v10 offset:10272
    v_mfma_f32_16x16x32_bf16 v[80:83], v[28:31], v[40:43], v[80:83]
    ds_read_b64_tr_b16 v[26:27], v10 offset:15392
    v_mfma_f32_16x16x32_bf16 v[100:103], v[28:31], v[44:47], v[100:103]
    ds_read_b128 v[68:71], v12 offset:7168
    v_mfma_f32_16x16x32_bf16 v[120:123], v[28:31], v[48:51], v[120:123]
    buffer_load_dwordx4 v1, s[20:23], s49 offen offset:1024 lds
    v_mfma_f32_16x16x32_bf16 v[140:143], v[28:31], v[52:55], v[140:143]
    s_waitcnt lgkmcnt(10)
    s_add_u32 m0, s53, 0
    ds_read_b64_tr_b16 v[28:29], v9 offset:10304
    v_mfma_f32_16x16x32_bf16 v[84:87], v[32:35], v[40:43], v[84:87]
    s_add_u32 s48, s51, 983040
    ds_read_b64_tr_b16 v[30:31], v9 offset:15424
    v_mfma_f32_16x16x32_bf16 v[104:107], v[32:35], v[44:47], v[104:107]
    buffer_load_dwordx4 v2, s[16:19], s48 offen offset:0 lds
    v_mfma_f32_16x16x32_bf16 v[124:127], v[32:35], v[48:51], v[124:127]
    buffer_load_dwordx4 v3, s[16:19], s48 offen offset:1024 lds
    v_mfma_f32_16x16x32_bf16 v[144:147], v[32:35], v[52:55], v[144:147]
    s_waitcnt lgkmcnt(10)
    ds_read_b64_tr_b16 v[32:33], v10 offset:10336
    v_mfma_f32_16x16x32_bf16 v[88:91], v[36:39], v[40:43], v[88:91]
    ds_read_b64_tr_b16 v[34:35], v10 offset:15456
    v_mfma_f32_16x16x32_bf16 v[108:111], v[36:39], v[44:47], v[108:111]
    buffer_load_dwordx4 v4, s[16:19], s48 offen offset:2048 lds
    v_mfma_f32_16x16x32_bf16 v[128:131], v[36:39], v[48:51], v[128:131]
    buffer_load_dwordx4 v5, s[16:19], s48 offen offset:3072 lds
    v_mfma_f32_16x16x32_bf16 v[148:151], v[36:39], v[52:55], v[148:151]
    s_waitcnt lgkmcnt(4)
    s_add_u32 m0, s53, 4096
    ds_read_b64_tr_b16 v[36:37], v9 offset:10368
    v_mfma_f32_16x16x32_bf16 v[72:75], v[20:23], v[56:59], v[72:75]
    s_nop 0
    ds_read_b64_tr_b16 v[38:39], v9 offset:15488
    v_mfma_f32_16x16x32_bf16 v[92:95], v[20:23], v[60:63], v[92:95]
    v_add_u32 v9, 110592, v7
    v_add_u32 v10, 110592, v8
    v_mfma_f32_16x16x32_bf16 v[112:115], v[20:23], v[64:67], v[112:115]
    buffer_load_dwordx4 v6, s[16:19], s48 offen lds
    v_add_u32 v12, 110592, v11
    v_mfma_f32_16x16x32_bf16 v[132:135], v[20:23], v[68:71], v[132:135]
    s_waitcnt vmcnt(9) lgkmcnt(0)
    s_barrier
    v_mfma_f32_16x16x32_bf16 v[76:79], v[24:27], v[56:59], v[76:79]
    s_add_u32 s49, s52, 26624
    s_add_u32 m0, s54, 36864
    s_nop 0
    v_mfma_f32_16x16x32_bf16 v[96:99], v[24:27], v[60:63], v[96:99]
    ds_read_b64_tr_b16 v[20:21], v9 offset:0
    v_mfma_f32_16x16x32_bf16 v[116:119], v[24:27], v[64:67], v[116:119]
    ds_read_b64_tr_b16 v[22:23], v9 offset:5120
    v_mfma_f32_16x16x32_bf16 v[136:139], v[24:27], v[68:71], v[136:139]
    ds_read_b64_tr_b16 v[24:25], v10 offset:32
    v_mfma_f32_16x16x32_bf16 v[80:83], v[28:31], v[56:59], v[80:83]
    ds_read_b64_tr_b16 v[26:27], v10 offset:5152
    v_mfma_f32_16x16x32_bf16 v[100:103], v[28:31], v[60:63], v[100:103]
    ds_read_b128 v[40:43], v12 offset:0
    v_mfma_f32_16x16x32_bf16 v[120:123], v[28:31], v[64:67], v[120:123]
    ds_read_b128 v[44:47], v12 offset:2048
    v_mfma_f32_16x16x32_bf16 v[140:143], v[28:31], v[68:71], v[140:143]
    ds_read_b64_tr_b16 v[28:29], v9 offset:64
    v_mfma_f32_16x16x32_bf16 v[84:87], v[32:35], v[56:59], v[84:87]
    ds_read_b64_tr_b16 v[30:31], v9 offset:5184
    v_mfma_f32_16x16x32_bf16 v[104:107], v[32:35], v[60:63], v[104:107]
    ds_read_b128 v[48:51], v12 offset:4096
    v_mfma_f32_16x16x32_bf16 v[124:127], v[32:35], v[64:67], v[124:127]
    ds_read_b128 v[52:55], v12 offset:6144
    v_mfma_f32_16x16x32_bf16 v[144:147], v[32:35], v[68:71], v[144:147]
    ds_read_b64_tr_b16 v[32:33], v10 offset:96
    v_mfma_f32_16x16x32_bf16 v[88:91], v[36:39], v[56:59], v[88:91]
    ds_read_b64_tr_b16 v[34:35], v10 offset:5216
    v_mfma_f32_16x16x32_bf16 v[108:111], v[36:39], v[60:63], v[108:111]
    buffer_load_dwordx4 v1, s[20:23], s49 offen offset:0 lds
    v_mfma_f32_16x16x32_bf16 v[128:131], v[36:39], v[64:67], v[128:131]
    buffer_load_dwordx4 v1, s[20:23], s49 offen offset:1024 lds
    v_mfma_f32_16x16x32_bf16 v[148:151], v[36:39], v[68:71], v[148:151]
    s_waitcnt lgkmcnt(2)
    s_add_u32 s49, s52, 157696
    ds_read_b64_tr_b16 v[36:37], v9 offset:128
    v_mfma_f32_16x16x32_bf16 v[72:75], v[20:23], v[40:43], v[72:75]
    s_add_u32 m0, s54, 38912
    s_nop 0
    ds_read_b64_tr_b16 v[38:39], v9 offset:5248
    v_mfma_f32_16x16x32_bf16 v[92:95], v[20:23], v[44:47], v[92:95]
    ds_read_b128 v[56:59], v12 offset:1024
    v_mfma_f32_16x16x32_bf16 v[112:115], v[20:23], v[48:51], v[112:115]
    buffer_load_dwordx4 v1, s[20:23], s49 offen offset:0 lds
    v_mfma_f32_16x16x32_bf16 v[132:135], v[20:23], v[52:55], v[132:135]
    ds_read_b64_tr_b16 v[20:21], v9 offset:10240
    v_mfma_f32_16x16x32_bf16 v[76:79], v[24:27], v[40:43], v[76:79]
    ds_read_b64_tr_b16 v[22:23], v9 offset:15360
    v_mfma_f32_16x16x32_bf16 v[96:99], v[24:27], v[44:47], v[96:99]
    ds_read_b128 v[60:63], v12 offset:3072
    v_mfma_f32_16x16x32_bf16 v[116:119], v[24:27], v[48:51], v[116:119]
    ds_read_b128 v[64:67], v12 offset:5120
    v_mfma_f32_16x16x32_bf16 v[136:139], v[24:27], v[52:55], v[136:139]
    ds_read_b64_tr_b16 v[24:25], v10 offset:10272
    v_mfma_f32_16x16x32_bf16 v[80:83], v[28:31], v[40:43], v[80:83]
    ds_read_b64_tr_b16 v[26:27], v10 offset:15392
    v_mfma_f32_16x16x32_bf16 v[100:103], v[28:31], v[44:47], v[100:103]
    ds_read_b128 v[68:71], v12 offset:7168
    v_mfma_f32_16x16x32_bf16 v[120:123], v[28:31], v[48:51], v[120:123]
    buffer_load_dwordx4 v1, s[20:23], s49 offen offset:1024 lds
    v_mfma_f32_16x16x32_bf16 v[140:143], v[28:31], v[52:55], v[140:143]
    s_waitcnt lgkmcnt(10)
    s_add_u32 m0, s53, 36864
    ds_read_b64_tr_b16 v[28:29], v9 offset:10304
    v_mfma_f32_16x16x32_bf16 v[84:87], v[32:35], v[40:43], v[84:87]
    s_add_u32 s48, s51, 1064960
    ds_read_b64_tr_b16 v[30:31], v9 offset:15424
    v_mfma_f32_16x16x32_bf16 v[104:107], v[32:35], v[44:47], v[104:107]
    buffer_load_dwordx4 v2, s[16:19], s48 offen offset:0 lds
    v_mfma_f32_16x16x32_bf16 v[124:127], v[32:35], v[48:51], v[124:127]
    buffer_load_dwordx4 v3, s[16:19], s48 offen offset:1024 lds
    v_mfma_f32_16x16x32_bf16 v[144:147], v[32:35], v[52:55], v[144:147]
    s_waitcnt lgkmcnt(10)
    ds_read_b64_tr_b16 v[32:33], v10 offset:10336
    v_mfma_f32_16x16x32_bf16 v[88:91], v[36:39], v[40:43], v[88:91]
    ds_read_b64_tr_b16 v[34:35], v10 offset:15456
    v_mfma_f32_16x16x32_bf16 v[108:111], v[36:39], v[44:47], v[108:111]
    buffer_load_dwordx4 v4, s[16:19], s48 offen offset:2048 lds
    v_mfma_f32_16x16x32_bf16 v[128:131], v[36:39], v[48:51], v[128:131]
    buffer_load_dwordx4 v5, s[16:19], s48 offen offset:3072 lds
    v_mfma_f32_16x16x32_bf16 v[148:151], v[36:39], v[52:55], v[148:151]
    s_waitcnt lgkmcnt(4)
    s_add_u32 m0, s53, 40960
    ds_read_b64_tr_b16 v[36:37], v9 offset:10368
    v_mfma_f32_16x16x32_bf16 v[72:75], v[20:23], v[56:59], v[72:75]
    s_nop 0
    ds_read_b64_tr_b16 v[38:39], v9 offset:15488
    v_mfma_f32_16x16x32_bf16 v[92:95], v[20:23], v[60:63], v[92:95]
    v_add_u32 v9, 0, v7
    v_add_u32 v10, 0, v8
    v_mfma_f32_16x16x32_bf16 v[112:115], v[20:23], v[64:67], v[112:115]
    buffer_load_dwordx4 v6, s[16:19], s48 offen lds
    v_add_u32 v12, 0, v11
    v_mfma_f32_16x16x32_bf16 v[132:135], v[20:23], v[68:71], v[132:135]
    s_waitcnt vmcnt(9) lgkmcnt(0)
    s_barrier
    v_mfma_f32_16x16x32_bf16 v[76:79], v[24:27], v[56:59], v[76:79]
    s_add_u32 s49, s52, 28672
    s_add_u32 m0, s54, 73728
    s_nop 0
    v_mfma_f32_16x16x32_bf16 v[96:99], v[24:27], v[60:63], v[96:99]
    ds_read_b64_tr_b16 v[20:21], v9 offset:0
    v_mfma_f32_16x16x32_bf16 v[116:119], v[24:27], v[64:67], v[116:119]
    ds_read_b64_tr_b16 v[22:23], v9 offset:5120
    v_mfma_f32_16x16x32_bf16 v[136:139], v[24:27], v[68:71], v[136:139]
    ds_read_b64_tr_b16 v[24:25], v10 offset:32
    v_mfma_f32_16x16x32_bf16 v[80:83], v[28:31], v[56:59], v[80:83]
    ds_read_b64_tr_b16 v[26:27], v10 offset:5152
    v_mfma_f32_16x16x32_bf16 v[100:103], v[28:31], v[60:63], v[100:103]
    ds_read_b128 v[40:43], v12 offset:0
    v_mfma_f32_16x16x32_bf16 v[120:123], v[28:31], v[64:67], v[120:123]
    ds_read_b128 v[44:47], v12 offset:2048
    v_mfma_f32_16x16x32_bf16 v[140:143], v[28:31], v[68:71], v[140:143]
    ds_read_b64_tr_b16 v[28:29], v9 offset:64
    v_mfma_f32_16x16x32_bf16 v[84:87], v[32:35], v[56:59], v[84:87]
    ds_read_b64_tr_b16 v[30:31], v9 offset:5184
    v_mfma_f32_16x16x32_bf16 v[104:107], v[32:35], v[60:63], v[104:107]
    ds_read_b128 v[48:51], v12 offset:4096
    v_mfma_f32_16x16x32_bf16 v[124:127], v[32:35], v[64:67], v[124:127]
    ds_read_b128 v[52:55], v12 offset:6144
    v_mfma_f32_16x16x32_bf16 v[144:147], v[32:35], v[68:71], v[144:147]
    ds_read_b64_tr_b16 v[32:33], v10 offset:96
    v_mfma_f32_16x16x32_bf16 v[88:91], v[36:39], v[56:59], v[88:91]
    ds_read_b64_tr_b16 v[34:35], v10 offset:5216
    v_mfma_f32_16x16x32_bf16 v[108:111], v[36:39], v[60:63], v[108:111]
    buffer_load_dwordx4 v1, s[20:23], s49 offen offset:0 lds
    v_mfma_f32_16x16x32_bf16 v[128:131], v[36:39], v[64:67], v[128:131]
    buffer_load_dwordx4 v1, s[20:23], s49 offen offset:1024 lds
    v_mfma_f32_16x16x32_bf16 v[148:151], v[36:39], v[68:71], v[148:151]
    s_waitcnt lgkmcnt(2)
    s_add_u32 s49, s52, 159744
    ds_read_b64_tr_b16 v[36:37], v9 offset:128
    v_mfma_f32_16x16x32_bf16 v[72:75], v[20:23], v[40:43], v[72:75]
    s_add_u32 m0, s54, 75776
    s_nop 0
    ds_read_b64_tr_b16 v[38:39], v9 offset:5248
    v_mfma_f32_16x16x32_bf16 v[92:95], v[20:23], v[44:47], v[92:95]
    ds_read_b128 v[56:59], v12 offset:1024
    v_mfma_f32_16x16x32_bf16 v[112:115], v[20:23], v[48:51], v[112:115]
    buffer_load_dwordx4 v1, s[20:23], s49 offen offset:0 lds
    v_mfma_f32_16x16x32_bf16 v[132:135], v[20:23], v[52:55], v[132:135]
    ds_read_b64_tr_b16 v[20:21], v9 offset:10240
    v_mfma_f32_16x16x32_bf16 v[76:79], v[24:27], v[40:43], v[76:79]
    ds_read_b64_tr_b16 v[22:23], v9 offset:15360
    v_mfma_f32_16x16x32_bf16 v[96:99], v[24:27], v[44:47], v[96:99]
    ds_read_b128 v[60:63], v12 offset:3072
    v_mfma_f32_16x16x32_bf16 v[116:119], v[24:27], v[48:51], v[116:119]
    ds_read_b128 v[64:67], v12 offset:5120
    v_mfma_f32_16x16x32_bf16 v[136:139], v[24:27], v[52:55], v[136:139]
    ds_read_b64_tr_b16 v[24:25], v10 offset:10272
    v_mfma_f32_16x16x32_bf16 v[80:83], v[28:31], v[40:43], v[80:83]
    ds_read_b64_tr_b16 v[26:27], v10 offset:15392
    v_mfma_f32_16x16x32_bf16 v[100:103], v[28:31], v[44:47], v[100:103]
    ds_read_b128 v[68:71], v12 offset:7168
    v_mfma_f32_16x16x32_bf16 v[120:123], v[28:31], v[48:51], v[120:123]
    buffer_load_dwordx4 v1, s[20:23], s49 offen offset:1024 lds
    v_mfma_f32_16x16x32_bf16 v[140:143], v[28:31], v[52:55], v[140:143]
    s_waitcnt lgkmcnt(10)
    s_add_u32 m0, s53, 73728
    ds_read_b64_tr_b16 v[28:29], v9 offset:10304
    v_mfma_f32_16x16x32_bf16 v[84:87], v[32:35], v[40:43], v[84:87]
    s_add_u32 s48, s51, 1146880
    ds_read_b64_tr_b16 v[30:31], v9 offset:15424
    v_mfma_f32_16x16x32_bf16 v[104:107], v[32:35], v[44:47], v[104:107]
    buffer_load_dwordx4 v2, s[16:19], s48 offen offset:0 lds
    v_mfma_f32_16x16x32_bf16 v[124:127], v[32:35], v[48:51], v[124:127]
    buffer_load_dwordx4 v3, s[16:19], s48 offen offset:1024 lds
    v_mfma_f32_16x16x32_bf16 v[144:147], v[32:35], v[52:55], v[144:147]
    s_waitcnt lgkmcnt(10)
    ds_read_b64_tr_b16 v[32:33], v10 offset:10336
    v_mfma_f32_16x16x32_bf16 v[88:91], v[36:39], v[40:43], v[88:91]
    ds_read_b64_tr_b16 v[34:35], v10 offset:15456
    v_mfma_f32_16x16x32_bf16 v[108:111], v[36:39], v[44:47], v[108:111]
    buffer_load_dwordx4 v4, s[16:19], s48 offen offset:2048 lds
    v_mfma_f32_16x16x32_bf16 v[128:131], v[36:39], v[48:51], v[128:131]
    buffer_load_dwordx4 v5, s[16:19], s48 offen offset:3072 lds
    v_mfma_f32_16x16x32_bf16 v[148:151], v[36:39], v[52:55], v[148:151]
    s_waitcnt lgkmcnt(4)
    s_add_u32 m0, s53, 77824
    ds_read_b64_tr_b16 v[36:37], v9 offset:10368
    v_mfma_f32_16x16x32_bf16 v[72:75], v[20:23], v[56:59], v[72:75]
    s_nop 0
    ds_read_b64_tr_b16 v[38:39], v9 offset:15488
    v_mfma_f32_16x16x32_bf16 v[92:95], v[20:23], v[60:63], v[92:95]
    v_add_u32 v9, 36864, v7
    v_add_u32 v10, 36864, v8
    v_mfma_f32_16x16x32_bf16 v[112:115], v[20:23], v[64:67], v[112:115]
    buffer_load_dwordx4 v6, s[16:19], s48 offen lds
    v_add_u32 v12, 36864, v11
    v_mfma_f32_16x16x32_bf16 v[132:135], v[20:23], v[68:71], v[132:135]
    s_waitcnt vmcnt(9) lgkmcnt(0)
    s_barrier
    v_mfma_f32_16x16x32_bf16 v[76:79], v[24:27], v[56:59], v[76:79]
    s_add_u32 s49, s52, 30720
    s_add_u32 m0, s54, 110592
    s_nop 0
    v_mfma_f32_16x16x32_bf16 v[96:99], v[24:27], v[60:63], v[96:99]
    ds_read_b64_tr_b16 v[20:21], v9 offset:0
    v_mfma_f32_16x16x32_bf16 v[116:119], v[24:27], v[64:67], v[116:119]
    ds_read_b64_tr_b16 v[22:23], v9 offset:5120
    v_mfma_f32_16x16x32_bf16 v[136:139], v[24:27], v[68:71], v[136:139]
    ds_read_b64_tr_b16 v[24:25], v10 offset:32
    v_mfma_f32_16x16x32_bf16 v[80:83], v[28:31], v[56:59], v[80:83]
    ds_read_b64_tr_b16 v[26:27], v10 offset:5152
    v_mfma_f32_16x16x32_bf16 v[100:103], v[28:31], v[60:63], v[100:103]
    ds_read_b128 v[40:43], v12 offset:0
    v_mfma_f32_16x16x32_bf16 v[120:123], v[28:31], v[64:67], v[120:123]
    ds_read_b128 v[44:47], v12 offset:2048
    v_mfma_f32_16x16x32_bf16 v[140:143], v[28:31], v[68:71], v[140:143]
    ds_read_b64_tr_b16 v[28:29], v9 offset:64
    v_mfma_f32_16x16x32_bf16 v[84:87], v[32:35], v[56:59], v[84:87]
    ds_read_b64_tr_b16 v[30:31], v9 offset:5184
    v_mfma_f32_16x16x32_bf16 v[104:107], v[32:35], v[60:63], v[104:107]
    ds_read_b128 v[48:51], v12 offset:4096
    v_mfma_f32_16x16x32_bf16 v[124:127], v[32:35], v[64:67], v[124:127]
    ds_read_b128 v[52:55], v12 offset:6144
    v_mfma_f32_16x16x32_bf16 v[144:147], v[32:35], v[68:71], v[144:147]
    ds_read_b64_tr_b16 v[32:33], v10 offset:96
    v_mfma_f32_16x16x32_bf16 v[88:91], v[36:39], v[56:59], v[88:91]
    ds_read_b64_tr_b16 v[34:35], v10 offset:5216
    v_mfma_f32_16x16x32_bf16 v[108:111], v[36:39], v[60:63], v[108:111]
    buffer_load_dwordx4 v1, s[20:23], s49 offen offset:0 lds
    v_mfma_f32_16x16x32_bf16 v[128:131], v[36:39], v[64:67], v[128:131]
    buffer_load_dwordx4 v1, s[20:23], s49 offen offset:1024 lds
    v_mfma_f32_16x16x32_bf16 v[148:151], v[36:39], v[68:71], v[148:151]
    s_waitcnt lgkmcnt(2)
    s_add_u32 s49, s52, 161792
    ds_read_b64_tr_b16 v[36:37], v9 offset:128
    v_mfma_f32_16x16x32_bf16 v[72:75], v[20:23], v[40:43], v[72:75]
    s_add_u32 m0, s54, 112640
    s_nop 0
    ds_read_b64_tr_b16 v[38:39], v9 offset:5248
    v_mfma_f32_16x16x32_bf16 v[92:95], v[20:23], v[44:47], v[92:95]
    ds_read_b128 v[56:59], v12 offset:1024
    v_mfma_f32_16x16x32_bf16 v[112:115], v[20:23], v[48:51], v[112:115]
    buffer_load_dwordx4 v1, s[20:23], s49 offen offset:0 lds
    v_mfma_f32_16x16x32_bf16 v[132:135], v[20:23], v[52:55], v[132:135]
    ds_read_b64_tr_b16 v[20:21], v9 offset:10240
    v_mfma_f32_16x16x32_bf16 v[76:79], v[24:27], v[40:43], v[76:79]
    ds_read_b64_tr_b16 v[22:23], v9 offset:15360
    v_mfma_f32_16x16x32_bf16 v[96:99], v[24:27], v[44:47], v[96:99]
    ds_read_b128 v[60:63], v12 offset:3072
    v_mfma_f32_16x16x32_bf16 v[116:119], v[24:27], v[48:51], v[116:119]
    ds_read_b128 v[64:67], v12 offset:5120
    v_mfma_f32_16x16x32_bf16 v[136:139], v[24:27], v[52:55], v[136:139]
    ds_read_b64_tr_b16 v[24:25], v10 offset:10272
    v_mfma_f32_16x16x32_bf16 v[80:83], v[28:31], v[40:43], v[80:83]
    ds_read_b64_tr_b16 v[26:27], v10 offset:15392
    v_mfma_f32_16x16x32_bf16 v[100:103], v[28:31], v[44:47], v[100:103]
    ds_read_b128 v[68:71], v12 offset:7168
    v_mfma_f32_16x16x32_bf16 v[120:123], v[28:31], v[48:51], v[120:123]
    buffer_load_dwordx4 v1, s[20:23], s49 offen offset:1024 lds
    v_mfma_f32_16x16x32_bf16 v[140:143], v[28:31], v[52:55], v[140:143]
    s_waitcnt lgkmcnt(10)
    s_add_u32 m0, s53, 110592
    ds_read_b64_tr_b16 v[28:29], v9 offset:10304
    v_mfma_f32_16x16x32_bf16 v[84:87], v[32:35], v[40:43], v[84:87]
    s_add_u32 s48, s51, 1228800
    ds_read_b64_tr_b16 v[30:31], v9 offset:15424
    v_mfma_f32_16x16x32_bf16 v[104:107], v[32:35], v[44:47], v[104:107]
    buffer_load_dwordx4 v2, s[16:19], s48 offen offset:0 lds
    v_mfma_f32_16x16x32_bf16 v[124:127], v[32:35], v[48:51], v[124:127]
    buffer_load_dwordx4 v3, s[16:19], s48 offen offset:1024 lds
    v_mfma_f32_16x16x32_bf16 v[144:147], v[32:35], v[52:55], v[144:147]
    s_waitcnt lgkmcnt(10)
    ds_read_b64_tr_b16 v[32:33], v10 offset:10336
    v_mfma_f32_16x16x32_bf16 v[88:91], v[36:39], v[40:43], v[88:91]
    ds_read_b64_tr_b16 v[34:35], v10 offset:15456
    v_mfma_f32_16x16x32_bf16 v[108:111], v[36:39], v[44:47], v[108:111]
    buffer_load_dwordx4 v4, s[16:19], s48 offen offset:2048 lds
    v_mfma_f32_16x16x32_bf16 v[128:131], v[36:39], v[48:51], v[128:131]
    buffer_load_dwordx4 v5, s[16:19], s48 offen offset:3072 lds
    v_mfma_f32_16x16x32_bf16 v[148:151], v[36:39], v[52:55], v[148:151]
    s_waitcnt lgkmcnt(4)
    s_add_u32 m0, s53, 114688
    ds_read_b64_tr_b16 v[36:37], v9 offset:10368
    v_mfma_f32_16x16x32_bf16 v[72:75], v[20:23], v[56:59], v[72:75]
    s_nop 0
    ds_read_b64_tr_b16 v[38:39], v9 offset:15488
    v_mfma_f32_16x16x32_bf16 v[92:95], v[20:23], v[60:63], v[92:95]
    v_add_u32 v9, 73728, v7
    v_add_u32 v10, 73728, v8
    v_mfma_f32_16x16x32_bf16 v[112:115], v[20:23], v[64:67], v[112:115]
    buffer_load_dwordx4 v6, s[16:19], s48 offen lds
    v_add_u32 v12, 73728, v11
    v_mfma_f32_16x16x32_bf16 v[132:135], v[20:23], v[68:71], v[132:135]
    s_waitcnt vmcnt(9) lgkmcnt(0)
    s_barrier
    v_mfma_f32_16x16x32_bf16 v[76:79], v[24:27], v[56:59], v[76:79]
    v_mfma_f32_16x16x32_bf16 v[96:99], v[24:27], v[60:63], v[96:99]
    ds_read_b64_tr_b16 v[20:21], v9 offset:0
    v_mfma_f32_16x16x32_bf16 v[116:119], v[24:27], v[64:67], v[116:119]
    ds_read_b64_tr_b16 v[22:23], v9 offset:5120
    v_mfma_f32_16x16x32_bf16 v[136:139], v[24:27], v[68:71], v[136:139]
    ds_read_b64_tr_b16 v[24:25], v10 offset:32
    v_mfma_f32_16x16x32_bf16 v[80:83], v[28:31], v[56:59], v[80:83]
    ds_read_b64_tr_b16 v[26:27], v10 offset:5152
    v_mfma_f32_16x16x32_bf16 v[100:103], v[28:31], v[60:63], v[100:103]
    ds_read_b128 v[40:43], v12 offset:0
    v_mfma_f32_16x16x32_bf16 v[120:123], v[28:31], v[64:67], v[120:123]
    ds_read_b128 v[44:47], v12 offset:2048
    v_mfma_f32_16x16x32_bf16 v[140:143], v[28:31], v[68:71], v[140:143]
    ds_read_b64_tr_b16 v[28:29], v9 offset:64
    v_mfma_f32_16x16x32_bf16 v[84:87], v[32:35], v[56:59], v[84:87]
    ds_read_b64_tr_b16 v[30:31], v9 offset:5184
    v_mfma_f32_16x16x32_bf16 v[104:107], v[32:35], v[60:63], v[104:107]
    ds_read_b128 v[48:51], v12 offset:4096
    v_mfma_f32_16x16x32_bf16 v[124:127], v[32:35], v[64:67], v[124:127]
    ds_read_b128 v[52:55], v12 offset:6144
    v_mfma_f32_16x16x32_bf16 v[144:147], v[32:35], v[68:71], v[144:147]
    ds_read_b64_tr_b16 v[32:33], v10 offset:96
    v_mfma_f32_16x16x32_bf16 v[88:91], v[36:39], v[56:59], v[88:91]
    ds_read_b64_tr_b16 v[34:35], v10 offset:5216
    v_mfma_f32_16x16x32_bf16 v[108:111], v[36:39], v[60:63], v[108:111]
    v_mfma_f32_16x16x32_bf16 v[128:131], v[36:39], v[64:67], v[128:131]
    v_mfma_f32_16x16x32_bf16 v[148:151], v[36:39], v[68:71], v[148:151]
    s_waitcnt lgkmcnt(2)
    ds_read_b64_tr_b16 v[36:37], v9 offset:128
    v_mfma_f32_16x16x32_bf16 v[72:75], v[20:23], v[40:43], v[72:75]
    ds_read_b64_tr_b16 v[38:39], v9 offset:5248
    v_mfma_f32_16x16x32_bf16 v[92:95], v[20:23], v[44:47], v[92:95]
    ds_read_b128 v[56:59], v12 offset:1024
    v_mfma_f32_16x16x32_bf16 v[112:115], v[20:23], v[48:51], v[112:115]
    v_mfma_f32_16x16x32_bf16 v[132:135], v[20:23], v[52:55], v[132:135]
    ds_read_b64_tr_b16 v[20:21], v9 offset:10240
    v_mfma_f32_16x16x32_bf16 v[76:79], v[24:27], v[40:43], v[76:79]
    ds_read_b64_tr_b16 v[22:23], v9 offset:15360
    v_mfma_f32_16x16x32_bf16 v[96:99], v[24:27], v[44:47], v[96:99]
    ds_read_b128 v[60:63], v12 offset:3072
    v_mfma_f32_16x16x32_bf16 v[116:119], v[24:27], v[48:51], v[116:119]
    ds_read_b128 v[64:67], v12 offset:5120
    v_mfma_f32_16x16x32_bf16 v[136:139], v[24:27], v[52:55], v[136:139]
    ds_read_b64_tr_b16 v[24:25], v10 offset:10272
    v_mfma_f32_16x16x32_bf16 v[80:83], v[28:31], v[40:43], v[80:83]
    ds_read_b64_tr_b16 v[26:27], v10 offset:15392
    v_mfma_f32_16x16x32_bf16 v[100:103], v[28:31], v[44:47], v[100:103]
    ds_read_b128 v[68:71], v12 offset:7168
    v_mfma_f32_16x16x32_bf16 v[120:123], v[28:31], v[48:51], v[120:123]
    v_mfma_f32_16x16x32_bf16 v[140:143], v[28:31], v[52:55], v[140:143]
    s_waitcnt lgkmcnt(10)
    ds_read_b64_tr_b16 v[28:29], v9 offset:10304
    v_mfma_f32_16x16x32_bf16 v[84:87], v[32:35], v[40:43], v[84:87]
    ds_read_b64_tr_b16 v[30:31], v9 offset:15424
    v_mfma_f32_16x16x32_bf16 v[104:107], v[32:35], v[44:47], v[104:107]
    v_mfma_f32_16x16x32_bf16 v[124:127], v[32:35], v[48:51], v[124:127]
    v_mfma_f32_16x16x32_bf16 v[144:147], v[32:35], v[52:55], v[144:147]
    s_waitcnt lgkmcnt(10)
    ds_read_b64_tr_b16 v[32:33], v10 offset:10336
    v_mfma_f32_16x16x32_bf16 v[88:91], v[36:39], v[40:43], v[88:91]
    ds_read_b64_tr_b16 v[34:35], v10 offset:15456
    v_mfma_f32_16x16x32_bf16 v[108:111], v[36:39], v[44:47], v[108:111]
    v_mfma_f32_16x16x32_bf16 v[128:131], v[36:39], v[48:51], v[128:131]
    v_mfma_f32_16x16x32_bf16 v[148:151], v[36:39], v[52:55], v[148:151]
    s_waitcnt lgkmcnt(4)
    ds_read_b64_tr_b16 v[36:37], v9 offset:10368
    v_mfma_f32_16x16x32_bf16 v[72:75], v[20:23], v[56:59], v[72:75]
    ds_read_b64_tr_b16 v[38:39], v9 offset:15488
    v_mfma_f32_16x16x32_bf16 v[92:95], v[20:23], v[60:63], v[92:95]
    v_add_u32 v9, 110592, v7
    v_add_u32 v10, 110592, v8
    v_mfma_f32_16x16x32_bf16 v[112:115], v[20:23], v[64:67], v[112:115]
    v_add_u32 v12, 110592, v11
    v_mfma_f32_16x16x32_bf16 v[132:135], v[20:23], v[68:71], v[132:135]
    s_waitcnt vmcnt(0) lgkmcnt(0)
    s_barrier
    v_mfma_f32_16x16x32_bf16 v[76:79], v[24:27], v[56:59], v[76:79]
    v_mfma_f32_16x16x32_bf16 v[96:99], v[24:27], v[60:63], v[96:99]
    ds_read_b64_tr_b16 v[20:21], v9 offset:0
    v_mfma_f32_16x16x32_bf16 v[116:119], v[24:27], v[64:67], v[116:119]
    ds_read_b64_tr_b16 v[22:23], v9 offset:5120
    v_mfma_f32_16x16x32_bf16 v[136:139], v[24:27], v[68:71], v[136:139]
    ds_read_b64_tr_b16 v[24:25], v10 offset:32
    v_mfma_f32_16x16x32_bf16 v[80:83], v[28:31], v[56:59], v[80:83]
    ds_read_b64_tr_b16 v[26:27], v10 offset:5152
    v_mfma_f32_16x16x32_bf16 v[100:103], v[28:31], v[60:63], v[100:103]
    ds_read_b128 v[40:43], v12 offset:0
    v_mfma_f32_16x16x32_bf16 v[120:123], v[28:31], v[64:67], v[120:123]
    ds_read_b128 v[44:47], v12 offset:2048
    v_mfma_f32_16x16x32_bf16 v[140:143], v[28:31], v[68:71], v[140:143]
    ds_read_b64_tr_b16 v[28:29], v9 offset:64
    v_mfma_f32_16x16x32_bf16 v[84:87], v[32:35], v[56:59], v[84:87]
    ds_read_b64_tr_b16 v[30:31], v9 offset:5184
    v_mfma_f32_16x16x32_bf16 v[104:107], v[32:35], v[60:63], v[104:107]
    ds_read_b128 v[48:51], v12 offset:4096
    v_mfma_f32_16x16x32_bf16 v[124:127], v[32:35], v[64:67], v[124:127]
    ds_read_b128 v[52:55], v12 offset:6144
    v_mfma_f32_16x16x32_bf16 v[144:147], v[32:35], v[68:71], v[144:147]
    ds_read_b64_tr_b16 v[32:33], v10 offset:96
    v_mfma_f32_16x16x32_bf16 v[88:91], v[36:39], v[56:59], v[88:91]
    ds_read_b64_tr_b16 v[34:35], v10 offset:5216
    v_mfma_f32_16x16x32_bf16 v[108:111], v[36:39], v[60:63], v[108:111]
    v_mfma_f32_16x16x32_bf16 v[128:131], v[36:39], v[64:67], v[128:131]
    v_mfma_f32_16x16x32_bf16 v[148:151], v[36:39], v[68:71], v[148:151]
    s_waitcnt lgkmcnt(2)
    ds_read_b64_tr_b16 v[36:37], v9 offset:128
    v_mfma_f32_16x16x32_bf16 v[72:75], v[20:23], v[40:43], v[72:75]
    ds_read_b64_tr_b16 v[38:39], v9 offset:5248
    v_mfma_f32_16x16x32_bf16 v[92:95], v[20:23], v[44:47], v[92:95]
    ds_read_b128 v[56:59], v12 offset:1024
    v_mfma_f32_16x16x32_bf16 v[112:115], v[20:23], v[48:51], v[112:115]
    v_mfma_f32_16x16x32_bf16 v[132:135], v[20:23], v[52:55], v[132:135]
    ds_read_b64_tr_b16 v[20:21], v9 offset:10240
    v_mfma_f32_16x16x32_bf16 v[76:79], v[24:27], v[40:43], v[76:79]
    ds_read_b64_tr_b16 v[22:23], v9 offset:15360
    v_mfma_f32_16x16x32_bf16 v[96:99], v[24:27], v[44:47], v[96:99]
    ds_read_b128 v[60:63], v12 offset:3072
    v_mfma_f32_16x16x32_bf16 v[116:119], v[24:27], v[48:51], v[116:119]
    ds_read_b128 v[64:67], v12 offset:5120
    v_mfma_f32_16x16x32_bf16 v[136:139], v[24:27], v[52:55], v[136:139]
    ds_read_b64_tr_b16 v[24:25], v10 offset:10272
    v_mfma_f32_16x16x32_bf16 v[80:83], v[28:31], v[40:43], v[80:83]
    ds_read_b64_tr_b16 v[26:27], v10 offset:15392
    v_mfma_f32_16x16x32_bf16 v[100:103], v[28:31], v[44:47], v[100:103]
    ds_read_b128 v[68:71], v12 offset:7168
    v_mfma_f32_16x16x32_bf16 v[120:123], v[28:31], v[48:51], v[120:123]
    v_mfma_f32_16x16x32_bf16 v[140:143], v[28:31], v[52:55], v[140:143]
    s_waitcnt lgkmcnt(10)
    ds_read_b64_tr_b16 v[28:29], v9 offset:10304
    v_mfma_f32_16x16x32_bf16 v[84:87], v[32:35], v[40:43], v[84:87]
    ds_read_b64_tr_b16 v[30:31], v9 offset:15424
    v_mfma_f32_16x16x32_bf16 v[104:107], v[32:35], v[44:47], v[104:107]
    v_mfma_f32_16x16x32_bf16 v[124:127], v[32:35], v[48:51], v[124:127]
    v_mfma_f32_16x16x32_bf16 v[144:147], v[32:35], v[52:55], v[144:147]
    s_waitcnt lgkmcnt(10)
    ds_read_b64_tr_b16 v[32:33], v10 offset:10336
    v_mfma_f32_16x16x32_bf16 v[88:91], v[36:39], v[40:43], v[88:91]
    ds_read_b64_tr_b16 v[34:35], v10 offset:15456
    v_mfma_f32_16x16x32_bf16 v[108:111], v[36:39], v[44:47], v[108:111]
    v_mfma_f32_16x16x32_bf16 v[128:131], v[36:39], v[48:51], v[128:131]
    v_mfma_f32_16x16x32_bf16 v[148:151], v[36:39], v[52:55], v[148:151]
    s_waitcnt lgkmcnt(4)
    ds_read_b64_tr_b16 v[36:37], v9 offset:10368
    v_mfma_f32_16x16x32_bf16 v[72:75], v[20:23], v[56:59], v[72:75]
    ds_read_b64_tr_b16 v[38:39], v9 offset:15488
    v_mfma_f32_16x16x32_bf16 v[92:95], v[20:23], v[60:63], v[92:95]
    v_mfma_f32_16x16x32_bf16 v[112:115], v[20:23], v[64:67], v[112:115]
    v_mfma_f32_16x16x32_bf16 v[132:135], v[20:23], v[68:71], v[132:135]
    v_mfma_f32_16x16x32_bf16 v[76:79], v[24:27], v[56:59], v[76:79]
    v_mfma_f32_16x16x32_bf16 v[96:99], v[24:27], v[60:63], v[96:99]
    v_mfma_f32_16x16x32_bf16 v[116:119], v[24:27], v[64:67], v[116:119]
    v_mfma_f32_16x16x32_bf16 v[136:139], v[24:27], v[68:71], v[136:139]
    s_waitcnt lgkmcnt(4)
    v_mfma_f32_16x16x32_bf16 v[80:83], v[28:31], v[56:59], v[80:83]
    v_mfma_f32_16x16x32_bf16 v[100:103], v[28:31], v[60:63], v[100:103]
    v_mfma_f32_16x16x32_bf16 v[120:123], v[28:31], v[64:67], v[120:123]
    v_mfma_f32_16x16x32_bf16 v[140:143], v[28:31], v[68:71], v[140:143]
    s_waitcnt lgkmcnt(2)
    v_mfma_f32_16x16x32_bf16 v[84:87], v[32:35], v[56:59], v[84:87]
    v_mfma_f32_16x16x32_bf16 v[104:107], v[32:35], v[60:63], v[104:107]
    v_mfma_f32_16x16x32_bf16 v[124:127], v[32:35], v[64:67], v[124:127]
    v_mfma_f32_16x16x32_bf16 v[144:147], v[32:35], v[68:71], v[144:147]
    s_waitcnt lgkmcnt(0)
    v_mfma_f32_16x16x32_bf16 v[88:91], v[36:39], v[56:59], v[88:91]
    v_mfma_f32_16x16x32_bf16 v[108:111], v[36:39], v[60:63], v[108:111]
    v_mfma_f32_16x16x32_bf16 v[128:131], v[36:39], v[64:67], v[128:131]
    v_mfma_f32_16x16x32_bf16 v[148:151], v[36:39], v[68:71], v[148:151]
    s_nop 7
    v_cvt_pk_bf16_f32 v72, v72, v73
    v_cvt_pk_bf16_f32 v73, v74, v75
    v_cvt_pk_bf16_f32 v74, v76, v77
    v_cvt_pk_bf16_f32 v75, v78, v79
    v_cvt_pk_bf16_f32 v76, v80, v81
    v_cvt_pk_bf16_f32 v77, v82, v83
    v_cvt_pk_bf16_f32 v78, v84, v85
    v_cvt_pk_bf16_f32 v79, v86, v87
    v_cvt_pk_bf16_f32 v80, v88, v89
    v_cvt_pk_bf16_f32 v81, v90, v91
    s_add_u32 s48, s55, 0
    buffer_store_dwordx4 v[72:75], v1, s[24:27], s48 offen sc1
    buffer_store_dwordx4 v[76:79], v1, s[24:27], s48 offen offset:1024 sc1
    v_cvt_pk_bf16_f32 v92, v92, v93
    v_cvt_pk_bf16_f32 v93, v94, v95
    v_cvt_pk_bf16_f32 v94, v96, v97
    v_cvt_pk_bf16_f32 v95, v98, v99
    v_cvt_pk_bf16_f32 v96, v100, v101
    v_cvt_pk_bf16_f32 v97, v102, v103
    v_cvt_pk_bf16_f32 v98, v104, v105
    v_cvt_pk_bf16_f32 v99, v106, v107
    v_cvt_pk_bf16_f32 v100, v108, v109
    v_cvt_pk_bf16_f32 v101, v110, v111
    s_add_u32 s48, s55, 20480
    buffer_store_dwordx4 v[92:95], v1, s[24:27], s48 offen sc1
    buffer_store_dwordx4 v[96:99], v1, s[24:27], s48 offen offset:1024 sc1
    v_mov_b32 v82, v100
    v_mov_b32 v83, v101
    s_add_u32 s48, s60, 0
    buffer_store_dwordx4 v[80:83], v1, s[24:27], s48 offen sc1
    v_cvt_pk_bf16_f32 v112, v112, v113
    v_cvt_pk_bf16_f32 v113, v114, v115
    v_cvt_pk_bf16_f32 v114, v116, v117
    v_cvt_pk_bf16_f32 v115, v118, v119
    v_cvt_pk_bf16_f32 v116, v120, v121
    v_cvt_pk_bf16_f32 v117, v122, v123
    v_cvt_pk_bf16_f32 v118, v124, v125
    v_cvt_pk_bf16_f32 v119, v126, v127
    v_cvt_pk_bf16_f32 v120, v128, v129
    v_cvt_pk_bf16_f32 v121, v130, v131
    s_add_u32 s48, s55, 40960
    buffer_store_dwordx4 v[112:115], v1, s[24:27], s48 offen sc1
    buffer_store_dwordx4 v[116:119], v1, s[24:27], s48 offen offset:1024 sc1
    v_cvt_pk_bf16_f32 v132, v132, v133
    v_cvt_pk_bf16_f32 v133, v134, v135
    v_cvt_pk_bf16_f32 v134, v136, v137
    v_cvt_pk_bf16_f32 v135, v138, v139
    v_cvt_pk_bf16_f32 v136, v140, v141
    v_cvt_pk_bf16_f32 v137, v142, v143
    v_cvt_pk_bf16_f32 v138, v144, v145
    v_cvt_pk_bf16_f32 v139, v146, v147
    v_cvt_pk_bf16_f32 v140, v148, v149
    v_cvt_pk_bf16_f32 v141, v150, v151
    s_add_u32 s48, s55, 61440
    buffer_store_dwordx4 v[132:135], v1, s[24:27], s48 offen sc1
    buffer_store_dwordx4 v[136:139], v1, s[24:27], s48 offen offset:1024 sc1
    v_mov_b32 v122, v140
    v_mov_b32 v123, v141
    s_add_u32 s48, s60, 8192
    buffer_store_dwordx4 v[120:123], v1, s[24:27], s48 offen sc1
    s_waitcnt vmcnt(0)
    s_barrier
    s_cmp_lg_u32 s44, 0
    s_cbranch_scc1 sequential_preLN__compressed_kv_cla__moe_arch_mod__prompt_kernel_t_nosig
    s_lshl_b32 s48, s46, 7
    s_lshl_b32 s49, s45, 4
    s_add_u32 s48, s48, s49
    s_lshl_b32 s49, s47, 2
    s_add_u32 s48, s48, s49
    s_add_u32 s48, s48, 2105344
    v_mov_b32 v13, 0
    v_mov_b32 v14, s3
    v_cmp_eq_u32 vcc, 0, v0
    s_nop 1
    s_and_saveexec_b64 s[14:15], vcc
    buffer_store_dword v14, v13, s[56:59], s48 offen sc1
    s_mov_b64 exec, s[14:15]
sequential_preLN__compressed_kv_cla__moe_arch_mod__prompt_kernel_t_nosig:
    s_lshl_b32 s55, s45, 2
    s_add_u32 s55, s55, s47
    v_and_b32 v2, 7, v0
    v_bfe_u32 v13, v0, 3, 2
    v_lshrrev_b32 v14, 5, v0
    s_lshr_b32 s48, s55, 1
    s_lshl_b32 s49, s46, 3
    s_add_u32 s48, s48, s49
    s_mov_b32 s70, s48
    s_lshl_b32 s49, s48, 4
    s_and_b32 s50, s55, 1
    s_lshl_b32 s50, s50, 3
    s_add_u32 s49, s49, s50
    v_add_u32 v8, s49, v2
    v_lshl_add_u32 v15, v13, 4, v2
    v_add_u32 v15, s50, v15
    s_lshl_b32 s48, s48, 3
    s_lshl_b32 s50, s44, 1
    s_add_u32 s48, s48, s50
    v_add_u32 v16, s48, v14
    v_mul_u32_u24 v16, 2560, v16
    v_lshl_add_u32 v3, v15, 4, v16
    s_lshr_b32 s14, s70, 1
    s_lshl_b32 s14, s14, 3
    s_add_u32 s14, s14, s50
    v_add_u32 v4, s14, v14
    v_lshlrev_b32 v4, 10, v4
    v_lshl_add_u32 v4, v15, 4, v4
    s_and_b32 s14, s70, 1
    s_lshl_b32 s14, s14, 3
    s_add_u32 s14, s14, 10485760
    v_add_u32 v4, s14, v4
    s_mul_i32 s50, s44, 320
    v_mul_u32_u24 v17, 160, v14
    v_lshl_add_u32 v17, v13, 3, v17
    v_add_u32 v17, s50, v17
    v_mul_u32_u24 v5, 1280, v8
    v_add_u32 v5, v5, v17
    s_load_dwordx2 s[14:15], s[0:1], 56
    buffer_load_dwordx2 v[60:61], v5, s[32:35], 0 offen offset:0
    buffer_load_dwordx2 v[62:63], v5, s[32:35], 0 offen offset:32
    buffer_load_dwordx2 v[64:65], v5, s[32:35], 0 offen offset:64
    buffer_load_dwordx2 v[66:67], v5, s[32:35], 0 offen offset:96
    buffer_load_dwordx2 v[68:69], v5, s[32:35], 0 offen offset:128
    s_waitcnt lgkmcnt(0)
    s_mov_b32 s8, s14
    s_mov_b32 s9, s15
    s_mov_b32 s10, 1280
    s_mov_b32 s11, 0x00020000
    buffer_load_dwordx2 v[70:71], v17, s[8:11], 0 offen offset:0
    buffer_load_dwordx2 v[72:73], v17, s[8:11], 0 offen offset:32
    buffer_load_dwordx2 v[74:75], v17, s[8:11], 0 offen offset:64
    buffer_load_dwordx2 v[76:77], v17, s[8:11], 0 offen offset:96
    buffer_load_dwordx2 v[78:79], v17, s[8:11], 0 offen offset:128
    s_lshl_b32 s49, s44, 5
    v_lshlrev_b32 v6, 2, v2
    v_add_u32 v6, 143360, v6
    v_add_u32 v7, s49, v6
    s_cmp_ge_u32 s62, 54
    s_cbranch_scc1 sequential_preLN__compressed_kv_cla__moe_arch_mod__prompt_kernel_t_nowl
    s_mul_i32 s50, s44, 10240
    v_add_u32 v126, s50, v1
    v_add_u32 v127, 65536, v126
    ds_write_b128 v126, a[132:135] offset:0
    ds_write_b128 v126, a[136:139] offset:1024
    ds_write_b128 v126, a[140:143] offset:2048
    ds_write_b128 v126, a[144:147] offset:3072
    ds_write_b128 v126, a[148:151] offset:4096
    ds_write_b128 v126, a[152:155] offset:5120
    ds_write_b128 v126, a[156:159] offset:6144
    ds_write_b128 v126, a[160:163] offset:7168
    ds_write_b128 v126, a[164:167] offset:8192
    ds_write_b128 v126, a[168:171] offset:9216
    ds_write_b128 v126, a[172:175] offset:40960
    ds_write_b128 v126, a[176:179] offset:41984
    ds_write_b128 v126, a[180:183] offset:43008
    ds_write_b128 v126, a[184:187] offset:44032
    ds_write_b128 v126, a[188:191] offset:45056
    ds_write_b128 v126, a[192:195] offset:46080
    ds_write_b128 v126, a[196:199] offset:47104
    ds_write_b128 v126, a[200:203] offset:48128
    ds_write_b128 v126, a[204:207] offset:49152
    ds_write_b128 v126, a[208:211] offset:50176
    ds_write_b128 v127, a[212:215] offset:16384
    ds_write_b128 v127, a[216:219] offset:17408
    ds_write_b128 v127, a[220:223] offset:18432
    ds_write_b128 v127, a[224:227] offset:19456
    ds_write_b128 v127, a[228:231] offset:20480
    ds_write_b128 v127, a[232:235] offset:21504
    ds_write_b128 v127, a[236:239] offset:22528
    ds_write_b128 v127, a[240:243] offset:23552
    ds_write_b128 v127, a[244:247] offset:24576
    ds_write_b128 v127, a[248:251] offset:25600
sequential_preLN__compressed_kv_cla__moe_arch_mod__prompt_kernel_t_nowl:
    s_cmp_lg_u32 s44, 0
    s_cbranch_scc1 sequential_preLN__compressed_kv_cla__moe_arch_mod__prompt_kernel_t_w1
    s_lshl_b32 s48, s46, 7
    s_add_u32 s48, s48, 2105344
    v_and_b32 v126, 15, v0
    v_lshlrev_b32 v126, 2, v126
    s_mov_b32 s49, 0
sequential_preLN__compressed_kv_cla__moe_arch_mod__prompt_kernel_t_pollM_2:
    buffer_load_dword v127, v126, s[56:59], s48 offen sc1
    s_waitcnt vmcnt(0)
    v_cmp_ne_u32 vcc, s3, v127
    s_add_u32 s49, s49, 1
    s_cbranch_vccz sequential_preLN__compressed_kv_cla__moe_arch_mod__prompt_kernel_t_pollM_2_ok
    s_cmp_ge_u32 s49, 65536
    s_cbranch_scc1 sequential_preLN__compressed_kv_cla__moe_arch_mod__prompt_kernel_t_pollM_2_ok
    s_sleep 2
    s_branch sequential_preLN__compressed_kv_cla__moe_arch_mod__prompt_kernel_t_pollM_2
sequential_preLN__compressed_kv_cla__moe_arch_mod__prompt_kernel_t_pollM_2_ok:
sequential_preLN__compressed_kv_cla__moe_arch_mod__prompt_kernel_t_w1:
    s_barrier
    s_mov_b32 s48, 0
    buffer_load_dwordx4 v[20:23], v3, s[24:27], s48 offen sc1
    buffer_load_dwordx4 v[24:27], v3, s[24:27], s48 offen offset:1024 sc1
    s_mov_b32 s49, 0
    buffer_load_dwordx2 v[28:29], v4, s[24:27], s49 offen sc1
    s_mov_b32 s48, 2621440
    buffer_load_dwordx4 v[30:33], v3, s[24:27], s48 offen sc1
    buffer_load_dwordx4 v[34:37], v3, s[24:27], s48 offen offset:1024 sc1
    s_mov_b32 s49, 524288
    buffer_load_dwordx2 v[38:39], v4, s[24:27], s49 offen sc1
    s_mov_b32 s48, 5242880
    buffer_load_dwordx4 v[40:43], v3, s[24:27], s48 offen sc1
    buffer_load_dwordx4 v[44:47], v3, s[24:27], s48 offen offset:1024 sc1
    s_mov_b32 s49, 1048576
    buffer_load_dwordx2 v[48:49], v4, s[24:27], s49 offen sc1
    s_mov_b32 s48, 7864320
    buffer_load_dwordx4 v[50:53], v3, s[24:27], s48 offen sc1
    buffer_load_dwordx4 v[54:57], v3, s[24:27], s48 offen offset:1024 sc1
    s_mov_b32 s49, 1572864
    buffer_load_dwordx2 v[58:59], v4, s[24:27], s49 offen sc1
    s_waitcnt vmcnt(0)
    v_mov_b32 v126, 143360
    v_mov_b32 v127, 0
    ds_write_b32 v126, v127 offset:516
    s_mov_b32 s61, 0xffff0000
    v_lshlrev_b32 v80, 16, v20
    v_and_b32 v81, s61, v20
    v_lshlrev_b32 v82, 16, v21
    v_and_b32 v83, s61, v21
    v_lshlrev_b32 v84, 16, v22
    v_and_b32 v85, s61, v22
    v_lshlrev_b32 v86, 16, v23
    v_and_b32 v87, s61, v23
    v_lshlrev_b32 v88, 16, v24
    v_and_b32 v89, s61, v24
    v_lshlrev_b32 v90, 16, v25
    v_and_b32 v91, s61, v25
    v_lshlrev_b32 v92, 16, v26
    v_and_b32 v93, s61, v26
    v_lshlrev_b32 v94, 16, v27
    v_and_b32 v95, s61, v27
    v_lshlrev_b32 v96, 16, v28
    v_and_b32 v97, s61, v28
    v_lshlrev_b32 v98, 16, v29
    v_and_b32 v99, s61, v29
    v_lshlrev_b32 v160, 16, v30
    v_and_b32 v161, s61, v30
    v_lshlrev_b32 v162, 16, v31
    v_and_b32 v163, s61, v31
    v_lshlrev_b32 v164, 16, v32
    v_and_b32 v165, s61, v32
    v_lshlrev_b32 v166, 16, v33
    v_and_b32 v167, s61, v33
    v_lshlrev_b32 v168, 16, v34
    v_and_b32 v169, s61, v34
    v_lshlrev_b32 v170, 16, v35
    v_and_b32 v171, s61, v35
    v_lshlrev_b32 v172, 16, v36
    v_and_b32 v173, s61, v36
    v_lshlrev_b32 v174, 16, v37
    v_and_b32 v175, s61, v37
    v_lshlrev_b32 v176, 16, v38
    v_and_b32 v177, s61, v38
    v_lshlrev_b32 v178, 16, v39
    v_and_b32 v179, s61, v39
    v_lshlrev_b32 v180, 16, v40
    v_and_b32 v181, s61, v40
    v_lshlrev_b32 v182, 16, v41
    v_and_b32 v183, s61, v41
    v_lshlrev_b32 v184, 16, v42
    v_and_b32 v185, s61, v42
    v_lshlrev_b32 v186, 16, v43
    v_and_b32 v187, s61, v43
    v_lshlrev_b32 v188, 16, v44
    v_and_b32 v189, s61, v44
    v_lshlrev_b32 v190, 16, v45
    v_and_b32 v191, s61, v45
    v_lshlrev_b32 v192, 16, v46
    v_and_b32 v193, s61, v46
    v_lshlrev_b32 v194, 16, v47
    v_and_b32 v195, s61, v47
    v_lshlrev_b32 v196, 16, v48
    v_and_b32 v197, s61, v48
    v_lshlrev_b32 v198, 16, v49
    v_and_b32 v199, s61, v49
    v_add_f32 v80, v80, v160
    v_add_f32 v81, v81, v161
    v_add_f32 v82, v82, v162
    v_add_f32 v83, v83, v163
    v_add_f32 v84, v84, v164
    v_add_f32 v85, v85, v165
    v_add_f32 v86, v86, v166
    v_add_f32 v87, v87, v167
    v_add_f32 v88, v88, v168
    v_add_f32 v89, v89, v169
    v_add_f32 v90, v90, v170
    v_add_f32 v91, v91, v171
    v_add_f32 v92, v92, v172
    v_add_f32 v93, v93, v173
    v_add_f32 v94, v94, v174
    v_add_f32 v95, v95, v175
    v_add_f32 v96, v96, v176
    v_add_f32 v97, v97, v177
    v_add_f32 v98, v98, v178
    v_add_f32 v99, v99, v179
    v_lshlrev_b32 v160, 16, v50
    v_and_b32 v161, s61, v50
    v_lshlrev_b32 v162, 16, v51
    v_and_b32 v163, s61, v51
    v_lshlrev_b32 v164, 16, v52
    v_and_b32 v165, s61, v52
    v_lshlrev_b32 v166, 16, v53
    v_and_b32 v167, s61, v53
    v_lshlrev_b32 v168, 16, v54
    v_and_b32 v169, s61, v54
    v_lshlrev_b32 v170, 16, v55
    v_and_b32 v171, s61, v55
    v_lshlrev_b32 v172, 16, v56
    v_and_b32 v173, s61, v56
    v_lshlrev_b32 v174, 16, v57
    v_and_b32 v175, s61, v57
    v_lshlrev_b32 v176, 16, v58
    v_and_b32 v177, s61, v58
    v_lshlrev_b32 v178, 16, v59
    v_and_b32 v179, s61, v59
    v_add_f32 v180, v180, v160
    v_add_f32 v181, v181, v161
    v_add_f32 v182, v182, v162
    v_add_f32 v183, v183, v163
    v_add_f32 v184, v184, v164
    v_add_f32 v185, v185, v165
    v_add_f32 v186, v186, v166
    v_add_f32 v187, v187, v167
    v_add_f32 v188, v188, v168
    v_add_f32 v189, v189, v169
    v_add_f32 v190, v190, v170
    v_add_f32 v191, v191, v171
    v_add_f32 v192, v192, v172
    v_add_f32 v193, v193, v173
    v_add_f32 v194, v194, v174
    v_add_f32 v195, v195, v175
    v_add_f32 v196, v196, v176
    v_add_f32 v197, v197, v177
    v_add_f32 v198, v198, v178
    v_add_f32 v199, v199, v179
    v_add_f32 v80, v80, v180
    v_add_f32 v81, v81, v181
    v_add_f32 v82, v82, v182
    v_add_f32 v83, v83, v183
    v_add_f32 v84, v84, v184
    v_add_f32 v85, v85, v185
    v_add_f32 v86, v86, v186
    v_add_f32 v87, v87, v187
    v_add_f32 v88, v88, v188
    v_add_f32 v89, v89, v189
    v_add_f32 v90, v90, v190
    v_add_f32 v91, v91, v191
    v_add_f32 v92, v92, v192
    v_add_f32 v93, v93, v193
    v_add_f32 v94, v94, v194
    v_add_f32 v95, v95, v195
    v_add_f32 v96, v96, v196
    v_add_f32 v97, v97, v197
    v_add_f32 v98, v98, v198
    v_add_f32 v99, v99, v199
    v_cvt_pk_bf16_f32 v160, v80, v81
    v_cvt_pk_bf16_f32 v161, v82, v83
    v_cvt_pk_bf16_f32 v162, v84, v85
    v_cvt_pk_bf16_f32 v163, v86, v87
    v_cvt_pk_bf16_f32 v164, v88, v89
    v_cvt_pk_bf16_f32 v165, v90, v91
    v_cvt_pk_bf16_f32 v166, v92, v93
    v_cvt_pk_bf16_f32 v167, v94, v95
    v_cvt_pk_bf16_f32 v168, v96, v97
    v_cvt_pk_bf16_f32 v169, v98, v99
    v_lshlrev_b32 v80, 16, v160
    v_and_b32 v81, s61, v160
    v_lshlrev_b32 v82, 16, v161
    v_and_b32 v83, s61, v161
    v_lshlrev_b32 v84, 16, v162
    v_and_b32 v85, s61, v162
    v_lshlrev_b32 v86, 16, v163
    v_and_b32 v87, s61, v163
    v_lshlrev_b32 v88, 16, v164
    v_and_b32 v89, s61, v164
    v_lshlrev_b32 v90, 16, v165
    v_and_b32 v91, s61, v165
    v_lshlrev_b32 v92, 16, v166
    v_and_b32 v93, s61, v166
    v_lshlrev_b32 v94, 16, v167
    v_and_b32 v95, s61, v167
    v_lshlrev_b32 v96, 16, v168
    v_and_b32 v97, s61, v168
    v_lshlrev_b32 v98, 16, v169
    v_and_b32 v99, s61, v169
    v_lshlrev_b32 v180, 16, v60
    v_and_b32 v181, s61, v60
    v_lshlrev_b32 v182, 16, v61
    v_and_b32 v183, s61, v61
    v_lshlrev_b32 v184, 16, v62
    v_and_b32 v185, s61, v62
    v_lshlrev_b32 v186, 16, v63
    v_and_b32 v187, s61, v63
    v_lshlrev_b32 v188, 16, v64
    v_and_b32 v189, s61, v64
    v_lshlrev_b32 v190, 16, v65
    v_and_b32 v191, s61, v65
    v_lshlrev_b32 v192, 16, v66
    v_and_b32 v193, s61, v66
    v_lshlrev_b32 v194, 16, v67
    v_and_b32 v195, s61, v67
    v_lshlrev_b32 v196, 16, v68
    v_and_b32 v197, s61, v68
    v_lshlrev_b32 v198, 16, v69
    v_and_b32 v199, s61, v69
    v_add_f32 v80, v80, v180
    v_add_f32 v81, v81, v181
    v_add_f32 v82, v82, v182
    v_add_f32 v83, v83, v183
    v_add_f32 v84, v84, v184
    v_add_f32 v85, v85, v185
    v_add_f32 v86, v86, v186
    v_add_f32 v87, v87, v187
    v_add_f32 v88, v88, v188
    v_add_f32 v89, v89, v189
    v_add_f32 v90, v90, v190
    v_add_f32 v91, v91, v191
    v_add_f32 v92, v92, v192
    v_add_f32 v93, v93, v193
    v_add_f32 v94, v94, v194
    v_add_f32 v95, v95, v195
    v_add_f32 v96, v96, v196
    v_add_f32 v97, v97, v197
    v_add_f32 v98, v98, v198
    v_add_f32 v99, v99, v199
    v_cvt_pk_bf16_f32 v60, v80, v81
    v_cvt_pk_bf16_f32 v61, v82, v83
    v_cvt_pk_bf16_f32 v62, v84, v85
    v_cvt_pk_bf16_f32 v63, v86, v87
    v_cvt_pk_bf16_f32 v64, v88, v89
    v_cvt_pk_bf16_f32 v65, v90, v91
    v_cvt_pk_bf16_f32 v66, v92, v93
    v_cvt_pk_bf16_f32 v67, v94, v95
    v_cvt_pk_bf16_f32 v68, v96, v97
    v_cvt_pk_bf16_f32 v69, v98, v99
    v_lshlrev_b32 v80, 16, v60
    v_and_b32 v81, s61, v60
    v_lshlrev_b32 v82, 16, v61
    v_and_b32 v83, s61, v61
    v_lshlrev_b32 v84, 16, v62
    v_and_b32 v85, s61, v62
    v_lshlrev_b32 v86, 16, v63
    v_and_b32 v87, s61, v63
    v_lshlrev_b32 v88, 16, v64
    v_and_b32 v89, s61, v64
    v_lshlrev_b32 v90, 16, v65
    v_and_b32 v91, s61, v65
    v_lshlrev_b32 v92, 16, v66
    v_and_b32 v93, s61, v66
    v_lshlrev_b32 v94, 16, v67
    v_and_b32 v95, s61, v67
    v_lshlrev_b32 v96, 16, v68
    v_and_b32 v97, s61, v68
    v_lshlrev_b32 v98, 16, v69
    v_and_b32 v99, s61, v69
    v_mul_u32_u24 v9, 1280, v2
    v_add_u32 v9, v9, v17
    v_add_u32 v9, 122880, v9
    ds_write_b64 v9, v[60:61] offset:0
    ds_write_b64 v9, v[62:63] offset:32
    ds_write_b64 v9, v[64:65] offset:64
    ds_write_b64 v9, v[66:67] offset:96
    ds_write_b64 v9, v[68:69] offset:128
    v_add_f32 v160, v80, v90
    v_add_f32 v161, v81, v91
    v_add_f32 v162, v82, v92
    v_add_f32 v163, v83, v93
    v_add_f32 v164, v84, v94
    v_add_f32 v165, v85, v95
    v_add_f32 v166, v86, v96
    v_add_f32 v167, v87, v97
    v_add_f32 v168, v88, v98
    v_add_f32 v169, v89, v99
    v_add_f32 v160, v160, v165
    v_add_f32 v161, v161, v166
    v_add_f32 v162, v162, v167
    v_add_f32 v163, v163, v168
    v_add_f32 v164, v164, v169
    v_add_f32 v160, v160, v161
    v_add_f32 v162, v162, v163
    s_nop 0
    v_add_f32 v160, v160, v164
    s_nop 0
    v_add_f32 v120, v160, v162
    s_nop 0
    v_mul_f32 v121, 0x3d4ccccd, v120
    s_nop 0
    v_mul_f32 v124, v120, v121
    v_sub_f32 v160, v80, v121
    v_sub_f32 v161, v81, v121
    v_sub_f32 v162, v82, v121
    v_sub_f32 v163, v83, v121
    v_sub_f32 v164, v84, v121
    v_sub_f32 v165, v85, v121
    v_sub_f32 v166, v86, v121
    v_sub_f32 v167, v87, v121
    v_sub_f32 v168, v88, v121
    v_sub_f32 v169, v89, v121
    v_sub_f32 v170, v90, v121
    v_sub_f32 v171, v91, v121
    v_sub_f32 v172, v92, v121
    v_sub_f32 v173, v93, v121
    v_sub_f32 v174, v94, v121
    v_sub_f32 v175, v95, v121
    v_sub_f32 v176, v96, v121
    v_sub_f32 v177, v97, v121
    v_sub_f32 v178, v98, v121
    v_sub_f32 v179, v99, v121
    v_mul_f32 v180, v160, v160
    v_mul_f32 v181, v161, v161
    v_mul_f32 v182, v162, v162
    v_mul_f32 v183, v163, v163
    v_mul_f32 v184, v164, v164
    v_mul_f32 v185, v165, v165
    v_mul_f32 v186, v166, v166
    v_mul_f32 v187, v167, v167
    v_mul_f32 v188, v168, v168
    v_mul_f32 v189, v169, v169
    v_fmac_f32 v180, v170, v170
    v_fmac_f32 v181, v171, v171
    v_fmac_f32 v182, v172, v172
    v_fmac_f32 v183, v173, v173
    v_fmac_f32 v184, v174, v174
    v_fmac_f32 v185, v175, v175
    v_fmac_f32 v186, v176, v176
    v_fmac_f32 v187, v177, v177
    v_fmac_f32 v188, v178, v178
    v_fmac_f32 v189, v179, v179
    v_add_f32 v180, v180, v185
    v_add_f32 v181, v181, v186
    v_add_f32 v182, v182, v187
    v_add_f32 v183, v183, v188
    v_add_f32 v184, v184, v189
    v_add_f32 v180, v180, v181
    v_add_f32 v182, v182, v183
    s_nop 0
    v_add_f32 v180, v180, v184
    s_nop 0
    v_add_f32 v123, v180, v182
    s_nop 1
    v_add_f32_dpp v120, v120, v120 row_ror:8 row_mask:0xf bank_mask:0xf
    v_add_f32_dpp v123, v123, v123 row_ror:8 row_mask:0xf bank_mask:0xf
    v_add_f32_dpp v124, v124, v124 row_ror:8 row_mask:0xf bank_mask:0xf
    v_mov_b32 v128, v120
    v_mov_b32 v129, v123
    v_mov_b32 v130, v124
    s_nop 1
    v_permlane16_swap_b32 v120, v128
    v_permlane16_swap_b32 v123, v129
    v_permlane16_swap_b32 v124, v130
    s_nop 1
    v_add_f32 v120, v120, v128
    v_add_f32 v123, v123, v129
    v_add_f32 v124, v124, v130
    v_mov_b32 v128, v120
    v_mov_b32 v129, v123
    v_mov_b32 v130, v124
    s_nop 1
    v_permlane32_swap_b32 v120, v128
    v_permlane32_swap_b32 v123, v129
    v_permlane32_swap_b32 v124, v130
    s_nop 1
    v_add_f32 v120, v120, v128
    v_add_f32 v123, v123, v129
    v_add_f32 v124, v124, v130
    ds_write_b32 v7, v120 offset:0
    ds_write_b32 v7, v123 offset:128
    ds_write_b32 v7, v124 offset:256
    s_waitcnt lgkmcnt(0)
    s_barrier
    ds_read_b32 v128, v6 offset:0
    ds_read_b32 v129, v6 offset:32
    ds_read_b32 v130, v6 offset:64
    ds_read_b32 v131, v6 offset:96
    ds_read_b32 v132, v6 offset:128
    ds_read_b32 v133, v6 offset:160
    ds_read_b32 v134, v6 offset:192
    ds_read_b32 v135, v6 offset:224
    ds_read_b32 v136, v6 offset:256
    ds_read_b32 v137, v6 offset:288
    ds_read_b32 v138, v6 offset:320
    ds_read_b32 v139, v6 offset:352
    s_waitcnt lgkmcnt(0)
    v_add_f32 v128, v128, v129
    v_add_f32 v130, v130, v131
    v_add_f32 v120, v128, v130
    v_add_f32 v132, v132, v133
    v_add_f32 v134, v134, v135
    v_add_f32 v123, v132, v134
    v_add_f32 v136, v136, v137
    v_add_f32 v138, v138, v139
    v_add_f32 v124, v136, v138
    v_mul_f32 v121, 0x3acccccd, v120
    v_cvt_pk_bf16_f32 v122, v121, v121
    v_lshlrev_b32 v122, 16, v122
    v_fma_f32 v124, -v120, v121, v124
    v_max_f32 v124, 0, v124
    v_add_f32 v123, v123, v124
    v_mul_f32 v123, 0x3acccccd, v123
    v_cvt_pk_bf16_f32 v123, v123, v123
    v_lshlrev_b32 v123, 16, v123
    v_add_f32 v123, 0x3727c5ac, v123
    v_cvt_pk_bf16_f32 v123, v123, v123
    v_lshlrev_b32 v123, 16, v123
    v_sqrt_f32 v124, v123
    s_nop 0
    v_cvt_pk_bf16_f32 v124, v124, v124
    v_lshlrev_b32 v124, 16, v124
    v_rcp_f32 v125, v124
    s_nop 0
    v_mov_b32 v120, v125
    v_sub_f32 v160, v80, v122
    v_sub_f32 v161, v81, v122
    v_sub_f32 v162, v82, v122
    v_sub_f32 v163, v83, v122
    v_sub_f32 v164, v84, v122
    v_sub_f32 v165, v85, v122
    v_sub_f32 v166, v86, v122
    v_sub_f32 v167, v87, v122
    v_sub_f32 v168, v88, v122
    v_sub_f32 v169, v89, v122
    v_sub_f32 v170, v90, v122
    v_sub_f32 v171, v91, v122
    v_sub_f32 v172, v92, v122
    v_sub_f32 v173, v93, v122
    v_sub_f32 v174, v94, v122
    v_sub_f32 v175, v95, v122
    v_sub_f32 v176, v96, v122
    v_sub_f32 v177, v97, v122
    v_sub_f32 v178, v98, v122
    v_sub_f32 v179, v99, v122
    v_cvt_pk_bf16_f32 v180, v160, v161
    v_cvt_pk_bf16_f32 v181, v162, v163
    v_cvt_pk_bf16_f32 v182, v164, v165
    v_cvt_pk_bf16_f32 v183, v166, v167
    v_cvt_pk_bf16_f32 v184, v168, v169
    v_cvt_pk_bf16_f32 v185, v170, v171
    v_cvt_pk_bf16_f32 v186, v172, v173
    v_cvt_pk_bf16_f32 v187, v174, v175
    v_cvt_pk_bf16_f32 v188, v176, v177
    v_cvt_pk_bf16_f32 v189, v178, v179
    v_lshlrev_b32 v160, 16, v180
    v_and_b32 v161, s61, v180
    v_lshlrev_b32 v162, 16, v181
    v_and_b32 v163, s61, v181
    v_lshlrev_b32 v164, 16, v182
    v_and_b32 v165, s61, v182
    v_lshlrev_b32 v166, 16, v183
    v_and_b32 v167, s61, v183
    v_lshlrev_b32 v168, 16, v184
    v_and_b32 v169, s61, v184
    v_lshlrev_b32 v170, 16, v185
    v_and_b32 v171, s61, v185
    v_lshlrev_b32 v172, 16, v186
    v_and_b32 v173, s61, v186
    v_lshlrev_b32 v174, 16, v187
    v_and_b32 v175, s61, v187
    v_lshlrev_b32 v176, 16, v188
    v_and_b32 v177, s61, v188
    v_lshlrev_b32 v178, 16, v189
    v_and_b32 v179, s61, v189
    v_mul_f32 v160, v160, v120
    v_mul_f32 v161, v161, v120
    v_mul_f32 v162, v162, v120
    v_mul_f32 v163, v163, v120
    v_mul_f32 v164, v164, v120
    v_mul_f32 v165, v165, v120
    v_mul_f32 v166, v166, v120
    v_mul_f32 v167, v167, v120
    v_mul_f32 v168, v168, v120
    v_mul_f32 v169, v169, v120
    v_mul_f32 v170, v170, v120
    v_mul_f32 v171, v171, v120
    v_mul_f32 v172, v172, v120
    v_mul_f32 v173, v173, v120
    v_mul_f32 v174, v174, v120
    v_mul_f32 v175, v175, v120
    v_mul_f32 v176, v176, v120
    v_mul_f32 v177, v177, v120
    v_mul_f32 v178, v178, v120
    v_mul_f32 v179, v179, v120
    v_cvt_pk_bf16_f32 v180, v160, v161
    v_cvt_pk_bf16_f32 v181, v162, v163
    v_cvt_pk_bf16_f32 v182, v164, v165
    v_cvt_pk_bf16_f32 v183, v166, v167
    v_cvt_pk_bf16_f32 v184, v168, v169
    v_cvt_pk_bf16_f32 v185, v170, v171
    v_cvt_pk_bf16_f32 v186, v172, v173
    v_cvt_pk_bf16_f32 v187, v174, v175
    v_cvt_pk_bf16_f32 v188, v176, v177
    v_cvt_pk_bf16_f32 v189, v178, v179
    v_lshlrev_b32 v100, 16, v180
    v_and_b32 v101, s61, v180
    v_lshlrev_b32 v102, 16, v181
    v_and_b32 v103, s61, v181
    v_lshlrev_b32 v104, 16, v182
    v_and_b32 v105, s61, v182
    v_lshlrev_b32 v106, 16, v183
    v_and_b32 v107, s61, v183
    v_lshlrev_b32 v108, 16, v184
    v_and_b32 v109, s61, v184
    v_lshlrev_b32 v110, 16, v185
    v_and_b32 v111, s61, v185
    v_lshlrev_b32 v112, 16, v186
    v_and_b32 v113, s61, v186
    v_lshlrev_b32 v114, 16, v187
    v_and_b32 v115, s61, v187
    v_lshlrev_b32 v116, 16, v188
    v_and_b32 v117, s61, v188
    v_lshlrev_b32 v118, 16, v189
    v_and_b32 v119, s61, v189
    v_lshlrev_b32 v160, 16, v70
    v_and_b32 v161, s61, v70
    v_lshlrev_b32 v162, 16, v71
    v_and_b32 v163, s61, v71
    v_lshlrev_b32 v164, 16, v72
    v_and_b32 v165, s61, v72
    v_lshlrev_b32 v166, 16, v73
    v_and_b32 v167, s61, v73
    v_lshlrev_b32 v168, 16, v74
    v_and_b32 v169, s61, v74
    v_lshlrev_b32 v170, 16, v75
    v_and_b32 v171, s61, v75
    v_lshlrev_b32 v172, 16, v76
    v_and_b32 v173, s61, v76
    v_lshlrev_b32 v174, 16, v77
    v_and_b32 v175, s61, v77
    v_lshlrev_b32 v176, 16, v78
    v_and_b32 v177, s61, v78
    v_lshlrev_b32 v178, 16, v79
    v_and_b32 v179, s61, v79
    v_mul_f32 v180, v100, v160
    v_mul_f32 v181, v101, v161
    v_mul_f32 v182, v102, v162
    v_mul_f32 v183, v103, v163
    v_mul_f32 v184, v104, v164
    v_mul_f32 v185, v105, v165
    v_mul_f32 v186, v106, v166
    v_mul_f32 v187, v107, v167
    v_mul_f32 v188, v108, v168
    v_mul_f32 v189, v109, v169
    v_fmac_f32 v180, v110, v170
    v_fmac_f32 v181, v111, v171
    v_fmac_f32 v182, v112, v172
    v_fmac_f32 v183, v113, v173
    v_fmac_f32 v184, v114, v174
    v_fmac_f32 v185, v115, v175
    v_fmac_f32 v186, v116, v176
    v_fmac_f32 v187, v117, v177
    v_fmac_f32 v188, v118, v178
    v_fmac_f32 v189, v119, v179
    v_add_f32 v160, v80, v100
    v_add_f32 v161, v81, v101
    v_add_f32 v162, v82, v102
    v_add_f32 v163, v83, v103
    v_add_f32 v164, v84, v104
    v_add_f32 v165, v85, v105
    v_add_f32 v166, v86, v106
    v_add_f32 v167, v87, v107
    v_add_f32 v168, v88, v108
    v_add_f32 v169, v89, v109
    v_add_f32 v170, v90, v110
    v_add_f32 v171, v91, v111
    v_add_f32 v172, v92, v112
    v_add_f32 v173, v93, v113
    v_add_f32 v174, v94, v114
    v_add_f32 v175, v95, v115
    v_add_f32 v176, v96, v116
    v_add_f32 v177, v97, v117
    v_add_f32 v178, v98, v118
    v_add_f32 v179, v99, v119
    v_add_f32 v180, v180, v185
    v_add_f32 v181, v181, v186
    v_add_f32 v182, v182, v187
    v_add_f32 v183, v183, v188
    v_add_f32 v184, v184, v189
    v_cvt_pk_bf16_f32 v20, v160, v161
    v_cvt_pk_bf16_f32 v21, v162, v163
    v_cvt_pk_bf16_f32 v22, v164, v165
    v_cvt_pk_bf16_f32 v23, v166, v167
    v_cvt_pk_bf16_f32 v24, v168, v169
    v_cvt_pk_bf16_f32 v25, v170, v171
    v_cvt_pk_bf16_f32 v26, v172, v173
    v_cvt_pk_bf16_f32 v27, v174, v175
    v_cvt_pk_bf16_f32 v28, v176, v177
    v_cvt_pk_bf16_f32 v29, v178, v179
    v_add_f32 v180, v180, v181
    v_add_f32 v182, v182, v183
    s_nop 0
    v_add_f32 v180, v180, v184
    s_nop 0
    v_add_f32 v123, v180, v182
    ds_write_b64 v9, v[20:21] offset:10240
    ds_write_b64 v9, v[22:23] offset:10272
    ds_write_b64 v9, v[24:25] offset:10304
    ds_write_b64 v9, v[26:27] offset:10336
    ds_write_b64 v9, v[28:29] offset:10368
    s_nop 1
    v_add_f32_dpp v123, v123, v123 row_ror:8 row_mask:0xf bank_mask:0xf
    v_mov_b32 v128, v123
    s_nop 1
    v_permlane16_swap_b32 v123, v128
    s_nop 1
    v_add_f32 v123, v123, v128
    v_mov_b32 v128, v123
    s_nop 1
    v_permlane32_swap_b32 v123, v128
    s_nop 1
    v_add_f32 v123, v123, v128
    ds_write_b32 v7, v123 offset:384
    s_waitcnt lgkmcnt(0)
    s_barrier
    ds_read_b32 v128, v6 offset:384
    ds_read_b32 v129, v6 offset:416
    ds_read_b32 v130, v6 offset:448
    ds_read_b32 v131, v6 offset:480
    s_waitcnt lgkmcnt(0)
    v_add_f32 v128, v128, v129
    v_add_f32 v130, v130, v131
    v_add_f32 v123, v128, v130
    v_cvt_pk_bf16_f32 v123, v123, v123
    s_cmp_lg_u32 s44, 0
    s_cbranch_scc1 sequential_preLN__compressed_kv_cla__moe_arch_mod__prompt_kernel_t_w123
    v_and_b32 v126, 0xffff, v123
    v_or_b32 v127, 0x8000, v126
    v_xor_b32 v125, 0xffff, v126
    v_cmp_lt_u32 vcc, 0x7fff, v126
    s_nop 1
    v_cndmask_b32 v127, v127, v125, vcc
    v_sub_u32 v126, 0xffff, v8
    v_lshl_or_b32 v127, v127, 16, v126
    s_nop 1
    v_max_u32_dpp v127, v127, v127 row_ror:4 row_mask:0xf bank_mask:0xf
    s_nop 1
    v_max_u32_dpp v127, v127, v127 row_ror:2 row_mask:0xf bank_mask:0xf
    s_nop 1
    v_max_u32_dpp v127, v127, v127 row_ror:1 row_mask:0xf bank_mask:0xf
    s_lshl_b32 s48, s2, 3
    s_add_u32 s48, s48, 2107392
    v_mov_b32 v126, 0
    v_mov_b32 v128, v127
    v_mov_b32 v129, s3
    buffer_store_dwordx2 v[128:129], v126, s[56:59], s48 offen sc1
    s_cmp_ge_u32 s62, 54
    s_cbranch_scc1 sequential_preLN__compressed_kv_cla__moe_arch_mod__prompt_kernel_t_fin
    v_lshrrev_b32 v5, 4, v0
    v_bfe_u32 v7, v0, 2, 2
    v_lshl_add_u32 v7, v5, 3, v7
    v_and_b32 v8, 3, v0
    v_lshlrev_b32 v8, 3, v8
    v_lshl_add_u32 v6, v7, 6, v8
    s_mul_i32 s48, s44, 10240
    v_add_u32 v6, s48, v6
    v_mul_u32_u24 v7, 1280, v7
    v_add_u32 v7, v7, v8
    s_mul_i32 s48, s44, 320
    s_add_u32 s48, s48, 81920
    v_add_u32 v7, s48, v7
    ds_read_b64_tr_b16 v[128:129], v6 offset:0
    ds_read_b64_tr_b16 v[130:131], v6 offset:256
    ds_read_b64_tr_b16 v[132:133], v6 offset:32
    ds_read_b64_tr_b16 v[134:135], v6 offset:288
    ds_read_b64_tr_b16 v[136:137], v6 offset:40960
    ds_read_b64_tr_b16 v[138:139], v6 offset:41216
    ds_read_b64_tr_b16 v[140:141], v6 offset:40992
    ds_read_b64_tr_b16 v[142:143], v6 offset:41248
    ds_read_b64_tr_b16 v[144:145], v6 offset:2048
    ds_read_b64_tr_b16 v[146:147], v6 offset:2304
    ds_read_b64_tr_b16 v[148:149], v6 offset:2080
    ds_read_b64_tr_b16 v[150:151], v6 offset:2336
    ds_read_b64_tr_b16 v[152:153], v6 offset:43008
    ds_read_b64_tr_b16 v[154:155], v6 offset:43264
    ds_read_b64_tr_b16 v[156:157], v6 offset:43040
    ds_read_b64_tr_b16 v[158:159], v6 offset:43296
    ds_read_b64_tr_b16 v[160:161], v6 offset:4096
    ds_read_b64_tr_b16 v[162:163], v6 offset:4352
    ds_read_b64_tr_b16 v[164:165], v6 offset:4128
    ds_read_b64_tr_b16 v[166:167], v6 offset:4384
    ds_read_b64_tr_b16 v[168:169], v6 offset:45056
    ds_read_b64_tr_b16 v[170:171], v6 offset:45312
    ds_read_b64_tr_b16 v[172:173], v6 offset:45088
    ds_read_b64_tr_b16 v[174:175], v6 offset:45344
    ds_read_b64_tr_b16 v[176:177], v6 offset:6144
    ds_read_b64_tr_b16 v[178:179], v6 offset:6400
    ds_read_b64_tr_b16 v[180:181], v6 offset:6176
    ds_read_b64_tr_b16 v[182:183], v6 offset:6432
    ds_read_b64_tr_b16 v[184:185], v6 offset:47104
    ds_read_b64_tr_b16 v[186:187], v6 offset:47360
    ds_read_b64_tr_b16 v[188:189], v6 offset:47136
    ds_read_b64_tr_b16 v[190:191], v6 offset:47392
    ds_read_b64_tr_b16 v[192:193], v6 offset:8192
    ds_read_b64_tr_b16 v[194:195], v6 offset:8448
    ds_read_b64_tr_b16 v[196:197], v6 offset:8224
    ds_read_b64_tr_b16 v[198:199], v6 offset:8480
    ds_read_b64_tr_b16 v[200:201], v6 offset:49152
    ds_read_b64_tr_b16 v[202:203], v6 offset:49408
    ds_read_b64_tr_b16 v[204:205], v6 offset:49184
    ds_read_b64_tr_b16 v[206:207], v6 offset:49440
    ds_read_b64_tr_b16 v[208:209], v7 offset:0
    ds_read_b64_tr_b16 v[210:211], v7 offset:5120
    ds_read_b64_tr_b16 v[212:213], v7 offset:32
    ds_read_b64_tr_b16 v[214:215], v7 offset:5152
    ds_read_b64_tr_b16 v[216:217], v7 offset:64
    ds_read_b64_tr_b16 v[218:219], v7 offset:5184
    ds_read_b64_tr_b16 v[220:221], v7 offset:96
    ds_read_b64_tr_b16 v[222:223], v7 offset:5216
    ds_read_b64_tr_b16 v[224:225], v7 offset:128
    ds_read_b64_tr_b16 v[226:227], v7 offset:5248
    ds_read_b64_tr_b16 v[228:229], v7 offset:160
    ds_read_b64_tr_b16 v[230:231], v7 offset:5280
    ds_read_b64_tr_b16 v[232:233], v7 offset:192
    ds_read_b64_tr_b16 v[234:235], v7 offset:5312
    ds_read_b64_tr_b16 v[236:237], v7 offset:224
    ds_read_b64_tr_b16 v[238:239], v7 offset:5344
    ds_read_b64_tr_b16 v[240:241], v7 offset:256
    ds_read_b64_tr_b16 v[242:243], v7 offset:5376
    ds_read_b64_tr_b16 v[244:245], v7 offset:288
    ds_read_b64_tr_b16 v[246:247], v7 offset:5408
    s_branch sequential_preLN__compressed_kv_cla__moe_arch_mod__prompt_kernel_t_w0poll
sequential_preLN__compressed_kv_cla__moe_arch_mod__prompt_kernel_t_w123:
    s_sub_u32 s48, s44, 1
    s_lshl_b32 s48, s48, 10
    v_add_u32 v126, s48, v1
    v_add_u32 v127, 122880, v126
    ds_read_b128 v[20:23], v127 offset:0
    ds_read_b128 v[24:27], v127 offset:3072
    ds_read_b128 v[28:31], v127 offset:6144
    ds_read_b128 v[32:35], v127 offset:9216
    ds_read_b128 v[36:39], v127 offset:10240
    ds_read_b128 v[40:43], v127 offset:13312
    ds_read_b128 v[44:47], v127 offset:16384
    ds_read_b128 v[48:51], v127 offset:19456
    s_lshl_b32 s49, s70, 4
    s_and_b32 s50, s55, 1
    s_lshl_b32 s50, s50, 3
    s_add_u32 s49, s49, s50
    s_mul_i32 s49, s49, 1280
    s_waitcnt lgkmcnt(0)
    s_add_u32 s50, s49, 0
    buffer_store_dwordx4 v[20:23], v126, s[40:43], s50 offen sc1
    s_add_u32 s50, s49, 3072
    buffer_store_dwordx4 v[24:27], v126, s[40:43], s50 offen sc1
    s_add_u32 s50, s49, 6144
    buffer_store_dwordx4 v[28:31], v126, s[40:43], s50 offen sc1
    s_add_u32 s50, s49, 0
    buffer_store_dwordx4 v[36:39], v126, s[36:39], s50 offen sc1
    s_add_u32 s50, s49, 3072
    buffer_store_dwordx4 v[40:43], v126, s[36:39], s50 offen sc1
    s_add_u32 s50, s49, 6144
    buffer_store_dwordx4 v[44:47], v126, s[36:39], s50 offen sc1
    s_cmp_lg_u32 s44, 1
    s_cbranch_scc1 sequential_preLN__compressed_kv_cla__moe_arch_mod__prompt_kernel_t_ns3
    s_add_u32 s50, s49, 9216
    buffer_store_dwordx4 v[32:35], v126, s[40:43], s50 offen sc1
    buffer_store_dwordx4 v[48:51], v126, s[36:39], s50 offen sc1
    v_cmp_gt_u32 vcc, 8, v0
    s_nop 1
    s_and_saveexec_b64 s[14:15], vcc
    v_lshlrev_b32 v127, 2, v8
    s_mov_b32 s48, 8192
    buffer_store_dword v122, v127, s[56:59], s48 offen sc1
    s_mov_b32 s48, 16384
    buffer_store_dword v124, v127, s[56:59], s48 offen sc1
    s_mov_b64 exec, s[14:15]
sequential_preLN__compressed_kv_cla__moe_arch_mod__prompt_kernel_t_ns3:
    s_waitcnt vmcnt(0) lgkmcnt(0)
    v_mov_b32 v126, 143360
    v_mov_b32 v127, 1
    v_cmp_eq_u32 vcc, 0, v0
    s_nop 1
    s_and_saveexec_b64 s[14:15], vcc
    ds_add_rtn_u32 v127, v126, v127 offset:516
    s_waitcnt lgkmcnt(0)
    s_mov_b64 exec, s[14:15]
    v_readfirstlane_b32 s48, v127
    s_nop 3
    s_cmp_lg_u32 s48, 2
    s_cbranch_scc1 sequential_preLN__compressed_kv_cla__moe_arch_mod__prompt_kernel_t_w3
    s_lshl_b32 s48, s2, 2
    s_add_u32 s48, s48, 2109440
    v_mov_b32 v126, 0
    v_mov_b32 v127, s3
    buffer_store_dword v127, v126, s[56:59], s48 offen sc1
sequential_preLN__compressed_kv_cla__moe_arch_mod__prompt_kernel_t_w3:
    s_cmp_ge_u32 s62, 54
    s_cbranch_scc1 sequential_preLN__compressed_kv_cla__moe_arch_mod__prompt_kernel_t_fin
    v_lshrrev_b32 v5, 4, v0
    v_bfe_u32 v7, v0, 2, 2
    v_lshl_add_u32 v7, v5, 3, v7
    v_and_b32 v8, 3, v0
    v_lshlrev_b32 v8, 3, v8
    v_lshl_add_u32 v6, v7, 6, v8
    s_mul_i32 s48, s44, 10240
    v_add_u32 v6, s48, v6
    v_mul_u32_u24 v7, 1280, v7
    v_add_u32 v7, v7, v8
    s_mul_i32 s48, s44, 320
    s_add_u32 s48, s48, 81920
    v_add_u32 v7, s48, v7
    ds_read_b64_tr_b16 v[128:129], v6 offset:0
    ds_read_b64_tr_b16 v[130:131], v6 offset:256
    ds_read_b64_tr_b16 v[132:133], v6 offset:32
    ds_read_b64_tr_b16 v[134:135], v6 offset:288
    ds_read_b64_tr_b16 v[136:137], v6 offset:40960
    ds_read_b64_tr_b16 v[138:139], v6 offset:41216
    ds_read_b64_tr_b16 v[140:141], v6 offset:40992
    ds_read_b64_tr_b16 v[142:143], v6 offset:41248
    ds_read_b64_tr_b16 v[144:145], v6 offset:2048
    ds_read_b64_tr_b16 v[146:147], v6 offset:2304
    ds_read_b64_tr_b16 v[148:149], v6 offset:2080
    ds_read_b64_tr_b16 v[150:151], v6 offset:2336
    ds_read_b64_tr_b16 v[152:153], v6 offset:43008
    ds_read_b64_tr_b16 v[154:155], v6 offset:43264
    ds_read_b64_tr_b16 v[156:157], v6 offset:43040
    ds_read_b64_tr_b16 v[158:159], v6 offset:43296
    ds_read_b64_tr_b16 v[160:161], v6 offset:4096
    ds_read_b64_tr_b16 v[162:163], v6 offset:4352
    ds_read_b64_tr_b16 v[164:165], v6 offset:4128
    ds_read_b64_tr_b16 v[166:167], v6 offset:4384
    ds_read_b64_tr_b16 v[168:169], v6 offset:45056
    ds_read_b64_tr_b16 v[170:171], v6 offset:45312
    ds_read_b64_tr_b16 v[172:173], v6 offset:45088
    ds_read_b64_tr_b16 v[174:175], v6 offset:45344
    ds_read_b64_tr_b16 v[176:177], v6 offset:6144
    ds_read_b64_tr_b16 v[178:179], v6 offset:6400
    ds_read_b64_tr_b16 v[180:181], v6 offset:6176
    ds_read_b64_tr_b16 v[182:183], v6 offset:6432
    ds_read_b64_tr_b16 v[184:185], v6 offset:47104
    ds_read_b64_tr_b16 v[186:187], v6 offset:47360
    ds_read_b64_tr_b16 v[188:189], v6 offset:47136
    ds_read_b64_tr_b16 v[190:191], v6 offset:47392
    ds_read_b64_tr_b16 v[192:193], v6 offset:8192
    ds_read_b64_tr_b16 v[194:195], v6 offset:8448
    ds_read_b64_tr_b16 v[196:197], v6 offset:8224
    ds_read_b64_tr_b16 v[198:199], v6 offset:8480
    ds_read_b64_tr_b16 v[200:201], v6 offset:49152
    ds_read_b64_tr_b16 v[202:203], v6 offset:49408
    ds_read_b64_tr_b16 v[204:205], v6 offset:49184
    ds_read_b64_tr_b16 v[206:207], v6 offset:49440
    ds_read_b64_tr_b16 v[208:209], v7 offset:0
    ds_read_b64_tr_b16 v[210:211], v7 offset:5120
    ds_read_b64_tr_b16 v[212:213], v7 offset:32
    ds_read_b64_tr_b16 v[214:215], v7 offset:5152
    ds_read_b64_tr_b16 v[216:217], v7 offset:64
    ds_read_b64_tr_b16 v[218:219], v7 offset:5184
    ds_read_b64_tr_b16 v[220:221], v7 offset:96
    ds_read_b64_tr_b16 v[222:223], v7 offset:5216
    ds_read_b64_tr_b16 v[224:225], v7 offset:128
    ds_read_b64_tr_b16 v[226:227], v7 offset:5248
    ds_read_b64_tr_b16 v[228:229], v7 offset:160
    ds_read_b64_tr_b16 v[230:231], v7 offset:5280
    ds_read_b64_tr_b16 v[232:233], v7 offset:192
    ds_read_b64_tr_b16 v[234:235], v7 offset:5312
    ds_read_b64_tr_b16 v[236:237], v7 offset:224
    ds_read_b64_tr_b16 v[238:239], v7 offset:5344
    ds_read_b64_tr_b16 v[240:241], v7 offset:256
    ds_read_b64_tr_b16 v[242:243], v7 offset:5376
    ds_read_b64_tr_b16 v[244:245], v7 offset:288
    ds_read_b64_tr_b16 v[246:247], v7 offset:5408
    s_branch sequential_preLN__compressed_kv_cla__moe_arch_mod__prompt_kernel_t_w4
sequential_preLN__compressed_kv_cla__moe_arch_mod__prompt_kernel_t_w0poll:
    s_mov_b32 s49, 0
    s_mov_b32 s48, 2107392
    v_lshlrev_b32 v28, 5, v0
sequential_preLN__compressed_kv_cla__moe_arch_mod__prompt_kernel_t_pollK_3:
    buffer_load_dwordx4 v[20:23], v28, s[56:59], s48 offen sc1
    buffer_load_dwordx4 v[24:27], v28, s[56:59], s48 offen offset:16 sc1
    s_waitcnt vmcnt(0)
    v_xor_b32 v21, s3, v21
    v_xor_b32 v23, s3, v23
    v_xor_b32 v25, s3, v25
    v_xor_b32 v27, s3, v27
    v_or3_b32 v21, v21, v23, v25
    v_or_b32 v21, v21, v27
    v_cmp_ne_u32 vcc, 0, v21
    s_add_u32 s49, s49, 1
    s_cbranch_vccz sequential_preLN__compressed_kv_cla__moe_arch_mod__prompt_kernel_t_pollK_3_ok
    s_cmp_ge_u32 s49, 65536
    s_cbranch_scc1 sequential_preLN__compressed_kv_cla__moe_arch_mod__prompt_kernel_t_pollK_3_ok
    s_sleep 1
    s_branch sequential_preLN__compressed_kv_cla__moe_arch_mod__prompt_kernel_t_pollK_3
sequential_preLN__compressed_kv_cla__moe_arch_mod__prompt_kernel_t_pollK_3_ok:
    v_max_u32 v20, v20, v22
    v_max_u32 v24, v24, v26
    s_nop 0
    v_max_u32 v20, v20, v24
    s_nop 1
    v_max_u32_dpp v20, v20, v20 row_ror:8 row_mask:0xf bank_mask:0xf
    s_nop 1
    v_max_u32_dpp v20, v20, v20 row_ror:4 row_mask:0xf bank_mask:0xf
    s_nop 1
    v_max_u32_dpp v20, v20, v20 row_ror:2 row_mask:0xf bank_mask:0xf
    s_nop 1
    v_max_u32_dpp v20, v20, v20 row_ror:1 row_mask:0xf bank_mask:0xf
    v_mov_b32 v21, v20
    s_nop 1
    v_permlane16_swap_b32 v20, v21
    s_nop 1
    v_max_u32 v20, v20, v21
    v_mov_b32 v21, v20
    s_nop 1
    v_permlane32_swap_b32 v20, v21
    s_nop 1
    v_max_u32 v20, v20, v21
    v_mov_b32 v21, 143360
    ds_write_b32 v21, v20 offset:512
    s_waitcnt lgkmcnt(0)
sequential_preLN__compressed_kv_cla__moe_arch_mod__prompt_kernel_t_w4:
    s_barrier
    v_mov_b32 v21, 143360
    ds_read_b32 v20, v21 offset:512
    s_waitcnt lgkmcnt(0)
    v_readfirstlane_b32 s69, v20
    s_nop 4
    s_and_b32 s68, s69, 0xffff
    s_sub_u32 s68, 0xffff, s68
    s_min_u32 s68, s68, 2047
    s_lshr_b32 s69, s69, 16
    s_xor_b32 s48, s69, 0xffff
    s_and_b32 s49, s69, 0x7fff
    s_bitcmp1_b32 s69, 15
    s_cselect_b32 s69, s49, s48
    s_lshl_b32 s69, s69, 16
    s_lshr_b32 s48, s68, 7
    s_bfe_u32 s49, s68, 0x40003
    s_lshr_b32 s50, s49, 2
    s_lshl_b32 s50, s50, 1
    s_lshr_b32 s14, s48, 3
    s_add_u32 s50, s50, s14
    s_and_b32 s49, s49, 3
    s_lshl_b32 s49, s49, 3
    s_and_b32 s48, s48, 7
    s_add_u32 s49, s49, s48
    s_lshl_b32 s49, s49, 3
    s_add_u32 s49, s49, s50
    s_lshl_b32 s49, s49, 2
    s_add_u32 s48, s49, 2109440
    s_mov_b32 s49, 0
    v_mov_b32 v126, 0
sequential_preLN__compressed_kv_cla__moe_arch_mod__prompt_kernel_t_pollR_4:
    buffer_load_dword v127, v126, s[56:59], s48 offen sc1
    s_waitcnt vmcnt(0)
    v_readfirstlane_b32 s50, v127
    s_add_u32 s49, s49, 1
    s_cmp_eq_u32 s50, s3
    s_cbranch_scc1 sequential_preLN__compressed_kv_cla__moe_arch_mod__prompt_kernel_t_pollR_4_ok
    s_cmp_ge_u32 s49, 65536
    s_cbranch_scc1 sequential_preLN__compressed_kv_cla__moe_arch_mod__prompt_kernel_t_pollR_4_ok
    s_branch sequential_preLN__compressed_kv_cla__moe_arch_mod__prompt_kernel_t_pollR_4
sequential_preLN__compressed_kv_cla__moe_arch_mod__prompt_kernel_t_pollR_4_ok:
    s_lshl_b32 s48, s44, 6
    v_add_u32 v2, s48, v0
    v_lshlrev_b32 v3, 4, v2
    s_mul_i32 s49, s68, 1280
    buffer_load_dwordx4 v[20:23], v3, s[40:43], s49 offen sc1
    s_lshl_b32 s48, s68, 2
    v_mov_b32 v4, s48
    s_mov_b32 s48, 8192
    buffer_load_dword v122, v4, s[56:59], s48 offen sc1
    s_mov_b32 s48, 16384
    buffer_load_dword v124, v4, s[56:59], s48 offen sc1
    s_waitcnt vmcnt(0)
    v_rcp_f32 v120, v124
    v_lshlrev_b32 v126, 16, v20
    v_and_b32 v127, 0xffff0000, v20
    v_sub_f32 v126, v126, v122
    v_sub_f32 v127, v127, v122
    v_cvt_pk_bf16_f32 v126, v126, v127
    v_and_b32 v127, 0xffff0000, v126
    v_lshlrev_b32 v126, 16, v126
    v_mul_f32 v126, v126, v120
    v_mul_f32 v127, v127, v120
    v_cvt_pk_bf16_f32 v24, v126, v127
    v_lshlrev_b32 v126, 16, v21
    v_and_b32 v127, 0xffff0000, v21
    v_sub_f32 v126, v126, v122
    v_sub_f32 v127, v127, v122
    v_cvt_pk_bf16_f32 v126, v126, v127
    v_and_b32 v127, 0xffff0000, v126
    v_lshlrev_b32 v126, 16, v126
    v_mul_f32 v126, v126, v120
    v_mul_f32 v127, v127, v120
    v_cvt_pk_bf16_f32 v25, v126, v127
    v_lshlrev_b32 v126, 16, v22
    v_and_b32 v127, 0xffff0000, v22
    v_sub_f32 v126, v126, v122
    v_sub_f32 v127, v127, v122
    v_cvt_pk_bf16_f32 v126, v126, v127
    v_and_b32 v127, 0xffff0000, v126
    v_lshlrev_b32 v126, 16, v126
    v_mul_f32 v126, v126, v120
    v_mul_f32 v127, v127, v120
    v_cvt_pk_bf16_f32 v26, v126, v127
    v_lshlrev_b32 v126, 16, v23
    v_and_b32 v127, 0xffff0000, v23
    v_sub_f32 v126, v126, v122
    v_sub_f32 v127, v127, v122
    v_cvt_pk_bf16_f32 v126, v126, v127
    v_and_b32 v127, 0xffff0000, v126
    v_lshlrev_b32 v126, 16, v126
    v_mul_f32 v126, v126, v120
    v_mul_f32 v127, v127, v120
    v_cvt_pk_bf16_f32 v27, v126, v127
    v_cmp_gt_u32 vcc, 80, v2
    s_nop 1
    s_and_saveexec_b64 s[14:15], vcc
    s_cbranch_execz sequential_preLN__compressed_kv_cla__moe_arch_mod__prompt_kernel_t_h1
    v_add_u32 v4, 122880, v3
    ds_write_b128 v4, v[24:27]
    ds_write_b128 v4, v[20:23] offset:1280
sequential_preLN__compressed_kv_cla__moe_arch_mod__prompt_kernel_t_h1:
    s_mov_b64 exec, s[14:15]
    s_waitcnt lgkmcnt(0)
    s_barrier
    s_mul_i32 s48, s44, 320
    s_add_u32 s48, s48, 122880
    v_lshlrev_b32 v6, 4, v5
    v_add_u32 v6, s48, v6
    ds_read_b128 v[28:31], v6 offset:0
    ds_read_b128 v[32:35], v6 offset:64
    ds_read_b128 v[36:39], v6 offset:128
    ds_read_b128 v[40:43], v6 offset:192
    ds_read_b128 v[44:47], v6 offset:256
    s_waitcnt lgkmcnt(0)
    v_mfma_f32_16x16x32_bf16 v[48:51], v[28:31], v[128:131], 0
    v_mfma_f32_16x16x32_bf16 v[52:55], v[28:31], v[132:135], 0
    v_mfma_f32_16x16x32_bf16 v[56:59], v[28:31], v[136:139], 0
    v_mfma_f32_16x16x32_bf16 v[60:63], v[28:31], v[140:143], 0
    v_mfma_f32_16x16x32_bf16 v[48:51], v[32:35], v[144:147], v[48:51]
    v_mfma_f32_16x16x32_bf16 v[52:55], v[32:35], v[148:151], v[52:55]
    v_mfma_f32_16x16x32_bf16 v[56:59], v[32:35], v[152:155], v[56:59]
    v_mfma_f32_16x16x32_bf16 v[60:63], v[32:35], v[156:159], v[60:63]
    v_mfma_f32_16x16x32_bf16 v[48:51], v[36:39], v[160:163], v[48:51]
    v_mfma_f32_16x16x32_bf16 v[52:55], v[36:39], v[164:167], v[52:55]
    v_mfma_f32_16x16x32_bf16 v[56:59], v[36:39], v[168:171], v[56:59]
    v_mfma_f32_16x16x32_bf16 v[60:63], v[36:39], v[172:175], v[60:63]
    v_mfma_f32_16x16x32_bf16 v[48:51], v[40:43], v[176:179], v[48:51]
    v_mfma_f32_16x16x32_bf16 v[52:55], v[40:43], v[180:183], v[52:55]
    v_mfma_f32_16x16x32_bf16 v[56:59], v[40:43], v[184:187], v[56:59]
    v_mfma_f32_16x16x32_bf16 v[60:63], v[40:43], v[188:191], v[60:63]
    v_mfma_f32_16x16x32_bf16 v[48:51], v[44:47], v[192:195], v[48:51]
    v_mfma_f32_16x16x32_bf16 v[52:55], v[44:47], v[196:199], v[52:55]
    v_mfma_f32_16x16x32_bf16 v[56:59], v[44:47], v[200:203], v[56:59]
    v_mfma_f32_16x16x32_bf16 v[60:63], v[44:47], v[204:207], v[60:63]
    s_nop 7
    v_and_b32 v8, 15, v0
    v_lshlrev_b32 v8, 2, v8
    s_lshl_b32 s48, s44, 8
    s_add_u32 s48, s48, 144384
    v_add_u32 v9, s48, v8
    ds_write_b32 v9, v48 offset:0
    ds_write_b32 v9, v52 offset:64
    ds_write_b32 v9, v56 offset:128
    ds_write_b32 v9, v60 offset:192
    s_waitcnt lgkmcnt(0)
    s_barrier
    v_and_b32 v8, 31, v0
    v_lshlrev_b32 v8, 2, v8
    v_add_u32 v8, 144384, v8
    ds_read_b32 v20, v8 offset:0
    ds_read_b32 v24, v8 offset:128
    ds_read_b32 v21, v8 offset:256
    ds_read_b32 v25, v8 offset:384
    ds_read_b32 v22, v8 offset:512
    ds_read_b32 v26, v8 offset:640
    ds_read_b32 v23, v8 offset:768
    ds_read_b32 v27, v8 offset:896
    s_waitcnt lgkmcnt(0)
    v_add_f32 v20, v20, v21
    v_add_f32 v22, v22, v23
    v_add_f32 v20, v20, v22
    v_add_f32 v24, v24, v25
    v_add_f32 v26, v26, v27
    v_add_f32 v24, v24, v26
    v_cvt_pk_bf16_f32 v20, v20, v20
    v_lshlrev_b32 v20, 16, v20
    v_cvt_pk_bf16_f32 v24, v24, v24
    v_lshlrev_b32 v24, 16, v24
    v_mul_f32 v127, 0xbfb8aa3b, v20
    v_exp_f32 v127, v127
    s_nop 0
    v_add_f32 v127, 1.0, v127
    v_rcp_f32 v127, v127
    s_nop 0
    v_mul_f32 v20, v20, v127
    v_cvt_pk_bf16_f32 v20, v20, v20
    v_lshlrev_b32 v20, 16, v20
    v_mul_f32 v20, v20, v24
    v_cvt_pk_bf16_f32 v20, v20, v20
    s_lshl_b32 s48, s44, 6
    s_add_u32 s48, s48, 145408
    v_and_b32 v8, 31, v0
    v_lshlrev_b32 v8, 1, v8
    v_add_u32 v8, s48, v8
    ds_write_b16 v8, v20
    v_lshlrev_b32 v9, 4, v5
    v_add_u32 v9, s48, v9
    s_waitcnt lgkmcnt(0)
    ds_read_b128 v[28:31], v9
    s_waitcnt lgkmcnt(0)
    v_mfma_f32_16x16x32_bf16 v[48:51], v[28:31], v[208:211], 0
    v_mfma_f32_16x16x32_bf16 v[52:55], v[28:31], v[212:215], 0
    v_mfma_f32_16x16x32_bf16 v[56:59], v[28:31], v[216:219], 0
    v_mfma_f32_16x16x32_bf16 v[60:63], v[28:31], v[220:223], 0
    v_mfma_f32_16x16x32_bf16 v[64:67], v[28:31], v[224:227], 0
    v_mfma_f32_16x16x32_bf16 v[68:71], v[28:31], v[228:231], 0
    v_mfma_f32_16x16x32_bf16 v[72:75], v[28:31], v[232:235], 0
    v_mfma_f32_16x16x32_bf16 v[76:79], v[28:31], v[236:239], 0
    v_mfma_f32_16x16x32_bf16 v[80:83], v[28:31], v[240:243], 0
    v_mfma_f32_16x16x32_bf16 v[84:87], v[28:31], v[244:247], 0
    s_nop 7
    v_mov_b32 v20, v48
    v_cmp_eq_u32 vcc, 1, v5
    s_nop 1
    v_cndmask_b32 v20, v20, v52, vcc
    v_cmp_eq_u32 vcc, 2, v5
    s_nop 1
    v_cndmask_b32 v20, v20, v56, vcc
    v_cmp_eq_u32 vcc, 3, v5
    s_nop 1
    v_cndmask_b32 v20, v20, v60, vcc
    v_mov_b32 v21, v64
    v_cmp_eq_u32 vcc, 1, v5
    s_nop 1
    v_cndmask_b32 v21, v21, v68, vcc
    v_cmp_eq_u32 vcc, 2, v5
    s_nop 1
    v_cndmask_b32 v21, v21, v72, vcc
    v_cmp_eq_u32 vcc, 3, v5
    s_nop 1
    v_cndmask_b32 v21, v21, v76, vcc
    v_mov_b32 v22, v80
    v_cmp_eq_u32 vcc, 1, v5
    s_nop 1
    v_cndmask_b32 v22, v22, v84, vcc
    s_and_b32 s48, s62, 7
    s_mul_i32 s48, s48, 2560
    s_add_u32 s48, s48, 1048576
    s_mul_i32 s49, s44, 640
    s_add_u32 s48, s48, s49
    v_lshlrev_b32 v8, 2, v0
    buffer_atomic_add_f32 v20, v8, s[56:59], s48 offen
    buffer_atomic_add_f32 v21, v8, s[56:59], s48 offen offset:256
    v_cmp_gt_u32 vcc, 32, v0
    s_nop 1
    s_and_saveexec_b64 s[14:15], vcc
    buffer_atomic_add_f32 v22, v8, s[56:59], s48 offen offset:512
    s_mov_b64 exec, s[14:15]
    s_waitcnt vmcnt(0)
    s_barrier
    s_cmp_lg_u32 s44, 0
    s_cbranch_scc1 sequential_preLN__compressed_kv_cla__moe_arch_mod__prompt_kernel_t_w5
    s_lshl_b32 s48, s62, 2
    s_add_u32 s48, s48, 2110464
    v_mov_b32 v126, 0
    v_mov_b32 v127, s3
    v_cmp_eq_u32 vcc, 0, v0
    s_nop 1
    s_and_saveexec_b64 s[14:15], vcc
    buffer_store_dword v127, v126, s[56:59], s48 offen sc1
    s_mov_b64 exec, s[14:15]
sequential_preLN__compressed_kv_cla__moe_arch_mod__prompt_kernel_t_w5:
    s_cmp_lg_u32 s62, 0
    s_cbranch_scc1 sequential_preLN__compressed_kv_cla__moe_arch_mod__prompt_kernel_t_fin
    s_mov_b32 s49, 0
    s_mov_b32 s48, 2110464
    v_lshlrev_b32 v126, 2, v0
    v_cmp_gt_u32 s[14:15], 54, v0
sequential_preLN__compressed_kv_cla__moe_arch_mod__prompt_kernel_t_pollF_5:
    buffer_load_dword v127, v126, s[56:59], s48 offen sc1
    s_waitcnt vmcnt(0)
    v_cmp_ne_u32 vcc, s3, v127
    s_add_u32 s49, s49, 1
    s_nop 0
    s_and_b64 vcc, vcc, s[14:15]
    s_cbranch_vccz sequential_preLN__compressed_kv_cla__moe_arch_mod__prompt_kernel_t_pollF_5_ok
    s_cmp_ge_u32 s49, 65536
    s_cbranch_scc1 sequential_preLN__compressed_kv_cla__moe_arch_mod__prompt_kernel_t_pollF_5_ok
    s_sleep 1
    s_branch sequential_preLN__compressed_kv_cla__moe_arch_mod__prompt_kernel_t_pollF_5
sequential_preLN__compressed_kv_cla__moe_arch_mod__prompt_kernel_t_pollF_5_ok:
    v_lshlrev_b32 v8, 2, v2
    s_mov_b32 s48, 1048576
    buffer_load_dword v20, v8, s[56:59], s48 offen sc0 sc1
    s_mov_b32 s48, 1051136
    buffer_load_dword v21, v8, s[56:59], s48 offen sc0 sc1
    s_mov_b32 s48, 1053696
    buffer_load_dword v22, v8, s[56:59], s48 offen sc0 sc1
    s_mov_b32 s48, 1056256
    buffer_load_dword v23, v8, s[56:59], s48 offen sc0 sc1
    s_mov_b32 s48, 1058816
    buffer_load_dword v24, v8, s[56:59], s48 offen sc0 sc1
    s_mov_b32 s48, 1061376
    buffer_load_dword v25, v8, s[56:59], s48 offen sc0 sc1
    s_mov_b32 s48, 1063936
    buffer_load_dword v26, v8, s[56:59], s48 offen sc0 sc1
    s_mov_b32 s48, 1066496
    buffer_load_dword v27, v8, s[56:59], s48 offen sc0 sc1
    s_mov_b32 s48, 1049600
    buffer_load_dword v28, v8, s[56:59], s48 offen sc0 sc1
    s_mov_b32 s48, 1052160
    buffer_load_dword v29, v8, s[56:59], s48 offen sc0 sc1
    s_mov_b32 s48, 1054720
    buffer_load_dword v30, v8, s[56:59], s48 offen sc0 sc1
    s_mov_b32 s48, 1057280
    buffer_load_dword v31, v8, s[56:59], s48 offen sc0 sc1
    s_mov_b32 s48, 1059840
    buffer_load_dword v32, v8, s[56:59], s48 offen sc0 sc1
    s_mov_b32 s48, 1062400
    buffer_load_dword v33, v8, s[56:59], s48 offen sc0 sc1
    s_mov_b32 s48, 1064960
    buffer_load_dword v34, v8, s[56:59], s48 offen sc0 sc1
    s_mov_b32 s48, 1067520
    buffer_load_dword v35, v8, s[56:59], s48 offen sc0 sc1
    s_mov_b32 s48, 1050624
    buffer_load_dword v36, v8, s[56:59], s48 offen sc0 sc1
    s_mov_b32 s48, 1053184
    buffer_load_dword v37, v8, s[56:59], s48 offen sc0 sc1
    s_mov_b32 s48, 1055744
    buffer_load_dword v38, v8, s[56:59], s48 offen sc0 sc1
    s_mov_b32 s48, 1058304
    buffer_load_dword v39, v8, s[56:59], s48 offen sc0 sc1
    s_mov_b32 s48, 1060864
    buffer_load_dword v40, v8, s[56:59], s48 offen sc0 sc1
    s_mov_b32 s48, 1063424
    buffer_load_dword v41, v8, s[56:59], s48 offen sc0 sc1
    s_mov_b32 s48, 1065984
    buffer_load_dword v42, v8, s[56:59], s48 offen sc0 sc1
    s_mov_b32 s48, 1068544
    buffer_load_dword v43, v8, s[56:59], s48 offen sc0 sc1
    v_lshlrev_b32 v9, 1, v2
    v_add_u32 v10, 122880, v9
    ds_read_u16 v50, v10 offset:0
    ds_read_u16 v54, v10 offset:1280
    ds_read_u16 v51, v10 offset:512
    ds_read_u16 v55, v10 offset:1792
    ds_read_u16 v52, v10 offset:1024
    ds_read_u16 v56, v10 offset:2304
    v_mov_b32 v127, s69
    v_mul_f32 v127, 0xbfb8aa3b, v127
    v_exp_f32 v127, v127
    s_nop 0
    v_add_f32 v127, 1.0, v127
    v_rcp_f32 v127, v127
    s_nop 0
    v_cvt_pk_bf16_f32 v127, v127, v127
    v_lshlrev_b32 v127, 16, v127
    s_waitcnt vmcnt(0) lgkmcnt(0)
    s_mul_i32 s49, s68, 1280
    v_add_f32 v20, v20, v21
    v_add_f32 v20, v20, v22
    v_add_f32 v20, v20, v23
    v_add_f32 v20, v20, v24
    v_add_f32 v20, v20, v25
    v_add_f32 v20, v20, v26
    v_add_f32 v20, v20, v27
    v_cvt_pk_bf16_f32 v20, v20, v20
    v_lshlrev_b32 v20, 16, v20
    v_mul_f32 v20, v20, v127
    v_cvt_pk_bf16_f32 v20, v20, v20
    v_lshlrev_b32 v20, 16, v20
    v_lshlrev_b32 v50, 16, v50
    v_lshlrev_b32 v54, 16, v54
    v_add_f32 v20, v20, v50
    v_cvt_pk_bf16_f32 v20, v20, v20
    v_lshlrev_b32 v20, 16, v20
    v_add_f32 v20, v20, v54
    v_cvt_pk_bf16_f32 v20, v20, v20
    v_add_f32 v28, v28, v29
    v_add_f32 v28, v28, v30
    v_add_f32 v28, v28, v31
    v_add_f32 v28, v28, v32
    v_add_f32 v28, v28, v33
    v_add_f32 v28, v28, v34
    v_add_f32 v28, v28, v35
    v_cvt_pk_bf16_f32 v28, v28, v28
    v_lshlrev_b32 v28, 16, v28
    v_mul_f32 v28, v28, v127
    v_cvt_pk_bf16_f32 v28, v28, v28
    v_lshlrev_b32 v28, 16, v28
    v_lshlrev_b32 v51, 16, v51
    v_lshlrev_b32 v55, 16, v55
    v_add_f32 v28, v28, v51
    v_cvt_pk_bf16_f32 v28, v28, v28
    v_lshlrev_b32 v28, 16, v28
    v_add_f32 v28, v28, v55
    v_cvt_pk_bf16_f32 v28, v28, v28
    v_add_f32 v36, v36, v37
    v_add_f32 v36, v36, v38
    v_add_f32 v36, v36, v39
    v_add_f32 v36, v36, v40
    v_add_f32 v36, v36, v41
    v_add_f32 v36, v36, v42
    v_add_f32 v36, v36, v43
    v_cvt_pk_bf16_f32 v36, v36, v36
    v_lshlrev_b32 v36, 16, v36
    v_mul_f32 v36, v36, v127
    v_cvt_pk_bf16_f32 v36, v36, v36
    v_lshlrev_b32 v36, 16, v36
    v_lshlrev_b32 v52, 16, v52
    v_lshlrev_b32 v56, 16, v56
    v_add_f32 v36, v36, v52
    v_cvt_pk_bf16_f32 v36, v36, v36
    v_lshlrev_b32 v36, 16, v36
    v_add_f32 v36, v36, v56
    v_cvt_pk_bf16_f32 v36, v36, v36
    buffer_store_short v20, v9, s[36:39], s49 offen sc1
    buffer_store_short v28, v9, s[36:39], s49 offen offset:512 sc1
    v_cmp_gt_u32 vcc, 128, v2
    s_nop 1
    s_and_saveexec_b64 s[14:15], vcc
    s_cbranch_execz sequential_preLN__compressed_kv_cla__moe_arch_mod__prompt_kernel_t_x
    buffer_store_short v36, v9, s[36:39], s49 offen offset:1024 sc1
sequential_preLN__compressed_kv_cla__moe_arch_mod__prompt_kernel_t_x:
    s_mov_b64 exec, s[14:15]
sequential_preLN__compressed_kv_cla__moe_arch_mod__prompt_kernel_t_fin:
sequential_preLN__compressed_kv_cla__moe_arch_mod__prompt_kernel_t_tdone:
sequential_preLN__compressed_kv_cla__moe_arch_mod__prompt_kernel_done:
    s_endpgm
code_end_all:
    s_endpgm
.section .rodata,"a"
.p2align 6
.amdhsa_kernel sequential_preLN__compressed_kv_cla__moe_arch_mod__prompt_kernel
  .amdhsa_next_free_vgpr 512
  .amdhsa_next_free_sgpr 102
  .amdhsa_accum_offset 256
  .amdhsa_group_segment_fixed_size 0
  .amdhsa_kernarg_size 112
  .amdhsa_user_sgpr_count 2
  .amdhsa_user_sgpr_kernarg_segment_ptr 1
  .amdhsa_system_sgpr_workgroup_id_x 1
  .amdhsa_float_denorm_mode_32 3
  .amdhsa_float_denorm_mode_16_64 3
.end_amdhsa_kernel
```
